```python
import torch

def _softmax(x, axis=-1):
    return torch.softmax(x, dim=axis)
def _gelu(x):
    return torch.nn.functional.gelu(x, approximate="tanh")
def _silu(x):
    return torch.nn.functional.silu(x)
def _sigmoid(x):
    return torch.sigmoid(x)
def _layernorm(x, axis=-1, eps=1e-5):
    m = x.mean(dim=axis, keepdim=True)
    v = x.var(dim=axis, keepdim=True, unbiased=False)
    return (x - m) / torch.sqrt(v + eps)
def _scatter_add(tgt, idx, src, axis=0):
    return tgt.clone().index_add_(axis, idx, src)
def _segment_sum(src, seg, n):
    out = torch.zeros((n,) + src.shape[1:], dtype=src.dtype)
    return out.index_add_(0, seg, src)
def _pad(x, pw):
    flat = tuple(v for pair in reversed(pw) for v in pair)
    return torch.nn.functional.pad(x, flat)

kernel_name = 'parallel_sum__sliding_block__glu_gated_bilinear__prompt'

def setup_inputs():

    _w = (lambda a: (lambda t: t.to(torch.bfloat16) if t.is_floating_point() else t)(torch.as_tensor(a)))
    def _A_setup():
        B, S, D = 1, 2048, 576
        return {
            "x": _w((lambda *s: torch.randn(*s, dtype=torch.bfloat16) * 0.05)(B, S, D)),
            "wqkv": _w((lambda *s: torch.randn(*s, dtype=torch.bfloat16) * 0.05)(D, 3 * D)),
            "wo": _w((lambda *s: torch.randn(*s, dtype=torch.bfloat16) * 0.05)(D, D)),
        }
    _A_in = _A_setup()

    def _B_setup():
        B, S, D, F = 1, 2048, 576, 4608
        return {
            "x": _w((lambda *s: torch.randn(*s, dtype=torch.bfloat16) * 0.05)(B, S, D)),
            "w_gate": _w((lambda *s: torch.randn(*s, dtype=torch.bfloat16) * 0.8)(D, F) * (D ** -0.5)),
            "w_up": _w((lambda *s: torch.randn(*s, dtype=torch.bfloat16) * 0.8)(D, F) * (D ** -0.5)),
            "w_down": _w((lambda *s: torch.randn(*s, dtype=torch.bfloat16) * 0.8)(F, D) * (F ** -0.5)),
        }
    _B_in = _B_setup()

    return {
        "A_x": _A_in["x"],
        "A_wqkv": _A_in["wqkv"],
        "A_wo": _A_in["wo"],
        "B_x": _B_in["x"],
        "B_w_gate": _B_in["w_gate"],
        "B_w_up": _B_in["w_up"],
        "B_w_down": _B_in["w_down"],
    }

def reference(A_x, A_wqkv, A_wo, B_x, B_w_gate, B_w_up, B_w_down):
    def _A_ref(x, wqkv, wo):
        B, S, D = x.shape
        H = 32; Dh = D // H; W = 256
        qkv = (lambda x, *d: x.permute(*d))((x @ wqkv).reshape(B, S, 3, H, Dh), 2, 0, 3, 1, 4)
        q, k, v = qkv[0], qkv[1], qkv[2]
        scores = torch.einsum("bhqd,bhkd->bhqk", q, k) * (Dh ** -0.5)
        idx = torch.arange(S)
        mask = (idx[:, None] - idx[None, :] >= 0) & (idx[:, None] - idx[None, :] < W)
        scores = torch.where(mask[None, None], scores, -1e9)
        p = _softmax(scores, axis=-1)
        o = torch.einsum("bhqk,bhkd->bhqd", p, v)
        return (lambda x, *d: x.permute(*d))(o, 0, 2, 1, 3).reshape(B, S, D) @ wo

    def _B_ref(x, w_gate, w_up, w_down):
        g = torch.einsum("bsd,df->bsf", x, w_gate)
        u = torch.einsum("bsd,df->bsf", x, w_up)
        h = g * u
        return torch.einsum("bsf,fd->bsd", h, w_down)

    x = A_x
    xn = _layernorm(x, axis=-1)
    return x + _A_ref(xn, A_wqkv, A_wo) + _B_ref(xn, B_w_gate, B_w_up, B_w_down)
```

```asm
; @launch grid=(256,1,1) block=(256,1,1) lds=163840
.amdgcn_target "amdgcn-amd-amdhsa--gfx950"
.text
.globl parallel_sum__sliding_block__glu_gated_bilinear__prompt_kernel
.p2align 12
.type parallel_sum__sliding_block__glu_gated_bilinear__prompt_kernel,@function
parallel_sum__sliding_block__glu_gated_bilinear__prompt_kernel:
    s_cmp_ge_u32 s2, 256
    s_cbranch_scc1 L_end
    s_load_dwordx16 s[84:99], s[0:1], 0
    s_load_dwordx4 s[80:83], s[0:1], 64
    s_getpc_b64 s[74:75]
    s_lshr_b32 s67, s2, 3
    s_lshl_b32 s67, s67, 12
    v_lshlrev_b32 v252, 4, v0
    v_add_u32 v252, s67, v252
    v_min_u32 v252, 74000, v252
    global_load_dwordx4 a[156:159], v252, s[74:75]
    v_lshrrev_b32 v253, 6, v0
    v_and_b32_e64 v255, 63, v0
    v_readfirstlane_b32 s56, v253
    s_and_b32 s58, s2, 0
    s_lshl_b32 s58, s58, 4
    s_lshr_b32 s67, s2, 4
    s_add_u32 s58, s58, s67
    s_bfe_u32 s57, s2, 0x30000
    s_lshl_b32 s57, s57, 1
    s_bfe_u32 s67, s2, 0x10003
    s_add_u32 s57, s57, s67
    s_lshr_b32 s67, s58, 2
    s_add_u32 s67, s67, s57
    s_mul_hi_u32 s68, s67, 0x55555556
    s_mul_i32 s68, s68, 3
    s_sub_u32 s70, s67, s68
    s_add_u32 s45, s70, 0
    s_cmp_ge_u32 s45, 3
    s_cselect_b32 s67, 3, 0
    s_sub_u32 s45, s45, s67
    s_add_u32 s46, s70, 1
    s_cmp_ge_u32 s46, 3
    s_cselect_b32 s67, 3, 0
    s_sub_u32 s46, s46, s67
    s_add_u32 s47, s70, 2
    s_cmp_ge_u32 s47, 3
    s_cselect_b32 s67, 3, 0
    s_sub_u32 s47, s47, s67
    v_lshrrev_b32 v144, 3, v255
    v_and_b32 v145, 7, v255
    v_add_u32_e64 v146, 0, v144
    v_bfe_u32 v147, v146, 1, 3
    v_xor_b32_e64 v147, v147, v145
    v_mul_u32_u24 v146, 1152, v146
    v_lshl_add_u32 v228, v147, 4, v146
    v_add_u32_e64 v146, 8, v144
    v_bfe_u32 v147, v146, 1, 3
    v_xor_b32_e64 v147, v147, v145
    v_mul_u32_u24 v146, 1152, v146
    v_lshl_add_u32 v229, v147, 4, v146
    v_subrev_u32 v229, 1024, v229
    s_lshl_b32 s71, s58, 2
    s_add_u32 s71, s71, s56
    s_mul_i32 s71, s71, 36864
    s_mul_i32 s40, s45, 384
    s_add_u32 s40, s40, s71
    s_mul_i32 s41, s46, 384
    s_add_u32 s41, s41, s71
    s_mul_i32 s42, s47, 384
    s_add_u32 s42, s42, s71
    s_mul_i32 s73, s56, 20480
    s_waitcnt lgkmcnt(0)
    s_mov_b32 s4, s84
    s_mov_b32 s5, s85
    s_mov_b32 s6, 2359296
    s_mov_b32 s7, 0x00020000
    s_add_u32 m0, s73, 74112
    s_add_u32 s66, s40, 0
    buffer_load_dwordx4 v228, s[4:7], s66 offen offset:0 lds
    buffer_load_dwordx4 v229, s[4:7], s66 offen offset:1024 lds
    s_add_u32 m0, s73, 76160
    s_add_u32 s66, s40, 128
    buffer_load_dwordx4 v228, s[4:7], s66 offen offset:0 lds
    buffer_load_dwordx4 v229, s[4:7], s66 offen offset:1024 lds
    s_add_u32 m0, s73, 78208
    s_add_u32 s66, s40, 256
    buffer_load_dwordx4 v228, s[4:7], s66 offen offset:0 lds
    buffer_load_dwordx4 v229, s[4:7], s66 offen offset:1024 lds
    s_add_u32 m0, s73, 80256
    s_add_u32 s66, s41, 0
    buffer_load_dwordx4 v228, s[4:7], s66 offen offset:0 lds
    buffer_load_dwordx4 v229, s[4:7], s66 offen offset:1024 lds
    s_add_u32 m0, s73, 82304
    s_add_u32 s66, s41, 128
    buffer_load_dwordx4 v228, s[4:7], s66 offen offset:0 lds
    buffer_load_dwordx4 v229, s[4:7], s66 offen offset:1024 lds
    s_mov_b32 s24, s86
    s_mov_b32 s25, s87
    s_mov_b32 s26, 1990656
    s_mov_b32 s27, 0x00020000
    s_sub_u32 s28, s88, 2048
    s_subb_u32 s29, s89, 0
    s_mov_b32 s30, 665600
    s_mov_b32 s31, 0x00020000
    s_mov_b32 s8, s92
    s_mov_b32 s9, s93
    s_mov_b32 s10, 5308416
    s_mov_b32 s11, 0x00020000
    s_mov_b32 s12, s94
    s_mov_b32 s13, s95
    s_mov_b32 s14, 5308416
    s_mov_b32 s15, 0x00020000
    s_sub_u32 s16, s96, 2048
    s_subb_u32 s17, s97, 0
    s_mov_b32 s18, 5310464
    s_mov_b32 s19, 0x00020000
    s_mov_b32 s36, s98
    s_mov_b32 s37, s99
    s_mov_b32 s38, 2359296
    s_mov_b32 s39, 0x00020000
    s_mov_b32 s32, s80
    s_mov_b32 s33, s81
    s_mov_b32 s34, 256
    s_mov_b32 s35, 0x00020000
    s_mov_b32 s20, s82
    s_mov_b32 s21, s83
    s_mov_b32 s22, 268435456
    s_mov_b32 s23, 0x00020000
    s_or_b32 s67, s2, s56
    s_cbranch_scc1 L_noep
    s_add_u32 s82, s82, 47185920
    s_addc_u32 s83, s83, 0
    s_load_dword s52, s[82:83], 0
L_noep:
    v_and_b32 v148, 15, v255
    v_lshrrev_b32_e64 v149, 4, v255
    v_bfe_u32 v150, v255, 2, 3
    v_lshrrev_b32 v151, 5, v255
    v_and_b32 v152, 3, v255
    v_lshlrev_b32 v152, 4, v152
    v_lshlrev_b32 v254, 4, v255
    v_lshrrev_b32 v145, 1, v148
    v_xor_b32 v145, v145, v149
    v_lshlrev_b32_e64 v144, 7, v148
    s_add_u32 s67, s73, 74112
    v_add_u32_e64 v144, s67, v144
    v_lshl_add_u32 v232, v145, 4, v144
    v_xor_b32_e64 v145, 4, v145
    v_lshl_add_u32 v233, v145, 4, v144
    s_mul_i32 s96, s45, 1769472
    s_mul_i32 s99, s45, 663552
    s_mul_i32 s97, s46, 1769472
    s_mul_i32 s100, s46, 663552
    s_mul_i32 s98, s47, 1769472
    s_mul_i32 s101, s47, 663552
    s_mul_i32 s78, s57, 216
    s_add_u32 s99, s99, s78
    s_add_u32 s100, s100, s78
    s_add_u32 s101, s101, s78
    s_mul_i32 s64, s56, 6176
    s_lshr_b32 s65, s57, 1
    s_lshl_b32 s67, s56, 3
    v_add_u32 v146, s67, v150
    v_lshl_add_u32 v147, v151, 6, v152
    v_mul_u32_u24 v246, 3456, v146
    v_add_u32_e64 v246, v246, v147
    v_add_u32 v247, 109568, v246
    v_add_u32 v248, 219136, v246
    v_mul_u32_u24 v144, 9216, v146
    v_add_u32_e64 v243, v144, v147
    v_add_u32 v244, 293888, v243
    v_add_u32 v245, 587776, v243
    s_mov_b32 s76, 0x3f803f80
    s_mov_b32 s77, 0x3f80
    s_mov_b32 s47, 0x3f800000
    v_bfe_u32 v144, v255, 2, 2
    v_lshlrev_b32 v145, 6, v144
    v_and_b32_e64 v144, 3, v255
    v_lshl_add_u32 v145, v144, 3, v145
    v_mul_u32_u24 v144, 6176, v149
    v_add_u32_e64 v240, v144, v145
    v_add_u32 v241, 49408, v240
    v_add_u32 v242, 98816, v240
    s_mul_i32 s68, s57, 576
    s_and_b32 s69, s57, 1
    s_lshl_b32 s70, s69, 6
    s_add_u32 s70, s70, s68
    s_add_u32 s59, s58, 0
    s_and_b32 s59, s59, 3
    s_lshl_b32 s59, s59, 7
    s_add_u32 s59, s59, s70
    s_add_u32 s60, s58, 1
    s_and_b32 s60, s60, 3
    s_lshl_b32 s60, s60, 7
    s_add_u32 s60, s60, s70
    s_add_u32 s61, s58, 2
    s_and_b32 s61, s61, 3
    s_lshl_b32 s61, s61, 7
    s_add_u32 s61, s61, s70
    s_add_u32 s62, s58, 3
    s_and_b32 s62, s62, 3
    s_lshl_b32 s62, s62, 7
    s_add_u32 s62, s62, s70
    s_xor_b32 s69, s69, 1
    s_lshl_b32 s69, s69, 9
    s_add_u32 s63, s69, s68
    s_mov_b32 s53, 0x40000
    s_waitcnt vmcnt(8)
    ds_read_b128 v[0:3], v232 offset:0
    ds_read_b128 v[8:11], v233 offset:0
    s_add_u32 m0, s73, 84352
    s_add_u32 s66, s41, 256
    buffer_load_dwordx4 v228, s[4:7], s66 offen offset:0 lds
    buffer_load_dwordx4 v229, s[4:7], s66 offen offset:1024 lds
    s_waitcnt vmcnt(8)
    ds_read_b128 v[16:19], v232 offset:2048
    ds_read_b128 v[24:27], v233 offset:2048
    s_add_u32 m0, s73, 86400
    s_add_u32 s66, s42, 0
    buffer_load_dwordx4 v228, s[4:7], s66 offen offset:0 lds
    buffer_load_dwordx4 v229, s[4:7], s66 offen offset:1024 lds
    s_waitcnt lgkmcnt(2)
    v_dot2_f32_bf16 v234, v0, s76, 0
    v_dot2_f32_bf16 v236, v0, v0, 0
    v_dot2_f32_bf16 v235, v1, s76, 0
    v_dot2_f32_bf16 v237, v1, v1, 0
    v_dot2_f32_bf16 v234, v2, s76, v234
    v_dot2_f32_bf16 v236, v2, v2, v236
    v_dot2_f32_bf16 v235, v3, s76, v235
    v_dot2_f32_bf16 v237, v3, v3, v237
    v_dot2_f32_bf16 v234, v8, s76, v234
    v_dot2_f32_bf16 v236, v8, v8, v236
    v_dot2_f32_bf16 v235, v9, s76, v235
    v_dot2_f32_bf16 v237, v9, v9, v237
    v_dot2_f32_bf16 v234, v10, s76, v234
    v_dot2_f32_bf16 v236, v10, v10, v236
    v_dot2_f32_bf16 v235, v11, s76, v235
    v_dot2_f32_bf16 v237, v11, v11, v237
    s_mov_b64 exec, 0
    s_cmp_eq_u32 s56, 0
    s_cbranch_scc1 L_w0
    s_cmp_eq_u32 s56, 1
    s_cbranch_scc1 L_w1
    s_cmp_eq_u32 s56, 2
    s_cbranch_scc1 L_w2
    s_branch L_w3
L_wret0:
    s_mov_b64 exec, -1
    s_waitcnt vmcnt(8)
    ds_read_b128 v[32:35], v232 offset:4096
    ds_read_b128 v[40:43], v233 offset:4096
    s_add_u32 m0, s73, 88448
    s_add_u32 s66, s42, 128
    buffer_load_dwordx4 v228, s[4:7], s66 offen offset:0 lds
    buffer_load_dwordx4 v229, s[4:7], s66 offen offset:1024 lds
    s_waitcnt lgkmcnt(2)
    v_dot2_f32_bf16 v234, v16, s76, v234
    v_dot2_f32_bf16 v236, v16, v16, v236
    v_dot2_f32_bf16 v235, v17, s76, v235
    v_dot2_f32_bf16 v237, v17, v17, v237
    v_dot2_f32_bf16 v234, v18, s76, v234
    v_dot2_f32_bf16 v236, v18, v18, v236
    v_dot2_f32_bf16 v235, v19, s76, v235
    v_dot2_f32_bf16 v237, v19, v19, v237
    v_dot2_f32_bf16 v234, v24, s76, v234
    v_dot2_f32_bf16 v236, v24, v24, v236
    v_dot2_f32_bf16 v235, v25, s76, v235
    v_dot2_f32_bf16 v237, v25, v25, v237
    v_dot2_f32_bf16 v234, v26, s76, v234
    v_dot2_f32_bf16 v236, v26, v26, v236
    v_dot2_f32_bf16 v235, v27, s76, v235
    v_dot2_f32_bf16 v237, v27, v27, v237
    s_waitcnt vmcnt(8)
    ds_read_b128 v[48:51], v232 offset:6144
    ds_read_b128 v[56:59], v233 offset:6144
    s_add_u32 m0, s73, 90496
    s_add_u32 s66, s42, 256
    buffer_load_dwordx4 v228, s[4:7], s66 offen offset:0 lds
    buffer_load_dwordx4 v229, s[4:7], s66 offen offset:1024 lds
    s_waitcnt lgkmcnt(2)
    v_dot2_f32_bf16 v234, v32, s76, v234
    v_dot2_f32_bf16 v236, v32, v32, v236
    v_dot2_f32_bf16 v235, v33, s76, v235
    v_dot2_f32_bf16 v237, v33, v33, v237
    v_dot2_f32_bf16 v234, v34, s76, v234
    v_dot2_f32_bf16 v236, v34, v34, v236
    v_dot2_f32_bf16 v235, v35, s76, v235
    v_dot2_f32_bf16 v237, v35, v35, v237
    v_dot2_f32_bf16 v234, v40, s76, v234
    v_dot2_f32_bf16 v236, v40, v40, v236
    v_dot2_f32_bf16 v235, v41, s76, v235
    v_dot2_f32_bf16 v237, v41, v41, v237
    v_dot2_f32_bf16 v234, v42, s76, v234
    v_dot2_f32_bf16 v236, v42, v42, v236
    v_dot2_f32_bf16 v235, v43, s76, v235
    v_dot2_f32_bf16 v237, v43, v43, v237
    s_mov_b64 exec, 0
    s_cmp_eq_u32 s56, 0
    s_cbranch_scc1 L_w4
    s_cmp_eq_u32 s56, 1
    s_cbranch_scc1 L_w5
    s_cmp_eq_u32 s56, 2
    s_cbranch_scc1 L_w6
    s_branch L_w7
L_wret1:
    s_mov_b64 exec, -1
    s_waitcnt vmcnt(8)
    ds_read_b128 v[64:67], v232 offset:8192
    ds_read_b128 v[72:75], v233 offset:8192
    s_add_u32 m0, s73, 92544
    s_add_u32 s66, s40, 18432
    buffer_load_dwordx4 v228, s[4:7], s66 offen offset:0 lds
    buffer_load_dwordx4 v229, s[4:7], s66 offen offset:1024 lds
    s_waitcnt lgkmcnt(2)
    v_dot2_f32_bf16 v234, v48, s76, v234
    v_dot2_f32_bf16 v236, v48, v48, v236
    v_dot2_f32_bf16 v235, v49, s76, v235
    v_dot2_f32_bf16 v237, v49, v49, v237
    v_dot2_f32_bf16 v234, v50, s76, v234
    v_dot2_f32_bf16 v236, v50, v50, v236
    v_dot2_f32_bf16 v235, v51, s76, v235
    v_dot2_f32_bf16 v237, v51, v51, v237
    v_dot2_f32_bf16 v234, v56, s76, v234
    v_dot2_f32_bf16 v236, v56, v56, v236
    v_dot2_f32_bf16 v235, v57, s76, v235
    v_dot2_f32_bf16 v237, v57, v57, v237
    v_dot2_f32_bf16 v234, v58, s76, v234
    v_dot2_f32_bf16 v236, v58, v58, v236
    v_dot2_f32_bf16 v235, v59, s76, v235
    v_dot2_f32_bf16 v237, v59, v59, v237
    s_waitcnt vmcnt(8)
    ds_read_b128 v[80:83], v232 offset:10240
    ds_read_b128 v[88:91], v233 offset:10240
    s_add_u32 m0, s73, 74112
    s_add_u32 s66, s40, 18560
    buffer_load_dwordx4 v228, s[4:7], s66 offen offset:0 lds
    buffer_load_dwordx4 v229, s[4:7], s66 offen offset:1024 lds
    s_waitcnt lgkmcnt(2)
    v_dot2_f32_bf16 v234, v64, s76, v234
    v_dot2_f32_bf16 v236, v64, v64, v236
    v_dot2_f32_bf16 v235, v65, s76, v235
    v_dot2_f32_bf16 v237, v65, v65, v237
    v_dot2_f32_bf16 v234, v66, s76, v234
    v_dot2_f32_bf16 v236, v66, v66, v236
    v_dot2_f32_bf16 v235, v67, s76, v235
    v_dot2_f32_bf16 v237, v67, v67, v237
    v_dot2_f32_bf16 v234, v72, s76, v234
    v_dot2_f32_bf16 v236, v72, v72, v236
    v_dot2_f32_bf16 v235, v73, s76, v235
    v_dot2_f32_bf16 v237, v73, v73, v237
    v_dot2_f32_bf16 v234, v74, s76, v234
    v_dot2_f32_bf16 v236, v74, v74, v236
    v_dot2_f32_bf16 v235, v75, s76, v235
    v_dot2_f32_bf16 v237, v75, v75, v237
    s_mov_b64 exec, 0
    s_cmp_eq_u32 s56, 0
    s_cbranch_scc1 L_w8
    s_cmp_eq_u32 s56, 1
    s_cbranch_scc1 L_w9
    s_cmp_eq_u32 s56, 2
    s_cbranch_scc1 L_w10
    s_branch L_w11
L_wret2:
    s_mov_b64 exec, -1
    s_waitcnt vmcnt(8)
    ds_read_b128 v[96:99], v232 offset:12288
    ds_read_b128 v[104:107], v233 offset:12288
    s_add_u32 m0, s73, 76160
    s_add_u32 s66, s40, 18688
    buffer_load_dwordx4 v228, s[4:7], s66 offen offset:0 lds
    buffer_load_dwordx4 v229, s[4:7], s66 offen offset:1024 lds
    s_waitcnt lgkmcnt(2)
    v_dot2_f32_bf16 v234, v80, s76, v234
    v_dot2_f32_bf16 v236, v80, v80, v236
    v_dot2_f32_bf16 v235, v81, s76, v235
    v_dot2_f32_bf16 v237, v81, v81, v237
    v_dot2_f32_bf16 v234, v82, s76, v234
    v_dot2_f32_bf16 v236, v82, v82, v236
    v_dot2_f32_bf16 v235, v83, s76, v235
    v_dot2_f32_bf16 v237, v83, v83, v237
    v_dot2_f32_bf16 v234, v88, s76, v234
    v_dot2_f32_bf16 v236, v88, v88, v236
    v_dot2_f32_bf16 v235, v89, s76, v235
    v_dot2_f32_bf16 v237, v89, v89, v237
    v_dot2_f32_bf16 v234, v90, s76, v234
    v_dot2_f32_bf16 v236, v90, v90, v236
    v_dot2_f32_bf16 v235, v91, s76, v235
    v_dot2_f32_bf16 v237, v91, v91, v237
    s_waitcnt vmcnt(8)
    ds_read_b128 v[112:115], v232 offset:14336
    ds_read_b128 v[120:123], v233 offset:14336
    s_add_u32 m0, s73, 78208
    s_add_u32 s66, s41, 18432
    buffer_load_dwordx4 v228, s[4:7], s66 offen offset:0 lds
    buffer_load_dwordx4 v229, s[4:7], s66 offen offset:1024 lds
    s_waitcnt lgkmcnt(2)
    v_dot2_f32_bf16 v234, v96, s76, v234
    v_dot2_f32_bf16 v236, v96, v96, v236
    v_dot2_f32_bf16 v235, v97, s76, v235
    v_dot2_f32_bf16 v237, v97, v97, v237
    v_dot2_f32_bf16 v234, v98, s76, v234
    v_dot2_f32_bf16 v236, v98, v98, v236
    v_dot2_f32_bf16 v235, v99, s76, v235
    v_dot2_f32_bf16 v237, v99, v99, v237
    v_dot2_f32_bf16 v234, v104, s76, v234
    v_dot2_f32_bf16 v236, v104, v104, v236
    v_dot2_f32_bf16 v235, v105, s76, v235
    v_dot2_f32_bf16 v237, v105, v105, v237
    v_dot2_f32_bf16 v234, v106, s76, v234
    v_dot2_f32_bf16 v236, v106, v106, v236
    v_dot2_f32_bf16 v235, v107, s76, v235
    v_dot2_f32_bf16 v237, v107, v107, v237
    s_mov_b64 exec, 0
    s_cmp_eq_u32 s56, 0
    s_cbranch_scc1 L_w12
    s_cmp_eq_u32 s56, 1
    s_cbranch_scc1 L_w13
    s_cmp_eq_u32 s56, 2
    s_cbranch_scc1 L_w14
    s_branch L_w15
L_w15:
L_wret3:
    s_mov_b64 exec, -1
    s_waitcnt vmcnt(8)
    ds_read_b128 v[128:131], v232 offset:16384
    ds_read_b128 v[136:139], v233 offset:16384
    s_add_u32 m0, s73, 80256
    s_add_u32 s66, s41, 18560
    buffer_load_dwordx4 v228, s[4:7], s66 offen offset:0 lds
    buffer_load_dwordx4 v229, s[4:7], s66 offen offset:1024 lds
    s_waitcnt lgkmcnt(2)
    v_dot2_f32_bf16 v234, v112, s76, v234
    v_dot2_f32_bf16 v236, v112, v112, v236
    v_dot2_f32_bf16 v235, v113, s76, v235
    v_dot2_f32_bf16 v237, v113, v113, v237
    v_dot2_f32_bf16 v234, v114, s76, v234
    v_dot2_f32_bf16 v236, v114, v114, v236
    v_dot2_f32_bf16 v235, v115, s76, v235
    v_dot2_f32_bf16 v237, v115, v115, v237
    v_dot2_f32_bf16 v234, v120, s76, v234
    v_dot2_f32_bf16 v236, v120, v120, v236
    v_dot2_f32_bf16 v235, v121, s76, v235
    v_dot2_f32_bf16 v237, v121, v121, v237
    v_dot2_f32_bf16 v234, v122, s76, v234
    v_dot2_f32_bf16 v236, v122, v122, v236
    v_dot2_f32_bf16 v235, v123, s76, v235
    v_dot2_f32_bf16 v237, v123, v123, v237
    s_or_b32 s67, s2, s56
    s_cbranch_scc1 L_nocas
    s_waitcnt lgkmcnt(0)
    s_add_u32 s52, s52, 2654435768
    s_or_b32 s52, s52, 1
    v_mov_b32_e64 v238, s52
    v_mov_b32 v239, 47185920
    buffer_store_dword v238, off, s[32:35], 0 sc1
    buffer_store_dword v238, v239, s[20:23], 0 offen sc1
L_nocas:
    s_waitcnt lgkmcnt(0)
    v_dot2_f32_bf16 v234, v128, s76, v234
    v_dot2_f32_bf16 v236, v128, v128, v236
    v_dot2_f32_bf16 v235, v129, s76, v235
    v_dot2_f32_bf16 v237, v129, v129, v237
    v_dot2_f32_bf16 v234, v130, s76, v234
    v_dot2_f32_bf16 v236, v130, v130, v236
    v_dot2_f32_bf16 v235, v131, s76, v235
    v_dot2_f32_bf16 v237, v131, v131, v237
    v_dot2_f32_bf16 v234, v136, s76, v234
    v_dot2_f32_bf16 v236, v136, v136, v236
    v_dot2_f32_bf16 v235, v137, s76, v235
    v_dot2_f32_bf16 v237, v137, v137, v237
    v_dot2_f32_bf16 v234, v138, s76, v234
    v_dot2_f32_bf16 v236, v138, v138, v236
    v_dot2_f32_bf16 v235, v139, s76, v235
    v_dot2_f32_bf16 v237, v139, v139, v237
    s_nop 2
    v_add_f32 v234, v234, v235
    v_add_f32 v236, v236, v237
    v_mov_b32 v160, v234
    v_mov_b32 v161, v236
    s_nop 1
    v_permlane32_swap_b32 v234, v160
    v_permlane32_swap_b32 v236, v161
    s_nop 0
    v_add_f32 v234, v234, v160
    v_add_f32 v236, v236, v161
    v_mov_b32 v160, v234
    v_mov_b32 v161, v236
    s_nop 1
    v_permlane16_swap_b32 v234, v160
    v_permlane16_swap_b32 v236, v161
    s_nop 0
    v_add_f32 v234, v234, v160
    v_add_f32 v236, v236, v161
    v_mul_f32 v234, 0x3ae38e39, v234
    v_mul_f32 v236, 0x3ae38e39, v236
    v_fma_f32 v236, -v234, v234, v236
    v_max_f32_e64 v236, 0, v236
    v_cvt_pk_bf16_f32 v236, v236, v236
    v_lshlrev_b32_e64 v236, 16, v236
    v_add_f32 v236, 0x3727c5ac, v236
    v_cvt_pk_bf16_f32 v236, v236, v236
    v_lshlrev_b32 v236, 16, v236
    v_sqrt_f32 v236, v236
    v_cvt_pk_bf16_f32 v234, v234, v234
    v_lshlrev_b32_e64 v234, 16, v234
    v_cvt_pk_bf16_f32 v236, v236, v236
    v_lshlrev_b32 v236, 16, v236
    v_rcp_f32 v230, v236
    v_sub_f32 v231, 0, v234
    v_mul_f32 v252, v230, v230
    v_mul_f32 v250, 0x3f154857, v230
    s_waitcnt vmcnt(8)
    ds_read_b128 v[4:7], v232 offset:18432
    ds_read_b128 v[12:15], v233 offset:18432
    s_add_u32 m0, s73, 82304
    s_add_u32 s66, s41, 18688
    buffer_load_dwordx4 v228, s[4:7], s66 offen offset:0 lds
    buffer_load_dwordx4 v229, s[4:7], s66 offen offset:1024 lds
    v_dot2_f32_bf16 v164, v0, s77, v231
    v_dot2_f32_bf16 v165, v0, s47, v231
    v_dot2_f32_bf16 v166, v1, s77, v231
    v_dot2_f32_bf16 v167, v1, s47, v231
    v_dot2_f32_bf16 v168, v2, s77, v231
    v_dot2_f32_bf16 v169, v2, s47, v231
    v_dot2_f32_bf16 v170, v3, s77, v231
    v_dot2_f32_bf16 v171, v3, s47, v231
    v_cvt_pk_bf16_f32 v0, v164, v165
    v_cvt_pk_bf16_f32 v1, v166, v167
    v_cvt_pk_bf16_f32 v2, v168, v169
    v_cvt_pk_bf16_f32 v3, v170, v171
    v_dot2_f32_bf16 v164, v8, s77, v231
    v_dot2_f32_bf16 v165, v8, s47, v231
    v_dot2_f32_bf16 v166, v9, s77, v231
    v_dot2_f32_bf16 v167, v9, s47, v231
    v_dot2_f32_bf16 v168, v10, s77, v231
    v_dot2_f32_bf16 v169, v10, s47, v231
    v_dot2_f32_bf16 v170, v11, s77, v231
    v_dot2_f32_bf16 v171, v11, s47, v231
    v_cvt_pk_bf16_f32 v8, v164, v165
    v_cvt_pk_bf16_f32 v9, v166, v167
    v_cvt_pk_bf16_f32 v10, v168, v169
    v_cvt_pk_bf16_f32 v11, v170, v171
    s_waitcnt lgkmcnt(0)
    v_dot2_f32_bf16 v234, v4, s76, 0
    v_dot2_f32_bf16 v236, v4, v4, 0
    v_dot2_f32_bf16 v235, v5, s76, 0
    v_dot2_f32_bf16 v237, v5, v5, 0
    v_dot2_f32_bf16 v234, v6, s76, v234
    v_dot2_f32_bf16 v236, v6, v6, v236
    v_dot2_f32_bf16 v235, v7, s76, v235
    v_dot2_f32_bf16 v237, v7, v7, v237
    v_dot2_f32_bf16 v234, v12, s76, v234
    v_dot2_f32_bf16 v236, v12, v12, v236
    v_dot2_f32_bf16 v235, v13, s76, v235
    v_dot2_f32_bf16 v237, v13, v13, v237
    v_dot2_f32_bf16 v234, v14, s76, v234
    v_dot2_f32_bf16 v236, v14, v14, v236
    v_dot2_f32_bf16 v235, v15, s76, v235
    v_dot2_f32_bf16 v237, v15, v15, v237
    s_waitcnt vmcnt(8)
    ds_read_b128 v[20:23], v232 offset:0
    ds_read_b128 v[28:31], v233 offset:0
    s_add_u32 m0, s73, 84352
    s_add_u32 s66, s42, 18432
    buffer_load_dwordx4 v228, s[4:7], s66 offen offset:0 lds
    buffer_load_dwordx4 v229, s[4:7], s66 offen offset:1024 lds
    v_dot2_f32_bf16 v164, v16, s77, v231
    v_dot2_f32_bf16 v165, v16, s47, v231
    v_dot2_f32_bf16 v166, v17, s77, v231
    v_dot2_f32_bf16 v167, v17, s47, v231
    v_dot2_f32_bf16 v168, v18, s77, v231
    v_dot2_f32_bf16 v169, v18, s47, v231
    v_dot2_f32_bf16 v170, v19, s77, v231
    v_dot2_f32_bf16 v171, v19, s47, v231
    v_cvt_pk_bf16_f32 v16, v164, v165
    v_cvt_pk_bf16_f32 v17, v166, v167
    v_cvt_pk_bf16_f32 v18, v168, v169
    v_cvt_pk_bf16_f32 v19, v170, v171
    v_dot2_f32_bf16 v164, v24, s77, v231
    v_dot2_f32_bf16 v165, v24, s47, v231
    v_dot2_f32_bf16 v166, v25, s77, v231
    v_dot2_f32_bf16 v167, v25, s47, v231
    v_dot2_f32_bf16 v168, v26, s77, v231
    v_dot2_f32_bf16 v169, v26, s47, v231
    v_dot2_f32_bf16 v170, v27, s77, v231
    v_dot2_f32_bf16 v171, v27, s47, v231
    v_cvt_pk_bf16_f32 v24, v164, v165
    v_cvt_pk_bf16_f32 v25, v166, v167
    v_cvt_pk_bf16_f32 v26, v168, v169
    v_cvt_pk_bf16_f32 v27, v170, v171
    s_waitcnt lgkmcnt(0)
    v_dot2_f32_bf16 v234, v20, s76, v234
    v_dot2_f32_bf16 v236, v20, v20, v236
    v_dot2_f32_bf16 v235, v21, s76, v235
    v_dot2_f32_bf16 v237, v21, v21, v237
    v_dot2_f32_bf16 v234, v22, s76, v234
    v_dot2_f32_bf16 v236, v22, v22, v236
    v_dot2_f32_bf16 v235, v23, s76, v235
    v_dot2_f32_bf16 v237, v23, v23, v237
    v_dot2_f32_bf16 v234, v28, s76, v234
    v_dot2_f32_bf16 v236, v28, v28, v236
    v_dot2_f32_bf16 v235, v29, s76, v235
    v_dot2_f32_bf16 v237, v29, v29, v237
    v_dot2_f32_bf16 v234, v30, s76, v234
    v_dot2_f32_bf16 v236, v30, v30, v236
    v_dot2_f32_bf16 v235, v31, s76, v235
    v_dot2_f32_bf16 v237, v31, v31, v237
    s_waitcnt vmcnt(8)
    ds_read_b128 v[36:39], v232 offset:2048
    ds_read_b128 v[44:47], v233 offset:2048
    s_add_u32 m0, s73, 86400
    s_add_u32 s66, s42, 18560
    buffer_load_dwordx4 v228, s[4:7], s66 offen offset:0 lds
    buffer_load_dwordx4 v229, s[4:7], s66 offen offset:1024 lds
    v_dot2_f32_bf16 v164, v32, s77, v231
    v_dot2_f32_bf16 v165, v32, s47, v231
    v_dot2_f32_bf16 v166, v33, s77, v231
    v_dot2_f32_bf16 v167, v33, s47, v231
    v_dot2_f32_bf16 v168, v34, s77, v231
    v_dot2_f32_bf16 v169, v34, s47, v231
    v_dot2_f32_bf16 v170, v35, s77, v231
    v_dot2_f32_bf16 v171, v35, s47, v231
    v_cvt_pk_bf16_f32 v32, v164, v165
    v_cvt_pk_bf16_f32 v33, v166, v167
    v_cvt_pk_bf16_f32 v34, v168, v169
    v_cvt_pk_bf16_f32 v35, v170, v171
    v_dot2_f32_bf16 v164, v40, s77, v231
    v_dot2_f32_bf16 v165, v40, s47, v231
    v_dot2_f32_bf16 v166, v41, s77, v231
    v_dot2_f32_bf16 v167, v41, s47, v231
    v_dot2_f32_bf16 v168, v42, s77, v231
    v_dot2_f32_bf16 v169, v42, s47, v231
    v_dot2_f32_bf16 v170, v43, s77, v231
    v_dot2_f32_bf16 v171, v43, s47, v231
    v_cvt_pk_bf16_f32 v40, v164, v165
    v_cvt_pk_bf16_f32 v41, v166, v167
    v_cvt_pk_bf16_f32 v42, v168, v169
    v_cvt_pk_bf16_f32 v43, v170, v171
    s_waitcnt lgkmcnt(0)
    v_dot2_f32_bf16 v234, v36, s76, v234
    v_dot2_f32_bf16 v236, v36, v36, v236
    v_dot2_f32_bf16 v235, v37, s76, v235
    v_dot2_f32_bf16 v237, v37, v37, v237
    v_dot2_f32_bf16 v234, v38, s76, v234
    v_dot2_f32_bf16 v236, v38, v38, v236
    v_dot2_f32_bf16 v235, v39, s76, v235
    v_dot2_f32_bf16 v237, v39, v39, v237
    v_dot2_f32_bf16 v234, v44, s76, v234
    v_dot2_f32_bf16 v236, v44, v44, v236
    v_dot2_f32_bf16 v235, v45, s76, v235
    v_dot2_f32_bf16 v237, v45, v45, v237
    v_dot2_f32_bf16 v234, v46, s76, v234
    v_dot2_f32_bf16 v236, v46, v46, v236
    v_dot2_f32_bf16 v235, v47, s76, v235
    v_dot2_f32_bf16 v237, v47, v47, v237
    s_waitcnt vmcnt(8)
    ds_read_b128 v[52:55], v232 offset:4096
    ds_read_b128 v[60:63], v233 offset:4096
    s_add_u32 m0, s73, 88448
    s_add_u32 s66, s42, 18688
    buffer_load_dwordx4 v228, s[4:7], s66 offen offset:0 lds
    buffer_load_dwordx4 v229, s[4:7], s66 offen offset:1024 lds
    v_dot2_f32_bf16 v164, v48, s77, v231
    v_dot2_f32_bf16 v165, v48, s47, v231
    v_dot2_f32_bf16 v166, v49, s77, v231
    v_dot2_f32_bf16 v167, v49, s47, v231
    v_dot2_f32_bf16 v168, v50, s77, v231
    v_dot2_f32_bf16 v169, v50, s47, v231
    v_dot2_f32_bf16 v170, v51, s77, v231
    v_dot2_f32_bf16 v171, v51, s47, v231
    v_cvt_pk_bf16_f32 v48, v164, v165
    v_cvt_pk_bf16_f32 v49, v166, v167
    v_cvt_pk_bf16_f32 v50, v168, v169
    v_cvt_pk_bf16_f32 v51, v170, v171
    v_dot2_f32_bf16 v164, v56, s77, v231
    v_dot2_f32_bf16 v165, v56, s47, v231
    v_dot2_f32_bf16 v166, v57, s77, v231
    v_dot2_f32_bf16 v167, v57, s47, v231
    v_dot2_f32_bf16 v168, v58, s77, v231
    v_dot2_f32_bf16 v169, v58, s47, v231
    v_dot2_f32_bf16 v170, v59, s77, v231
    v_dot2_f32_bf16 v171, v59, s47, v231
    v_cvt_pk_bf16_f32 v56, v164, v165
    v_cvt_pk_bf16_f32 v57, v166, v167
    v_cvt_pk_bf16_f32 v58, v168, v169
    v_cvt_pk_bf16_f32 v59, v170, v171
    s_waitcnt lgkmcnt(0)
    v_dot2_f32_bf16 v234, v52, s76, v234
    v_dot2_f32_bf16 v236, v52, v52, v236
    v_dot2_f32_bf16 v235, v53, s76, v235
    v_dot2_f32_bf16 v237, v53, v53, v237
    v_dot2_f32_bf16 v234, v54, s76, v234
    v_dot2_f32_bf16 v236, v54, v54, v236
    v_dot2_f32_bf16 v235, v55, s76, v235
    v_dot2_f32_bf16 v237, v55, v55, v237
    v_dot2_f32_bf16 v234, v60, s76, v234
    v_dot2_f32_bf16 v236, v60, v60, v236
    v_dot2_f32_bf16 v235, v61, s76, v235
    v_dot2_f32_bf16 v237, v61, v61, v237
    v_dot2_f32_bf16 v234, v62, s76, v234
    v_dot2_f32_bf16 v236, v62, v62, v236
    v_dot2_f32_bf16 v235, v63, s76, v235
    v_dot2_f32_bf16 v237, v63, v63, v237
    s_waitcnt vmcnt(8)
    ds_read_b128 v[68:71], v232 offset:6144
    ds_read_b128 v[76:79], v233 offset:6144
    s_add_u32 m0, s64, 0
    s_add_u32 s66, s99, 0
    buffer_load_dwordx4 v246, s[24:27], s66 offen offset:0 lds
    buffer_load_dwordx4 v247, s[24:27], s66 offen offset:1024 lds
    v_dot2_f32_bf16 v164, v64, s77, v231
    v_dot2_f32_bf16 v165, v64, s47, v231
    v_dot2_f32_bf16 v166, v65, s77, v231
    v_dot2_f32_bf16 v167, v65, s47, v231
    v_dot2_f32_bf16 v168, v66, s77, v231
    v_dot2_f32_bf16 v169, v66, s47, v231
    v_dot2_f32_bf16 v170, v67, s77, v231
    v_dot2_f32_bf16 v171, v67, s47, v231
    v_cvt_pk_bf16_f32 v64, v164, v165
    v_cvt_pk_bf16_f32 v65, v166, v167
    v_cvt_pk_bf16_f32 v66, v168, v169
    v_cvt_pk_bf16_f32 v67, v170, v171
    v_dot2_f32_bf16 v164, v72, s77, v231
    v_dot2_f32_bf16 v165, v72, s47, v231
    v_dot2_f32_bf16 v166, v73, s77, v231
    v_dot2_f32_bf16 v167, v73, s47, v231
    v_dot2_f32_bf16 v168, v74, s77, v231
    v_dot2_f32_bf16 v169, v74, s47, v231
    v_dot2_f32_bf16 v170, v75, s77, v231
    v_dot2_f32_bf16 v171, v75, s47, v231
    v_cvt_pk_bf16_f32 v72, v164, v165
    v_cvt_pk_bf16_f32 v73, v166, v167
    v_cvt_pk_bf16_f32 v74, v168, v169
    v_cvt_pk_bf16_f32 v75, v170, v171
    s_waitcnt lgkmcnt(0)
    v_dot2_f32_bf16 v234, v68, s76, v234
    v_dot2_f32_bf16 v236, v68, v68, v236
    v_dot2_f32_bf16 v235, v69, s76, v235
    v_dot2_f32_bf16 v237, v69, v69, v237
    v_dot2_f32_bf16 v234, v70, s76, v234
    v_dot2_f32_bf16 v236, v70, v70, v236
    v_dot2_f32_bf16 v235, v71, s76, v235
    v_dot2_f32_bf16 v237, v71, v71, v237
    v_dot2_f32_bf16 v234, v76, s76, v234
    v_dot2_f32_bf16 v236, v76, v76, v236
    v_dot2_f32_bf16 v235, v77, s76, v235
    v_dot2_f32_bf16 v237, v77, v77, v237
    v_dot2_f32_bf16 v234, v78, s76, v234
    v_dot2_f32_bf16 v236, v78, v78, v236
    v_dot2_f32_bf16 v235, v79, s76, v235
    v_dot2_f32_bf16 v237, v79, v79, v237
    s_waitcnt vmcnt(8)
    ds_read_b128 v[84:87], v232 offset:8192
    ds_read_b128 v[92:95], v233 offset:8192
    buffer_load_dwordx4 v248, s[24:27], s66 offen offset:2048 lds
    s_add_u32 m0, s64, 3072
    s_add_u32 s66, s99, 128
    buffer_load_dwordx4 v246, s[24:27], s66 offen offset:0 lds
    v_dot2_f32_bf16 v164, v80, s77, v231
    v_dot2_f32_bf16 v165, v80, s47, v231
    v_dot2_f32_bf16 v166, v81, s77, v231
    v_dot2_f32_bf16 v167, v81, s47, v231
    v_dot2_f32_bf16 v168, v82, s77, v231
    v_dot2_f32_bf16 v169, v82, s47, v231
    v_dot2_f32_bf16 v170, v83, s77, v231
    v_dot2_f32_bf16 v171, v83, s47, v231
    v_cvt_pk_bf16_f32 v80, v164, v165
    v_cvt_pk_bf16_f32 v81, v166, v167
    v_cvt_pk_bf16_f32 v82, v168, v169
    v_cvt_pk_bf16_f32 v83, v170, v171
    v_dot2_f32_bf16 v164, v88, s77, v231
    v_dot2_f32_bf16 v165, v88, s47, v231
    v_dot2_f32_bf16 v166, v89, s77, v231
    v_dot2_f32_bf16 v167, v89, s47, v231
    v_dot2_f32_bf16 v168, v90, s77, v231
    v_dot2_f32_bf16 v169, v90, s47, v231
    v_dot2_f32_bf16 v170, v91, s77, v231
    v_dot2_f32_bf16 v171, v91, s47, v231
    v_cvt_pk_bf16_f32 v88, v164, v165
    v_cvt_pk_bf16_f32 v89, v166, v167
    v_cvt_pk_bf16_f32 v90, v168, v169
    v_cvt_pk_bf16_f32 v91, v170, v171
    s_waitcnt lgkmcnt(0)
    v_dot2_f32_bf16 v234, v84, s76, v234
    v_dot2_f32_bf16 v236, v84, v84, v236
    v_dot2_f32_bf16 v235, v85, s76, v235
    v_dot2_f32_bf16 v237, v85, v85, v237
    v_dot2_f32_bf16 v234, v86, s76, v234
    v_dot2_f32_bf16 v236, v86, v86, v236
    v_dot2_f32_bf16 v235, v87, s76, v235
    v_dot2_f32_bf16 v237, v87, v87, v237
    v_dot2_f32_bf16 v234, v92, s76, v234
    v_dot2_f32_bf16 v236, v92, v92, v236
    v_dot2_f32_bf16 v235, v93, s76, v235
    v_dot2_f32_bf16 v237, v93, v93, v237
    v_dot2_f32_bf16 v234, v94, s76, v234
    v_dot2_f32_bf16 v236, v94, v94, v236
    v_dot2_f32_bf16 v235, v95, s76, v235
    v_dot2_f32_bf16 v237, v95, v95, v237
    s_waitcnt vmcnt(8)
    ds_read_b128 v[100:103], v232 offset:10240
    ds_read_b128 v[108:111], v233 offset:10240
    buffer_load_dwordx4 v247, s[24:27], s66 offen offset:1024 lds
    buffer_load_dwordx4 v248, s[24:27], s66 offen offset:2048 lds
    v_dot2_f32_bf16 v164, v96, s77, v231
    v_dot2_f32_bf16 v165, v96, s47, v231
    v_dot2_f32_bf16 v166, v97, s77, v231
    v_dot2_f32_bf16 v167, v97, s47, v231
    v_dot2_f32_bf16 v168, v98, s77, v231
    v_dot2_f32_bf16 v169, v98, s47, v231
    v_dot2_f32_bf16 v170, v99, s77, v231
    v_dot2_f32_bf16 v171, v99, s47, v231
    v_cvt_pk_bf16_f32 v96, v164, v165
    v_cvt_pk_bf16_f32 v97, v166, v167
    v_cvt_pk_bf16_f32 v98, v168, v169
    v_cvt_pk_bf16_f32 v99, v170, v171
    v_dot2_f32_bf16 v164, v104, s77, v231
    v_dot2_f32_bf16 v165, v104, s47, v231
    v_dot2_f32_bf16 v166, v105, s77, v231
    v_dot2_f32_bf16 v167, v105, s47, v231
    v_dot2_f32_bf16 v168, v106, s77, v231
    v_dot2_f32_bf16 v169, v106, s47, v231
    v_dot2_f32_bf16 v170, v107, s77, v231
    v_dot2_f32_bf16 v171, v107, s47, v231
    v_cvt_pk_bf16_f32 v104, v164, v165
    v_cvt_pk_bf16_f32 v105, v166, v167
    v_cvt_pk_bf16_f32 v106, v168, v169
    v_cvt_pk_bf16_f32 v107, v170, v171
    s_waitcnt lgkmcnt(0)
    v_dot2_f32_bf16 v234, v100, s76, v234
    v_dot2_f32_bf16 v236, v100, v100, v236
    v_dot2_f32_bf16 v235, v101, s76, v235
    v_dot2_f32_bf16 v237, v101, v101, v237
    v_dot2_f32_bf16 v234, v102, s76, v234
    v_dot2_f32_bf16 v236, v102, v102, v236
    v_dot2_f32_bf16 v235, v103, s76, v235
    v_dot2_f32_bf16 v237, v103, v103, v237
    v_dot2_f32_bf16 v234, v108, s76, v234
    v_dot2_f32_bf16 v236, v108, v108, v236
    v_dot2_f32_bf16 v235, v109, s76, v235
    v_dot2_f32_bf16 v237, v109, v109, v237
    v_dot2_f32_bf16 v234, v110, s76, v234
    v_dot2_f32_bf16 v236, v110, v110, v236
    v_dot2_f32_bf16 v235, v111, s76, v235
    v_dot2_f32_bf16 v237, v111, v111, v237
    s_waitcnt vmcnt(8)
    ds_read_b128 v[116:119], v232 offset:12288
    ds_read_b128 v[124:127], v233 offset:12288
    s_add_u32 m0, s64, 24704
    s_add_u32 s66, s99, 331776
    buffer_load_dwordx4 v246, s[24:27], s66 offen offset:0 lds
    buffer_load_dwordx4 v247, s[24:27], s66 offen offset:1024 lds
    v_dot2_f32_bf16 v164, v112, s77, v231
    v_dot2_f32_bf16 v165, v112, s47, v231
    v_dot2_f32_bf16 v166, v113, s77, v231
    v_dot2_f32_bf16 v167, v113, s47, v231
    v_dot2_f32_bf16 v168, v114, s77, v231
    v_dot2_f32_bf16 v169, v114, s47, v231
    v_dot2_f32_bf16 v170, v115, s77, v231
    v_dot2_f32_bf16 v171, v115, s47, v231
    v_cvt_pk_bf16_f32 v112, v164, v165
    v_cvt_pk_bf16_f32 v113, v166, v167
    v_cvt_pk_bf16_f32 v114, v168, v169
    v_cvt_pk_bf16_f32 v115, v170, v171
    v_dot2_f32_bf16 v164, v120, s77, v231
    v_dot2_f32_bf16 v165, v120, s47, v231
    v_dot2_f32_bf16 v166, v121, s77, v231
    v_dot2_f32_bf16 v167, v121, s47, v231
    v_dot2_f32_bf16 v168, v122, s77, v231
    v_dot2_f32_bf16 v169, v122, s47, v231
    v_dot2_f32_bf16 v170, v123, s77, v231
    v_dot2_f32_bf16 v171, v123, s47, v231
    v_cvt_pk_bf16_f32 v120, v164, v165
    v_cvt_pk_bf16_f32 v121, v166, v167
    v_cvt_pk_bf16_f32 v122, v168, v169
    v_cvt_pk_bf16_f32 v123, v170, v171
    s_waitcnt lgkmcnt(0)
    v_dot2_f32_bf16 v234, v116, s76, v234
    v_dot2_f32_bf16 v236, v116, v116, v236
    v_dot2_f32_bf16 v235, v117, s76, v235
    v_dot2_f32_bf16 v237, v117, v117, v237
    v_dot2_f32_bf16 v234, v118, s76, v234
    v_dot2_f32_bf16 v236, v118, v118, v236
    v_dot2_f32_bf16 v235, v119, s76, v235
    v_dot2_f32_bf16 v237, v119, v119, v237
    v_dot2_f32_bf16 v234, v124, s76, v234
    v_dot2_f32_bf16 v236, v124, v124, v236
    v_dot2_f32_bf16 v235, v125, s76, v235
    v_dot2_f32_bf16 v237, v125, v125, v237
    v_dot2_f32_bf16 v234, v126, s76, v234
    v_dot2_f32_bf16 v236, v126, v126, v236
    v_dot2_f32_bf16 v235, v127, s76, v235
    v_dot2_f32_bf16 v237, v127, v127, v237
    s_waitcnt vmcnt(8)
    ds_read_b128 v[132:135], v232 offset:14336
    ds_read_b128 v[140:143], v233 offset:14336
    buffer_load_dwordx4 v248, s[24:27], s66 offen offset:2048 lds
    s_add_u32 m0, s64, 27776
    s_add_u32 s66, s99, 331904
    buffer_load_dwordx4 v246, s[24:27], s66 offen offset:0 lds
    v_dot2_f32_bf16 v164, v128, s77, v231
    v_dot2_f32_bf16 v165, v128, s47, v231
    v_dot2_f32_bf16 v166, v129, s77, v231
    v_dot2_f32_bf16 v167, v129, s47, v231
    v_dot2_f32_bf16 v168, v130, s77, v231
    v_dot2_f32_bf16 v169, v130, s47, v231
    v_dot2_f32_bf16 v170, v131, s77, v231
    v_dot2_f32_bf16 v171, v131, s47, v231
    v_cvt_pk_bf16_f32 v128, v164, v165
    v_cvt_pk_bf16_f32 v129, v166, v167
    v_cvt_pk_bf16_f32 v130, v168, v169
    v_cvt_pk_bf16_f32 v131, v170, v171
    v_dot2_f32_bf16 v164, v136, s77, v231
    v_dot2_f32_bf16 v165, v136, s47, v231
    v_dot2_f32_bf16 v166, v137, s77, v231
    v_dot2_f32_bf16 v167, v137, s47, v231
    v_dot2_f32_bf16 v168, v138, s77, v231
    v_dot2_f32_bf16 v169, v138, s47, v231
    v_dot2_f32_bf16 v170, v139, s77, v231
    v_dot2_f32_bf16 v171, v139, s47, v231
    v_cvt_pk_bf16_f32 v136, v164, v165
    v_cvt_pk_bf16_f32 v137, v166, v167
    v_cvt_pk_bf16_f32 v138, v168, v169
    v_cvt_pk_bf16_f32 v139, v170, v171
    s_waitcnt lgkmcnt(0)
    v_dot2_f32_bf16 v234, v132, s76, v234
    v_dot2_f32_bf16 v236, v132, v132, v236
    v_dot2_f32_bf16 v235, v133, s76, v235
    v_dot2_f32_bf16 v237, v133, v133, v237
    v_dot2_f32_bf16 v234, v134, s76, v234
    v_dot2_f32_bf16 v236, v134, v134, v236
    v_dot2_f32_bf16 v235, v135, s76, v235
    v_dot2_f32_bf16 v237, v135, v135, v237
    v_dot2_f32_bf16 v234, v140, s76, v234
    v_dot2_f32_bf16 v236, v140, v140, v236
    v_dot2_f32_bf16 v235, v141, s76, v235
    v_dot2_f32_bf16 v237, v141, v141, v237
    v_dot2_f32_bf16 v234, v142, s76, v234
    v_dot2_f32_bf16 v236, v142, v142, v236
    v_dot2_f32_bf16 v235, v143, s76, v235
    v_dot2_f32_bf16 v237, v143, v143, v237
    s_nop 2
    v_add_f32 v234, v234, v235
    v_add_f32 v236, v236, v237
    v_mov_b32 v160, v234
    v_mov_b32 v161, v236
    s_nop 1
    v_permlane32_swap_b32 v234, v160
    v_permlane32_swap_b32 v236, v161
    s_nop 0
    v_add_f32 v234, v234, v160
    v_add_f32 v236, v236, v161
    v_mov_b32 v160, v234
    v_mov_b32 v161, v236
    s_nop 1
    v_permlane16_swap_b32 v234, v160
    v_permlane16_swap_b32 v236, v161
    s_nop 0
    v_add_f32 v234, v234, v160
    v_add_f32_e64 v236, v236, v161
    v_mul_f32 v234, 0x3ae38e39, v234
    v_mul_f32 v236, 0x3ae38e39, v236
    v_fma_f32 v236, -v234, v234, v236
    v_max_f32_e64 v236, 0, v236
    v_cvt_pk_bf16_f32 v236, v236, v236
    v_lshlrev_b32_e64 v236, 16, v236
    v_add_f32 v236, 0x3727c5ac, v236
    v_cvt_pk_bf16_f32 v236, v236, v236
    v_lshlrev_b32 v236, 16, v236
    v_sqrt_f32 v236, v236
    v_cvt_pk_bf16_f32 v234, v234, v234
    v_lshlrev_b32_e64 v234, 16, v234
    v_cvt_pk_bf16_f32 v236, v236, v236
    v_lshlrev_b32 v236, 16, v236
    v_rcp_f32 v238, v236
    v_sub_f32 v239, 0, v234
    v_mul_f32 v253, v238, v238
    v_mul_f32 v251, 0x3f154857, v238
    v_dot2_f32_bf16 v164, v4, s77, v239
    v_dot2_f32_bf16 v165, v4, s47, v239
    v_dot2_f32_bf16 v166, v5, s77, v239
    v_dot2_f32_bf16 v167, v5, s47, v239
    v_dot2_f32_bf16 v168, v6, s77, v239
    v_dot2_f32_bf16 v169, v6, s47, v239
    v_dot2_f32_bf16 v170, v7, s77, v239
    v_dot2_f32_bf16 v171, v7, s47, v239
    v_cvt_pk_bf16_f32 v4, v164, v165
    v_cvt_pk_bf16_f32 v5, v166, v167
    v_cvt_pk_bf16_f32 v6, v168, v169
    v_cvt_pk_bf16_f32 v7, v170, v171
    buffer_load_dwordx4 v247, s[24:27], s66 offen offset:1024 lds
    v_dot2_f32_bf16 v164, v12, s77, v239
    v_dot2_f32_bf16 v165, v12, s47, v239
    v_dot2_f32_bf16 v166, v13, s77, v239
    v_dot2_f32_bf16 v167, v13, s47, v239
    v_dot2_f32_bf16 v168, v14, s77, v239
    v_dot2_f32_bf16 v169, v14, s47, v239
    v_dot2_f32_bf16 v170, v15, s77, v239
    v_dot2_f32_bf16 v171, v15, s47, v239
    v_cvt_pk_bf16_f32 v12, v164, v165
    v_cvt_pk_bf16_f32 v13, v166, v167
    v_cvt_pk_bf16_f32 v14, v168, v169
    v_cvt_pk_bf16_f32 v15, v170, v171
    buffer_load_dwordx4 v248, s[24:27], s66 offen offset:2048 lds
    v_dot2_f32_bf16 v164, v20, s77, v239
    v_dot2_f32_bf16 v165, v20, s47, v239
    v_dot2_f32_bf16 v166, v21, s77, v239
    v_dot2_f32_bf16 v167, v21, s47, v239
    v_dot2_f32_bf16 v168, v22, s77, v239
    v_dot2_f32_bf16 v169, v22, s47, v239
    v_dot2_f32_bf16 v170, v23, s77, v239
    v_dot2_f32_bf16 v171, v23, s47, v239
    v_cvt_pk_bf16_f32 v20, v164, v165
    v_cvt_pk_bf16_f32 v21, v166, v167
    v_cvt_pk_bf16_f32 v22, v168, v169
    v_cvt_pk_bf16_f32 v23, v170, v171
    s_add_u32 m0, s64, 49408
    s_add_u32 s66, s100, 0
    buffer_load_dwordx4 v246, s[24:27], s66 offen offset:0 lds
    v_dot2_f32_bf16 v164, v28, s77, v239
    v_dot2_f32_bf16 v165, v28, s47, v239
    v_dot2_f32_bf16 v166, v29, s77, v239
    v_dot2_f32_bf16 v167, v29, s47, v239
    v_dot2_f32_bf16 v168, v30, s77, v239
    v_dot2_f32_bf16 v169, v30, s47, v239
    v_dot2_f32_bf16 v170, v31, s77, v239
    v_dot2_f32_bf16 v171, v31, s47, v239
    v_cvt_pk_bf16_f32 v28, v164, v165
    v_cvt_pk_bf16_f32 v29, v166, v167
    v_cvt_pk_bf16_f32 v30, v168, v169
    v_cvt_pk_bf16_f32 v31, v170, v171
    buffer_load_dwordx4 v247, s[24:27], s66 offen offset:1024 lds
    v_dot2_f32_bf16 v164, v36, s77, v239
    v_dot2_f32_bf16 v165, v36, s47, v239
    v_dot2_f32_bf16 v166, v37, s77, v239
    v_dot2_f32_bf16 v167, v37, s47, v239
    v_dot2_f32_bf16 v168, v38, s77, v239
    v_dot2_f32_bf16 v169, v38, s47, v239
    v_dot2_f32_bf16 v170, v39, s77, v239
    v_dot2_f32_bf16 v171, v39, s47, v239
    v_cvt_pk_bf16_f32 v36, v164, v165
    v_cvt_pk_bf16_f32 v37, v166, v167
    v_cvt_pk_bf16_f32 v38, v168, v169
    v_cvt_pk_bf16_f32 v39, v170, v171
    buffer_load_dwordx4 v248, s[24:27], s66 offen offset:2048 lds
    v_dot2_f32_bf16 v164, v44, s77, v239
    v_dot2_f32_bf16 v165, v44, s47, v239
    v_dot2_f32_bf16 v166, v45, s77, v239
    v_dot2_f32_bf16 v167, v45, s47, v239
    v_dot2_f32_bf16 v168, v46, s77, v239
    v_dot2_f32_bf16 v169, v46, s47, v239
    v_dot2_f32_bf16 v170, v47, s77, v239
    v_dot2_f32_bf16 v171, v47, s47, v239
    v_cvt_pk_bf16_f32 v44, v164, v165
    v_cvt_pk_bf16_f32 v45, v166, v167
    v_cvt_pk_bf16_f32 v46, v168, v169
    v_cvt_pk_bf16_f32 v47, v170, v171
    s_add_u32 m0, s64, 52480
    s_add_u32 s66, s100, 128
    buffer_load_dwordx4 v246, s[24:27], s66 offen offset:0 lds
    v_dot2_f32_bf16 v164, v52, s77, v239
    v_dot2_f32_bf16 v165, v52, s47, v239
    v_dot2_f32_bf16 v166, v53, s77, v239
    v_dot2_f32_bf16 v167, v53, s47, v239
    v_dot2_f32_bf16 v168, v54, s77, v239
    v_dot2_f32_bf16 v169, v54, s47, v239
    v_dot2_f32_bf16 v170, v55, s77, v239
    v_dot2_f32_bf16 v171, v55, s47, v239
    v_cvt_pk_bf16_f32 v52, v164, v165
    v_cvt_pk_bf16_f32 v53, v166, v167
    v_cvt_pk_bf16_f32 v54, v168, v169
    v_cvt_pk_bf16_f32 v55, v170, v171
    buffer_load_dwordx4 v247, s[24:27], s66 offen offset:1024 lds
    v_dot2_f32_bf16 v164, v60, s77, v239
    v_dot2_f32_bf16 v165, v60, s47, v239
    v_dot2_f32_bf16 v166, v61, s77, v239
    v_dot2_f32_bf16 v167, v61, s47, v239
    v_dot2_f32_bf16 v168, v62, s77, v239
    v_dot2_f32_bf16 v169, v62, s47, v239
    v_dot2_f32_bf16 v170, v63, s77, v239
    v_dot2_f32_bf16 v171, v63, s47, v239
    v_cvt_pk_bf16_f32 v60, v164, v165
    v_cvt_pk_bf16_f32 v61, v166, v167
    v_cvt_pk_bf16_f32 v62, v168, v169
    v_cvt_pk_bf16_f32 v63, v170, v171
    buffer_load_dwordx4 v248, s[24:27], s66 offen offset:2048 lds
    v_dot2_f32_bf16 v164, v68, s77, v239
    v_dot2_f32_bf16 v165, v68, s47, v239
    v_dot2_f32_bf16 v166, v69, s77, v239
    v_dot2_f32_bf16 v167, v69, s47, v239
    v_dot2_f32_bf16 v168, v70, s77, v239
    v_dot2_f32_bf16 v169, v70, s47, v239
    v_dot2_f32_bf16 v170, v71, s77, v239
    v_dot2_f32_bf16 v171, v71, s47, v239
    v_cvt_pk_bf16_f32 v68, v164, v165
    v_cvt_pk_bf16_f32 v69, v166, v167
    v_cvt_pk_bf16_f32 v70, v168, v169
    v_cvt_pk_bf16_f32 v71, v170, v171
    v_dot2_f32_bf16 v164, v76, s77, v239
    v_dot2_f32_bf16 v165, v76, s47, v239
    v_dot2_f32_bf16 v166, v77, s77, v239
    v_dot2_f32_bf16 v167, v77, s47, v239
    v_dot2_f32_bf16 v168, v78, s77, v239
    v_dot2_f32_bf16 v169, v78, s47, v239
    v_dot2_f32_bf16 v170, v79, s77, v239
    v_dot2_f32_bf16 v171, v79, s47, v239
    v_cvt_pk_bf16_f32 v76, v164, v165
    v_cvt_pk_bf16_f32 v77, v166, v167
    v_cvt_pk_bf16_f32 v78, v168, v169
    v_cvt_pk_bf16_f32 v79, v170, v171
    v_dot2_f32_bf16 v164, v84, s77, v239
    v_dot2_f32_bf16 v165, v84, s47, v239
    v_dot2_f32_bf16 v166, v85, s77, v239
    v_dot2_f32_bf16 v167, v85, s47, v239
    v_dot2_f32_bf16 v168, v86, s77, v239
    v_dot2_f32_bf16 v169, v86, s47, v239
    v_dot2_f32_bf16 v170, v87, s77, v239
    v_dot2_f32_bf16 v171, v87, s47, v239
    v_cvt_pk_bf16_f32 v84, v164, v165
    v_cvt_pk_bf16_f32 v85, v166, v167
    v_cvt_pk_bf16_f32 v86, v168, v169
    v_cvt_pk_bf16_f32 v87, v170, v171
    v_dot2_f32_bf16 v164, v92, s77, v239
    v_dot2_f32_bf16 v165, v92, s47, v239
    v_dot2_f32_bf16 v166, v93, s77, v239
    v_dot2_f32_bf16 v167, v93, s47, v239
    v_dot2_f32_bf16 v168, v94, s77, v239
    v_dot2_f32_bf16 v169, v94, s47, v239
    v_dot2_f32_bf16 v170, v95, s77, v239
    v_dot2_f32_bf16 v171, v95, s47, v239
    v_cvt_pk_bf16_f32 v92, v164, v165
    v_cvt_pk_bf16_f32 v93, v166, v167
    v_cvt_pk_bf16_f32 v94, v168, v169
    v_cvt_pk_bf16_f32 v95, v170, v171
    v_dot2_f32_bf16 v164, v100, s77, v239
    v_dot2_f32_bf16 v165, v100, s47, v239
    v_dot2_f32_bf16 v166, v101, s77, v239
    v_dot2_f32_bf16 v167, v101, s47, v239
    v_dot2_f32_bf16 v168, v102, s77, v239
    v_dot2_f32_bf16 v169, v102, s47, v239
    v_dot2_f32_bf16 v170, v103, s77, v239
    v_dot2_f32_bf16 v171, v103, s47, v239
    v_cvt_pk_bf16_f32 v100, v164, v165
    v_cvt_pk_bf16_f32 v101, v166, v167
    v_cvt_pk_bf16_f32 v102, v168, v169
    v_cvt_pk_bf16_f32 v103, v170, v171
    s_and_b32 s68, s57, 1
    s_mul_i32 s69, s65, 1152
    s_mul_i32 s67, s58, 294912
    s_add_u32 s67, s67, s69
    s_lshl_b32 s70, s68, 7
    s_add_u32 s67, s67, s70
    buffer_load_dwordx4 a[156:159], v243, s[12:15], s67 offen offset:0
    v_dot2_f32_bf16 v164, v108, s77, v239
    v_dot2_f32_bf16 v165, v108, s47, v239
L_w0:
    s_cbranch_execz L_wret0
    v_dot2_f32_bf16 v166, v109, s77, v239
    v_dot2_f32_bf16 v167, v109, s47, v239
    v_dot2_f32_bf16 v168, v110, s77, v239
    v_dot2_f32_bf16 v169, v110, s47, v239
    v_dot2_f32_bf16 v170, v111, s77, v239
    v_dot2_f32_bf16 v171, v111, s47, v239
    v_cvt_pk_bf16_f32 v108, v164, v165
    v_cvt_pk_bf16_f32 v109, v166, v167
    v_cvt_pk_bf16_f32 v110, v168, v169
    v_cvt_pk_bf16_f32 v111, v170, v171
    buffer_load_dwordx4 a[156:159], v243, s[12:15], s67 offen offset:256
    v_dot2_f32_bf16 v164, v116, s77, v239
    v_dot2_f32_bf16 v165, v116, s47, v239
    v_dot2_f32_bf16 v166, v117, s77, v239
    v_dot2_f32_bf16 v167, v117, s47, v239
    v_dot2_f32_bf16 v168, v118, s77, v239
    v_dot2_f32_bf16 v169, v118, s47, v239
    v_dot2_f32_bf16 v170, v119, s77, v239
    v_dot2_f32_bf16 v171, v119, s47, v239
    v_cvt_pk_bf16_f32 v116, v164, v165
    v_cvt_pk_bf16_f32 v117, v166, v167
    v_cvt_pk_bf16_f32 v118, v168, v169
    v_cvt_pk_bf16_f32 v119, v170, v171
    buffer_load_dwordx4 a[156:159], v243, s[12:15], s67 offen offset:512
    v_dot2_f32_bf16 v164, v124, s77, v239
    v_dot2_f32_bf16 v165, v124, s47, v239
    v_dot2_f32_bf16 v166, v125, s77, v239
    v_dot2_f32_bf16 v167, v125, s47, v239
    v_dot2_f32_bf16 v168, v126, s77, v239
    v_dot2_f32_bf16 v169, v126, s47, v239
    v_dot2_f32_bf16 v170, v127, s77, v239
    v_dot2_f32_bf16 v171, v127, s47, v239
    v_cvt_pk_bf16_f32 v124, v164, v165
    v_cvt_pk_bf16_f32 v125, v166, v167
    v_cvt_pk_bf16_f32 v126, v168, v169
    v_cvt_pk_bf16_f32 v127, v170, v171
    buffer_load_dwordx4 a[156:159], v243, s[12:15], s67 offen offset:768
    v_dot2_f32_bf16 v164, v132, s77, v239
    v_dot2_f32_bf16 v165, v132, s47, v239
    v_dot2_f32_bf16 v166, v133, s77, v239
    v_dot2_f32_bf16 v167, v133, s47, v239
    v_dot2_f32_bf16 v168, v134, s77, v239
    v_dot2_f32_bf16 v169, v134, s47, v239
    v_dot2_f32_bf16 v170, v135, s77, v239
    v_dot2_f32_bf16 v171, v135, s47, v239
    v_cvt_pk_bf16_f32 v132, v164, v165
    v_cvt_pk_bf16_f32 v133, v166, v167
    v_cvt_pk_bf16_f32 v134, v168, v169
    v_cvt_pk_bf16_f32 v135, v170, v171
    buffer_load_dwordx4 a[156:159], v243, s[12:15], s67 offen offset:1024
    v_dot2_f32_bf16 v164, v140, s77, v239
    v_dot2_f32_bf16 v165, v140, s47, v239
    v_dot2_f32_bf16 v166, v141, s77, v239
    v_dot2_f32_bf16 v167, v141, s47, v239
    v_dot2_f32_bf16 v168, v142, s77, v239
    v_dot2_f32_bf16 v169, v142, s47, v239
    v_dot2_f32_bf16 v170, v143, s77, v239
    v_dot2_f32_bf16 v171, v143, s47, v239
    v_cvt_pk_bf16_f32 v140, v164, v165
    v_cvt_pk_bf16_f32 v141, v166, v167
    v_cvt_pk_bf16_f32 v142, v168, v169
    v_cvt_pk_bf16_f32 v143, v170, v171
    s_add_u32 s68, s68, 16
    s_mul_i32 s68, s68, 294912
    s_add_u32 s68, s68, s69
    s_min_u32 s70, s58, 8
    s_lshl_b32 s70, s70, 7
    s_add_u32 s68, s68, s70
    buffer_load_dwordx4 a[156:159], v243, s[12:15], s68 offen
    s_waitcnt vmcnt(18)
    s_barrier
    ds_read_b64_tr_b16 a[168:169], v240 offset:0
    ds_read_b64_tr_b16 a[170:171], v240 offset:256
    ds_read_b64_tr_b16 a[172:173], v240 offset:32
    ds_read_b64_tr_b16 a[174:175], v240 offset:288
    ds_read_b64_tr_b16 a[176:177], v240 offset:512
    ds_read_b64_tr_b16 a[178:179], v240 offset:768
    ds_read_b64_tr_b16 a[180:181], v240 offset:544
    ds_read_b64_tr_b16 a[182:183], v240 offset:800
    ds_read_b64_tr_b16 a[184:185], v240 offset:3072
    ds_read_b64_tr_b16 a[186:187], v240 offset:3328
    ds_read_b64_tr_b16 a[188:189], v240 offset:3104
    ds_read_b64_tr_b16 a[190:191], v240 offset:3360
    ds_read_b64_tr_b16 a[192:193], v240 offset:3584
    ds_read_b64_tr_b16 a[194:195], v240 offset:3840
    s_waitcnt lgkmcnt(10)
    v_mfma_f32_16x16x32_bf16 v[144:147], a[168:171], v[0:3], 0
    ds_read_b64_tr_b16 a[196:197], v240 offset:1024
    v_bfe_u32 v211, v254, 4, 4
    v_mfma_f32_16x16x32_bf16 v[148:151], a[168:171], v[4:7], 0
    ds_read_b64_tr_b16 a[198:199], v240 offset:1280
    s_add_u32 m0, s64, 74112
    v_mfma_f32_16x16x32_bf16 v[152:155], a[172:175], v[0:3], 0
    ds_read_b64_tr_b16 a[168:169], v240 offset:1056
    s_add_u32 s66, s100, 331776
    v_mfma_f32_16x16x32_bf16 v[156:159], a[172:175], v[4:7], 0
    ds_read_b64_tr_b16 a[170:171], v240 offset:1312
    s_waitcnt lgkmcnt(8)
    v_mfma_f32_16x16x32_bf16 v[160:163], a[176:179], v[0:3], 0
    ds_read_b64_tr_b16 a[172:173], v240 offset:1536
    v_lshrrev_b32_e64 v212, 8, v254
    v_mfma_f32_16x16x32_bf16 v[164:167], a[176:179], v[4:7], 0
    ds_read_b64_tr_b16 a[174:175], v240 offset:1792
    s_lshl_b32 s45, s56, 8
    v_mfma_f32_16x16x32_bf16 v[168:171], a[180:183], v[0:3], 0
    ds_read_b64_tr_b16 a[176:177], v240 offset:1568
    v_lshlrev_b32 v208, 3, v211
    v_mfma_f32_16x16x32_bf16 v[172:175], a[180:183], v[4:7], 0
    ds_read_b64_tr_b16 a[178:179], v240 offset:1824
    buffer_load_dwordx4 v246, s[24:27], s66 offen offset:0 lds
    v_mfma_f32_16x16x32_bf16 v[176:179], a[184:187], v[0:3], 0
    ds_read_b64_tr_b16 a[180:181], v240 offset:4096
    v_add_u32_e64 v208, s45, v208
    v_mfma_f32_16x16x32_bf16 v[180:183], a[184:187], v[4:7], 0
    ds_read_b64_tr_b16 a[182:183], v240 offset:4352
    s_waitcnt lgkmcnt(8)
    v_mfma_f32_16x16x32_bf16 v[184:187], a[188:191], v[0:3], 0
    ds_read_b64_tr_b16 a[184:185], v240 offset:4128
    v_lshl_add_u32 v209, v212, 10, v208
    v_mfma_f32_16x16x32_bf16 v[188:191], a[188:191], v[4:7], 0
    ds_read_b64_tr_b16 a[186:187], v240 offset:4384
    v_accvgpr_write_b32 a228, v209
    v_mfma_f32_16x16x32_bf16 v[192:195], a[192:195], v[0:3], 0
    ds_read_b64_tr_b16 a[188:189], v240 offset:4608
    v_add_u32 v210, 1, v212
    v_mfma_f32_16x16x32_bf16 v[196:199], a[192:195], v[4:7], 0
    ds_read_b64_tr_b16 a[190:191], v240 offset:4864
    buffer_load_dwordx4 v247, s[24:27], s66 offen offset:1024 lds
    v_mfma_f32_16x16x32_bf16 v[144:147], a[196:199], v[8:11], v[144:147]
    ds_read_b64_tr_b16 a[192:193], v240 offset:2048
    v_lshrrev_b32_e64 v210, 2, v210
    v_mfma_f32_16x16x32_bf16 v[148:151], a[196:199], v[12:15], v[148:151]
    ds_read_b64_tr_b16 a[194:195], v240 offset:2304
    s_waitcnt lgkmcnt(8)
    v_mfma_f32_16x16x32_bf16 v[152:155], a[168:171], v[8:11], v[152:155]
    ds_read_b64_tr_b16 a[196:197], v240 offset:2080
    v_lshl_add_u32 v209, v210, 29, v209
    v_mfma_f32_16x16x32_bf16 v[156:159], a[168:171], v[12:15], v[156:159]
    ds_read_b64_tr_b16 a[198:199], v240 offset:2336
    v_accvgpr_write_b32 a229, v209
    v_mfma_f32_16x16x32_bf16 v[160:163], a[172:175], v[8:11], v[160:163]
    ds_read_b64_tr_b16 a[168:169], v240 offset:2560
    s_mul_i32 s45, s58, 432
    v_mfma_f32_16x16x32_bf16 v[164:167], a[172:175], v[12:15], v[164:167]
    ds_read_b64_tr_b16 a[170:171], v240 offset:2816
    buffer_load_dwordx4 v248, s[24:27], s66 offen offset:2048 lds
    v_mfma_f32_16x16x32_bf16 v[168:171], a[176:179], v[8:11], v[168:171]
    ds_read_b64_tr_b16 a[172:173], v240 offset:2592
    s_add_u32 m0, s64, 77184
    v_mfma_f32_16x16x32_bf16 v[172:175], a[176:179], v[12:15], v[172:175]
    ds_read_b64_tr_b16 a[174:175], v240 offset:2848
    s_waitcnt lgkmcnt(8)
    v_mfma_f32_16x16x32_bf16 v[176:179], a[180:183], v[8:11], v[176:179]
    ds_read_b64_tr_b16 a[176:177], v240 offset:5120
    s_add_u32 s66, s100, 331904
    v_mfma_f32_16x16x32_bf16 v[180:183], a[180:183], v[12:15], v[180:183]
    ds_read_b64_tr_b16 a[178:179], v240 offset:5376
    s_mul_i32 s52, s57, 27
    v_mfma_f32_16x16x32_bf16 v[184:187], a[184:187], v[8:11], v[184:187]
    ds_read_b64_tr_b16 a[180:181], v240 offset:5152
    s_add_u32 s52, s52, s45
    v_mfma_f32_16x16x32_bf16 v[188:191], a[184:187], v[12:15], v[188:191]
    ds_read_b64_tr_b16 a[182:183], v240 offset:5408
    buffer_load_dwordx4 v246, s[24:27], s66 offen offset:0 lds
    v_mfma_f32_16x16x32_bf16 v[192:195], a[188:191], v[8:11], v[192:195]
    ds_read_b64_tr_b16 a[184:185], v240 offset:5632
    s_lshl_b32 s52, s52, 10
    v_mfma_f32_16x16x32_bf16 v[196:199], a[188:191], v[12:15], v[196:199]
    ds_read_b64_tr_b16 a[186:187], v240 offset:5888
    s_waitcnt lgkmcnt(8)
    v_mfma_f32_16x16x32_bf16 v[144:147], a[192:195], v[16:19], v[144:147]
    s_waitcnt vmcnt(16)
    s_barrier
    ds_read_b64_tr_b16 a[188:189], v240 offset:24704
    v_mfma_f32_16x16x32_bf16 v[148:151], a[192:195], v[20:23], v[148:151]
    ds_read_b64_tr_b16 a[190:191], v240 offset:24960
    s_add_u32 s54, s52, 37748736
    v_mfma_f32_16x16x32_bf16 v[152:155], a[196:199], v[16:19], v[152:155]
    ds_read_b64_tr_b16 a[192:193], v240 offset:24736
    v_lshl_add_u32 v209, v212, 11, v208
    v_mfma_f32_16x16x32_bf16 v[156:159], a[196:199], v[20:23], v[156:159]
    ds_read_b64_tr_b16 a[194:195], v240 offset:24992
    buffer_load_dwordx4 v247, s[24:27], s66 offen offset:1024 lds
    v_mfma_f32_16x16x32_bf16 v[160:163], a[168:171], v[16:19], v[160:163]
    ds_read_b64_tr_b16 a[196:197], v240 offset:25216
    v_accvgpr_write_b32 a209, v209
    v_mfma_f32_16x16x32_bf16 v[164:167], a[168:171], v[20:23], v[164:167]
    ds_read_b64_tr_b16 a[198:199], v240 offset:25472
    s_waitcnt lgkmcnt(8)
    v_mfma_f32_16x16x32_bf16 v[168:171], a[172:175], v[16:19], v[168:171]
    ds_read_b64_tr_b16 a[168:169], v240 offset:25248
    v_lshl_add_u32 v209, v212, 1, 5
    v_mfma_f32_16x16x32_bf16 v[172:175], a[172:175], v[20:23], v[172:175]
    ds_read_b64_tr_b16 a[170:171], v240 offset:25504
    v_cmp_gt_u32 s[40:41], 2, v212
    v_mfma_f32_16x16x32_bf16 v[176:179], a[176:179], v[16:19], v[176:179]
    ds_read_b64_tr_b16 a[172:173], v240 offset:27776
    v_cndmask_b32 v209, 4, v209, s[40:41]
    v_mfma_f32_16x16x32_bf16 v[180:183], a[176:179], v[20:23], v[180:183]
    ds_read_b64_tr_b16 a[174:175], v240 offset:28032
    buffer_load_dwordx4 v248, s[24:27], s66 offen offset:2048 lds
    v_mfma_f32_16x16x32_bf16 v[184:187], a[180:183], v[16:19], v[184:187]
    ds_read_b64_tr_b16 a[176:177], v240 offset:27808
    s_add_u32 m0, s64, 98816
    v_mfma_f32_16x16x32_bf16 v[188:191], a[180:183], v[20:23], v[188:191]
    ds_read_b64_tr_b16 a[178:179], v240 offset:28064
    s_waitcnt lgkmcnt(8)
    v_mfma_f32_16x16x32_bf16 v[192:195], a[184:187], v[16:19], v[192:195]
    ds_read_b64_tr_b16 a[180:181], v240 offset:28288
    s_add_u32 s66, s101, 0
    v_mfma_f32_16x16x32_bf16 v[196:199], a[184:187], v[20:23], v[196:199]
    ds_read_b64_tr_b16 a[182:183], v240 offset:28544
    v_lshl_add_u32 v209, v209, 10, v208
    v_mfma_f32_16x16x32_bf16 v[144:147], a[188:191], v[24:27], v[144:147]
    ds_read_b64_tr_b16 a[184:185], v240 offset:25728
    v_accvgpr_write_b32 a210, v209
    v_mfma_f32_16x16x32_bf16 v[148:151], a[188:191], v[28:31], v[148:151]
    ds_read_b64_tr_b16 a[186:187], v240 offset:25984
    buffer_load_dwordx4 v246, s[24:27], s66 offen offset:0 lds
    v_mfma_f32_16x16x32_bf16 v[152:155], a[192:195], v[24:27], v[152:155]
    ds_read_b64_tr_b16 a[188:189], v240 offset:25760
    s_mul_i32 s52, s57, 9
    v_mfma_f32_16x16x32_bf16 v[156:159], a[192:195], v[28:31], v[156:159]
    ds_read_b64_tr_b16 a[190:191], v240 offset:26016
    s_waitcnt lgkmcnt(8)
    v_mfma_f32_16x16x32_bf16 v[160:163], a[196:199], v[24:27], v[160:163]
    ds_read_b64_tr_b16 a[192:193], v240 offset:26240
    s_add_u32 s52, s52, s45
    v_mfma_f32_16x16x32_bf16 v[164:167], a[196:199], v[28:31], v[164:167]
    ds_read_b64_tr_b16 a[194:195], v240 offset:26496
    s_lshl_b32 s52, s52, 10
    v_mfma_f32_16x16x32_bf16 v[168:171], a[168:171], v[24:27], v[168:171]
    ds_read_b64_tr_b16 a[196:197], v240 offset:26272
    s_add_u32 s55, s52, 37748736
    v_mfma_f32_16x16x32_bf16 v[172:175], a[168:171], v[28:31], v[172:175]
    ds_read_b64_tr_b16 a[198:199], v240 offset:26528
    buffer_load_dwordx4 v247, s[24:27], s66 offen offset:1024 lds
    v_mfma_f32_16x16x32_bf16 v[176:179], a[172:175], v[24:27], v[176:179]
    ds_read_b64_tr_b16 a[168:169], v240 offset:28800
    s_add_u32 s78, s56, 144
    v_mfma_f32_16x16x32_bf16 v[180:183], a[172:175], v[28:31], v[180:183]
    ds_read_b64_tr_b16 a[170:171], v240 offset:29056
    s_waitcnt lgkmcnt(8)
    v_mfma_f32_16x16x32_bf16 v[184:187], a[176:179], v[24:27], v[184:187]
    ds_read_b64_tr_b16 a[172:173], v240 offset:28832
    s_lshl_b32 s78, s78, 10
    v_mfma_f32_16x16x32_bf16 v[188:191], a[176:179], v[28:31], v[188:191]
    ds_read_b64_tr_b16 a[174:175], v240 offset:29088
    s_add_u32 s50, s78, s55
    v_mfma_f32_16x16x32_bf16 v[192:195], a[180:183], v[24:27], v[192:195]
    ds_read_b64_tr_b16 a[176:177], v240 offset:29312
    s_sub_u32 s48, s50, 884736
    v_mfma_f32_16x16x32_bf16 v[196:199], a[180:183], v[28:31], v[196:199]
    ds_read_b64_tr_b16 a[178:179], v240 offset:29568
    buffer_load_dwordx4 v248, s[24:27], s66 offen offset:2048 lds
    v_mfma_f32_16x16x32_bf16 v[144:147], a[184:187], v[32:35], v[144:147]
    ds_read_b64_tr_b16 a[180:181], v240 offset:26752
    s_add_u32 m0, s64, 101888
    v_mfma_f32_16x16x32_bf16 v[148:151], a[184:187], v[36:39], v[148:151]
    ds_read_b64_tr_b16 a[182:183], v240 offset:27008
    s_waitcnt lgkmcnt(8)
    v_mfma_f32_16x16x32_bf16 v[152:155], a[188:191], v[32:35], v[152:155]
    ds_read_b64_tr_b16 a[184:185], v240 offset:26784
    s_add_u32 s66, s101, 128
    v_mfma_f32_16x16x32_bf16 v[156:159], a[188:191], v[36:39], v[156:159]
    ds_read_b64_tr_b16 a[186:187], v240 offset:27040
    s_cmp_ge_u32 s58, 2
    s_cselect_b32 s48, s48, 536870912
    v_mfma_f32_16x16x32_bf16 v[160:163], a[192:195], v[32:35], v[160:163]
    ds_read_b64_tr_b16 a[188:189], v240 offset:27264
    s_sub_u32 s49, s50, 443392
    v_mfma_f32_16x16x32_bf16 v[164:167], a[192:195], v[36:39], v[164:167]
    ds_read_b64_tr_b16 a[190:191], v240 offset:27520
    buffer_load_dwordx4 v246, s[24:27], s66 offen offset:0 lds
    v_mfma_f32_16x16x32_bf16 v[168:171], a[196:199], v[32:35], v[168:171]
    ds_read_b64_tr_b16 a[192:193], v240 offset:27296
    s_cmp_ge_u32 s58, 1
    s_cselect_b32 s49, s49, 536870912
    v_mfma_f32_16x16x32_bf16 v[172:175], a[196:199], v[36:39], v[172:175]
    ds_read_b64_tr_b16 a[194:195], v240 offset:27552
    s_waitcnt lgkmcnt(8)
    v_mfma_f32_16x16x32_bf16 v[176:179], a[168:171], v[32:35], v[176:179]
    ds_read_b64_tr_b16 a[196:197], v240 offset:29824
    s_sub_u32 s50, s50, 2048
    v_mfma_f32_16x16x32_bf16 v[180:183], a[168:171], v[36:39], v[180:183]
    ds_read_b64_tr_b16 a[198:199], v240 offset:30080
    s_and_b32 s78, s57, 1
    v_mfma_f32_16x16x32_bf16 v[184:187], a[172:175], v[32:35], v[184:187]
    ds_read_b64_tr_b16 a[168:169], v240 offset:29856
    s_lshl_b32 s52, s58, 1
    v_mfma_f32_16x16x32_bf16 v[188:191], a[172:175], v[36:39], v[188:191]
    ds_read_b64_tr_b16 a[170:171], v240 offset:30112
    buffer_load_dwordx4 v247, s[24:27], s66 offen offset:1024 lds
    v_mfma_f32_16x16x32_bf16 v[192:195], a[176:179], v[32:35], v[192:195]
    ds_read_b64_tr_b16 a[172:173], v240 offset:30336
    s_add_u32 s52, s52, s78
    v_mfma_f32_16x16x32_bf16 v[196:199], a[176:179], v[36:39], v[196:199]
    ds_read_b64_tr_b16 a[174:175], v240 offset:30592
    s_waitcnt lgkmcnt(8)
    v_mfma_f32_16x16x32_bf16 v[144:147], a[180:183], v[40:43], v[144:147]
    s_waitcnt vmcnt(17)
    s_barrier
    ds_read_b64_tr_b16 a[176:177], v241 offset:0
    v_mfma_f32_16x16x32_bf16 v[148:151], a[180:183], v[44:47], v[148:151]
    ds_read_b64_tr_b16 a[178:179], v241 offset:256
    s_mul_i32 s3, s52, 20
    v_mfma_f32_16x16x32_bf16 v[152:155], a[184:187], v[40:43], v[152:155]
    ds_read_b64_tr_b16 a[180:181], v241 offset:32
    s_add_u32 s3, s3, s56
    v_mfma_f32_16x16x32_bf16 v[156:159], a[184:187], v[44:47], v[156:159]
    ds_read_b64_tr_b16 a[182:183], v241 offset:288
    buffer_load_dwordx4 v248, s[24:27], s66 offen offset:2048 lds
    v_mfma_f32_16x16x32_bf16 v[160:163], a[188:191], v[40:43], v[160:163]
    ds_read_b64_tr_b16 a[184:185], v241 offset:512
    s_add_u32 m0, s64, 123520
    v_mfma_f32_16x16x32_bf16 v[164:167], a[188:191], v[44:47], v[164:167]
    ds_read_b64_tr_b16 a[186:187], v241 offset:768
    s_waitcnt lgkmcnt(8)
    v_mfma_f32_16x16x32_bf16 v[168:171], a[192:195], v[40:43], v[168:171]
    ds_read_b64_tr_b16 a[188:189], v241 offset:544
    s_add_u32 s66, s101, 331776
    v_mfma_f32_16x16x32_bf16 v[172:175], a[192:195], v[44:47], v[172:175]
    ds_read_b64_tr_b16 a[190:191], v241 offset:800
    s_lshl_b32 s3, s3, 6
    v_mfma_f32_16x16x32_bf16 v[176:179], a[196:199], v[40:43], v[176:179]
    ds_read_b64_tr_b16 a[192:193], v241 offset:3072
    s_add_u32 s3, s3, 46399488
    v_mfma_f32_16x16x32_bf16 v[180:183], a[196:199], v[44:47], v[180:183]
    ds_read_b64_tr_b16 a[194:195], v241 offset:3328
    buffer_load_dwordx4 v246, s[24:27], s66 offen offset:0 lds
    v_mfma_f32_16x16x32_bf16 v[184:187], a[168:171], v[40:43], v[184:187]
    ds_read_b64_tr_b16 a[196:197], v241 offset:3104
    s_lshl_b32 s52, s58, 4
    v_mfma_f32_16x16x32_bf16 v[188:191], a[168:171], v[44:47], v[188:191]
    ds_read_b64_tr_b16 a[198:199], v241 offset:3360
    s_waitcnt lgkmcnt(8)
    v_mfma_f32_16x16x32_bf16 v[192:195], a[172:175], v[40:43], v[192:195]
    ds_read_b64_tr_b16 a[168:169], v241 offset:3584
    s_add_u32 s52, s52, s57
    v_mfma_f32_16x16x32_bf16 v[196:199], a[172:175], v[44:47], v[196:199]
    ds_read_b64_tr_b16 a[170:171], v241 offset:3840
    s_lshl_b32 s73, s52, 2
    v_mfma_f32_16x16x32_bf16 v[144:147], a[176:179], v[48:51], v[144:147]
    ds_read_b64_tr_b16 a[172:173], v241 offset:1024
    s_add_u32 s73, s73, s56
    v_mfma_f32_16x16x32_bf16 v[148:151], a[176:179], v[52:55], v[148:151]
    ds_read_b64_tr_b16 a[174:175], v241 offset:1280
    buffer_load_dwordx4 v247, s[24:27], s66 offen offset:1024 lds
    v_mfma_f32_16x16x32_bf16 v[152:155], a[180:183], v[48:51], v[152:155]
    ds_read_b64_tr_b16 a[176:177], v241 offset:1056
    s_mul_i32 s74, s73, 27648
    v_mfma_f32_16x16x32_bf16 v[156:159], a[180:183], v[52:55], v[156:159]
    ds_read_b64_tr_b16 a[178:179], v241 offset:1312
    s_waitcnt lgkmcnt(8)
    v_mfma_f32_16x16x32_bf16 v[160:163], a[184:187], v[48:51], v[160:163]
    ds_read_b64_tr_b16 a[180:181], v241 offset:1536
    s_add_u32 s74, s74, 50331648
    v_mfma_f32_16x16x32_bf16 v[164:167], a[184:187], v[52:55], v[164:167]
    ds_read_b64_tr_b16 a[182:183], v241 offset:1792
    s_lshl_b32 s52, s73, 6
    v_mfma_f32_16x16x32_bf16 v[168:171], a[188:191], v[48:51], v[168:171]
    ds_read_b64_tr_b16 a[184:185], v241 offset:1568
    s_add_u32 s52, s52, 46202880
    v_mfma_f32_16x16x32_bf16 v[172:175], a[188:191], v[52:55], v[172:175]
    ds_read_b64_tr_b16 a[186:187], v241 offset:1824
    buffer_load_dwordx4 v248, s[24:27], s66 offen offset:2048 lds
    v_mfma_f32_16x16x32_bf16 v[176:179], a[192:195], v[48:51], v[176:179]
    ds_read_b64_tr_b16 a[188:189], v241 offset:4096
    s_add_u32 m0, s64, 126592
    v_mfma_f32_16x16x32_bf16 v[180:183], a[192:195], v[52:55], v[180:183]
    ds_read_b64_tr_b16 a[190:191], v241 offset:4352
    s_waitcnt lgkmcnt(8)
    v_mfma_f32_16x16x32_bf16 v[184:187], a[196:199], v[48:51], v[184:187]
    ds_read_b64_tr_b16 a[192:193], v241 offset:4128
    s_add_u32 s66, s101, 331904
    v_mfma_f32_16x16x32_bf16 v[188:191], a[196:199], v[52:55], v[188:191]
    ds_read_b64_tr_b16 a[194:195], v241 offset:4384
    v_accvgpr_write_b32 a211, s52
    v_mfma_f32_16x16x32_bf16 v[192:195], a[168:171], v[48:51], v[192:195]
    ds_read_b64_tr_b16 a[196:197], v241 offset:4608
    v_min_u32 v208, 64, v254
    v_mfma_f32_16x16x32_bf16 v[196:199], a[168:171], v[52:55], v[196:199]
    ds_read_b64_tr_b16 a[198:199], v241 offset:4864
    buffer_load_dwordx4 v246, s[24:27], s66 offen offset:0 lds
    v_mfma_f32_16x16x32_bf16 v[144:147], a[172:175], v[56:59], v[144:147]
    ds_read_b64_tr_b16 a[168:169], v241 offset:2048
    v_lshlrev_b32 v208, 4, v208
    v_mfma_f32_16x16x32_bf16 v[148:151], a[172:175], v[60:63], v[148:151]
    ds_read_b64_tr_b16 a[170:171], v241 offset:2304
    s_waitcnt lgkmcnt(8)
    v_mfma_f32_16x16x32_bf16 v[152:155], a[176:179], v[56:59], v[152:155]
    ds_read_b64_tr_b16 a[172:173], v241 offset:2080
    v_add_u32 v208, s3, v208
    v_mfma_f32_16x16x32_bf16 v[156:159], a[176:179], v[60:63], v[156:159]
    ds_read_b64_tr_b16 a[174:175], v241 offset:2336
    v_writelane_b32 v208, s52, 7
    v_mfma_f32_16x16x32_bf16 v[160:163], a[180:183], v[56:59], v[160:163]
    ds_read_b64_tr_b16 a[176:177], v241 offset:2560
    v_accvgpr_write_b32 a236, v208
    v_mfma_f32_16x16x32_bf16 v[164:167], a[180:183], v[60:63], v[164:167]
    ds_read_b64_tr_b16 a[178:179], v241 offset:2816
    buffer_load_dwordx4 v247, s[24:27], s66 offen offset:1024 lds
    v_mfma_f32_16x16x32_bf16 v[168:171], a[184:187], v[56:59], v[168:171]
    ds_read_b64_tr_b16 a[180:181], v241 offset:2592
    s_xor_b32 s52, s52, 256
    v_mfma_f32_16x16x32_bf16 v[172:175], a[184:187], v[60:63], v[172:175]
    ds_read_b64_tr_b16 a[182:183], v241 offset:2848
    s_waitcnt lgkmcnt(8)
    v_mfma_f32_16x16x32_bf16 v[176:179], a[188:191], v[56:59], v[176:179]
    ds_read_b64_tr_b16 a[184:185], v241 offset:5120
    v_accvgpr_write_b32 a212, s52
    v_mfma_f32_16x16x32_bf16 v[180:183], a[188:191], v[60:63], v[180:183]
    ds_read_b64_tr_b16 a[186:187], v241 offset:5376
    s_xor_b32 s73, s73, 4
    v_mfma_f32_16x16x32_bf16 v[184:187], a[192:195], v[56:59], v[184:187]
    ds_read_b64_tr_b16 a[188:189], v241 offset:5152
    s_mul_i32 s75, s73, 27648
    v_mfma_f32_16x16x32_bf16 v[188:191], a[192:195], v[60:63], v[188:191]
    ds_read_b64_tr_b16 a[190:191], v241 offset:5408
    buffer_load_dwordx4 v248, s[24:27], s66 offen offset:2048 lds
    v_mfma_f32_16x16x32_bf16 v[192:195], a[196:199], v[56:59], v[192:195]
    ds_read_b64_tr_b16 a[192:193], v241 offset:5632
    s_add_u32 m0, s64, 0
    v_mfma_f32_16x16x32_bf16 v[196:199], a[196:199], v[60:63], v[196:199]
    ds_read_b64_tr_b16 a[194:195], v241 offset:5888
    s_waitcnt lgkmcnt(8)
    v_mfma_f32_16x16x32_bf16 v[144:147], a[168:171], v[64:67], v[144:147]
    s_waitcnt vmcnt(12)
    s_barrier
    ds_read_b64_tr_b16 a[196:197], v241 offset:24704
    v_mfma_f32_16x16x32_bf16 v[148:151], a[168:171], v[68:71], v[148:151]
    ds_read_b64_tr_b16 a[198:199], v241 offset:24960
    s_add_u32 s66, s59, s96
    v_mfma_f32_16x16x32_bf16 v[152:155], a[172:175], v[64:67], v[152:155]
    ds_read_b64_tr_b16 a[168:169], v241 offset:24736
    s_add_u32 s75, s75, 50331648
    v_mfma_f32_16x16x32_bf16 v[156:159], a[172:175], v[68:71], v[156:159]
    ds_read_b64_tr_b16 a[170:171], v241 offset:24992
    buffer_load_dwordx4 v243, s[8:11], s66 offen offset:0 lds
    v_mfma_f32_16x16x32_bf16 v[160:163], a[176:179], v[64:67], v[160:163]
    ds_read_b64_tr_b16 a[172:173], v241 offset:25216
    s_and_b32 s45, s65, 1
    v_mfma_f32_16x16x32_bf16 v[164:167], a[176:179], v[68:71], v[164:167]
    ds_read_b64_tr_b16 a[174:175], v241 offset:25472
    s_waitcnt lgkmcnt(8)
    v_mfma_f32_16x16x32_bf16 v[168:171], a[180:183], v[64:67], v[168:171]
    ds_read_b64_tr_b16 a[176:177], v241 offset:25248
    s_xor_b32 s45, s45, 1
    v_mfma_f32_16x16x32_bf16 v[172:175], a[180:183], v[68:71], v[172:175]
    ds_read_b64_tr_b16 a[178:179], v241 offset:25504
    s_mul_i32 s73, s78, 20480
    v_mfma_f32_16x16x32_bf16 v[176:179], a[184:187], v[64:67], v[176:179]
    ds_read_b64_tr_b16 a[180:181], v241 offset:27776
    s_sub_u32 s52, s75, s73
    v_mfma_f32_16x16x32_bf16 v[180:183], a[184:187], v[68:71], v[180:183]
    ds_read_b64_tr_b16 a[182:183], v241 offset:28032
    buffer_load_dwordx4 v244, s[8:11], s66 offen offset:1024 lds
    v_mfma_f32_16x16x32_bf16 v[184:187], a[188:191], v[64:67], v[184:187]
    ds_read_b64_tr_b16 a[184:185], v241 offset:27808
    s_lshl_b32 s73, s45, 11
    v_mfma_f32_16x16x32_bf16 v[188:191], a[188:191], v[68:71], v[188:191]
    ds_read_b64_tr_b16 a[186:187], v241 offset:28064
    s_waitcnt lgkmcnt(8)
    v_mfma_f32_16x16x32_bf16 v[192:195], a[192:195], v[64:67], v[192:195]
    ds_read_b64_tr_b16 a[188:189], v241 offset:28288
    s_add_u32 s82, s52, s73
    v_mfma_f32_16x16x32_bf16 v[196:199], a[192:195], v[68:71], v[196:199]
    ds_read_b64_tr_b16 a[190:191], v241 offset:28544
    s_xor_b32 s73, s73, 0x800
    v_mfma_f32_16x16x32_bf16 v[144:147], a[196:199], v[72:75], v[144:147]
    ds_read_b64_tr_b16 a[192:193], v241 offset:25728
    s_add_u32 s83, s52, s73
    v_mfma_f32_16x16x32_bf16 v[148:151], a[196:199], v[76:79], v[148:151]
    ds_read_b64_tr_b16 a[194:195], v241 offset:25984
    buffer_load_dwordx4 v245, s[8:11], s66 offen offset:2048 lds
    v_mfma_f32_16x16x32_bf16 v[152:155], a[168:171], v[72:75], v[152:155]
    ds_read_b64_tr_b16 a[196:197], v241 offset:25760
    s_add_u32 m0, s64, 3072
    v_mfma_f32_16x16x32_bf16 v[156:159], a[168:171], v[76:79], v[156:159]
    ds_read_b64_tr_b16 a[198:199], v241 offset:26016
    s_waitcnt lgkmcnt(8)
    v_mfma_f32_16x16x32_bf16 v[160:163], a[172:175], v[72:75], v[160:163]
    ds_read_b64_tr_b16 a[168:169], v241 offset:26240
    s_add_u32 s66, s66, 884736
    v_mfma_f32_16x16x32_bf16 v[164:167], a[172:175], v[76:79], v[164:167]
    ds_read_b64_tr_b16 a[170:171], v241 offset:26496
    s_mul_i32 s73, s65, 221184
    v_mfma_f32_16x16x32_bf16 v[168:171], a[176:179], v[72:75], v[168:171]
    ds_read_b64_tr_b16 a[172:173], v241 offset:26272
    s_sub_u32 s79, s75, s73
    v_mfma_f32_16x16x32_bf16 v[172:175], a[176:179], v[76:79], v[172:175]
    ds_read_b64_tr_b16 a[174:175], v241 offset:26528
    buffer_load_dwordx4 v243, s[8:11], s66 offen offset:0 lds
    v_mfma_f32_16x16x32_bf16 v[176:179], a[180:183], v[72:75], v[176:179]
    ds_read_b64_tr_b16 a[176:177], v241 offset:28800
    v_and_b32 v212, 48, v254
    v_mfma_f32_16x16x32_bf16 v[180:183], a[180:183], v[76:79], v[180:183]
    ds_read_b64_tr_b16 a[178:179], v241 offset:29056
    s_waitcnt lgkmcnt(8)
    v_mfma_f32_16x16x32_bf16 v[184:187], a[184:187], v[72:75], v[184:187]
    ds_read_b64_tr_b16 a[180:181], v241 offset:28832
    v_lshrrev_b32 v213, 9, v254
    v_mfma_f32_16x16x32_bf16 v[188:191], a[184:187], v[76:79], v[188:191]
    ds_read_b64_tr_b16 a[182:183], v241 offset:29088
    v_mul_u32_u24 v209, 294848, v213
    v_mfma_f32_16x16x32_bf16 v[192:195], a[188:191], v[72:75], v[192:195]
    ds_read_b64_tr_b16 a[184:185], v241 offset:29312
    v_add_u32_e64 v209, v209, v243
    v_mfma_f32_16x16x32_bf16 v[196:199], a[188:191], v[76:79], v[196:199]
    ds_read_b64_tr_b16 a[186:187], v241 offset:29568
    buffer_load_dwordx4 v244, s[8:11], s66 offen offset:1024 lds
    v_mfma_f32_16x16x32_bf16 v[144:147], a[192:195], v[80:83], v[144:147]
    ds_read_b64_tr_b16 a[188:189], v241 offset:26752
    v_accvgpr_write_b32 a200, v209
    v_mfma_f32_16x16x32_bf16 v[148:151], a[192:195], v[84:87], v[148:151]
    ds_read_b64_tr_b16 a[190:191], v241 offset:27008
    s_waitcnt lgkmcnt(8)
    v_mfma_f32_16x16x32_bf16 v[152:155], a[196:199], v[80:83], v[152:155]
    ds_read_b64_tr_b16 a[192:193], v241 offset:26784
    v_add_u32 v209, 588800, v209
    v_mfma_f32_16x16x32_bf16 v[156:159], a[196:199], v[84:87], v[156:159]
    ds_read_b64_tr_b16 a[194:195], v241 offset:27040
    v_accvgpr_write_b32 a201, v209
    v_mfma_f32_16x16x32_bf16 v[160:163], a[168:171], v[80:83], v[160:163]
    ds_read_b64_tr_b16 a[196:197], v241 offset:27264
    v_add_u32 v209, 588800, v209
    v_mfma_f32_16x16x32_bf16 v[164:167], a[168:171], v[84:87], v[164:167]
    ds_read_b64_tr_b16 a[198:199], v241 offset:27520
    buffer_load_dwordx4 v245, s[8:11], s66 offen offset:2048 lds
    v_mfma_f32_16x16x32_bf16 v[168:171], a[172:175], v[80:83], v[168:171]
    ds_read_b64_tr_b16 a[168:169], v241 offset:27296
    s_add_u32 m0, s64, 24704
    v_mfma_f32_16x16x32_bf16 v[172:175], a[172:175], v[84:87], v[172:175]
    ds_read_b64_tr_b16 a[170:171], v241 offset:27552
    s_waitcnt lgkmcnt(8)
    v_mfma_f32_16x16x32_bf16 v[176:179], a[176:179], v[80:83], v[176:179]
    ds_read_b64_tr_b16 a[172:173], v241 offset:29824
    s_add_u32 s66, s59, s97
    v_mfma_f32_16x16x32_bf16 v[180:183], a[176:179], v[84:87], v[180:183]
    ds_read_b64_tr_b16 a[174:175], v241 offset:30080
    v_accvgpr_write_b32 a202, v209
    v_mfma_f32_16x16x32_bf16 v[184:187], a[180:183], v[80:83], v[184:187]
    ds_read_b64_tr_b16 a[176:177], v241 offset:29856
    s_and_b32 s45, s65, 1
    v_mfma_f32_16x16x32_bf16 v[188:191], a[180:183], v[84:87], v[188:191]
    ds_read_b64_tr_b16 a[178:179], v241 offset:30112
    buffer_load_dwordx4 v243, s[8:11], s66 offen offset:0 lds
    v_mfma_f32_16x16x32_bf16 v[192:195], a[184:187], v[80:83], v[192:195]
    ds_read_b64_tr_b16 a[180:181], v241 offset:30336
    s_xor_b32 s45, s45, 1
    v_mfma_f32_16x16x32_bf16 v[196:199], a[184:187], v[84:87], v[196:199]
    ds_read_b64_tr_b16 a[182:183], v241 offset:30592
L_w1:
    s_cbranch_execz L_wret0
    s_waitcnt lgkmcnt(8)
    v_mfma_f32_16x16x32_bf16 v[144:147], a[188:191], v[88:91], v[144:147]
    s_waitcnt vmcnt(13)
    s_barrier
    ds_read_b64_tr_b16 a[184:185], v242 offset:0
    v_mfma_f32_16x16x32_bf16 v[148:151], a[188:191], v[92:95], v[148:151]
    ds_read_b64_tr_b16 a[186:187], v242 offset:256
    v_xor_b32_e64 v211, s45, v213
    v_mfma_f32_16x16x32_bf16 v[152:155], a[192:195], v[88:91], v[152:155]
    ds_read_b64_tr_b16 a[188:189], v242 offset:32
    v_lshlrev_b32_e64 v211, 6, v211
    v_mfma_f32_16x16x32_bf16 v[156:159], a[192:195], v[92:95], v[156:159]
    ds_read_b64_tr_b16 a[190:191], v242 offset:288
    buffer_load_dwordx4 v244, s[8:11], s66 offen offset:1024 lds
    v_mfma_f32_16x16x32_bf16 v[160:163], a[196:199], v[88:91], v[160:163]
    ds_read_b64_tr_b16 a[192:193], v242 offset:512
    v_bfe_u32 v208, v254, 6, 2
    v_mfma_f32_16x16x32_bf16 v[164:167], a[196:199], v[92:95], v[164:167]
    ds_read_b64_tr_b16 a[194:195], v242 offset:768
    s_waitcnt lgkmcnt(8)
    v_mfma_f32_16x16x32_bf16 v[168:171], a[168:171], v[88:91], v[168:171]
    ds_read_b64_tr_b16 a[196:197], v242 offset:544
    v_bfe_u32 v209, v254, 8, 1
    v_mfma_f32_16x16x32_bf16 v[172:175], a[168:171], v[92:95], v[172:175]
    ds_read_b64_tr_b16 a[198:199], v242 offset:800
    v_xor_b32 v210, s57, v209
    v_mfma_f32_16x16x32_bf16 v[176:179], a[172:175], v[88:91], v[176:179]
    ds_read_b64_tr_b16 a[168:169], v242 offset:3072
    v_mul_u32_u24 v210, 36, v210
    v_mfma_f32_16x16x32_bf16 v[180:183], a[172:175], v[92:95], v[180:183]
    ds_read_b64_tr_b16 a[170:171], v242 offset:3328
    buffer_load_dwordx4 v245, s[8:11], s66 offen offset:2048 lds
    v_mfma_f32_16x16x32_bf16 v[184:187], a[176:179], v[88:91], v[184:187]
    ds_read_b64_tr_b16 a[172:173], v242 offset:3104
    s_add_u32 m0, s64, 27776
    v_mfma_f32_16x16x32_bf16 v[188:191], a[176:179], v[92:95], v[188:191]
    ds_read_b64_tr_b16 a[174:175], v242 offset:3360
    s_waitcnt lgkmcnt(8)
    v_mfma_f32_16x16x32_bf16 v[192:195], a[180:183], v[88:91], v[192:195]
    ds_read_b64_tr_b16 a[176:177], v242 offset:3584
    s_add_u32 s66, s66, 884736
    v_mfma_f32_16x16x32_bf16 v[196:199], a[180:183], v[92:95], v[196:199]
    ds_read_b64_tr_b16 a[178:179], v242 offset:3840
    v_add3_u32 v210, v210, v208, 16
    v_mfma_f32_16x16x32_bf16 v[144:147], a[184:187], v[96:99], v[144:147]
    ds_read_b64_tr_b16 a[180:181], v242 offset:1024
    v_mul_u32_u24 v210, 1152, v210
    v_mfma_f32_16x16x32_bf16 v[148:151], a[184:187], v[100:103], v[148:151]
    ds_read_b64_tr_b16 a[182:183], v242 offset:1280
    buffer_load_dwordx4 v243, s[8:11], s66 offen offset:0 lds
    v_mfma_f32_16x16x32_bf16 v[152:155], a[188:191], v[96:99], v[152:155]
    ds_read_b64_tr_b16 a[184:185], v242 offset:1056
    v_add_u32_e64 v210, v210, v212
    v_mfma_f32_16x16x32_bf16 v[156:159], a[188:191], v[100:103], v[156:159]
    ds_read_b64_tr_b16 a[186:187], v242 offset:1312
    s_waitcnt lgkmcnt(8)
    v_mfma_f32_16x16x32_bf16 v[160:163], a[192:195], v[96:99], v[160:163]
    ds_read_b64_tr_b16 a[188:189], v242 offset:1536
    v_accvgpr_write_b32 a208, v210
    v_mfma_f32_16x16x32_bf16 v[164:167], a[192:195], v[100:103], v[164:167]
    ds_read_b64_tr_b16 a[190:191], v242 offset:1792
    v_add_u32 v210, v210, v211
    v_mfma_f32_16x16x32_bf16 v[168:171], a[196:199], v[96:99], v[168:171]
    ds_read_b64_tr_b16 a[192:193], v242 offset:1568
    v_accvgpr_write_b32 a207, v210
    v_mfma_f32_16x16x32_bf16 v[172:175], a[196:199], v[100:103], v[172:175]
    ds_read_b64_tr_b16 a[194:195], v242 offset:1824
    buffer_load_dwordx4 v244, s[8:11], s66 offen offset:1024 lds
    v_mfma_f32_16x16x32_bf16 v[176:179], a[168:171], v[96:99], v[176:179]
    ds_read_b64_tr_b16 a[196:197], v242 offset:4096
    s_lshl_b32 s52, s56, 2
    v_mfma_f32_16x16x32_bf16 v[180:183], a[168:171], v[100:103], v[180:183]
    ds_read_b64_tr_b16 a[198:199], v242 offset:4352
    s_waitcnt lgkmcnt(8)
    v_mfma_f32_16x16x32_bf16 v[184:187], a[172:175], v[96:99], v[184:187]
    ds_read_b64_tr_b16 a[168:169], v242 offset:4128
    v_add_u32_e64 v208, s52, v208
    v_mfma_f32_16x16x32_bf16 v[188:191], a[172:175], v[100:103], v[188:191]
    ds_read_b64_tr_b16 a[170:171], v242 offset:4384
    v_mad_u32_u24 v210, v209, 16, v208
    v_mfma_f32_16x16x32_bf16 v[192:195], a[176:179], v[96:99], v[192:195]
    ds_read_b64_tr_b16 a[172:173], v242 offset:4608
    v_mul_u32_u24 v210, 1152, v210
    v_mfma_f32_16x16x32_bf16 v[196:199], a[176:179], v[100:103], v[196:199]
    ds_read_b64_tr_b16 a[174:175], v242 offset:4864
    buffer_load_dwordx4 v245, s[8:11], s66 offen offset:2048 lds
    v_mfma_f32_16x16x32_bf16 v[144:147], a[180:183], v[104:107], v[144:147]
    ds_read_b64_tr_b16 a[176:177], v242 offset:2048
    s_add_u32 m0, s64, 49408
    v_mfma_f32_16x16x32_bf16 v[148:151], a[180:183], v[108:111], v[148:151]
    ds_read_b64_tr_b16 a[178:179], v242 offset:2304
    s_waitcnt lgkmcnt(8)
    v_mfma_f32_16x16x32_bf16 v[152:155], a[184:187], v[104:107], v[152:155]
    ds_read_b64_tr_b16 a[180:181], v242 offset:2080
    s_add_u32 s66, s59, s98
    v_mfma_f32_16x16x32_bf16 v[156:159], a[184:187], v[108:111], v[156:159]
    ds_read_b64_tr_b16 a[182:183], v242 offset:2336
    v_add_u32_e64 v210, v210, v212
    v_mfma_f32_16x16x32_bf16 v[160:163], a[188:191], v[104:107], v[160:163]
    ds_read_b64_tr_b16 a[184:185], v242 offset:2560
    v_accvgpr_write_b32 a204, v210
    v_mfma_f32_16x16x32_bf16 v[164:167], a[188:191], v[108:111], v[164:167]
    ds_read_b64_tr_b16 a[186:187], v242 offset:2816
    buffer_load_dwordx4 v243, s[8:11], s66 offen offset:0 lds
    v_mfma_f32_16x16x32_bf16 v[168:171], a[192:195], v[104:107], v[168:171]
    ds_read_b64_tr_b16 a[188:189], v242 offset:2592
    v_add_u32_e64 v210, v210, v211
    v_mfma_f32_16x16x32_bf16 v[172:175], a[192:195], v[108:111], v[172:175]
    ds_read_b64_tr_b16 a[190:191], v242 offset:2848
    s_waitcnt lgkmcnt(8)
    v_mfma_f32_16x16x32_bf16 v[176:179], a[196:199], v[104:107], v[176:179]
    ds_read_b64_tr_b16 a[192:193], v242 offset:5120
    v_accvgpr_write_b32 a203, v210
    v_mfma_f32_16x16x32_bf16 v[180:183], a[196:199], v[108:111], v[180:183]
    ds_read_b64_tr_b16 a[194:195], v242 offset:5376
    v_mad_u32_u24 v210, v209, 20, v208
    v_mfma_f32_16x16x32_bf16 v[184:187], a[168:171], v[104:107], v[184:187]
    ds_read_b64_tr_b16 a[196:197], v242 offset:5152
    v_mul_u32_u24 v210, 1152, v210
    v_mfma_f32_16x16x32_bf16 v[188:191], a[168:171], v[108:111], v[188:191]
    ds_read_b64_tr_b16 a[198:199], v242 offset:5408
    buffer_load_dwordx4 v244, s[8:11], s66 offen offset:1024 lds
    v_mfma_f32_16x16x32_bf16 v[192:195], a[172:175], v[104:107], v[192:195]
    ds_read_b64_tr_b16 a[168:169], v242 offset:5632
    v_add_u32 v210, v210, v212
    v_mfma_f32_16x16x32_bf16 v[196:199], a[172:175], v[108:111], v[196:199]
    ds_read_b64_tr_b16 a[170:171], v242 offset:5888
    s_waitcnt lgkmcnt(8)
    v_mfma_f32_16x16x32_bf16 v[144:147], a[176:179], v[112:115], v[144:147]
    s_waitcnt vmcnt(14)
    s_barrier
    ds_read_b64_tr_b16 a[172:173], v242 offset:24704
    v_mfma_f32_16x16x32_bf16 v[148:151], a[176:179], v[116:119], v[148:151]
    ds_read_b64_tr_b16 a[174:175], v242 offset:24960
    v_accvgpr_write_b32 a206, v210
    v_mfma_f32_16x16x32_bf16 v[152:155], a[180:183], v[112:115], v[152:155]
    ds_read_b64_tr_b16 a[176:177], v242 offset:24736
    v_add_u32 v210, v210, v211
    v_mfma_f32_16x16x32_bf16 v[156:159], a[180:183], v[116:119], v[156:159]
    ds_read_b64_tr_b16 a[178:179], v242 offset:24992
    buffer_load_dwordx4 v245, s[8:11], s66 offen offset:2048 lds
    v_mfma_f32_16x16x32_bf16 v[160:163], a[184:187], v[112:115], v[160:163]
    ds_read_b64_tr_b16 a[180:181], v242 offset:25216
    s_add_u32 m0, s64, 52480
    v_mfma_f32_16x16x32_bf16 v[164:167], a[184:187], v[116:119], v[164:167]
    ds_read_b64_tr_b16 a[182:183], v242 offset:25472
    s_waitcnt lgkmcnt(8)
    v_mfma_f32_16x16x32_bf16 v[168:171], a[188:191], v[112:115], v[168:171]
    ds_read_b64_tr_b16 a[184:185], v242 offset:25248
    s_add_u32 s66, s66, 884736
    v_mfma_f32_16x16x32_bf16 v[172:175], a[188:191], v[116:119], v[172:175]
    ds_read_b64_tr_b16 a[186:187], v242 offset:25504
    v_accvgpr_write_b32 a205, v210
    v_mfma_f32_16x16x32_bf16 v[176:179], a[192:195], v[112:115], v[176:179]
    ds_read_b64_tr_b16 a[188:189], v242 offset:27776
    v_mfma_f32_16x16x32_bf16 v[180:183], a[192:195], v[116:119], v[180:183]
    ds_read_b64_tr_b16 a[190:191], v242 offset:28032
    buffer_load_dwordx4 v243, s[8:11], s66 offen offset:0 lds
    v_mfma_f32_16x16x32_bf16 v[184:187], a[196:199], v[112:115], v[184:187]
    ds_read_b64_tr_b16 a[192:193], v242 offset:27808
    v_mfma_f32_16x16x32_bf16 v[188:191], a[196:199], v[116:119], v[188:191]
    ds_read_b64_tr_b16 a[194:195], v242 offset:28064
    s_waitcnt lgkmcnt(8)
    v_mfma_f32_16x16x32_bf16 v[192:195], a[168:171], v[112:115], v[192:195]
    ds_read_b64_tr_b16 a[196:197], v242 offset:28288
    v_mfma_f32_16x16x32_bf16 v[196:199], a[168:171], v[116:119], v[196:199]
    ds_read_b64_tr_b16 a[198:199], v242 offset:28544
    v_mfma_f32_16x16x32_bf16 v[144:147], a[172:175], v[120:123], v[144:147]
    ds_read_b64_tr_b16 a[168:169], v242 offset:25728
    v_mfma_f32_16x16x32_bf16 v[148:151], a[172:175], v[124:127], v[148:151]
    ds_read_b64_tr_b16 a[170:171], v242 offset:25984
    buffer_load_dwordx4 v244, s[8:11], s66 offen offset:1024 lds
    v_mfma_f32_16x16x32_bf16 v[152:155], a[176:179], v[120:123], v[152:155]
    ds_read_b64_tr_b16 a[172:173], v242 offset:25760
    v_mfma_f32_16x16x32_bf16 v[156:159], a[176:179], v[124:127], v[156:159]
    ds_read_b64_tr_b16 a[174:175], v242 offset:26016
    s_waitcnt lgkmcnt(8)
    v_mfma_f32_16x16x32_bf16 v[160:163], a[180:183], v[120:123], v[160:163]
    ds_read_b64_tr_b16 a[176:177], v242 offset:26240
    v_mfma_f32_16x16x32_bf16 v[164:167], a[180:183], v[124:127], v[164:167]
    ds_read_b64_tr_b16 a[178:179], v242 offset:26496
    v_mfma_f32_16x16x32_bf16 v[168:171], a[184:187], v[120:123], v[168:171]
    ds_read_b64_tr_b16 a[180:181], v242 offset:26272
    v_mfma_f32_16x16x32_bf16 v[172:175], a[184:187], v[124:127], v[172:175]
    ds_read_b64_tr_b16 a[182:183], v242 offset:26528
    buffer_load_dwordx4 v245, s[8:11], s66 offen offset:2048 lds
    v_mfma_f32_16x16x32_bf16 v[176:179], a[188:191], v[120:123], v[176:179]
    ds_read_b64_tr_b16 a[184:185], v242 offset:28800
    s_add_u32 m0, s64, 74112
    v_mfma_f32_16x16x32_bf16 v[180:183], a[188:191], v[124:127], v[180:183]
    ds_read_b64_tr_b16 a[186:187], v242 offset:29056
    s_waitcnt lgkmcnt(8)
    v_mfma_f32_16x16x32_bf16 v[184:187], a[192:195], v[120:123], v[184:187]
    ds_read_b64_tr_b16 a[188:189], v242 offset:28832
    s_add_u32 s66, s59, s96
    v_mfma_f32_16x16x32_bf16 v[188:191], a[192:195], v[124:127], v[188:191]
    ds_read_b64_tr_b16 a[190:191], v242 offset:29088
    v_mfma_f32_16x16x32_bf16 v[192:195], a[196:199], v[120:123], v[192:195]
    ds_read_b64_tr_b16 a[192:193], v242 offset:29312
    v_mfma_f32_16x16x32_bf16 v[196:199], a[196:199], v[124:127], v[196:199]
    ds_read_b64_tr_b16 a[194:195], v242 offset:29568
    buffer_load_dwordx4 v243, s[12:15], s66 offen offset:0 lds
    v_mfma_f32_16x16x32_bf16 v[144:147], a[168:171], v[128:131], v[144:147]
    ds_read_b64_tr_b16 a[196:197], v242 offset:26752
    v_mfma_f32_16x16x32_bf16 v[148:151], a[168:171], v[132:135], v[148:151]
    ds_read_b64_tr_b16 a[198:199], v242 offset:27008
    s_waitcnt lgkmcnt(8)
    v_mfma_f32_16x16x32_bf16 v[152:155], a[172:175], v[128:131], v[152:155]
    ds_read_b64_tr_b16 a[168:169], v242 offset:26784
    v_mfma_f32_16x16x32_bf16 v[156:159], a[172:175], v[132:135], v[156:159]
    ds_read_b64_tr_b16 a[170:171], v242 offset:27040
    v_mfma_f32_16x16x32_bf16 v[160:163], a[176:179], v[128:131], v[160:163]
    ds_read_b64_tr_b16 a[172:173], v242 offset:27264
    v_mfma_f32_16x16x32_bf16 v[164:167], a[176:179], v[132:135], v[164:167]
    ds_read_b64_tr_b16 a[174:175], v242 offset:27520
    buffer_load_dwordx4 v244, s[12:15], s66 offen offset:1024 lds
    v_mfma_f32_16x16x32_bf16 v[168:171], a[180:183], v[128:131], v[168:171]
    ds_read_b64_tr_b16 a[176:177], v242 offset:27296
    v_mfma_f32_16x16x32_bf16 v[172:175], a[180:183], v[132:135], v[172:175]
    ds_read_b64_tr_b16 a[178:179], v242 offset:27552
    s_waitcnt lgkmcnt(8)
    v_mfma_f32_16x16x32_bf16 v[176:179], a[184:187], v[128:131], v[176:179]
    ds_read_b64_tr_b16 a[180:181], v242 offset:29824
    v_mfma_f32_16x16x32_bf16 v[180:183], a[184:187], v[132:135], v[180:183]
    ds_read_b64_tr_b16 a[182:183], v242 offset:30080
    v_mfma_f32_16x16x32_bf16 v[184:187], a[188:191], v[128:131], v[184:187]
    ds_read_b64_tr_b16 a[184:185], v242 offset:29856
    v_mfma_f32_16x16x32_bf16 v[188:191], a[188:191], v[132:135], v[188:191]
    ds_read_b64_tr_b16 a[186:187], v242 offset:30112
    buffer_load_dwordx4 v245, s[12:15], s66 offen offset:2048 lds
    v_mfma_f32_16x16x32_bf16 v[192:195], a[192:195], v[128:131], v[192:195]
    ds_read_b64_tr_b16 a[188:189], v242 offset:30336
    s_add_u32 m0, s64, 77184
    v_mfma_f32_16x16x32_bf16 v[196:199], a[192:195], v[132:135], v[196:199]
    ds_read_b64_tr_b16 a[190:191], v242 offset:30592
    s_waitcnt lgkmcnt(8)
    v_mfma_f32_16x16x32_bf16 v[144:147], a[196:199], v[136:139], v[144:147]
    s_waitcnt vmcnt(15)
    s_barrier
    ds_read_b64_tr_b16 a[192:193], v240 offset:0
    v_mfma_f32_16x16x32_bf16 v[148:151], a[196:199], v[140:143], v[148:151]
    ds_read_b64_tr_b16 a[194:195], v240 offset:256
    s_add_u32 s66, s66, 884736
    v_mfma_f32_16x16x32_bf16 v[152:155], a[168:171], v[136:139], v[152:155]
    ds_read_b64_tr_b16 a[196:197], v240 offset:32
    v_mfma_f32_16x16x32_bf16 v[156:159], a[168:171], v[140:143], v[156:159]
    ds_read_b64_tr_b16 a[198:199], v240 offset:288
    buffer_load_dwordx4 v243, s[12:15], s66 offen offset:0 lds
    v_mfma_f32_16x16x32_bf16 v[160:163], a[172:175], v[136:139], v[160:163]
    ds_read_b64_tr_b16 a[168:169], v240 offset:512
    v_mfma_f32_16x16x32_bf16 v[164:167], a[172:175], v[140:143], v[164:167]
    ds_read_b64_tr_b16 a[170:171], v240 offset:768
    s_waitcnt lgkmcnt(8)
    v_mfma_f32_16x16x32_bf16 v[168:171], a[176:179], v[136:139], v[168:171]
    ds_read_b64_tr_b16 a[172:173], v240 offset:544
    v_mfma_f32_16x16x32_bf16 v[172:175], a[176:179], v[140:143], v[172:175]
    ds_read_b64_tr_b16 a[174:175], v240 offset:800
    v_mfma_f32_16x16x32_bf16 v[176:179], a[180:183], v[136:139], v[176:179]
    ds_read_b64_tr_b16 a[176:177], v240 offset:1024
    v_mfma_f32_16x16x32_bf16 v[180:183], a[180:183], v[140:143], v[180:183]
    ds_read_b64_tr_b16 a[178:179], v240 offset:1280
    buffer_load_dwordx4 v244, s[12:15], s66 offen offset:1024 lds
    v_mfma_f32_16x16x32_bf16 v[184:187], a[184:187], v[136:139], v[184:187]
    ds_read_b64_tr_b16 a[180:181], v240 offset:1056
    v_mfma_f32_16x16x32_bf16 v[188:191], a[184:187], v[140:143], v[188:191]
    ds_read_b64_tr_b16 a[182:183], v240 offset:1312
    s_waitcnt lgkmcnt(8)
    v_mfma_f32_16x16x32_bf16 v[192:195], a[188:191], v[136:139], v[192:195]
    ds_read_b64_tr_b16 a[184:185], v240 offset:1536
    v_mfma_f32_16x16x32_bf16 v[196:199], a[188:191], v[140:143], v[196:199]
    ds_read_b64_tr_b16 a[186:187], v240 offset:1792
    v_mfma_f32_16x16x32_bf16 v[208:211], a[192:195], v[0:3], 0
    ds_read_b64_tr_b16 a[188:189], v240 offset:1568
    v_mfma_f32_16x16x32_bf16 v[212:215], a[192:195], v[4:7], 0
    ds_read_b64_tr_b16 a[190:191], v240 offset:1824
    buffer_load_dwordx4 v245, s[12:15], s66 offen offset:2048 lds
    v_mfma_f32_16x16x32_bf16 v[216:219], a[196:199], v[0:3], 0
    ds_read_b64_tr_b16 a[192:193], v240 offset:2048
    s_add_u32 m0, s64, 98816
    v_mfma_f32_16x16x32_bf16 v[220:223], a[196:199], v[4:7], 0
    ds_read_b64_tr_b16 a[194:195], v240 offset:2304
    s_waitcnt lgkmcnt(8)
    v_mfma_f32_16x16x32_bf16 v[224:227], a[168:171], v[0:3], 0
    ds_read_b64_tr_b16 a[196:197], v240 offset:2080
    s_add_u32 s66, s59, s97
    v_mfma_f32_16x16x32_bf16 v[228:231], a[168:171], v[4:7], 0
    ds_read_b64_tr_b16 a[198:199], v240 offset:2336
    v_accvgpr_read_b32 v249, a228
    v_mfma_f32_16x16x32_bf16 v[232:235], a[172:175], v[0:3], 0
    ds_read_b64_tr_b16 a[168:169], v240 offset:2560
    s_add_u32 s72, s54, 0
    v_mfma_f32_16x16x32_bf16 v[236:239], a[172:175], v[4:7], 0
    ds_read_b64_tr_b16 a[170:171], v240 offset:2816
    buffer_load_dwordx4 v243, s[12:15], s66 offen offset:0 lds
    v_mfma_f32_16x16x32_bf16 v[208:211], a[176:179], v[8:11], v[208:211]
    ds_read_b64_tr_b16 a[172:173], v240 offset:2592
    v_mul_f32 v144, v250, v144
    v_mfma_f32_16x16x32_bf16 v[212:215], a[176:179], v[12:15], v[212:215]
    ds_read_b64_tr_b16 a[174:175], v240 offset:2848
    s_waitcnt lgkmcnt(8)
    v_mfma_f32_16x16x32_bf16 v[216:219], a[180:183], v[8:11], v[216:219]
    ds_read_b64_tr_b16 a[176:177], v240 offset:3072
    v_mul_f32 v145, v250, v145
    v_mfma_f32_16x16x32_bf16 v[220:223], a[180:183], v[12:15], v[220:223]
    ds_read_b64_tr_b16 a[178:179], v240 offset:3328
    v_mul_f32_e64 v146, v250, v146
    v_mfma_f32_16x16x32_bf16 v[224:227], a[184:187], v[8:11], v[224:227]
    ds_read_b64_tr_b16 a[180:181], v240 offset:3104
    v_mul_f32_e64 v147, v250, v147
    v_mfma_f32_16x16x32_bf16 v[228:231], a[184:187], v[12:15], v[228:231]
    ds_read_b64_tr_b16 a[182:183], v240 offset:3360
    buffer_load_dwordx4 v244, s[12:15], s66 offen offset:1024 lds
    v_mfma_f32_16x16x32_bf16 v[232:235], a[188:191], v[8:11], v[232:235]
    ds_read_b64_tr_b16 a[184:185], v240 offset:3584
    v_cvt_pk_bf16_f32 v144, v144, v145
    v_mfma_f32_16x16x32_bf16 v[236:239], a[188:191], v[12:15], v[236:239]
    ds_read_b64_tr_b16 a[186:187], v240 offset:3840
    s_waitcnt lgkmcnt(8)
    v_mfma_f32_16x16x32_bf16 v[208:211], a[192:195], v[16:19], v[208:211]
    ds_read_b64_tr_b16 a[188:189], v240 offset:3616
    v_cvt_pk_bf16_f32 v145, v146, v147
    v_mfma_f32_16x16x32_bf16 v[212:215], a[192:195], v[20:23], v[212:215]
    ds_read_b64_tr_b16 a[190:191], v240 offset:3872
    buffer_store_dwordx2 v[144:145], v249, s[20:23], s72 offen offset:0 sc1
    v_mfma_f32_16x16x32_bf16 v[216:219], a[196:199], v[16:19], v[216:219]
    ds_read_b64_tr_b16 a[192:193], v240 offset:4096
    v_mul_f32 v148, v251, v148
    v_mfma_f32_16x16x32_bf16 v[220:223], a[196:199], v[20:23], v[220:223]
    ds_read_b64_tr_b16 a[194:195], v240 offset:4352
    buffer_load_dwordx4 v245, s[12:15], s66 offen offset:2048 lds
    v_mfma_f32_16x16x32_bf16 v[224:227], a[168:171], v[16:19], v[224:227]
    ds_read_b64_tr_b16 a[196:197], v240 offset:4128
    s_add_u32 m0, s64, 101888
    v_mfma_f32_16x16x32_bf16 v[228:231], a[168:171], v[20:23], v[228:231]
    ds_read_b64_tr_b16 a[198:199], v240 offset:4384
    s_waitcnt lgkmcnt(8)
    v_mfma_f32_16x16x32_bf16 v[232:235], a[172:175], v[16:19], v[232:235]
    ds_read_b64_tr_b16 a[168:169], v240 offset:4608
    s_add_u32 s66, s66, 884736
    v_mfma_f32_16x16x32_bf16 v[236:239], a[172:175], v[20:23], v[236:239]
    ds_read_b64_tr_b16 a[170:171], v240 offset:4864
    v_mul_f32 v149, v251, v149
    v_mfma_f32_16x16x32_bf16 v[208:211], a[176:179], v[24:27], v[208:211]
    ds_read_b64_tr_b16 a[172:173], v240 offset:4640
    v_mul_f32_e64 v150, v251, v150
    v_mfma_f32_16x16x32_bf16 v[212:215], a[176:179], v[28:31], v[212:215]
    ds_read_b64_tr_b16 a[174:175], v240 offset:4896
    buffer_load_dwordx4 v243, s[12:15], s66 offen offset:0 lds
    v_mfma_f32_16x16x32_bf16 v[216:219], a[180:183], v[24:27], v[216:219]
    ds_read_b64_tr_b16 a[176:177], v240 offset:5120
    v_mul_f32_e64 v151, v251, v151
    v_mfma_f32_16x16x32_bf16 v[220:223], a[180:183], v[28:31], v[220:223]
    ds_read_b64_tr_b16 a[178:179], v240 offset:5376
    s_waitcnt lgkmcnt(8)
    v_mfma_f32_16x16x32_bf16 v[224:227], a[184:187], v[24:27], v[224:227]
    ds_read_b64_tr_b16 a[180:181], v240 offset:5152
    v_cvt_pk_bf16_f32 v148, v148, v149
    v_mfma_f32_16x16x32_bf16 v[228:231], a[184:187], v[28:31], v[228:231]
    ds_read_b64_tr_b16 a[182:183], v240 offset:5408
    v_cvt_pk_bf16_f32 v149, v150, v151
    v_mfma_f32_16x16x32_bf16 v[232:235], a[188:191], v[24:27], v[232:235]
    ds_read_b64_tr_b16 a[184:185], v240 offset:5632
    buffer_store_dwordx2 v[148:149], v249, s[20:23], s72 offen offset:128 sc1
    v_mfma_f32_16x16x32_bf16 v[236:239], a[188:191], v[28:31], v[236:239]
    ds_read_b64_tr_b16 a[186:187], v240 offset:5888
    s_add_u32 s72, s54, 4096
    v_mfma_f32_16x16x32_bf16 v[208:211], a[192:195], v[32:35], v[208:211]
    ds_read_b64_tr_b16 a[188:189], v240 offset:5664
    buffer_load_dwordx4 v244, s[12:15], s66 offen offset:1024 lds
    v_mfma_f32_16x16x32_bf16 v[212:215], a[192:195], v[36:39], v[212:215]
    ds_read_b64_tr_b16 a[190:191], v240 offset:5920
    s_waitcnt lgkmcnt(8)
    v_mfma_f32_16x16x32_bf16 v[216:219], a[196:199], v[32:35], v[216:219]
    s_waitcnt vmcnt(19)
    s_barrier
    buffer_load_dword v207, off, s[32:35], 0 sc1
    ds_read_b64_tr_b16 a[192:193], v240 offset:24704
    v_mfma_f32_16x16x32_bf16 v[220:223], a[196:199], v[36:39], v[220:223]
    ds_read_b64_tr_b16 a[194:195], v240 offset:24960
    v_mul_f32_e64 v152, v250, v152
    v_mfma_f32_16x16x32_bf16 v[224:227], a[168:171], v[32:35], v[224:227]
    ds_read_b64_tr_b16 a[196:197], v240 offset:24736
    v_mul_f32_e64 v153, v250, v153
    v_mfma_f32_16x16x32_bf16 v[228:231], a[168:171], v[36:39], v[228:231]
    ds_read_b64_tr_b16 a[198:199], v240 offset:24992
    v_mul_f32_e64 v154, v250, v154
    v_mfma_f32_16x16x32_bf16 v[232:235], a[172:175], v[32:35], v[232:235]
    ds_read_b64_tr_b16 a[168:169], v240 offset:25216
    buffer_load_dwordx4 v245, s[12:15], s66 offen offset:2048 lds
    v_mfma_f32_16x16x32_bf16 v[236:239], a[172:175], v[36:39], v[236:239]
    ds_read_b64_tr_b16 a[170:171], v240 offset:25472
    s_waitcnt lgkmcnt(8)
    v_mfma_f32_16x16x32_bf16 v[208:211], a[176:179], v[40:43], v[208:211]
    ds_read_b64_tr_b16 a[172:173], v240 offset:25248
    s_add_u32 m0, s64, 123520
    v_mfma_f32_16x16x32_bf16 v[212:215], a[176:179], v[44:47], v[212:215]
    ds_read_b64_tr_b16 a[174:175], v240 offset:25504
    s_add_u32 s66, s59, s98
    v_mfma_f32_16x16x32_bf16 v[216:219], a[180:183], v[40:43], v[216:219]
    ds_read_b64_tr_b16 a[176:177], v240 offset:25728
    v_mul_f32_e64 v155, v250, v155
    v_mfma_f32_16x16x32_bf16 v[220:223], a[180:183], v[44:47], v[220:223]
    ds_read_b64_tr_b16 a[178:179], v240 offset:25984
    v_cvt_pk_bf16_f32 v152, v152, v153
    v_mfma_f32_16x16x32_bf16 v[224:227], a[184:187], v[40:43], v[224:227]
    ds_read_b64_tr_b16 a[180:181], v240 offset:25760
    buffer_load_dwordx4 v243, s[12:15], s66 offen offset:0 lds
    v_mfma_f32_16x16x32_bf16 v[228:231], a[184:187], v[44:47], v[228:231]
    ds_read_b64_tr_b16 a[182:183], v240 offset:26016
    s_waitcnt lgkmcnt(8)
    v_mfma_f32_16x16x32_bf16 v[232:235], a[188:191], v[40:43], v[232:235]
    ds_read_b64_tr_b16 a[184:185], v240 offset:26240
    v_cvt_pk_bf16_f32 v153, v154, v155
    v_mfma_f32_16x16x32_bf16 v[236:239], a[188:191], v[44:47], v[236:239]
    ds_read_b64_tr_b16 a[186:187], v240 offset:26496
    buffer_store_dwordx2 v[152:153], v249, s[20:23], s72 offen offset:0 sc1
    v_mfma_f32_16x16x32_bf16 v[208:211], a[192:195], v[48:51], v[208:211]
    ds_read_b64_tr_b16 a[188:189], v240 offset:26272
    v_mul_f32 v156, v251, v156
    v_mfma_f32_16x16x32_bf16 v[212:215], a[192:195], v[52:55], v[212:215]
    ds_read_b64_tr_b16 a[190:191], v240 offset:26528
    v_mul_f32_e64 v157, v251, v157
    v_mfma_f32_16x16x32_bf16 v[216:219], a[196:199], v[48:51], v[216:219]
    ds_read_b64_tr_b16 a[192:193], v240 offset:26752
    buffer_load_dwordx4 v244, s[12:15], s66 offen offset:1024 lds
    v_mfma_f32_16x16x32_bf16 v[220:223], a[196:199], v[52:55], v[220:223]
    ds_read_b64_tr_b16 a[194:195], v240 offset:27008
    s_waitcnt lgkmcnt(8)
    v_mfma_f32_16x16x32_bf16 v[224:227], a[168:171], v[48:51], v[224:227]
    ds_read_b64_tr_b16 a[196:197], v240 offset:26784
    v_mul_f32 v158, v251, v158
    v_mfma_f32_16x16x32_bf16 v[228:231], a[168:171], v[52:55], v[228:231]
    ds_read_b64_tr_b16 a[198:199], v240 offset:27040
    v_mul_f32_e64 v159, v251, v159
    v_mfma_f32_16x16x32_bf16 v[232:235], a[172:175], v[48:51], v[232:235]
    ds_read_b64_tr_b16 a[168:169], v240 offset:27264
    v_cvt_pk_bf16_f32 v156, v156, v157
    v_mfma_f32_16x16x32_bf16 v[236:239], a[172:175], v[52:55], v[236:239]
    ds_read_b64_tr_b16 a[170:171], v240 offset:27520
    v_cvt_pk_bf16_f32 v157, v158, v159
    v_mfma_f32_16x16x32_bf16 v[208:211], a[176:179], v[56:59], v[208:211]
    ds_read_b64_tr_b16 a[172:173], v240 offset:27296
    buffer_load_dwordx4 v245, s[12:15], s66 offen offset:2048 lds
    v_mfma_f32_16x16x32_bf16 v[212:215], a[176:179], v[60:63], v[212:215]
    ds_read_b64_tr_b16 a[174:175], v240 offset:27552
    s_waitcnt lgkmcnt(8)
    v_mfma_f32_16x16x32_bf16 v[216:219], a[180:183], v[56:59], v[216:219]
    ds_read_b64_tr_b16 a[176:177], v240 offset:27776
    s_add_u32 m0, s64, 126592
    v_mfma_f32_16x16x32_bf16 v[220:223], a[180:183], v[60:63], v[220:223]
    ds_read_b64_tr_b16 a[178:179], v240 offset:28032
    s_add_u32 s66, s66, 884736
    v_mfma_f32_16x16x32_bf16 v[224:227], a[184:187], v[56:59], v[224:227]
    ds_read_b64_tr_b16 a[180:181], v240 offset:27808
    buffer_store_dwordx2 v[156:157], v249, s[20:23], s72 offen offset:128 sc1
    v_mfma_f32_16x16x32_bf16 v[228:231], a[184:187], v[60:63], v[228:231]
    ds_read_b64_tr_b16 a[182:183], v240 offset:28064
    s_add_u32 s72, s54, 8192
    v_mfma_f32_16x16x32_bf16 v[232:235], a[188:191], v[56:59], v[232:235]
    ds_read_b64_tr_b16 a[184:185], v240 offset:28288
    buffer_load_dwordx4 v243, s[12:15], s66 offen offset:0 lds
    v_mfma_f32_16x16x32_bf16 v[236:239], a[188:191], v[60:63], v[236:239]
    ds_read_b64_tr_b16 a[186:187], v240 offset:28544
    s_waitcnt lgkmcnt(8)
    v_mfma_f32_16x16x32_bf16 v[208:211], a[192:195], v[64:67], v[208:211]
    ds_read_b64_tr_b16 a[188:189], v240 offset:28320
    v_mul_f32_e64 v160, v250, v160
    v_mfma_f32_16x16x32_bf16 v[212:215], a[192:195], v[68:71], v[212:215]
    ds_read_b64_tr_b16 a[190:191], v240 offset:28576
    v_mul_f32_e64 v161, v250, v161
    v_mfma_f32_16x16x32_bf16 v[216:219], a[196:199], v[64:67], v[216:219]
    ds_read_b64_tr_b16 a[192:193], v240 offset:28800
    v_mul_f32_e64 v162, v250, v162
    v_mfma_f32_16x16x32_bf16 v[220:223], a[196:199], v[68:71], v[220:223]
    ds_read_b64_tr_b16 a[194:195], v240 offset:29056
    v_mul_f32_e64 v163, v250, v163
    v_mfma_f32_16x16x32_bf16 v[224:227], a[168:171], v[64:67], v[224:227]
    ds_read_b64_tr_b16 a[196:197], v240 offset:28832
    buffer_load_dwordx4 v244, s[12:15], s66 offen offset:1024 lds
    v_mfma_f32_16x16x32_bf16 v[228:231], a[168:171], v[68:71], v[228:231]
    ds_read_b64_tr_b16 a[198:199], v240 offset:29088
    s_waitcnt lgkmcnt(8)
    v_mfma_f32_16x16x32_bf16 v[232:235], a[172:175], v[64:67], v[232:235]
    ds_read_b64_tr_b16 a[168:169], v240 offset:29312
    v_cvt_pk_bf16_f32 v160, v160, v161
    v_mfma_f32_16x16x32_bf16 v[236:239], a[172:175], v[68:71], v[236:239]
    ds_read_b64_tr_b16 a[170:171], v240 offset:29568
    v_cvt_pk_bf16_f32 v161, v162, v163
    v_mfma_f32_16x16x32_bf16 v[208:211], a[176:179], v[72:75], v[208:211]
    ds_read_b64_tr_b16 a[172:173], v240 offset:29344
    buffer_store_dwordx2 v[160:161], v249, s[20:23], s72 offen offset:0 sc1
    v_mfma_f32_16x16x32_bf16 v[212:215], a[176:179], v[76:79], v[212:215]
    ds_read_b64_tr_b16 a[174:175], v240 offset:29600
    v_mul_f32 v164, v251, v164
    v_mfma_f32_16x16x32_bf16 v[216:219], a[180:183], v[72:75], v[216:219]
    ds_read_b64_tr_b16 a[176:177], v240 offset:29824
    buffer_load_dwordx4 v245, s[12:15], s66 offen offset:2048 lds
    v_mfma_f32_16x16x32_bf16 v[220:223], a[180:183], v[76:79], v[220:223]
    ds_read_b64_tr_b16 a[178:179], v240 offset:30080
    s_waitcnt lgkmcnt(8)
    v_mfma_f32_16x16x32_bf16 v[224:227], a[184:187], v[72:75], v[224:227]
    ds_read_b64_tr_b16 a[180:181], v240 offset:29856
    v_mul_f32 v165, v251, v165
    v_mfma_f32_16x16x32_bf16 v[228:231], a[184:187], v[76:79], v[228:231]
    ds_read_b64_tr_b16 a[182:183], v240 offset:30112
    v_mul_f32_e64 v166, v251, v166
    v_mfma_f32_16x16x32_bf16 v[232:235], a[188:191], v[72:75], v[232:235]
    ds_read_b64_tr_b16 a[184:185], v240 offset:30336
    v_mul_f32_e64 v167, v251, v167
    v_mfma_f32_16x16x32_bf16 v[236:239], a[188:191], v[76:79], v[236:239]
    ds_read_b64_tr_b16 a[186:187], v240 offset:30592
    v_cvt_pk_bf16_f32 v164, v164, v165
    v_mfma_f32_16x16x32_bf16 v[208:211], a[192:195], v[80:83], v[208:211]
    ds_read_b64_tr_b16 a[188:189], v240 offset:30368
    v_cvt_pk_bf16_f32 v165, v166, v167
    v_mfma_f32_16x16x32_bf16 v[212:215], a[192:195], v[84:87], v[212:215]
    ds_read_b64_tr_b16 a[190:191], v240 offset:30624
    s_waitcnt lgkmcnt(8)
    v_mfma_f32_16x16x32_bf16 v[216:219], a[196:199], v[80:83], v[216:219]
    s_waitcnt vmcnt(24)
    s_barrier
    ds_read_b64_tr_b16 a[192:193], v241 offset:0
    v_mfma_f32_16x16x32_bf16 v[220:223], a[196:199], v[84:87], v[220:223]
    ds_read_b64_tr_b16 a[194:195], v241 offset:256
    s_add_u32 m0, s64, 0
    v_mfma_f32_16x16x32_bf16 v[224:227], a[168:171], v[80:83], v[224:227]
    ds_read_b64_tr_b16 a[196:197], v241 offset:32
    s_add_u32 s66, s60, s96
    v_mfma_f32_16x16x32_bf16 v[228:231], a[168:171], v[84:87], v[228:231]
    ds_read_b64_tr_b16 a[198:199], v241 offset:288
    buffer_load_dwordx4 v243, s[8:11], s66 offen offset:0 lds
    v_mfma_f32_16x16x32_bf16 v[232:235], a[172:175], v[80:83], v[232:235]
    ds_read_b64_tr_b16 a[168:169], v241 offset:512
    v_mfma_f32_16x16x32_bf16 v[236:239], a[172:175], v[84:87], v[236:239]
    ds_read_b64_tr_b16 a[170:171], v241 offset:768
    s_waitcnt lgkmcnt(8)
    v_mfma_f32_16x16x32_bf16 v[208:211], a[176:179], v[88:91], v[208:211]
    ds_read_b64_tr_b16 a[172:173], v241 offset:544
    buffer_store_dwordx2 v[164:165], v249, s[20:23], s72 offen offset:128 sc1
    v_mfma_f32_16x16x32_bf16 v[212:215], a[176:179], v[92:95], v[212:215]
    ds_read_b64_tr_b16 a[174:175], v241 offset:800
    s_add_u32 s72, s54, 12288
    v_mfma_f32_16x16x32_bf16 v[216:219], a[180:183], v[88:91], v[216:219]
    ds_read_b64_tr_b16 a[176:177], v241 offset:1024
L_w2:
    s_cbranch_execz L_wret0
    v_mul_f32_e64 v168, v250, v168
    v_mfma_f32_16x16x32_bf16 v[220:223], a[180:183], v[92:95], v[220:223]
    ds_read_b64_tr_b16 a[178:179], v241 offset:1280
    buffer_load_dwordx4 v244, s[8:11], s66 offen offset:1024 lds
    v_mfma_f32_16x16x32_bf16 v[224:227], a[184:187], v[88:91], v[224:227]
    ds_read_b64_tr_b16 a[180:181], v241 offset:1056
    v_mul_f32_e64 v169, v250, v169
    v_mfma_f32_16x16x32_bf16 v[228:231], a[184:187], v[92:95], v[228:231]
    ds_read_b64_tr_b16 a[182:183], v241 offset:1312
    s_waitcnt lgkmcnt(8)
    v_mfma_f32_16x16x32_bf16 v[232:235], a[188:191], v[88:91], v[232:235]
    ds_read_b64_tr_b16 a[184:185], v241 offset:1536
    v_mul_f32 v170, v250, v170
    v_mfma_f32_16x16x32_bf16 v[236:239], a[188:191], v[92:95], v[236:239]
    ds_read_b64_tr_b16 a[186:187], v241 offset:1792
    v_mul_f32_e64 v171, v250, v171
    v_mfma_f32_16x16x32_bf16 v[208:211], a[192:195], v[96:99], v[208:211]
    ds_read_b64_tr_b16 a[188:189], v241 offset:1568
    v_cvt_pk_bf16_f32 v168, v168, v169
    v_mfma_f32_16x16x32_bf16 v[212:215], a[192:195], v[100:103], v[212:215]
    ds_read_b64_tr_b16 a[190:191], v241 offset:1824
    buffer_load_dwordx4 v245, s[8:11], s66 offen offset:2048 lds
    v_mfma_f32_16x16x32_bf16 v[216:219], a[196:199], v[96:99], v[216:219]
    ds_read_b64_tr_b16 a[192:193], v241 offset:2048
    s_add_u32 m0, s64, 3072
    v_mfma_f32_16x16x32_bf16 v[220:223], a[196:199], v[100:103], v[220:223]
    ds_read_b64_tr_b16 a[194:195], v241 offset:2304
    s_waitcnt lgkmcnt(8)
    v_mfma_f32_16x16x32_bf16 v[224:227], a[168:171], v[96:99], v[224:227]
    ds_read_b64_tr_b16 a[196:197], v241 offset:2080
    s_add_u32 s66, s66, 884736
    v_mfma_f32_16x16x32_bf16 v[228:231], a[168:171], v[100:103], v[228:231]
    ds_read_b64_tr_b16 a[198:199], v241 offset:2336
    v_cvt_pk_bf16_f32 v169, v170, v171
    v_mfma_f32_16x16x32_bf16 v[232:235], a[172:175], v[96:99], v[232:235]
    ds_read_b64_tr_b16 a[168:169], v241 offset:2560
    buffer_store_dwordx2 v[168:169], v249, s[20:23], s72 offen offset:0 sc1
    v_mfma_f32_16x16x32_bf16 v[236:239], a[172:175], v[100:103], v[236:239]
    ds_read_b64_tr_b16 a[170:171], v241 offset:2816
    v_mul_f32 v172, v251, v172
    v_mfma_f32_16x16x32_bf16 v[208:211], a[176:179], v[104:107], v[208:211]
    ds_read_b64_tr_b16 a[172:173], v241 offset:2592
    buffer_load_dwordx4 v243, s[8:11], s66 offen offset:0 lds
    v_mfma_f32_16x16x32_bf16 v[212:215], a[176:179], v[108:111], v[212:215]
    ds_read_b64_tr_b16 a[174:175], v241 offset:2848
    s_waitcnt lgkmcnt(8)
    v_mfma_f32_16x16x32_bf16 v[216:219], a[180:183], v[104:107], v[216:219]
    ds_read_b64_tr_b16 a[176:177], v241 offset:3072
    v_mul_f32 v173, v251, v173
    v_mfma_f32_16x16x32_bf16 v[220:223], a[180:183], v[108:111], v[220:223]
    ds_read_b64_tr_b16 a[178:179], v241 offset:3328
    v_mul_f32_e64 v174, v251, v174
    v_mfma_f32_16x16x32_bf16 v[224:227], a[184:187], v[104:107], v[224:227]
    ds_read_b64_tr_b16 a[180:181], v241 offset:3104
    v_mul_f32_e64 v175, v251, v175
    v_mfma_f32_16x16x32_bf16 v[228:231], a[184:187], v[108:111], v[228:231]
    ds_read_b64_tr_b16 a[182:183], v241 offset:3360
    v_cvt_pk_bf16_f32 v172, v172, v173
    v_mfma_f32_16x16x32_bf16 v[232:235], a[188:191], v[104:107], v[232:235]
    ds_read_b64_tr_b16 a[184:185], v241 offset:3584
    buffer_load_dwordx4 v244, s[8:11], s66 offen offset:1024 lds
    v_mfma_f32_16x16x32_bf16 v[236:239], a[188:191], v[108:111], v[236:239]
    ds_read_b64_tr_b16 a[186:187], v241 offset:3840
    s_waitcnt lgkmcnt(8)
    v_mfma_f32_16x16x32_bf16 v[208:211], a[192:195], v[112:115], v[208:211]
    ds_read_b64_tr_b16 a[188:189], v241 offset:3616
    v_cvt_pk_bf16_f32 v173, v174, v175
    v_mfma_f32_16x16x32_bf16 v[212:215], a[192:195], v[116:119], v[212:215]
    ds_read_b64_tr_b16 a[190:191], v241 offset:3872
    buffer_store_dwordx2 v[172:173], v249, s[20:23], s72 offen offset:128 sc1
    v_mfma_f32_16x16x32_bf16 v[216:219], a[196:199], v[112:115], v[216:219]
    ds_read_b64_tr_b16 a[192:193], v241 offset:4096
    s_add_u32 s72, s54, 16384
    v_mfma_f32_16x16x32_bf16 v[220:223], a[196:199], v[116:119], v[220:223]
    ds_read_b64_tr_b16 a[194:195], v241 offset:4352
    v_mul_f32 v176, v250, v176
    v_mfma_f32_16x16x32_bf16 v[224:227], a[168:171], v[112:115], v[224:227]
    ds_read_b64_tr_b16 a[196:197], v241 offset:4128
    buffer_load_dwordx4 v245, s[8:11], s66 offen offset:2048 lds
    v_mfma_f32_16x16x32_bf16 v[228:231], a[168:171], v[116:119], v[228:231]
    ds_read_b64_tr_b16 a[198:199], v241 offset:4384
    s_waitcnt lgkmcnt(8)
    v_mfma_f32_16x16x32_bf16 v[232:235], a[172:175], v[112:115], v[232:235]
    ds_read_b64_tr_b16 a[168:169], v241 offset:4608
    v_mul_f32 v177, v250, v177
    v_mfma_f32_16x16x32_bf16 v[236:239], a[172:175], v[116:119], v[236:239]
    ds_read_b64_tr_b16 a[170:171], v241 offset:4864
    v_mul_f32_e64 v178, v250, v178
    v_mfma_f32_16x16x32_bf16 v[208:211], a[176:179], v[120:123], v[208:211]
    ds_read_b64_tr_b16 a[172:173], v241 offset:4640
    v_mul_f32_e64 v179, v250, v179
    v_mfma_f32_16x16x32_bf16 v[212:215], a[176:179], v[124:127], v[212:215]
    ds_read_b64_tr_b16 a[174:175], v241 offset:4896
    v_cvt_pk_bf16_f32 v176, v176, v177
    v_mfma_f32_16x16x32_bf16 v[216:219], a[180:183], v[120:123], v[216:219]
    ds_read_b64_tr_b16 a[176:177], v241 offset:5120
    v_cvt_pk_bf16_f32 v177, v178, v179
    v_mfma_f32_16x16x32_bf16 v[220:223], a[180:183], v[124:127], v[220:223]
    ds_read_b64_tr_b16 a[178:179], v241 offset:5376
    s_waitcnt lgkmcnt(8)
    v_mfma_f32_16x16x32_bf16 v[224:227], a[184:187], v[120:123], v[224:227]
    ds_read_b64_tr_b16 a[180:181], v241 offset:5152
    buffer_store_dwordx2 v[176:177], v249, s[20:23], s72 offen offset:0 sc1
    v_mfma_f32_16x16x32_bf16 v[228:231], a[184:187], v[124:127], v[228:231]
    ds_read_b64_tr_b16 a[182:183], v241 offset:5408
    v_mul_f32 v180, v251, v180
    v_mfma_f32_16x16x32_bf16 v[232:235], a[188:191], v[120:123], v[232:235]
    ds_read_b64_tr_b16 a[184:185], v241 offset:5632
    v_mul_f32_e64 v181, v251, v181
    v_mfma_f32_16x16x32_bf16 v[236:239], a[188:191], v[124:127], v[236:239]
    ds_read_b64_tr_b16 a[186:187], v241 offset:5888
    v_mul_f32_e64 v182, v251, v182
    v_mfma_f32_16x16x32_bf16 v[208:211], a[192:195], v[128:131], v[208:211]
    ds_read_b64_tr_b16 a[188:189], v241 offset:5664
    v_mul_f32_e64 v183, v251, v183
    v_mfma_f32_16x16x32_bf16 v[212:215], a[192:195], v[132:135], v[212:215]
    ds_read_b64_tr_b16 a[190:191], v241 offset:5920
    s_waitcnt lgkmcnt(8)
    v_mfma_f32_16x16x32_bf16 v[216:219], a[196:199], v[128:131], v[216:219]
    s_waitcnt vmcnt(28)
    s_barrier
    ds_read_b64_tr_b16 a[192:193], v241 offset:24704
    v_mfma_f32_16x16x32_bf16 v[220:223], a[196:199], v[132:135], v[220:223]
    ds_read_b64_tr_b16 a[194:195], v241 offset:24960
    s_add_u32 m0, s64, 24704
    v_mfma_f32_16x16x32_bf16 v[224:227], a[168:171], v[128:131], v[224:227]
    ds_read_b64_tr_b16 a[196:197], v241 offset:24736
    s_add_u32 s66, s60, s97
    v_mfma_f32_16x16x32_bf16 v[228:231], a[168:171], v[132:135], v[228:231]
    ds_read_b64_tr_b16 a[198:199], v241 offset:24992
    buffer_load_dwordx4 v243, s[8:11], s66 offen offset:0 lds
    v_mfma_f32_16x16x32_bf16 v[232:235], a[172:175], v[128:131], v[232:235]
    ds_read_b64_tr_b16 a[168:169], v241 offset:25216
    v_cvt_pk_bf16_f32 v180, v180, v181
    v_mfma_f32_16x16x32_bf16 v[236:239], a[172:175], v[132:135], v[236:239]
    ds_read_b64_tr_b16 a[170:171], v241 offset:25472
    s_waitcnt lgkmcnt(8)
    v_mfma_f32_16x16x32_bf16 v[208:211], a[176:179], v[136:139], v[208:211]
    ds_read_b64_tr_b16 a[172:173], v241 offset:25248
    v_cvt_pk_bf16_f32 v181, v182, v183
    v_mfma_f32_16x16x32_bf16 v[212:215], a[176:179], v[140:143], v[212:215]
    ds_read_b64_tr_b16 a[174:175], v241 offset:25504
    buffer_store_dwordx2 v[180:181], v249, s[20:23], s72 offen offset:128 sc1
    v_mfma_f32_16x16x32_bf16 v[216:219], a[180:183], v[136:139], v[216:219]
    ds_read_b64_tr_b16 a[176:177], v241 offset:25728
    s_add_u32 s72, s54, 20480
    v_mfma_f32_16x16x32_bf16 v[220:223], a[180:183], v[140:143], v[220:223]
    ds_read_b64_tr_b16 a[178:179], v241 offset:25984
    buffer_load_dwordx4 v244, s[8:11], s66 offen offset:1024 lds
    v_mfma_f32_16x16x32_bf16 v[224:227], a[184:187], v[136:139], v[224:227]
    ds_read_b64_tr_b16 a[180:181], v241 offset:25760
    v_mul_f32 v184, v250, v184
    v_mfma_f32_16x16x32_bf16 v[228:231], a[184:187], v[140:143], v[228:231]
    ds_read_b64_tr_b16 a[182:183], v241 offset:26016
    s_waitcnt lgkmcnt(8)
    v_mfma_f32_16x16x32_bf16 v[232:235], a[188:191], v[136:139], v[232:235]
    ds_read_b64_tr_b16 a[184:185], v241 offset:26240
    v_mul_f32 v185, v250, v185
    v_mfma_f32_16x16x32_bf16 v[236:239], a[188:191], v[140:143], v[236:239]
    ds_read_b64_tr_b16 a[186:187], v241 offset:26496
    v_mul_f32_e64 v186, v250, v186
    v_mfma_f32_16x16x32_bf16 v[144:147], a[192:195], v[0:3], 0
    ds_read_b64_tr_b16 a[188:189], v241 offset:26272
    v_mul_f32_e64 v187, v250, v187
    v_mfma_f32_16x16x32_bf16 v[148:151], a[192:195], v[4:7], 0
    ds_read_b64_tr_b16 a[190:191], v241 offset:26528
    buffer_load_dwordx4 v245, s[8:11], s66 offen offset:2048 lds
    v_mfma_f32_16x16x32_bf16 v[152:155], a[196:199], v[0:3], 0
    ds_read_b64_tr_b16 a[192:193], v241 offset:26752
    s_add_u32 m0, s64, 27776
    v_mfma_f32_16x16x32_bf16 v[156:159], a[196:199], v[4:7], 0
    ds_read_b64_tr_b16 a[194:195], v241 offset:27008
    s_waitcnt lgkmcnt(8)
    v_mfma_f32_16x16x32_bf16 v[160:163], a[168:171], v[0:3], 0
    ds_read_b64_tr_b16 a[196:197], v241 offset:26784
    s_add_u32 s66, s66, 884736
    v_mfma_f32_16x16x32_bf16 v[164:167], a[168:171], v[4:7], 0
    ds_read_b64_tr_b16 a[198:199], v241 offset:27040
    v_cvt_pk_bf16_f32 v184, v184, v185
    v_mfma_f32_16x16x32_bf16 v[168:171], a[172:175], v[0:3], 0
    ds_read_b64_tr_b16 a[168:169], v241 offset:27264
    v_cvt_pk_bf16_f32 v185, v186, v187
    v_mfma_f32_16x16x32_bf16 v[172:175], a[172:175], v[4:7], 0
    ds_read_b64_tr_b16 a[170:171], v241 offset:27520
    buffer_load_dwordx4 v243, s[8:11], s66 offen offset:0 lds
    v_mfma_f32_16x16x32_bf16 v[144:147], a[176:179], v[8:11], v[144:147]
    ds_read_b64_tr_b16 a[172:173], v241 offset:27296
    v_bfe_u32 v200, v254, 6, 2
    v_mfma_f32_16x16x32_bf16 v[148:151], a[176:179], v[12:15], v[148:151]
    ds_read_b64_tr_b16 a[174:175], v241 offset:27552
    s_waitcnt lgkmcnt(8)
    v_mfma_f32_16x16x32_bf16 v[152:155], a[180:183], v[8:11], v[152:155]
    ds_read_b64_tr_b16 a[176:177], v241 offset:27776
    buffer_store_dwordx2 v[184:185], v249, s[20:23], s72 offen offset:0 sc1
    v_mfma_f32_16x16x32_bf16 v[156:159], a[180:183], v[12:15], v[156:159]
    ds_read_b64_tr_b16 a[178:179], v241 offset:28032
    v_mul_f32_e64 v188, v251, v188
    v_mfma_f32_16x16x32_bf16 v[160:163], a[184:187], v[8:11], v[160:163]
    ds_read_b64_tr_b16 a[180:181], v241 offset:27808
    v_mul_f32_e64 v189, v251, v189
    v_mfma_f32_16x16x32_bf16 v[164:167], a[184:187], v[12:15], v[164:167]
    ds_read_b64_tr_b16 a[182:183], v241 offset:28064
    buffer_load_dwordx4 v244, s[8:11], s66 offen offset:1024 lds
    v_mfma_f32_16x16x32_bf16 v[168:171], a[188:191], v[8:11], v[168:171]
    ds_read_b64_tr_b16 a[184:185], v241 offset:28288
    v_mul_f32_e64 v190, v251, v190
    v_mfma_f32_16x16x32_bf16 v[172:175], a[188:191], v[12:15], v[172:175]
    ds_read_b64_tr_b16 a[186:187], v241 offset:28544
    s_waitcnt lgkmcnt(8)
    v_mfma_f32_16x16x32_bf16 v[144:147], a[192:195], v[16:19], v[144:147]
    ds_read_b64_tr_b16 a[188:189], v241 offset:28320
    v_mul_f32 v191, v251, v191
    v_mfma_f32_16x16x32_bf16 v[148:151], a[192:195], v[20:23], v[148:151]
    ds_read_b64_tr_b16 a[190:191], v241 offset:28576
    v_cvt_pk_bf16_f32 v188, v188, v189
    v_mfma_f32_16x16x32_bf16 v[152:155], a[196:199], v[16:19], v[152:155]
    ds_read_b64_tr_b16 a[192:193], v241 offset:28800
    v_cvt_pk_bf16_f32 v189, v190, v191
    v_mfma_f32_16x16x32_bf16 v[156:159], a[196:199], v[20:23], v[156:159]
    ds_read_b64_tr_b16 a[194:195], v241 offset:29056
    buffer_load_dwordx4 v245, s[8:11], s66 offen offset:2048 lds
    v_mfma_f32_16x16x32_bf16 v[160:163], a[168:171], v[16:19], v[160:163]
    ds_read_b64_tr_b16 a[196:197], v241 offset:28832
    v_min_u32 v200, 2, v200
    v_mfma_f32_16x16x32_bf16 v[164:167], a[168:171], v[20:23], v[164:167]
    ds_read_b64_tr_b16 a[198:199], v241 offset:29088
    s_waitcnt lgkmcnt(8)
    v_mfma_f32_16x16x32_bf16 v[168:171], a[172:175], v[16:19], v[168:171]
    ds_read_b64_tr_b16 a[168:169], v241 offset:29312
    buffer_store_dwordx2 v[188:189], v249, s[20:23], s72 offen offset:128 sc1
    v_mfma_f32_16x16x32_bf16 v[172:175], a[172:175], v[20:23], v[172:175]
    ds_read_b64_tr_b16 a[170:171], v241 offset:29568
    v_accvgpr_read_b32 v249, a229
    v_mfma_f32_16x16x32_bf16 v[144:147], a[176:179], v[24:27], v[144:147]
    ds_read_b64_tr_b16 a[172:173], v241 offset:29344
    s_add_u32 s72, s54, 24576
    v_mfma_f32_16x16x32_bf16 v[148:151], a[176:179], v[28:31], v[148:151]
    ds_read_b64_tr_b16 a[174:175], v241 offset:29600
    v_mul_f32_e64 v192, v250, v192
    v_mfma_f32_16x16x32_bf16 v[152:155], a[180:183], v[24:27], v[152:155]
    ds_read_b64_tr_b16 a[176:177], v241 offset:29824
    v_mul_f32_e64 v193, v250, v193
    v_mfma_f32_16x16x32_bf16 v[156:159], a[180:183], v[28:31], v[156:159]
    ds_read_b64_tr_b16 a[178:179], v241 offset:30080
    s_waitcnt lgkmcnt(8)
    v_mfma_f32_16x16x32_bf16 v[160:163], a[184:187], v[24:27], v[160:163]
    ds_read_b64_tr_b16 a[180:181], v241 offset:29856
    v_mul_f32 v194, v250, v194
    v_mfma_f32_16x16x32_bf16 v[164:167], a[184:187], v[28:31], v[164:167]
    ds_read_b64_tr_b16 a[182:183], v241 offset:30112
    v_mul_f32_e64 v195, v250, v195
    v_mfma_f32_16x16x32_bf16 v[168:171], a[188:191], v[24:27], v[168:171]
    ds_read_b64_tr_b16 a[184:185], v241 offset:30336
    v_cvt_pk_bf16_f32 v192, v192, v193
    v_mfma_f32_16x16x32_bf16 v[172:175], a[188:191], v[28:31], v[172:175]
    ds_read_b64_tr_b16 a[186:187], v241 offset:30592
    v_cvt_pk_bf16_f32 v193, v194, v195
    v_mfma_f32_16x16x32_bf16 v[144:147], a[192:195], v[32:35], v[144:147]
    ds_read_b64_tr_b16 a[188:189], v241 offset:30368
    buffer_store_dwordx2 v[192:193], v249, s[20:23], s72 offen offset:0 sc1
    v_mfma_f32_16x16x32_bf16 v[148:151], a[192:195], v[36:39], v[148:151]
    ds_read_b64_tr_b16 a[190:191], v241 offset:30624
    s_waitcnt lgkmcnt(8)
    v_mfma_f32_16x16x32_bf16 v[152:155], a[196:199], v[32:35], v[152:155]
    s_waitcnt vmcnt(29)
    s_barrier
L_tagchk:
    v_readfirstlane_b32 s51, v207
    s_nop 0
    s_cmp_eq_u32 s51, 0
    s_cbranch_scc1 L_tagspin
L_tagok:
    ds_read_b64_tr_b16 a[192:193], v242 offset:0
    v_mfma_f32_16x16x32_bf16 v[156:159], a[196:199], v[36:39], v[156:159]
    ds_read_b64_tr_b16 a[194:195], v242 offset:256
    s_add_u32 m0, s64, 49408
    v_mfma_f32_16x16x32_bf16 v[160:163], a[168:171], v[32:35], v[160:163]
    ds_read_b64_tr_b16 a[196:197], v242 offset:32
    s_add_u32 s66, s60, s98
    v_mfma_f32_16x16x32_bf16 v[164:167], a[168:171], v[36:39], v[164:167]
    ds_read_b64_tr_b16 a[198:199], v242 offset:288
    buffer_load_dwordx4 v243, s[8:11], s66 offen offset:0 lds
    v_mfma_f32_16x16x32_bf16 v[168:171], a[172:175], v[32:35], v[168:171]
    ds_read_b64_tr_b16 a[168:169], v242 offset:512
    v_mul_f32_e64 v196, v251, v196
    v_mfma_f32_16x16x32_bf16 v[172:175], a[172:175], v[36:39], v[172:175]
    ds_read_b64_tr_b16 a[170:171], v242 offset:768
    s_waitcnt lgkmcnt(8)
    v_mfma_f32_16x16x32_bf16 v[144:147], a[176:179], v[40:43], v[144:147]
    ds_read_b64_tr_b16 a[172:173], v242 offset:544
    v_mul_f32 v197, v251, v197
    v_mfma_f32_16x16x32_bf16 v[148:151], a[176:179], v[44:47], v[148:151]
    ds_read_b64_tr_b16 a[174:175], v242 offset:800
    v_mul_f32_e64 v198, v251, v198
    v_mfma_f32_16x16x32_bf16 v[152:155], a[180:183], v[40:43], v[152:155]
    ds_read_b64_tr_b16 a[176:177], v242 offset:1024
    v_mul_f32_e64 v199, v251, v199
    v_mfma_f32_16x16x32_bf16 v[156:159], a[180:183], v[44:47], v[156:159]
    ds_read_b64_tr_b16 a[178:179], v242 offset:1280
    buffer_load_dwordx4 v244, s[8:11], s66 offen offset:1024 lds
    v_mfma_f32_16x16x32_bf16 v[160:163], a[184:187], v[40:43], v[160:163]
    ds_read_b64_tr_b16 a[180:181], v242 offset:1056
    v_cvt_pk_bf16_f32 v196, v196, v197
    v_mfma_f32_16x16x32_bf16 v[164:167], a[184:187], v[44:47], v[164:167]
    ds_read_b64_tr_b16 a[182:183], v242 offset:1312
    s_waitcnt lgkmcnt(8)
    v_mfma_f32_16x16x32_bf16 v[168:171], a[188:191], v[40:43], v[168:171]
    ds_read_b64_tr_b16 a[184:185], v242 offset:1536
    v_cvt_pk_bf16_f32 v197, v198, v199
    v_mfma_f32_16x16x32_bf16 v[172:175], a[188:191], v[44:47], v[172:175]
    ds_read_b64_tr_b16 a[186:187], v242 offset:1792
    buffer_store_dwordx2 v[196:197], v249, s[20:23], s72 offen offset:128 sc1
    v_mfma_f32_16x16x32_bf16 v[144:147], a[192:195], v[48:51], v[144:147]
    ds_read_b64_tr_b16 a[188:189], v242 offset:1568
    v_mul_f32 v208, v252, v208
    v_mfma_f32_16x16x32_bf16 v[148:151], a[192:195], v[52:55], v[148:151]
    ds_read_b64_tr_b16 a[190:191], v242 offset:1824
    buffer_load_dwordx4 v245, s[8:11], s66 offen offset:2048 lds
    v_mfma_f32_16x16x32_bf16 v[152:155], a[196:199], v[48:51], v[152:155]
    ds_read_b64_tr_b16 a[192:193], v242 offset:2048
    s_add_u32 m0, s64, 52480
    v_mfma_f32_16x16x32_bf16 v[156:159], a[196:199], v[52:55], v[156:159]
    ds_read_b64_tr_b16 a[194:195], v242 offset:2304
    s_waitcnt lgkmcnt(8)
    v_mfma_f32_16x16x32_bf16 v[160:163], a[168:171], v[48:51], v[160:163]
    ds_read_b64_tr_b16 a[196:197], v242 offset:2080
    s_add_u32 s66, s66, 884736
    v_mfma_f32_16x16x32_bf16 v[164:167], a[168:171], v[52:55], v[164:167]
    ds_read_b64_tr_b16 a[198:199], v242 offset:2336
    v_mul_f32 v209, v252, v209
    v_mfma_f32_16x16x32_bf16 v[168:171], a[172:175], v[48:51], v[168:171]
    ds_read_b64_tr_b16 a[168:169], v242 offset:2560
    v_mul_f32_e64 v210, v252, v210
    v_mfma_f32_16x16x32_bf16 v[172:175], a[172:175], v[52:55], v[172:175]
    ds_read_b64_tr_b16 a[170:171], v242 offset:2816
    buffer_load_dwordx4 v243, s[8:11], s66 offen offset:0 lds
    v_mfma_f32_16x16x32_bf16 v[144:147], a[176:179], v[56:59], v[144:147]
    ds_read_b64_tr_b16 a[172:173], v242 offset:2592
    v_mul_f32_e64 v211, v252, v211
    v_mfma_f32_16x16x32_bf16 v[148:151], a[176:179], v[60:63], v[148:151]
    ds_read_b64_tr_b16 a[174:175], v242 offset:2848
    s_waitcnt lgkmcnt(8)
    v_mfma_f32_16x16x32_bf16 v[152:155], a[180:183], v[56:59], v[152:155]
    ds_read_b64_tr_b16 a[176:177], v242 offset:3072
    v_mul_f32 v212, v253, v212
    v_mfma_f32_16x16x32_bf16 v[156:159], a[180:183], v[60:63], v[156:159]
    ds_read_b64_tr_b16 a[178:179], v242 offset:3328
    v_mul_f32_e64 v213, v253, v213
    v_mfma_f32_16x16x32_bf16 v[160:163], a[184:187], v[56:59], v[160:163]
    ds_read_b64_tr_b16 a[180:181], v242 offset:3104
    v_mul_f32_e64 v214, v253, v214
    v_mfma_f32_16x16x32_bf16 v[164:167], a[184:187], v[60:63], v[164:167]
    ds_read_b64_tr_b16 a[182:183], v242 offset:3360
    buffer_load_dwordx4 v244, s[8:11], s66 offen offset:1024 lds
    v_mfma_f32_16x16x32_bf16 v[168:171], a[188:191], v[56:59], v[168:171]
    ds_read_b64_tr_b16 a[184:185], v242 offset:3584
    v_mul_f32_e64 v215, v253, v215
    v_mfma_f32_16x16x32_bf16 v[172:175], a[188:191], v[60:63], v[172:175]
    ds_read_b64_tr_b16 a[186:187], v242 offset:3840
    s_waitcnt lgkmcnt(8)
    v_mfma_f32_16x16x32_bf16 v[144:147], a[192:195], v[64:67], v[144:147]
    ds_read_b64_tr_b16 a[188:189], v242 offset:3616
    v_mul_f32 v216, v252, v216
    v_mfma_f32_16x16x32_bf16 v[148:151], a[192:195], v[68:71], v[148:151]
    ds_read_b64_tr_b16 a[190:191], v242 offset:3872
    v_mul_f32_e64 v217, v252, v217
    v_mfma_f32_16x16x32_bf16 v[152:155], a[196:199], v[64:67], v[152:155]
    ds_read_b64_tr_b16 a[192:193], v242 offset:4096
    v_mul_f32_e64 v218, v252, v218
    v_mfma_f32_16x16x32_bf16 v[156:159], a[196:199], v[68:71], v[156:159]
    ds_read_b64_tr_b16 a[194:195], v242 offset:4352
    buffer_load_dwordx4 v245, s[8:11], s66 offen offset:2048 lds
    v_mfma_f32_16x16x32_bf16 v[160:163], a[168:171], v[64:67], v[160:163]
    ds_read_b64_tr_b16 a[196:197], v242 offset:4128
    v_mul_f32_e64 v219, v252, v219
    v_mfma_f32_16x16x32_bf16 v[164:167], a[168:171], v[68:71], v[164:167]
    ds_read_b64_tr_b16 a[198:199], v242 offset:4384
    s_waitcnt lgkmcnt(8)
    v_mfma_f32_16x16x32_bf16 v[168:171], a[172:175], v[64:67], v[168:171]
    ds_read_b64_tr_b16 a[168:169], v242 offset:4608
    v_mul_f32 v220, v253, v220
    v_mfma_f32_16x16x32_bf16 v[172:175], a[172:175], v[68:71], v[172:175]
    ds_read_b64_tr_b16 a[170:171], v242 offset:4864
    v_mul_f32_e64 v221, v253, v221
    v_mfma_f32_16x16x32_bf16 v[144:147], a[176:179], v[72:75], v[144:147]
    ds_read_b64_tr_b16 a[172:173], v242 offset:4640
    v_mul_f32_e64 v222, v253, v222
    v_mfma_f32_16x16x32_bf16 v[148:151], a[176:179], v[76:79], v[148:151]
    ds_read_b64_tr_b16 a[174:175], v242 offset:4896
    v_mul_f32_e64 v223, v253, v223
    v_mfma_f32_16x16x32_bf16 v[152:155], a[180:183], v[72:75], v[152:155]
    ds_read_b64_tr_b16 a[176:177], v242 offset:5120
    v_mul_f32_e64 v224, v252, v224
    v_mfma_f32_16x16x32_bf16 v[156:159], a[180:183], v[76:79], v[156:159]
    ds_read_b64_tr_b16 a[178:179], v242 offset:5376
    s_waitcnt lgkmcnt(8)
    v_mfma_f32_16x16x32_bf16 v[160:163], a[184:187], v[72:75], v[160:163]
    ds_read_b64_tr_b16 a[180:181], v242 offset:5152
    v_mul_f32 v225, v252, v225
    v_mfma_f32_16x16x32_bf16 v[164:167], a[184:187], v[76:79], v[164:167]
    ds_read_b64_tr_b16 a[182:183], v242 offset:5408
    v_mul_f32_e64 v226, v252, v226
    v_mfma_f32_16x16x32_bf16 v[168:171], a[188:191], v[72:75], v[168:171]
    ds_read_b64_tr_b16 a[184:185], v242 offset:5632
    v_mul_f32_e64 v227, v252, v227
    v_mfma_f32_16x16x32_bf16 v[172:175], a[188:191], v[76:79], v[172:175]
    ds_read_b64_tr_b16 a[186:187], v242 offset:5888
    v_mul_f32_e64 v228, v253, v228
    v_mfma_f32_16x16x32_bf16 v[144:147], a[192:195], v[80:83], v[144:147]
    ds_read_b64_tr_b16 a[188:189], v242 offset:5664
    v_mul_f32_e64 v229, v253, v229
    v_mfma_f32_16x16x32_bf16 v[148:151], a[192:195], v[84:87], v[148:151]
    ds_read_b64_tr_b16 a[190:191], v242 offset:5920
    s_waitcnt lgkmcnt(8)
    v_mfma_f32_16x16x32_bf16 v[152:155], a[196:199], v[80:83], v[152:155]
    s_waitcnt vmcnt(27)
    s_barrier
    ds_read_b64_tr_b16 a[192:193], v242 offset:24704
    v_mfma_f32_16x16x32_bf16 v[156:159], a[196:199], v[84:87], v[156:159]
    ds_read_b64_tr_b16 a[194:195], v242 offset:24960
    s_add_u32 m0, s64, 74112
    v_mfma_f32_16x16x32_bf16 v[160:163], a[168:171], v[80:83], v[160:163]
    ds_read_b64_tr_b16 a[196:197], v242 offset:24736
    s_add_u32 s66, s60, s96
    v_mfma_f32_16x16x32_bf16 v[164:167], a[168:171], v[84:87], v[164:167]
    ds_read_b64_tr_b16 a[198:199], v242 offset:24992
    buffer_load_dwordx4 v243, s[12:15], s66 offen offset:0 lds
    v_mfma_f32_16x16x32_bf16 v[168:171], a[172:175], v[80:83], v[168:171]
    ds_read_b64_tr_b16 a[168:169], v242 offset:25216
    v_mul_f32_e64 v230, v253, v230
    v_mfma_f32_16x16x32_bf16 v[172:175], a[172:175], v[84:87], v[172:175]
    ds_read_b64_tr_b16 a[170:171], v242 offset:25472
    s_waitcnt lgkmcnt(8)
    v_mfma_f32_16x16x32_bf16 v[144:147], a[176:179], v[88:91], v[144:147]
    ds_read_b64_tr_b16 a[172:173], v242 offset:25248
    v_mul_f32 v231, v253, v231
    v_mfma_f32_16x16x32_bf16 v[148:151], a[176:179], v[92:95], v[148:151]
    ds_read_b64_tr_b16 a[174:175], v242 offset:25504
    v_mul_f32_e64 v232, v252, v232
    v_mfma_f32_16x16x32_bf16 v[152:155], a[180:183], v[88:91], v[152:155]
    ds_read_b64_tr_b16 a[176:177], v242 offset:25728
    v_mul_f32_e64 v233, v252, v233
    v_mfma_f32_16x16x32_bf16 v[156:159], a[180:183], v[92:95], v[156:159]
    ds_read_b64_tr_b16 a[178:179], v242 offset:25984
    buffer_load_dwordx4 v244, s[12:15], s66 offen offset:1024 lds
    v_mfma_f32_16x16x32_bf16 v[160:163], a[184:187], v[88:91], v[160:163]
    ds_read_b64_tr_b16 a[180:181], v242 offset:25760
    v_mul_f32_e64 v234, v252, v234
    v_mfma_f32_16x16x32_bf16 v[164:167], a[184:187], v[92:95], v[164:167]
    ds_read_b64_tr_b16 a[182:183], v242 offset:26016
    s_waitcnt lgkmcnt(8)
    v_mfma_f32_16x16x32_bf16 v[168:171], a[188:191], v[88:91], v[168:171]
    ds_read_b64_tr_b16 a[184:185], v242 offset:26240
    v_mul_f32 v235, v252, v235
    v_mfma_f32_16x16x32_bf16 v[172:175], a[188:191], v[92:95], v[172:175]
    ds_read_b64_tr_b16 a[186:187], v242 offset:26496
    v_mul_f32_e64 v236, v253, v236
    v_mfma_f32_16x16x32_bf16 v[144:147], a[192:195], v[96:99], v[144:147]
    ds_read_b64_tr_b16 a[188:189], v242 offset:26272
    v_mul_f32_e64 v237, v253, v237
    v_mfma_f32_16x16x32_bf16 v[148:151], a[192:195], v[100:103], v[148:151]
    ds_read_b64_tr_b16 a[190:191], v242 offset:26528
    buffer_load_dwordx4 v245, s[12:15], s66 offen offset:2048 lds
    v_mfma_f32_16x16x32_bf16 v[152:155], a[196:199], v[96:99], v[152:155]
    ds_read_b64_tr_b16 a[192:193], v242 offset:26752
    s_add_u32 m0, s64, 77184
    v_mfma_f32_16x16x32_bf16 v[156:159], a[196:199], v[100:103], v[156:159]
    ds_read_b64_tr_b16 a[194:195], v242 offset:27008
    s_waitcnt lgkmcnt(8)
    v_mfma_f32_16x16x32_bf16 v[160:163], a[168:171], v[96:99], v[160:163]
    ds_read_b64_tr_b16 a[196:197], v242 offset:26784
    s_add_u32 s66, s66, 884736
    v_mfma_f32_16x16x32_bf16 v[164:167], a[168:171], v[100:103], v[164:167]
    ds_read_b64_tr_b16 a[198:199], v242 offset:27040
    v_mul_f32 v238, v253, v238
    v_mfma_f32_16x16x32_bf16 v[168:171], a[172:175], v[96:99], v[168:171]
    ds_read_b64_tr_b16 a[168:169], v242 offset:27264
    v_mul_f32_e64 v239, v253, v239
    v_mfma_f32_16x16x32_bf16 v[172:175], a[172:175], v[100:103], v[172:175]
    ds_read_b64_tr_b16 a[170:171], v242 offset:27520
    buffer_load_dwordx4 v243, s[12:15], s66 offen offset:0 lds
    v_mfma_f32_16x16x32_bf16 v[144:147], a[176:179], v[104:107], v[144:147]
    ds_read_b64_tr_b16 a[172:173], v242 offset:27296
    v_accvgpr_write_b32 a120, -1
    v_mfma_f32_16x16x32_bf16 v[148:151], a[176:179], v[108:111], v[148:151]
    ds_read_b64_tr_b16 a[174:175], v242 offset:27552
    s_waitcnt lgkmcnt(8)
    v_mfma_f32_16x16x32_bf16 v[152:155], a[180:183], v[104:107], v[152:155]
    ds_read_b64_tr_b16 a[176:177], v242 offset:27776
    v_accvgpr_write_b32 a121, -1
    v_mfma_f32_16x16x32_bf16 v[156:159], a[180:183], v[108:111], v[156:159]
    ds_read_b64_tr_b16 a[178:179], v242 offset:28032
    v_accvgpr_write_b32 a122, -1
    v_mfma_f32_16x16x32_bf16 v[160:163], a[184:187], v[104:107], v[160:163]
    ds_read_b64_tr_b16 a[180:181], v242 offset:27808
    v_accvgpr_write_b32 a123, -1
    v_mfma_f32_16x16x32_bf16 v[164:167], a[184:187], v[108:111], v[164:167]
    ds_read_b64_tr_b16 a[182:183], v242 offset:28064
    buffer_load_dwordx4 v244, s[12:15], s66 offen offset:1024 lds
    v_mfma_f32_16x16x32_bf16 v[168:171], a[188:191], v[104:107], v[168:171]
    ds_read_b64_tr_b16 a[184:185], v242 offset:28288
    s_add_u32 s70, s74, 21504
    v_mfma_f32_16x16x32_bf16 v[172:175], a[188:191], v[108:111], v[172:175]
    ds_read_b64_tr_b16 a[186:187], v242 offset:28544
    s_waitcnt lgkmcnt(8)
    v_mfma_f32_16x16x32_bf16 v[144:147], a[192:195], v[112:115], v[144:147]
    ds_read_b64_tr_b16 a[188:189], v242 offset:28320
    buffer_store_dwordx4 a[120:123], v254, s[20:23], s70 offen offset:0 sc1
    v_mfma_f32_16x16x32_bf16 v[148:151], a[192:195], v[116:119], v[148:151]
    ds_read_b64_tr_b16 a[190:191], v242 offset:28576
    v_bfe_u32 v201, v254, 4, 2
    v_mfma_f32_16x16x32_bf16 v[152:155], a[196:199], v[112:115], v[152:155]
    ds_read_b64_tr_b16 a[192:193], v242 offset:28800
    buffer_store_dwordx4 a[120:123], v254, s[20:23], s70 offen offset:1024 sc1
    v_mfma_f32_16x16x32_bf16 v[156:159], a[196:199], v[116:119], v[156:159]
    ds_read_b64_tr_b16 a[194:195], v242 offset:29056
    v_min_u32 v201, 2, v201
    v_mfma_f32_16x16x32_bf16 v[160:163], a[168:171], v[112:115], v[160:163]
    ds_read_b64_tr_b16 a[196:197], v242 offset:28832
    buffer_load_dwordx4 v245, s[12:15], s66 offen offset:2048 lds
    v_mfma_f32_16x16x32_bf16 v[164:167], a[168:171], v[116:119], v[164:167]
    ds_read_b64_tr_b16 a[198:199], v242 offset:29088
    s_waitcnt lgkmcnt(8)
    v_mfma_f32_16x16x32_bf16 v[168:171], a[172:175], v[112:115], v[168:171]
    ds_read_b64_tr_b16 a[168:169], v242 offset:29312
    v_min_u32 v202, 1, v200
    v_mfma_f32_16x16x32_bf16 v[172:175], a[172:175], v[116:119], v[172:175]
    ds_read_b64_tr_b16 a[170:171], v242 offset:29568
    v_mul_u32_u24 v201, v201, v202
    v_mfma_f32_16x16x32_bf16 v[144:147], a[176:179], v[120:123], v[144:147]
    ds_read_b64_tr_b16 a[172:173], v242 offset:29344
    v_sub_u32_e64 v201, s58, v201
    v_mfma_f32_16x16x32_bf16 v[148:151], a[176:179], v[124:127], v[148:151]
    ds_read_b64_tr_b16 a[174:175], v242 offset:29600
    v_max_i32 v201, 0, v201
    v_mfma_f32_16x16x32_bf16 v[152:155], a[180:183], v[120:123], v[152:155]
    ds_read_b64_tr_b16 a[176:177], v242 offset:29824
    buffer_store_dwordx4 a[120:123], v254, s[20:23], s70 offen offset:2048 sc1
    v_mfma_f32_16x16x32_bf16 v[156:159], a[180:183], v[124:127], v[156:159]
    ds_read_b64_tr_b16 a[178:179], v242 offset:30080
    s_waitcnt lgkmcnt(8)
    v_mfma_f32_16x16x32_bf16 v[160:163], a[184:187], v[120:123], v[160:163]
    ds_read_b64_tr_b16 a[180:181], v242 offset:29856
    v_lshl_add_u32 v200, v200, 4, s57
    v_mfma_f32_16x16x32_bf16 v[164:167], a[184:187], v[124:127], v[164:167]
    ds_read_b64_tr_b16 a[182:183], v242 offset:30112
    v_mul_u32_u24 v200, 0x5556, v200
L_w3:
    s_cbranch_execz L_wret0
    v_mfma_f32_16x16x32_bf16 v[168:171], a[188:191], v[120:123], v[168:171]
    ds_read_b64_tr_b16 a[184:185], v242 offset:30336
    v_lshrrev_b32_e64 v200, 16, v200
    v_mfma_f32_16x16x32_bf16 v[172:175], a[188:191], v[124:127], v[172:175]
    ds_read_b64_tr_b16 a[186:187], v242 offset:30592
    v_lshl_add_u32 v200, v201, 4, v200
    v_mfma_f32_16x16x32_bf16 v[144:147], a[192:195], v[128:131], v[144:147]
    ds_read_b64_tr_b16 a[188:189], v242 offset:30368
    v_lshlrev_b32_e64 v200, 7, v200
    v_mfma_f32_16x16x32_bf16 v[148:151], a[192:195], v[132:135], v[148:151]
    ds_read_b64_tr_b16 a[190:191], v242 offset:30624
    s_waitcnt lgkmcnt(8)
    v_mfma_f32_16x16x32_bf16 v[152:155], a[196:199], v[128:131], v[152:155]
    s_waitcnt vmcnt(27)
    s_barrier
    ds_read_b64_tr_b16 a[192:193], v240 offset:0
    v_mfma_f32_16x16x32_bf16 v[156:159], a[196:199], v[132:135], v[156:159]
    ds_read_b64_tr_b16 a[194:195], v240 offset:256
    s_add_u32 m0, s64, 98816
    v_mfma_f32_16x16x32_bf16 v[160:163], a[168:171], v[128:131], v[160:163]
    ds_read_b64_tr_b16 a[196:197], v240 offset:32
    s_add_u32 s66, s60, s97
    v_mfma_f32_16x16x32_bf16 v[164:167], a[168:171], v[132:135], v[164:167]
    ds_read_b64_tr_b16 a[198:199], v240 offset:288
    buffer_load_dwordx4 v243, s[12:15], s66 offen offset:0 lds
    v_mfma_f32_16x16x32_bf16 v[168:171], a[172:175], v[128:131], v[168:171]
    ds_read_b64_tr_b16 a[168:169], v240 offset:512
    v_add_u32 v200, 46137344, v200
    v_mfma_f32_16x16x32_bf16 v[172:175], a[172:175], v[132:135], v[172:175]
    ds_read_b64_tr_b16 a[170:171], v240 offset:768
    s_waitcnt lgkmcnt(8)
    v_mfma_f32_16x16x32_bf16 v[144:147], a[176:179], v[136:139], v[144:147]
    ds_read_b64_tr_b16 a[172:173], v240 offset:544
    v_accvgpr_write_b32 a213, v200
    v_mfma_f32_16x16x32_bf16 v[148:151], a[176:179], v[140:143], v[148:151]
    ds_read_b64_tr_b16 a[174:175], v240 offset:800
    v_mfma_f32_16x16x32_bf16 v[152:155], a[180:183], v[136:139], v[152:155]
    ds_read_b64_tr_b16 a[176:177], v240 offset:1024
    v_mfma_f32_16x16x32_bf16 v[156:159], a[180:183], v[140:143], v[156:159]
    ds_read_b64_tr_b16 a[178:179], v240 offset:1280
    buffer_load_dwordx4 v244, s[12:15], s66 offen offset:1024 lds
    v_mfma_f32_16x16x32_bf16 v[160:163], a[184:187], v[136:139], v[160:163]
    ds_read_b64_tr_b16 a[180:181], v240 offset:1056
    v_mfma_f32_16x16x32_bf16 v[164:167], a[184:187], v[140:143], v[164:167]
    ds_read_b64_tr_b16 a[182:183], v240 offset:1312
    s_waitcnt lgkmcnt(8)
    v_mfma_f32_16x16x32_bf16 v[168:171], a[188:191], v[136:139], v[168:171]
    ds_read_b64_tr_b16 a[184:185], v240 offset:1536
    v_mfma_f32_16x16x32_bf16 v[172:175], a[188:191], v[140:143], v[172:175]
    ds_read_b64_tr_b16 a[186:187], v240 offset:1792
    v_mfma_f32_16x16x32_bf16 v[176:179], a[192:195], v[0:3], 0
    ds_read_b64_tr_b16 a[188:189], v240 offset:1568
    v_mfma_f32_16x16x32_bf16 v[180:183], a[192:195], v[4:7], 0
    ds_read_b64_tr_b16 a[190:191], v240 offset:1824
    buffer_load_dwordx4 v245, s[12:15], s66 offen offset:2048 lds
    v_mfma_f32_16x16x32_bf16 v[184:187], a[196:199], v[0:3], 0
    ds_read_b64_tr_b16 a[192:193], v240 offset:2048
    s_add_u32 m0, s64, 101888
    v_mfma_f32_16x16x32_bf16 v[188:191], a[196:199], v[4:7], 0
    ds_read_b64_tr_b16 a[194:195], v240 offset:2304
    s_waitcnt lgkmcnt(8)
    v_mfma_f32_16x16x32_bf16 v[192:195], a[168:171], v[0:3], 0
    ds_read_b64_tr_b16 a[196:197], v240 offset:2080
    s_add_u32 s66, s66, 884736
    v_mfma_f32_16x16x32_bf16 v[196:199], a[168:171], v[4:7], 0
    ds_read_b64_tr_b16 a[198:199], v240 offset:2336
    s_add_u32 s72, s74, 0
    v_mfma_f32_16x16x32_bf16 v[200:203], a[172:175], v[0:3], 0
    ds_read_b64_tr_b16 a[168:169], v240 offset:2560
    v_mul_f32_e64 v208, v208, v144
    v_mfma_f32_16x16x32_bf16 v[204:207], a[172:175], v[4:7], 0
    ds_read_b64_tr_b16 a[170:171], v240 offset:2816
    buffer_load_dwordx4 v243, s[12:15], s66 offen offset:0 lds
    v_mfma_f32_16x16x32_bf16 v[176:179], a[176:179], v[8:11], v[176:179]
    ds_read_b64_tr_b16 a[172:173], v240 offset:2592
    v_mul_f32_e64 v209, v209, v145
    v_mfma_f32_16x16x32_bf16 v[180:183], a[176:179], v[12:15], v[180:183]
    ds_read_b64_tr_b16 a[174:175], v240 offset:2848
    s_waitcnt lgkmcnt(8)
    v_mfma_f32_16x16x32_bf16 v[184:187], a[180:183], v[8:11], v[184:187]
    ds_read_b64_tr_b16 a[176:177], v240 offset:3072
    v_mul_f32 v210, v210, v146
    v_mfma_f32_16x16x32_bf16 v[188:191], a[180:183], v[12:15], v[188:191]
    ds_read_b64_tr_b16 a[178:179], v240 offset:3328
    v_mul_f32_e64 v211, v211, v147
    v_mfma_f32_16x16x32_bf16 v[192:195], a[184:187], v[8:11], v[192:195]
    ds_read_b64_tr_b16 a[180:181], v240 offset:3104
    v_mul_f32_e64 v216, v216, v152
    v_mfma_f32_16x16x32_bf16 v[196:199], a[184:187], v[12:15], v[196:199]
    ds_read_b64_tr_b16 a[182:183], v240 offset:3360
    buffer_load_dwordx4 v244, s[12:15], s66 offen offset:1024 lds
    v_mfma_f32_16x16x32_bf16 v[200:203], a[188:191], v[8:11], v[200:203]
    ds_read_b64_tr_b16 a[184:185], v240 offset:3584
    v_mul_f32_e64 v217, v217, v153
    v_mfma_f32_16x16x32_bf16 v[204:207], a[188:191], v[12:15], v[204:207]
    ds_read_b64_tr_b16 a[186:187], v240 offset:3840
    s_waitcnt lgkmcnt(8)
    v_mfma_f32_16x16x32_bf16 v[176:179], a[192:195], v[16:19], v[176:179]
    ds_read_b64_tr_b16 a[188:189], v240 offset:3616
    v_mul_f32 v218, v218, v154
    v_mfma_f32_16x16x32_bf16 v[180:183], a[192:195], v[20:23], v[180:183]
    ds_read_b64_tr_b16 a[190:191], v240 offset:3872
    v_mul_f32_e64 v219, v219, v155
    v_mfma_f32_16x16x32_bf16 v[184:187], a[196:199], v[16:19], v[184:187]
    ds_read_b64_tr_b16 a[192:193], v240 offset:4096
    v_cvt_pk_bf16_f32 v208, v208, v209
    v_mfma_f32_16x16x32_bf16 v[188:191], a[196:199], v[20:23], v[188:191]
    ds_read_b64_tr_b16 a[194:195], v240 offset:4352
    buffer_load_dwordx4 v245, s[12:15], s66 offen offset:2048 lds
    v_mfma_f32_16x16x32_bf16 v[192:195], a[168:171], v[16:19], v[192:195]
    ds_read_b64_tr_b16 a[196:197], v240 offset:4128
    v_cvt_pk_bf16_f32 v209, v210, v211
    v_mfma_f32_16x16x32_bf16 v[196:199], a[168:171], v[20:23], v[196:199]
    ds_read_b64_tr_b16 a[198:199], v240 offset:4384
    s_waitcnt lgkmcnt(8)
    v_mfma_f32_16x16x32_bf16 v[200:203], a[172:175], v[16:19], v[200:203]
    ds_read_b64_tr_b16 a[168:169], v240 offset:4608
    v_cvt_pk_bf16_f32 v210, v216, v217
    v_mfma_f32_16x16x32_bf16 v[204:207], a[172:175], v[20:23], v[204:207]
    ds_read_b64_tr_b16 a[170:171], v240 offset:4864
    v_cvt_pk_bf16_f32 v211, v218, v219
    v_mfma_f32_16x16x32_bf16 v[176:179], a[176:179], v[24:27], v[176:179]
    ds_read_b64_tr_b16 a[172:173], v240 offset:4640
    v_accvgpr_write_b32 a0, v208
    v_mfma_f32_16x16x32_bf16 v[180:183], a[176:179], v[28:31], v[180:183]
    ds_read_b64_tr_b16 a[174:175], v240 offset:4896
    v_accvgpr_write_b32 a1, v209
    v_mfma_f32_16x16x32_bf16 v[184:187], a[180:183], v[24:27], v[184:187]
    ds_read_b64_tr_b16 a[176:177], v240 offset:5120
    v_accvgpr_write_b32 a2, v210
    v_mfma_f32_16x16x32_bf16 v[188:191], a[180:183], v[28:31], v[188:191]
    ds_read_b64_tr_b16 a[178:179], v240 offset:5376
    s_waitcnt lgkmcnt(8)
    v_mfma_f32_16x16x32_bf16 v[192:195], a[184:187], v[24:27], v[192:195]
    ds_read_b64_tr_b16 a[180:181], v240 offset:5152
    v_accvgpr_write_b32 a3, v211
    v_mfma_f32_16x16x32_bf16 v[196:199], a[184:187], v[28:31], v[196:199]
    ds_read_b64_tr_b16 a[182:183], v240 offset:5408
    buffer_store_dwordx4 v[208:211], v254, s[20:23], s72 offen offset:0 sc1
    v_mfma_f32_16x16x32_bf16 v[200:203], a[188:191], v[24:27], v[200:203]
    ds_read_b64_tr_b16 a[184:185], v240 offset:5632
    v_mul_f32_e64 v212, v212, v148
    v_mfma_f32_16x16x32_bf16 v[204:207], a[188:191], v[28:31], v[204:207]
    ds_read_b64_tr_b16 a[186:187], v240 offset:5888
    v_mul_f32_e64 v213, v213, v149
    v_mfma_f32_16x16x32_bf16 v[176:179], a[192:195], v[32:35], v[176:179]
    ds_read_b64_tr_b16 a[188:189], v240 offset:5664
    v_mul_f32_e64 v214, v214, v150
    v_mfma_f32_16x16x32_bf16 v[180:183], a[192:195], v[36:39], v[180:183]
    ds_read_b64_tr_b16 a[190:191], v240 offset:5920
    s_waitcnt lgkmcnt(8)
    v_mfma_f32_16x16x32_bf16 v[184:187], a[196:199], v[32:35], v[184:187]
    s_waitcnt vmcnt(25)
    s_barrier
    ds_read_b64_tr_b16 a[192:193], v240 offset:24704
    v_mfma_f32_16x16x32_bf16 v[188:191], a[196:199], v[36:39], v[188:191]
    ds_read_b64_tr_b16 a[194:195], v240 offset:24960
    s_add_u32 m0, s64, 123520
    v_mfma_f32_16x16x32_bf16 v[192:195], a[168:171], v[32:35], v[192:195]
    ds_read_b64_tr_b16 a[196:197], v240 offset:24736
    s_add_u32 s66, s60, s98
    v_mfma_f32_16x16x32_bf16 v[196:199], a[168:171], v[36:39], v[196:199]
    ds_read_b64_tr_b16 a[198:199], v240 offset:24992
    buffer_load_dwordx4 v243, s[12:15], s66 offen offset:0 lds
    v_mfma_f32_16x16x32_bf16 v[200:203], a[172:175], v[32:35], v[200:203]
    ds_read_b64_tr_b16 a[168:169], v240 offset:25216
    v_mul_f32_e64 v215, v215, v151
    v_mfma_f32_16x16x32_bf16 v[204:207], a[172:175], v[36:39], v[204:207]
    ds_read_b64_tr_b16 a[170:171], v240 offset:25472
    s_waitcnt lgkmcnt(8)
    v_mfma_f32_16x16x32_bf16 v[176:179], a[176:179], v[40:43], v[176:179]
    ds_read_b64_tr_b16 a[172:173], v240 offset:25248
    v_mul_f32 v220, v220, v156
    v_mfma_f32_16x16x32_bf16 v[180:183], a[176:179], v[44:47], v[180:183]
    ds_read_b64_tr_b16 a[174:175], v240 offset:25504
    v_mul_f32_e64 v221, v221, v157
    v_mfma_f32_16x16x32_bf16 v[184:187], a[180:183], v[40:43], v[184:187]
    ds_read_b64_tr_b16 a[176:177], v240 offset:25728
    v_mul_f32_e64 v222, v222, v158
    v_mfma_f32_16x16x32_bf16 v[188:191], a[180:183], v[44:47], v[188:191]
    ds_read_b64_tr_b16 a[178:179], v240 offset:25984
    buffer_load_dwordx4 v244, s[12:15], s66 offen offset:1024 lds
    v_mfma_f32_16x16x32_bf16 v[192:195], a[184:187], v[40:43], v[192:195]
    ds_read_b64_tr_b16 a[180:181], v240 offset:25760
    v_mul_f32_e64 v223, v223, v159
    v_mfma_f32_16x16x32_bf16 v[196:199], a[184:187], v[44:47], v[196:199]
    ds_read_b64_tr_b16 a[182:183], v240 offset:26016
    s_waitcnt lgkmcnt(8)
    v_mfma_f32_16x16x32_bf16 v[200:203], a[188:191], v[40:43], v[200:203]
    ds_read_b64_tr_b16 a[184:185], v240 offset:26240
    v_cvt_pk_bf16_f32 v212, v212, v213
    v_mfma_f32_16x16x32_bf16 v[204:207], a[188:191], v[44:47], v[204:207]
    ds_read_b64_tr_b16 a[186:187], v240 offset:26496
    v_cvt_pk_bf16_f32 v213, v214, v215
    v_mfma_f32_16x16x32_bf16 v[176:179], a[192:195], v[48:51], v[176:179]
    ds_read_b64_tr_b16 a[188:189], v240 offset:26272
    v_cvt_pk_bf16_f32 v214, v220, v221
    v_mfma_f32_16x16x32_bf16 v[180:183], a[192:195], v[52:55], v[180:183]
    ds_read_b64_tr_b16 a[190:191], v240 offset:26528
    buffer_load_dwordx4 v245, s[12:15], s66 offen offset:2048 lds
    v_mfma_f32_16x16x32_bf16 v[184:187], a[196:199], v[48:51], v[184:187]
    ds_read_b64_tr_b16 a[192:193], v240 offset:26752
    s_add_u32 m0, s64, 126592
    v_mfma_f32_16x16x32_bf16 v[188:191], a[196:199], v[52:55], v[188:191]
    ds_read_b64_tr_b16 a[194:195], v240 offset:27008
    s_waitcnt lgkmcnt(8)
    v_mfma_f32_16x16x32_bf16 v[192:195], a[168:171], v[48:51], v[192:195]
    ds_read_b64_tr_b16 a[196:197], v240 offset:26784
    s_add_u32 s66, s66, 884736
    v_mfma_f32_16x16x32_bf16 v[196:199], a[168:171], v[52:55], v[196:199]
    ds_read_b64_tr_b16 a[198:199], v240 offset:27040
    v_cvt_pk_bf16_f32 v215, v222, v223
    v_mfma_f32_16x16x32_bf16 v[200:203], a[172:175], v[48:51], v[200:203]
    ds_read_b64_tr_b16 a[168:169], v240 offset:27264
    v_accvgpr_write_b32 a4, v212
    v_mfma_f32_16x16x32_bf16 v[204:207], a[172:175], v[52:55], v[204:207]
    ds_read_b64_tr_b16 a[170:171], v240 offset:27520
    buffer_load_dwordx4 v243, s[12:15], s66 offen offset:0 lds
    v_mfma_f32_16x16x32_bf16 v[176:179], a[176:179], v[56:59], v[176:179]
    ds_read_b64_tr_b16 a[172:173], v240 offset:27296
    v_accvgpr_write_b32 a5, v213
    v_mfma_f32_16x16x32_bf16 v[180:183], a[176:179], v[60:63], v[180:183]
    ds_read_b64_tr_b16 a[174:175], v240 offset:27552
    s_waitcnt lgkmcnt(8)
    v_mfma_f32_16x16x32_bf16 v[184:187], a[180:183], v[56:59], v[184:187]
    ds_read_b64_tr_b16 a[176:177], v240 offset:27776
    v_accvgpr_write_b32 a6, v214
    v_mfma_f32_16x16x32_bf16 v[188:191], a[180:183], v[60:63], v[188:191]
    ds_read_b64_tr_b16 a[178:179], v240 offset:28032
    v_accvgpr_write_b32 a7, v215
    v_mfma_f32_16x16x32_bf16 v[192:195], a[184:187], v[56:59], v[192:195]
    ds_read_b64_tr_b16 a[180:181], v240 offset:27808
    buffer_store_dwordx4 v[212:215], v254, s[20:23], s72 offen offset:1024 sc1
    v_mfma_f32_16x16x32_bf16 v[196:199], a[184:187], v[60:63], v[196:199]
    ds_read_b64_tr_b16 a[182:183], v240 offset:28064
    s_add_u32 s72, s74, 2048
    v_mfma_f32_16x16x32_bf16 v[200:203], a[188:191], v[56:59], v[200:203]
    ds_read_b64_tr_b16 a[184:185], v240 offset:28288
    buffer_load_dwordx4 v244, s[12:15], s66 offen offset:1024 lds
    v_mfma_f32_16x16x32_bf16 v[204:207], a[188:191], v[60:63], v[204:207]
    ds_read_b64_tr_b16 a[186:187], v240 offset:28544
    s_waitcnt lgkmcnt(8)
    v_mfma_f32_16x16x32_bf16 v[176:179], a[192:195], v[64:67], v[176:179]
    ds_read_b64_tr_b16 a[188:189], v240 offset:28320
    v_mul_f32_e64 v224, v224, v160
    v_mfma_f32_16x16x32_bf16 v[180:183], a[192:195], v[68:71], v[180:183]
    ds_read_b64_tr_b16 a[190:191], v240 offset:28576
    v_mul_f32_e64 v225, v225, v161
    v_mfma_f32_16x16x32_bf16 v[184:187], a[196:199], v[64:67], v[184:187]
    ds_read_b64_tr_b16 a[192:193], v240 offset:28800
    v_mul_f32_e64 v226, v226, v162
    v_mfma_f32_16x16x32_bf16 v[188:191], a[196:199], v[68:71], v[188:191]
    ds_read_b64_tr_b16 a[194:195], v240 offset:29056
    v_mul_f32_e64 v227, v227, v163
    v_mfma_f32_16x16x32_bf16 v[192:195], a[168:171], v[64:67], v[192:195]
    ds_read_b64_tr_b16 a[196:197], v240 offset:28832
    buffer_load_dwordx4 v245, s[12:15], s66 offen offset:2048 lds
    v_mfma_f32_16x16x32_bf16 v[196:199], a[168:171], v[68:71], v[196:199]
    ds_read_b64_tr_b16 a[198:199], v240 offset:29088
    s_waitcnt lgkmcnt(8)
    v_mfma_f32_16x16x32_bf16 v[200:203], a[172:175], v[64:67], v[200:203]
    ds_read_b64_tr_b16 a[168:169], v240 offset:29312
    v_mul_f32 v232, v232, v168
    v_mfma_f32_16x16x32_bf16 v[204:207], a[172:175], v[68:71], v[204:207]
    ds_read_b64_tr_b16 a[170:171], v240 offset:29568
    v_mul_f32_e64 v233, v233, v169
    v_mfma_f32_16x16x32_bf16 v[176:179], a[176:179], v[72:75], v[176:179]
    ds_read_b64_tr_b16 a[172:173], v240 offset:29344
    v_mul_f32_e64 v234, v234, v170
    v_mfma_f32_16x16x32_bf16 v[180:183], a[176:179], v[76:79], v[180:183]
    ds_read_b64_tr_b16 a[174:175], v240 offset:29600
    v_mul_f32_e64 v235, v235, v171
    v_mfma_f32_16x16x32_bf16 v[184:187], a[180:183], v[72:75], v[184:187]
    ds_read_b64_tr_b16 a[176:177], v240 offset:29824
    v_cvt_pk_bf16_f32 v224, v224, v225
    v_mfma_f32_16x16x32_bf16 v[188:191], a[180:183], v[76:79], v[188:191]
    ds_read_b64_tr_b16 a[178:179], v240 offset:30080
    s_waitcnt lgkmcnt(8)
    v_mfma_f32_16x16x32_bf16 v[192:195], a[184:187], v[72:75], v[192:195]
    ds_read_b64_tr_b16 a[180:181], v240 offset:29856
    v_cvt_pk_bf16_f32 v225, v226, v227
    v_mfma_f32_16x16x32_bf16 v[196:199], a[184:187], v[76:79], v[196:199]
    ds_read_b64_tr_b16 a[182:183], v240 offset:30112
    v_cvt_pk_bf16_f32 v226, v232, v233
    v_mfma_f32_16x16x32_bf16 v[200:203], a[188:191], v[72:75], v[200:203]
    ds_read_b64_tr_b16 a[184:185], v240 offset:30336
    v_cvt_pk_bf16_f32 v227, v234, v235
    v_mfma_f32_16x16x32_bf16 v[204:207], a[188:191], v[76:79], v[204:207]
    ds_read_b64_tr_b16 a[186:187], v240 offset:30592
    v_accvgpr_write_b32 a8, v224
    v_mfma_f32_16x16x32_bf16 v[176:179], a[192:195], v[80:83], v[176:179]
    ds_read_b64_tr_b16 a[188:189], v240 offset:30368
    v_accvgpr_write_b32 a9, v225
    v_mfma_f32_16x16x32_bf16 v[180:183], a[192:195], v[84:87], v[180:183]
    ds_read_b64_tr_b16 a[190:191], v240 offset:30624
    s_waitcnt lgkmcnt(8)
    v_mfma_f32_16x16x32_bf16 v[184:187], a[196:199], v[80:83], v[184:187]
    s_waitcnt vmcnt(23)
    s_barrier
    s_lshl_b32 s67, s58, 4
    s_add_u32 s67, s67, s57
    s_lshl_b32 s67, s67, 7
    s_add_u32 s67, s67, 46137344
    v_mov_b32 v249, 0
    v_mov_b32_e64 v250, s51
    buffer_store_dword v250, v249, s[20:23], s67 offen offset:0 sc1
    ds_read_b64_tr_b16 a[192:193], v241 offset:0
    v_mfma_f32_16x16x32_bf16 v[188:191], a[196:199], v[84:87], v[188:191]
    ds_read_b64_tr_b16 a[194:195], v241 offset:256
    s_add_u32 m0, s64, 0
    v_mfma_f32_16x16x32_bf16 v[192:195], a[168:171], v[80:83], v[192:195]
    ds_read_b64_tr_b16 a[196:197], v241 offset:32
    s_add_u32 s66, s61, s96
    v_mfma_f32_16x16x32_bf16 v[196:199], a[168:171], v[84:87], v[196:199]
    ds_read_b64_tr_b16 a[198:199], v241 offset:288
    buffer_load_dwordx4 v243, s[8:11], s66 offen offset:0 lds
    v_mfma_f32_16x16x32_bf16 v[200:203], a[172:175], v[80:83], v[200:203]
    ds_read_b64_tr_b16 a[168:169], v241 offset:512
    v_accvgpr_write_b32 a10, v226
    v_mfma_f32_16x16x32_bf16 v[204:207], a[172:175], v[84:87], v[204:207]
    ds_read_b64_tr_b16 a[170:171], v241 offset:768
    s_waitcnt lgkmcnt(8)
    v_mfma_f32_16x16x32_bf16 v[176:179], a[176:179], v[88:91], v[176:179]
    ds_read_b64_tr_b16 a[172:173], v241 offset:544
    v_accvgpr_write_b32 a11, v227
    v_mfma_f32_16x16x32_bf16 v[180:183], a[176:179], v[92:95], v[180:183]
    ds_read_b64_tr_b16 a[174:175], v241 offset:800
    buffer_store_dwordx4 v[224:227], v254, s[20:23], s72 offen offset:0 sc1
    v_mfma_f32_16x16x32_bf16 v[184:187], a[180:183], v[88:91], v[184:187]
    ds_read_b64_tr_b16 a[176:177], v241 offset:1024
    v_mul_f32 v228, v228, v164
    v_mfma_f32_16x16x32_bf16 v[188:191], a[180:183], v[92:95], v[188:191]
    ds_read_b64_tr_b16 a[178:179], v241 offset:1280
    buffer_load_dwordx4 v244, s[8:11], s66 offen offset:1024 lds
    v_mfma_f32_16x16x32_bf16 v[192:195], a[184:187], v[88:91], v[192:195]
    ds_read_b64_tr_b16 a[180:181], v241 offset:1056
    v_mul_f32_e64 v229, v229, v165
    v_mfma_f32_16x16x32_bf16 v[196:199], a[184:187], v[92:95], v[196:199]
    ds_read_b64_tr_b16 a[182:183], v241 offset:1312
    s_waitcnt lgkmcnt(8)
    v_mfma_f32_16x16x32_bf16 v[200:203], a[188:191], v[88:91], v[200:203]
    ds_read_b64_tr_b16 a[184:185], v241 offset:1536
    v_mul_f32 v230, v230, v166
    v_mfma_f32_16x16x32_bf16 v[204:207], a[188:191], v[92:95], v[204:207]
    ds_read_b64_tr_b16 a[186:187], v241 offset:1792
    v_mul_f32_e64 v231, v231, v167
    v_mfma_f32_16x16x32_bf16 v[176:179], a[192:195], v[96:99], v[176:179]
    ds_read_b64_tr_b16 a[188:189], v241 offset:1568
    v_mul_f32_e64 v236, v236, v172
    v_mfma_f32_16x16x32_bf16 v[180:183], a[192:195], v[100:103], v[180:183]
    ds_read_b64_tr_b16 a[190:191], v241 offset:1824
    buffer_load_dwordx4 v245, s[8:11], s66 offen offset:2048 lds
    v_mfma_f32_16x16x32_bf16 v[184:187], a[196:199], v[96:99], v[184:187]
    ds_read_b64_tr_b16 a[192:193], v241 offset:2048
    s_add_u32 m0, s64, 3072
    v_mfma_f32_16x16x32_bf16 v[188:191], a[196:199], v[100:103], v[188:191]
    ds_read_b64_tr_b16 a[194:195], v241 offset:2304
    s_waitcnt lgkmcnt(8)
    v_mfma_f32_16x16x32_bf16 v[192:195], a[168:171], v[96:99], v[192:195]
    ds_read_b64_tr_b16 a[196:197], v241 offset:2080
    s_add_u32 s66, s66, 884736
    v_mfma_f32_16x16x32_bf16 v[196:199], a[168:171], v[100:103], v[196:199]
    ds_read_b64_tr_b16 a[198:199], v241 offset:2336
    v_mul_f32 v237, v237, v173
    v_mfma_f32_16x16x32_bf16 v[200:203], a[172:175], v[96:99], v[200:203]
    ds_read_b64_tr_b16 a[168:169], v241 offset:2560
    v_mul_f32_e64 v238, v238, v174
    v_mfma_f32_16x16x32_bf16 v[204:207], a[172:175], v[100:103], v[204:207]
    ds_read_b64_tr_b16 a[170:171], v241 offset:2816
    buffer_load_dwordx4 v243, s[8:11], s66 offen offset:0 lds
    v_mfma_f32_16x16x32_bf16 v[176:179], a[176:179], v[104:107], v[176:179]
    ds_read_b64_tr_b16 a[172:173], v241 offset:2592
    v_mul_f32_e64 v239, v239, v175
    v_mfma_f32_16x16x32_bf16 v[180:183], a[176:179], v[108:111], v[180:183]
    ds_read_b64_tr_b16 a[174:175], v241 offset:2848
    s_waitcnt lgkmcnt(8)
    v_mfma_f32_16x16x32_bf16 v[184:187], a[180:183], v[104:107], v[184:187]
    ds_read_b64_tr_b16 a[176:177], v241 offset:3072
    v_cvt_pk_bf16_f32 v228, v228, v229
    v_mfma_f32_16x16x32_bf16 v[188:191], a[180:183], v[108:111], v[188:191]
    ds_read_b64_tr_b16 a[178:179], v241 offset:3328
    v_cvt_pk_bf16_f32 v229, v230, v231
    v_mfma_f32_16x16x32_bf16 v[192:195], a[184:187], v[104:107], v[192:195]
    ds_read_b64_tr_b16 a[180:181], v241 offset:3104
    v_cvt_pk_bf16_f32 v230, v236, v237
    v_mfma_f32_16x16x32_bf16 v[196:199], a[184:187], v[108:111], v[196:199]
    ds_read_b64_tr_b16 a[182:183], v241 offset:3360
    buffer_load_dwordx4 v244, s[8:11], s66 offen offset:1024 lds
    v_mfma_f32_16x16x32_bf16 v[200:203], a[188:191], v[104:107], v[200:203]
    ds_read_b64_tr_b16 a[184:185], v241 offset:3584
    v_cvt_pk_bf16_f32 v231, v238, v239
    v_mfma_f32_16x16x32_bf16 v[204:207], a[188:191], v[108:111], v[204:207]
    ds_read_b64_tr_b16 a[186:187], v241 offset:3840
    s_waitcnt lgkmcnt(8)
    v_mfma_f32_16x16x32_bf16 v[176:179], a[192:195], v[112:115], v[176:179]
    ds_read_b64_tr_b16 a[188:189], v241 offset:3616
    v_accvgpr_write_b32 a12, v228
    v_mfma_f32_16x16x32_bf16 v[180:183], a[192:195], v[116:119], v[180:183]
    ds_read_b64_tr_b16 a[190:191], v241 offset:3872
    v_accvgpr_write_b32 a13, v229
    v_mfma_f32_16x16x32_bf16 v[184:187], a[196:199], v[112:115], v[184:187]
    ds_read_b64_tr_b16 a[192:193], v241 offset:4096
    v_accvgpr_write_b32 a14, v230
    v_mfma_f32_16x16x32_bf16 v[188:191], a[196:199], v[116:119], v[188:191]
    ds_read_b64_tr_b16 a[194:195], v241 offset:4352
    buffer_load_dwordx4 v245, s[8:11], s66 offen offset:2048 lds
    v_mfma_f32_16x16x32_bf16 v[192:195], a[168:171], v[112:115], v[192:195]
    ds_read_b64_tr_b16 a[196:197], v241 offset:4128
    v_accvgpr_write_b32 a15, v231
    v_mfma_f32_16x16x32_bf16 v[196:199], a[168:171], v[116:119], v[196:199]
    ds_read_b64_tr_b16 a[198:199], v241 offset:4384
    s_waitcnt lgkmcnt(8)
    v_mfma_f32_16x16x32_bf16 v[200:203], a[172:175], v[112:115], v[200:203]
    ds_read_b64_tr_b16 a[168:169], v241 offset:4608
    buffer_store_dwordx4 v[228:231], v254, s[20:23], s72 offen offset:1024 sc1
    v_mfma_f32_16x16x32_bf16 v[204:207], a[172:175], v[116:119], v[204:207]
    ds_read_b64_tr_b16 a[170:171], v241 offset:4864
    s_mul_i32 s84, s59, 576
    v_mfma_f32_16x16x32_bf16 v[176:179], a[176:179], v[120:123], v[176:179]
    ds_read_b64_tr_b16 a[172:173], v241 offset:4640
    s_mul_i32 s85, s60, 576
    v_mfma_f32_16x16x32_bf16 v[180:183], a[176:179], v[124:127], v[180:183]
    ds_read_b64_tr_b16 a[174:175], v241 offset:4896
    s_mul_i32 s86, s61, 576
    v_mfma_f32_16x16x32_bf16 v[184:187], a[180:183], v[120:123], v[184:187]
    ds_read_b64_tr_b16 a[176:177], v241 offset:5120
    s_mul_i32 s87, s62, 576
    v_mfma_f32_16x16x32_bf16 v[188:191], a[180:183], v[124:127], v[188:191]
    ds_read_b64_tr_b16 a[178:179], v241 offset:5376
    s_waitcnt lgkmcnt(8)
    v_mfma_f32_16x16x32_bf16 v[192:195], a[184:187], v[120:123], v[192:195]
    ds_read_b64_tr_b16 a[180:181], v241 offset:5152
    s_mul_i32 s88, s63, 576
    v_mfma_f32_16x16x32_bf16 v[196:199], a[184:187], v[124:127], v[196:199]
    ds_read_b64_tr_b16 a[182:183], v241 offset:5408
    s_and_b32 s45, s57, 1
    v_mfma_f32_16x16x32_bf16 v[200:203], a[188:191], v[120:123], v[200:203]
    ds_read_b64_tr_b16 a[184:185], v241 offset:5632
    s_lshl_b32 s45, s45, 1
    v_mfma_f32_16x16x32_bf16 v[204:207], a[188:191], v[124:127], v[204:207]
    ds_read_b64_tr_b16 a[186:187], v241 offset:5888
    s_sub_u32 s45, 1, s45
    v_mfma_f32_16x16x32_bf16 v[176:179], a[192:195], v[128:131], v[176:179]
    ds_read_b64_tr_b16 a[188:189], v241 offset:5664
    s_mul_i32 s52, s45, 368640
    v_mfma_f32_16x16x32_bf16 v[180:183], a[192:195], v[132:135], v[180:183]
    ds_read_b64_tr_b16 a[190:191], v241 offset:5920
    s_waitcnt lgkmcnt(8)
    v_mfma_f32_16x16x32_bf16 v[184:187], a[196:199], v[128:131], v[184:187]
    s_waitcnt vmcnt(24)
    s_barrier
    ds_read_b64_tr_b16 a[192:193], v241 offset:24704
    v_mfma_f32_16x16x32_bf16 v[188:191], a[196:199], v[132:135], v[188:191]
    ds_read_b64_tr_b16 a[194:195], v241 offset:24960
    s_add_u32 m0, s64, 24704
    v_mfma_f32_16x16x32_bf16 v[192:195], a[168:171], v[128:131], v[192:195]
    ds_read_b64_tr_b16 a[196:197], v241 offset:24736
    s_add_u32 s66, s61, s97
    v_mfma_f32_16x16x32_bf16 v[196:199], a[168:171], v[132:135], v[196:199]
    ds_read_b64_tr_b16 a[198:199], v241 offset:24992
    buffer_load_dwordx4 v243, s[8:11], s66 offen offset:0 lds
    v_mfma_f32_16x16x32_bf16 v[200:203], a[172:175], v[128:131], v[200:203]
    ds_read_b64_tr_b16 a[168:169], v241 offset:25216
    s_add_u32 s89, s84, s52
    v_mfma_f32_16x16x32_bf16 v[204:207], a[172:175], v[132:135], v[204:207]
    ds_read_b64_tr_b16 a[170:171], v241 offset:25472
    s_waitcnt lgkmcnt(8)
    v_mfma_f32_16x16x32_bf16 v[176:179], a[176:179], v[136:139], v[176:179]
    ds_read_b64_tr_b16 a[172:173], v241 offset:25248
    s_add_u32 s90, s85, s52
    v_mfma_f32_16x16x32_bf16 v[180:183], a[176:179], v[140:143], v[180:183]
    ds_read_b64_tr_b16 a[174:175], v241 offset:25504
    s_add_u32 s91, s86, s52
    v_mfma_f32_16x16x32_bf16 v[184:187], a[180:183], v[136:139], v[184:187]
    ds_read_b64_tr_b16 a[176:177], v241 offset:25728
    s_add_u32 s92, s87, s52
    v_mfma_f32_16x16x32_bf16 v[188:191], a[180:183], v[140:143], v[188:191]
    ds_read_b64_tr_b16 a[178:179], v241 offset:25984
    buffer_load_dwordx4 v244, s[8:11], s66 offen offset:1024 lds
    v_mfma_f32_16x16x32_bf16 v[192:195], a[184:187], v[136:139], v[192:195]
    ds_read_b64_tr_b16 a[180:181], v241 offset:25760
    s_mul_i32 s52, s45, 36864
    v_mfma_f32_16x16x32_bf16 v[196:199], a[184:187], v[140:143], v[196:199]
    ds_read_b64_tr_b16 a[182:183], v241 offset:26016
    s_waitcnt lgkmcnt(8)
    v_mfma_f32_16x16x32_bf16 v[200:203], a[188:191], v[136:139], v[200:203]
    ds_read_b64_tr_b16 a[184:185], v241 offset:26240
    s_add_u32 s93, s88, s52
    v_mfma_f32_16x16x32_bf16 v[204:207], a[188:191], v[140:143], v[204:207]
    ds_read_b64_tr_b16 a[186:187], v241 offset:26496
    s_mul_i32 s94, s57, 41472
    v_mfma_f32_16x16x32_bf16 v[208:211], a[192:195], v[0:3], 0
    ds_read_b64_tr_b16 a[188:189], v241 offset:26272
    s_mul_i32 s52, s45, 41472
    v_mfma_f32_16x16x32_bf16 v[212:215], a[192:195], v[4:7], 0
    ds_read_b64_tr_b16 a[190:191], v241 offset:26528
    buffer_load_dwordx4 v245, s[8:11], s66 offen offset:2048 lds
    v_mfma_f32_16x16x32_bf16 v[216:219], a[196:199], v[0:3], 0
    ds_read_b64_tr_b16 a[192:193], v241 offset:26752
    s_add_u32 m0, s64, 27776
    v_mfma_f32_16x16x32_bf16 v[220:223], a[196:199], v[4:7], 0
    ds_read_b64_tr_b16 a[194:195], v241 offset:27008
    s_waitcnt lgkmcnt(8)
    v_mfma_f32_16x16x32_bf16 v[224:227], a[168:171], v[0:3], 0
    ds_read_b64_tr_b16 a[196:197], v241 offset:26784
    s_add_u32 s66, s66, 884736
    v_mfma_f32_16x16x32_bf16 v[228:231], a[168:171], v[4:7], 0
    ds_read_b64_tr_b16 a[198:199], v241 offset:27040
    v_mul_f32 v176, v252, v176
    v_mfma_f32_16x16x32_bf16 v[232:235], a[172:175], v[0:3], 0
    ds_read_b64_tr_b16 a[168:169], v241 offset:27264
    v_mul_f32_e64 v177, v252, v177
    v_mfma_f32_16x16x32_bf16 v[236:239], a[172:175], v[4:7], 0
    ds_read_b64_tr_b16 a[170:171], v241 offset:27520
    buffer_load_dwordx4 v243, s[8:11], s66 offen offset:0 lds
    v_mfma_f32_16x16x32_bf16 v[208:211], a[176:179], v[8:11], v[208:211]
    ds_read_b64_tr_b16 a[172:173], v241 offset:27296
    v_mul_f32_e64 v178, v252, v178
    v_mfma_f32_16x16x32_bf16 v[212:215], a[176:179], v[12:15], v[212:215]
    ds_read_b64_tr_b16 a[174:175], v241 offset:27552
    s_waitcnt lgkmcnt(8)
    v_mfma_f32_16x16x32_bf16 v[216:219], a[180:183], v[8:11], v[216:219]
    ds_read_b64_tr_b16 a[176:177], v241 offset:27776
    v_mul_f32 v179, v252, v179
    v_mfma_f32_16x16x32_bf16 v[220:223], a[180:183], v[12:15], v[220:223]
    ds_read_b64_tr_b16 a[178:179], v241 offset:28032
    v_mul_f32_e64 v180, v253, v180
    v_mfma_f32_16x16x32_bf16 v[224:227], a[184:187], v[8:11], v[224:227]
    ds_read_b64_tr_b16 a[180:181], v241 offset:27808
    v_mul_f32_e64 v181, v253, v181
    v_mfma_f32_16x16x32_bf16 v[228:231], a[184:187], v[12:15], v[228:231]
    ds_read_b64_tr_b16 a[182:183], v241 offset:28064
    buffer_load_dwordx4 v244, s[8:11], s66 offen offset:1024 lds
    v_mfma_f32_16x16x32_bf16 v[232:235], a[188:191], v[8:11], v[232:235]
    ds_read_b64_tr_b16 a[184:185], v241 offset:28288
    v_mul_f32_e64 v182, v253, v182
    v_mfma_f32_16x16x32_bf16 v[236:239], a[188:191], v[12:15], v[236:239]
    ds_read_b64_tr_b16 a[186:187], v241 offset:28544
    s_waitcnt lgkmcnt(8)
    v_mfma_f32_16x16x32_bf16 v[208:211], a[192:195], v[16:19], v[208:211]
    ds_read_b64_tr_b16 a[188:189], v241 offset:28320
    v_mul_f32 v183, v253, v183
    v_mfma_f32_16x16x32_bf16 v[212:215], a[192:195], v[20:23], v[212:215]
    ds_read_b64_tr_b16 a[190:191], v241 offset:28576
L_w4:
    s_cbranch_execz L_wret1
    v_mul_f32_e64 v184, v252, v184
    v_mfma_f32_16x16x32_bf16 v[216:219], a[196:199], v[16:19], v[216:219]
    ds_read_b64_tr_b16 a[192:193], v241 offset:28800
    v_mul_f32_e64 v185, v252, v185
    v_mfma_f32_16x16x32_bf16 v[220:223], a[196:199], v[20:23], v[220:223]
    ds_read_b64_tr_b16 a[194:195], v241 offset:29056
    buffer_load_dwordx4 v245, s[8:11], s66 offen offset:2048 lds
    v_mfma_f32_16x16x32_bf16 v[224:227], a[168:171], v[16:19], v[224:227]
    ds_read_b64_tr_b16 a[196:197], v241 offset:28832
    v_mul_f32_e64 v186, v252, v186
    v_mfma_f32_16x16x32_bf16 v[228:231], a[168:171], v[20:23], v[228:231]
    ds_read_b64_tr_b16 a[198:199], v241 offset:29088
    s_waitcnt lgkmcnt(8)
    v_mfma_f32_16x16x32_bf16 v[232:235], a[172:175], v[16:19], v[232:235]
    ds_read_b64_tr_b16 a[168:169], v241 offset:29312
    v_mul_f32 v187, v252, v187
    v_mfma_f32_16x16x32_bf16 v[236:239], a[172:175], v[20:23], v[236:239]
    ds_read_b64_tr_b16 a[170:171], v241 offset:29568
    v_mul_f32_e64 v188, v253, v188
    v_mfma_f32_16x16x32_bf16 v[208:211], a[176:179], v[24:27], v[208:211]
    ds_read_b64_tr_b16 a[172:173], v241 offset:29344
    v_mul_f32_e64 v189, v253, v189
    v_mfma_f32_16x16x32_bf16 v[212:215], a[176:179], v[28:31], v[212:215]
    ds_read_b64_tr_b16 a[174:175], v241 offset:29600
    v_mul_f32_e64 v190, v253, v190
    v_mfma_f32_16x16x32_bf16 v[216:219], a[180:183], v[24:27], v[216:219]
    ds_read_b64_tr_b16 a[176:177], v241 offset:29824
    v_mul_f32_e64 v191, v253, v191
    v_mfma_f32_16x16x32_bf16 v[220:223], a[180:183], v[28:31], v[220:223]
    ds_read_b64_tr_b16 a[178:179], v241 offset:30080
    s_waitcnt lgkmcnt(8)
    v_mfma_f32_16x16x32_bf16 v[224:227], a[184:187], v[24:27], v[224:227]
    ds_read_b64_tr_b16 a[180:181], v241 offset:29856
    v_mul_f32 v192, v252, v192
    v_mfma_f32_16x16x32_bf16 v[228:231], a[184:187], v[28:31], v[228:231]
    ds_read_b64_tr_b16 a[182:183], v241 offset:30112
    v_mul_f32_e64 v193, v252, v193
    v_mfma_f32_16x16x32_bf16 v[232:235], a[188:191], v[24:27], v[232:235]
    ds_read_b64_tr_b16 a[184:185], v241 offset:30336
    v_mul_f32_e64 v194, v252, v194
    v_mfma_f32_16x16x32_bf16 v[236:239], a[188:191], v[28:31], v[236:239]
    ds_read_b64_tr_b16 a[186:187], v241 offset:30592
    v_mul_f32_e64 v195, v252, v195
    v_mfma_f32_16x16x32_bf16 v[208:211], a[192:195], v[32:35], v[208:211]
    ds_read_b64_tr_b16 a[188:189], v241 offset:30368
    v_mul_f32_e64 v196, v253, v196
    v_mfma_f32_16x16x32_bf16 v[212:215], a[192:195], v[36:39], v[212:215]
    ds_read_b64_tr_b16 a[190:191], v241 offset:30624
    s_waitcnt lgkmcnt(8)
    v_mfma_f32_16x16x32_bf16 v[216:219], a[196:199], v[32:35], v[216:219]
    s_waitcnt vmcnt(23)
    s_barrier
    ds_read_b64_tr_b16 a[192:193], v242 offset:0
    v_mfma_f32_16x16x32_bf16 v[220:223], a[196:199], v[36:39], v[220:223]
    ds_read_b64_tr_b16 a[194:195], v242 offset:256
    s_and_b32 s70, s58, 15
    v_mfma_f32_16x16x32_bf16 v[224:227], a[168:171], v[32:35], v[224:227]
    ds_read_b64_tr_b16 a[196:197], v242 offset:32
    s_lshl_b32 s70, s70, 1
    v_mfma_f32_16x16x32_bf16 v[228:231], a[168:171], v[36:39], v[228:231]
    ds_read_b64_tr_b16 a[198:199], v242 offset:288
    s_and_b32 s68, s57, 1
    v_mfma_f32_16x16x32_bf16 v[232:235], a[172:175], v[32:35], v[232:235]
    ds_read_b64_tr_b16 a[168:169], v242 offset:512
    s_add_u32 s70, s70, s68
    v_mfma_f32_16x16x32_bf16 v[236:239], a[172:175], v[36:39], v[236:239]
    ds_read_b64_tr_b16 a[170:171], v242 offset:768
    s_waitcnt lgkmcnt(8)
    v_mfma_f32_16x16x32_bf16 v[208:211], a[176:179], v[40:43], v[208:211]
    ds_read_b64_tr_b16 a[172:173], v242 offset:544
    s_lshl_b32 s70, s70, 2
    v_mfma_f32_16x16x32_bf16 v[212:215], a[176:179], v[44:47], v[212:215]
    ds_read_b64_tr_b16 a[174:175], v242 offset:800
    s_add_u32 s70, s70, s56
    v_mfma_f32_16x16x32_bf16 v[216:219], a[180:183], v[40:43], v[216:219]
    ds_read_b64_tr_b16 a[176:177], v242 offset:1024
    v_accvgpr_read_b32 v251, a236
    v_mfma_f32_16x16x32_bf16 v[220:223], a[180:183], v[44:47], v[220:223]
    ds_read_b64_tr_b16 a[178:179], v242 offset:1280
    buffer_load_dword a155, v251, s[20:23], 0 offen sc1
    v_mfma_f32_16x16x32_bf16 v[224:227], a[184:187], v[40:43], v[224:227]
    ds_read_b64_tr_b16 a[180:181], v242 offset:1056
    s_lshr_b32 s67, s70, 2
    v_mfma_f32_16x16x32_bf16 v[228:231], a[184:187], v[44:47], v[228:231]
    ds_read_b64_tr_b16 a[182:183], v242 offset:1312
    s_waitcnt lgkmcnt(8)
    v_mfma_f32_16x16x32_bf16 v[232:235], a[188:191], v[40:43], v[232:235]
    ds_read_b64_tr_b16 a[184:185], v242 offset:1536
    s_and_b32 s68, s63, 0xffffff80
    v_mfma_f32_16x16x32_bf16 v[236:239], a[188:191], v[44:47], v[236:239]
    ds_read_b64_tr_b16 a[186:187], v242 offset:1792
    s_add_u32 s69, s67, 0
    v_mfma_f32_16x16x32_bf16 v[208:211], a[192:195], v[48:51], v[208:211]
    ds_read_b64_tr_b16 a[188:189], v242 offset:1568
    s_mul_i32 s69, s69, 294912
    v_mfma_f32_16x16x32_bf16 v[212:215], a[192:195], v[52:55], v[212:215]
    ds_read_b64_tr_b16 a[190:191], v242 offset:1824
    s_add_u32 s69, s69, s68
    v_mfma_f32_16x16x32_bf16 v[216:219], a[196:199], v[48:51], v[216:219]
    ds_read_b64_tr_b16 a[192:193], v242 offset:2048
    buffer_load_dwordx4 a[156:159], v243, s[8:11], s69 offen
    v_mfma_f32_16x16x32_bf16 v[220:223], a[196:199], v[52:55], v[220:223]
    ds_read_b64_tr_b16 a[194:195], v242 offset:2304
    s_waitcnt lgkmcnt(8)
    v_mfma_f32_16x16x32_bf16 v[224:227], a[168:171], v[48:51], v[224:227]
    ds_read_b64_tr_b16 a[196:197], v242 offset:2080
    buffer_load_dwordx4 a[156:159], v243, s[12:15], s69 offen
    v_mfma_f32_16x16x32_bf16 v[228:231], a[168:171], v[52:55], v[228:231]
    ds_read_b64_tr_b16 a[198:199], v242 offset:2336
    s_add_u32 s69, s70, 2
    v_mfma_f32_16x16x32_bf16 v[232:235], a[172:175], v[48:51], v[232:235]
    ds_read_b64_tr_b16 a[168:169], v242 offset:2560
    s_min_u32 s69, s69, 82
    v_mfma_f32_16x16x32_bf16 v[236:239], a[172:175], v[52:55], v[236:239]
    ds_read_b64_tr_b16 a[170:171], v242 offset:2816
    s_lshl_b32 s69, s69, 10
    v_mfma_f32_16x16x32_bf16 v[208:211], a[176:179], v[56:59], v[208:211]
    ds_read_b64_tr_b16 a[172:173], v242 offset:2592
    s_mul_i32 s68, s65, 82944
    v_mfma_f32_16x16x32_bf16 v[212:215], a[176:179], v[60:63], v[212:215]
    ds_read_b64_tr_b16 a[174:175], v242 offset:2848
    s_waitcnt lgkmcnt(8)
    v_mfma_f32_16x16x32_bf16 v[216:219], a[180:183], v[56:59], v[216:219]
    ds_read_b64_tr_b16 a[176:177], v242 offset:3072
    s_add_u32 s69, s69, s68
    v_mfma_f32_16x16x32_bf16 v[220:223], a[180:183], v[60:63], v[220:223]
    ds_read_b64_tr_b16 a[178:179], v242 offset:3328
    buffer_load_dwordx4 a[156:159], v254, s[28:31], s69 offen
    v_mfma_f32_16x16x32_bf16 v[224:227], a[184:187], v[56:59], v[224:227]
    ds_read_b64_tr_b16 a[180:181], v242 offset:3104
    s_mul_i32 s67, s70, 5184
    v_mfma_f32_16x16x32_bf16 v[228:231], a[184:187], v[60:63], v[228:231]
    ds_read_b64_tr_b16 a[182:183], v242 offset:3360
    s_mul_i32 s68, s65, 663552
    v_mfma_f32_16x16x32_bf16 v[232:235], a[188:191], v[56:59], v[232:235]
    ds_read_b64_tr_b16 a[184:185], v242 offset:3584
    s_add_u32 s67, s67, s68
    v_mfma_f32_16x16x32_bf16 v[236:239], a[188:191], v[60:63], v[236:239]
    ds_read_b64_tr_b16 a[186:187], v242 offset:3840
    s_waitcnt lgkmcnt(8)
    v_mfma_f32_16x16x32_bf16 v[208:211], a[192:195], v[64:67], v[208:211]
    ds_read_b64_tr_b16 a[188:189], v242 offset:3616
    s_add_u32 s67, s67, 2048
    v_mfma_f32_16x16x32_bf16 v[212:215], a[192:195], v[68:71], v[212:215]
    ds_read_b64_tr_b16 a[190:191], v242 offset:3872
    buffer_load_dwordx4 a[156:159], v254, s[16:19], s67 offen offset:0
    v_mfma_f32_16x16x32_bf16 v[216:219], a[196:199], v[64:67], v[216:219]
    ds_read_b64_tr_b16 a[192:193], v242 offset:4096
    v_mul_f32 v197, v253, v197
    v_mfma_f32_16x16x32_bf16 v[220:223], a[196:199], v[68:71], v[220:223]
    ds_read_b64_tr_b16 a[194:195], v242 offset:4352
    buffer_load_dwordx4 a[156:159], v254, s[16:19], s67 offen offset:1024
    v_mfma_f32_16x16x32_bf16 v[224:227], a[168:171], v[64:67], v[224:227]
    ds_read_b64_tr_b16 a[196:197], v242 offset:4128
    v_mul_f32_e64 v198, v253, v198
    v_mfma_f32_16x16x32_bf16 v[228:231], a[168:171], v[68:71], v[228:231]
    ds_read_b64_tr_b16 a[198:199], v242 offset:4384
    s_waitcnt lgkmcnt(8)
    v_mfma_f32_16x16x32_bf16 v[232:235], a[172:175], v[64:67], v[232:235]
    ds_read_b64_tr_b16 a[168:169], v242 offset:4608
    buffer_load_dwordx4 a[156:159], v254, s[16:19], s67 offen offset:2048
    v_mfma_f32_16x16x32_bf16 v[236:239], a[172:175], v[68:71], v[236:239]
    ds_read_b64_tr_b16 a[170:171], v242 offset:4864
    v_mul_f32 v199, v253, v199
    v_mfma_f32_16x16x32_bf16 v[208:211], a[176:179], v[72:75], v[208:211]
    ds_read_b64_tr_b16 a[172:173], v242 offset:4640
    buffer_load_dwordx4 a[156:159], v254, s[16:19], s67 offen offset:3072
    v_mfma_f32_16x16x32_bf16 v[212:215], a[176:179], v[76:79], v[212:215]
    ds_read_b64_tr_b16 a[174:175], v242 offset:4896
    s_add_u32 s67, s67, 4096
    v_mfma_f32_16x16x32_bf16 v[216:219], a[180:183], v[72:75], v[216:219]
    ds_read_b64_tr_b16 a[176:177], v242 offset:5120
    buffer_load_dwordx4 a[156:159], v254, s[16:19], s67 offen offset:0
    v_mfma_f32_16x16x32_bf16 v[220:223], a[180:183], v[76:79], v[220:223]
    ds_read_b64_tr_b16 a[178:179], v242 offset:5376
    s_waitcnt lgkmcnt(8)
    v_mfma_f32_16x16x32_bf16 v[224:227], a[184:187], v[72:75], v[224:227]
    ds_read_b64_tr_b16 a[180:181], v242 offset:5152
    buffer_load_dwordx4 a[156:159], v254, s[16:19], s67 offen offset:1024
    v_mfma_f32_16x16x32_bf16 v[228:231], a[184:187], v[76:79], v[228:231]
    ds_read_b64_tr_b16 a[182:183], v242 offset:5408
    v_mul_f32 v200, v252, v200
    v_mfma_f32_16x16x32_bf16 v[232:235], a[188:191], v[72:75], v[232:235]
    ds_read_b64_tr_b16 a[184:185], v242 offset:5632
    s_add_u32 m0, s64, 49408
    v_mfma_f32_16x16x32_bf16 v[236:239], a[188:191], v[76:79], v[236:239]
    ds_read_b64_tr_b16 a[186:187], v242 offset:5888
    s_add_u32 s66, s61, s98
    v_mfma_f32_16x16x32_bf16 v[208:211], a[192:195], v[80:83], v[208:211]
    ds_read_b64_tr_b16 a[188:189], v242 offset:5664
    v_mul_f32 v201, v252, v201
    v_mfma_f32_16x16x32_bf16 v[212:215], a[192:195], v[84:87], v[212:215]
    ds_read_b64_tr_b16 a[190:191], v242 offset:5920
    s_waitcnt lgkmcnt(8)
    v_mfma_f32_16x16x32_bf16 v[216:219], a[196:199], v[80:83], v[216:219]
    s_waitcnt vmcnt(25)
    s_barrier
    ds_read_b64_tr_b16 a[192:193], v242 offset:24704
    v_mfma_f32_16x16x32_bf16 v[220:223], a[196:199], v[84:87], v[220:223]
    ds_read_b64_tr_b16 a[194:195], v242 offset:24960
    v_mul_f32 v202, v252, v202
    v_mfma_f32_16x16x32_bf16 v[224:227], a[168:171], v[80:83], v[224:227]
    ds_read_b64_tr_b16 a[196:197], v242 offset:24736
    v_mul_f32_e64 v203, v252, v203
    v_mfma_f32_16x16x32_bf16 v[228:231], a[168:171], v[84:87], v[228:231]
    ds_read_b64_tr_b16 a[198:199], v242 offset:24992
    v_mul_f32_e64 v204, v253, v204
    v_mfma_f32_16x16x32_bf16 v[232:235], a[172:175], v[80:83], v[232:235]
    ds_read_b64_tr_b16 a[168:169], v242 offset:25216
    v_mul_f32_e64 v205, v253, v205
    v_mfma_f32_16x16x32_bf16 v[236:239], a[172:175], v[84:87], v[236:239]
    ds_read_b64_tr_b16 a[170:171], v242 offset:25472
    s_waitcnt lgkmcnt(8)
    v_mfma_f32_16x16x32_bf16 v[208:211], a[176:179], v[88:91], v[208:211]
    ds_read_b64_tr_b16 a[172:173], v242 offset:25248
    v_mul_f32 v206, v253, v206
    v_mfma_f32_16x16x32_bf16 v[212:215], a[176:179], v[92:95], v[212:215]
    ds_read_b64_tr_b16 a[174:175], v242 offset:25504
    v_mul_f32_e64 v207, v253, v207
    v_mfma_f32_16x16x32_bf16 v[216:219], a[180:183], v[88:91], v[216:219]
    ds_read_b64_tr_b16 a[176:177], v242 offset:25728
    s_add_u32 s95, s94, s52
    v_mfma_f32_16x16x32_bf16 v[220:223], a[180:183], v[92:95], v[220:223]
    ds_read_b64_tr_b16 a[178:179], v242 offset:25984
    s_add_u32 s24, s84, 36864
    v_mfma_f32_16x16x32_bf16 v[224:227], a[184:187], v[88:91], v[224:227]
    ds_read_b64_tr_b16 a[180:181], v242 offset:25760
    s_add_u32 s25, s85, 36864
    v_mfma_f32_16x16x32_bf16 v[228:231], a[184:187], v[92:95], v[228:231]
    ds_read_b64_tr_b16 a[182:183], v242 offset:26016
    s_waitcnt lgkmcnt(8)
    v_mfma_f32_16x16x32_bf16 v[232:235], a[188:191], v[88:91], v[232:235]
    ds_read_b64_tr_b16 a[184:185], v242 offset:26240
    s_add_u32 s26, s86, 36864
    v_mfma_f32_16x16x32_bf16 v[236:239], a[188:191], v[92:95], v[236:239]
    ds_read_b64_tr_b16 a[186:187], v242 offset:26496
    s_add_u32 s27, s87, 36864
    v_mfma_f32_16x16x32_bf16 v[208:211], a[192:195], v[96:99], v[208:211]
    ds_read_b64_tr_b16 a[188:189], v242 offset:26272
    s_add_u32 s99, s89, 36864
    v_mfma_f32_16x16x32_bf16 v[212:215], a[192:195], v[100:103], v[212:215]
    ds_read_b64_tr_b16 a[190:191], v242 offset:26528
    s_add_u32 s100, s90, 36864
    v_mfma_f32_16x16x32_bf16 v[216:219], a[196:199], v[96:99], v[216:219]
    ds_read_b64_tr_b16 a[192:193], v242 offset:26752
    s_add_u32 s101, s91, 36864
    v_mfma_f32_16x16x32_bf16 v[220:223], a[196:199], v[100:103], v[220:223]
    ds_read_b64_tr_b16 a[194:195], v242 offset:27008
    s_waitcnt lgkmcnt(8)
    v_mfma_f32_16x16x32_bf16 v[224:227], a[168:171], v[96:99], v[224:227]
    ds_read_b64_tr_b16 a[196:197], v242 offset:26784
    s_add_u32 s77, s92, 36864
    v_mfma_f32_16x16x32_bf16 v[228:231], a[168:171], v[100:103], v[228:231]
    ds_read_b64_tr_b16 a[198:199], v242 offset:27040
    v_bfe_u32 v147, v254, 4, 4
    v_mfma_f32_16x16x32_bf16 v[232:235], a[172:175], v[96:99], v[232:235]
    ds_read_b64_tr_b16 a[168:169], v242 offset:27264
    v_lshrrev_b32 v148, 8, v254
    v_mfma_f32_16x16x32_bf16 v[236:239], a[172:175], v[100:103], v[236:239]
    ds_read_b64_tr_b16 a[170:171], v242 offset:27520
    s_lshl_b32 s45, s56, 8
    v_mfma_f32_16x16x32_bf16 v[208:211], a[176:179], v[104:107], v[208:211]
    ds_read_b64_tr_b16 a[172:173], v242 offset:27296
    s_add_u32 s45, s45, 101120
    v_mfma_f32_16x16x32_bf16 v[212:215], a[176:179], v[108:111], v[212:215]
    ds_read_b64_tr_b16 a[174:175], v242 offset:27552
    s_waitcnt lgkmcnt(8)
    v_mfma_f32_16x16x32_bf16 v[216:219], a[180:183], v[104:107], v[216:219]
    ds_read_b64_tr_b16 a[176:177], v242 offset:27776
    v_lshlrev_b32_e64 v144, 3, v147
    v_mfma_f32_16x16x32_bf16 v[220:223], a[180:183], v[108:111], v[220:223]
    ds_read_b64_tr_b16 a[178:179], v242 offset:28032
    v_add_u32_e64 v144, s45, v144
    v_mfma_f32_16x16x32_bf16 v[224:227], a[184:187], v[104:107], v[224:227]
    ds_read_b64_tr_b16 a[180:181], v242 offset:27808
    v_mul_u32_u24 v145, 6272, v148
    v_mfma_f32_16x16x32_bf16 v[228:231], a[184:187], v[108:111], v[228:231]
    ds_read_b64_tr_b16 a[182:183], v242 offset:28064
    v_add_u32_e64 v145, v145, v144
    v_mfma_f32_16x16x32_bf16 v[232:235], a[188:191], v[104:107], v[232:235]
    ds_read_b64_tr_b16 a[184:185], v242 offset:28288
    v_accvgpr_write_b32 a214, v145
    v_mfma_f32_16x16x32_bf16 v[236:239], a[188:191], v[108:111], v[236:239]
    ds_read_b64_tr_b16 a[186:187], v242 offset:28544
    s_waitcnt lgkmcnt(8)
    v_mfma_f32_16x16x32_bf16 v[208:211], a[192:195], v[112:115], v[208:211]
    ds_read_b64_tr_b16 a[188:189], v242 offset:28320
    v_lshl_add_u32 v145, v148, 1, 6
    v_mfma_f32_16x16x32_bf16 v[212:215], a[192:195], v[116:119], v[212:215]
    ds_read_b64_tr_b16 a[190:191], v242 offset:28576
    v_cmp_gt_u32 s[40:41], 2, v148
    v_mfma_f32_16x16x32_bf16 v[216:219], a[196:199], v[112:115], v[216:219]
    ds_read_b64_tr_b16 a[192:193], v242 offset:28800
    v_cndmask_b32 v145, 4, v145, s[40:41]
    v_mfma_f32_16x16x32_bf16 v[220:223], a[196:199], v[116:119], v[220:223]
    ds_read_b64_tr_b16 a[194:195], v242 offset:29056
    v_mul_u32_u24 v145, 3136, v145
    v_mfma_f32_16x16x32_bf16 v[224:227], a[168:171], v[112:115], v[224:227]
    ds_read_b64_tr_b16 a[196:197], v242 offset:28832
    v_add_u32 v145, v145, v144
    v_mfma_f32_16x16x32_bf16 v[228:231], a[168:171], v[116:119], v[228:231]
    ds_read_b64_tr_b16 a[198:199], v242 offset:29088
    s_waitcnt lgkmcnt(8)
    v_mfma_f32_16x16x32_bf16 v[232:235], a[172:175], v[112:115], v[232:235]
    ds_read_b64_tr_b16 a[168:169], v242 offset:29312
    v_accvgpr_write_b32 a215, v145
    v_mfma_f32_16x16x32_bf16 v[236:239], a[172:175], v[116:119], v[236:239]
    ds_read_b64_tr_b16 a[170:171], v242 offset:29568
    v_lshrrev_b32 v144, 6, v254
    v_mfma_f32_16x16x32_bf16 v[208:211], a[176:179], v[120:123], v[208:211]
    ds_read_b64_tr_b16 a[172:173], v242 offset:29344
    v_lshlrev_b32_e64 v144, 3, v144
    v_mfma_f32_16x16x32_bf16 v[212:215], a[176:179], v[124:127], v[212:215]
    ds_read_b64_tr_b16 a[174:175], v242 offset:29600
    buffer_load_dwordx4 v243, s[8:11], s66 offen offset:0 lds
    v_mfma_f32_16x16x32_bf16 v[216:219], a[180:183], v[120:123], v[216:219]
    ds_read_b64_tr_b16 a[176:177], v242 offset:29824
    s_add_u32 s45, s45, 31360
    v_mfma_f32_16x16x32_bf16 v[220:223], a[180:183], v[124:127], v[220:223]
    ds_read_b64_tr_b16 a[178:179], v242 offset:30080
    s_waitcnt lgkmcnt(8)
    v_mfma_f32_16x16x32_bf16 v[224:227], a[184:187], v[120:123], v[224:227]
    ds_read_b64_tr_b16 a[180:181], v242 offset:29856
    v_add_u32 v144, s45, v144
    v_mfma_f32_16x16x32_bf16 v[228:231], a[184:187], v[124:127], v[228:231]
    ds_read_b64_tr_b16 a[182:183], v242 offset:30112
    v_bfe_u32 v145, v254, 4, 2
    v_mfma_f32_16x16x32_bf16 v[232:235], a[188:191], v[120:123], v[232:235]
    ds_read_b64_tr_b16 a[184:185], v242 offset:30336
    v_mul_u32_u24 v146, 3136, v145
    v_mfma_f32_16x16x32_bf16 v[236:239], a[188:191], v[124:127], v[236:239]
    ds_read_b64_tr_b16 a[186:187], v242 offset:30592
    buffer_load_dwordx4 v244, s[8:11], s66 offen offset:1024 lds
    v_mfma_f32_16x16x32_bf16 v[208:211], a[192:195], v[128:131], v[208:211]
    ds_read_b64_tr_b16 a[188:189], v242 offset:30368
    v_add_u32_e64 v146, v146, v144
    v_mfma_f32_16x16x32_bf16 v[212:215], a[192:195], v[132:135], v[212:215]
    ds_read_b64_tr_b16 a[190:191], v242 offset:30624
    s_waitcnt lgkmcnt(8)
    v_mfma_f32_16x16x32_bf16 v[216:219], a[196:199], v[128:131], v[216:219]
    s_waitcnt vmcnt(19)
    s_barrier
    ds_read_b64_tr_b16 a[192:193], v240 offset:0
    v_mfma_f32_16x16x32_bf16 v[220:223], a[196:199], v[132:135], v[220:223]
    ds_read_b64_tr_b16 a[194:195], v240 offset:256
    v_accvgpr_write_b32 a216, v146
    v_mfma_f32_16x16x32_bf16 v[224:227], a[168:171], v[128:131], v[224:227]
    ds_read_b64_tr_b16 a[196:197], v240 offset:32
    v_min_u32 v145, 1, v145
    v_mfma_f32_16x16x32_bf16 v[228:231], a[168:171], v[132:135], v[228:231]
    ds_read_b64_tr_b16 a[198:199], v240 offset:288
    buffer_load_dwordx4 v245, s[8:11], s66 offen offset:2048 lds
    v_mfma_f32_16x16x32_bf16 v[232:235], a[172:175], v[128:131], v[232:235]
    ds_read_b64_tr_b16 a[168:169], v240 offset:512
    s_add_u32 m0, s64, 52480
    v_mfma_f32_16x16x32_bf16 v[236:239], a[172:175], v[132:135], v[236:239]
    ds_read_b64_tr_b16 a[170:171], v240 offset:768
    s_waitcnt lgkmcnt(8)
    v_mfma_f32_16x16x32_bf16 v[208:211], a[176:179], v[136:139], v[208:211]
    ds_read_b64_tr_b16 a[172:173], v240 offset:544
    s_add_u32 s66, s66, 884736
    v_mfma_f32_16x16x32_bf16 v[212:215], a[176:179], v[140:143], v[212:215]
    ds_read_b64_tr_b16 a[174:175], v240 offset:800
    v_add_u32 v145, 4, v145
    v_mfma_f32_16x16x32_bf16 v[216:219], a[180:183], v[136:139], v[216:219]
    ds_read_b64_tr_b16 a[176:177], v240 offset:1024
    v_mul_u32_u24 v146, 3136, v145
    v_mfma_f32_16x16x32_bf16 v[220:223], a[180:183], v[140:143], v[220:223]
    ds_read_b64_tr_b16 a[178:179], v240 offset:1280
    buffer_load_dwordx4 v243, s[8:11], s66 offen offset:0 lds
    v_mfma_f32_16x16x32_bf16 v[224:227], a[184:187], v[136:139], v[224:227]
    ds_read_b64_tr_b16 a[180:181], v240 offset:1056
    v_add_u32_e64 v146, v146, v144
    v_mfma_f32_16x16x32_bf16 v[228:231], a[184:187], v[140:143], v[228:231]
    ds_read_b64_tr_b16 a[182:183], v240 offset:1312
    s_waitcnt lgkmcnt(8)
    v_mfma_f32_16x16x32_bf16 v[232:235], a[188:191], v[136:139], v[232:235]
    ds_read_b64_tr_b16 a[184:185], v240 offset:1536
    v_accvgpr_write_b32 a217, v146
    v_mfma_f32_16x16x32_bf16 v[236:239], a[188:191], v[140:143], v[236:239]
    ds_read_b64_tr_b16 a[186:187], v240 offset:1792
    v_mul_u32_u24 v144, 1152, v147
    v_lshl_add_u32 v144, v148, 3, v144
    v_accvgpr_write_b32 a218, v144
    s_nop 1
    v_mfma_f32_16x16x32_bf16 v[144:147], a[192:195], v[0:3], 0
    ds_read_b64_tr_b16 a[188:189], v240 offset:1568
    v_mfma_f32_16x16x32_bf16 v[148:151], a[192:195], v[4:7], 0
    ds_read_b64_tr_b16 a[190:191], v240 offset:1824
    buffer_load_dwordx4 v244, s[8:11], s66 offen offset:1024 lds
    v_mfma_f32_16x16x32_bf16 v[152:155], a[196:199], v[0:3], 0
    ds_read_b64_tr_b16 a[192:193], v240 offset:2048
    v_mfma_f32_16x16x32_bf16 v[156:159], a[196:199], v[4:7], 0
    ds_read_b64_tr_b16 a[194:195], v240 offset:2304
    s_waitcnt lgkmcnt(8)
    v_mfma_f32_16x16x32_bf16 v[160:163], a[168:171], v[0:3], 0
    ds_read_b64_tr_b16 a[196:197], v240 offset:2080
    s_add_u32 s72, s74, 4096
    v_mfma_f32_16x16x32_bf16 v[164:167], a[168:171], v[4:7], 0
    ds_read_b64_tr_b16 a[198:199], v240 offset:2336
    v_mul_f32 v176, v176, v208
    v_mfma_f32_16x16x32_bf16 v[168:171], a[172:175], v[0:3], 0
    ds_read_b64_tr_b16 a[168:169], v240 offset:2560
    v_mul_f32_e64 v177, v177, v209
    v_mfma_f32_16x16x32_bf16 v[172:175], a[172:175], v[4:7], 0
    ds_read_b64_tr_b16 a[170:171], v240 offset:2816
    buffer_load_dwordx4 v245, s[8:11], s66 offen offset:2048 lds
    v_mfma_f32_16x16x32_bf16 v[144:147], a[176:179], v[8:11], v[144:147]
    ds_read_b64_tr_b16 a[172:173], v240 offset:2592
    s_add_u32 m0, s64, 74112
    v_mfma_f32_16x16x32_bf16 v[148:151], a[176:179], v[12:15], v[148:151]
    ds_read_b64_tr_b16 a[174:175], v240 offset:2848
    s_waitcnt lgkmcnt(8)
    v_mfma_f32_16x16x32_bf16 v[152:155], a[180:183], v[8:11], v[152:155]
    ds_read_b64_tr_b16 a[176:177], v240 offset:3072
    s_add_u32 s66, s61, s96
    v_mfma_f32_16x16x32_bf16 v[156:159], a[180:183], v[12:15], v[156:159]
    ds_read_b64_tr_b16 a[178:179], v240 offset:3328
    v_mul_f32_e64 v178, v178, v210
    v_mfma_f32_16x16x32_bf16 v[160:163], a[184:187], v[8:11], v[160:163]
    ds_read_b64_tr_b16 a[180:181], v240 offset:3104
    v_mul_f32_e64 v179, v179, v211
    v_mfma_f32_16x16x32_bf16 v[164:167], a[184:187], v[12:15], v[164:167]
    ds_read_b64_tr_b16 a[182:183], v240 offset:3360
    v_mul_f32_e64 v184, v184, v216
    v_mfma_f32_16x16x32_bf16 v[168:171], a[188:191], v[8:11], v[168:171]
    ds_read_b64_tr_b16 a[184:185], v240 offset:3584
    v_mul_f32_e64 v185, v185, v217
    v_mfma_f32_16x16x32_bf16 v[172:175], a[188:191], v[12:15], v[172:175]
    ds_read_b64_tr_b16 a[186:187], v240 offset:3840
    s_waitcnt lgkmcnt(8)
    v_mfma_f32_16x16x32_bf16 v[144:147], a[192:195], v[16:19], v[144:147]
    ds_read_b64_tr_b16 a[188:189], v240 offset:3616
    v_mul_f32 v186, v186, v218
    v_mfma_f32_16x16x32_bf16 v[148:151], a[192:195], v[20:23], v[148:151]
    ds_read_b64_tr_b16 a[190:191], v240 offset:3872
    v_mul_f32_e64 v187, v187, v219
    v_mfma_f32_16x16x32_bf16 v[152:155], a[196:199], v[16:19], v[152:155]
    ds_read_b64_tr_b16 a[192:193], v240 offset:4096
    v_cvt_pk_bf16_f32 v176, v176, v177
    v_mfma_f32_16x16x32_bf16 v[156:159], a[196:199], v[20:23], v[156:159]
    ds_read_b64_tr_b16 a[194:195], v240 offset:4352
    v_cvt_pk_bf16_f32 v177, v178, v179
    v_mfma_f32_16x16x32_bf16 v[160:163], a[168:171], v[16:19], v[160:163]
    ds_read_b64_tr_b16 a[196:197], v240 offset:4128
    v_cvt_pk_bf16_f32 v178, v184, v185
    v_mfma_f32_16x16x32_bf16 v[164:167], a[168:171], v[20:23], v[164:167]
    ds_read_b64_tr_b16 a[198:199], v240 offset:4384
    s_waitcnt lgkmcnt(8)
    v_mfma_f32_16x16x32_bf16 v[168:171], a[172:175], v[16:19], v[168:171]
    ds_read_b64_tr_b16 a[168:169], v240 offset:4608
    v_cvt_pk_bf16_f32 v179, v186, v187
    v_mfma_f32_16x16x32_bf16 v[172:175], a[172:175], v[20:23], v[172:175]
    ds_read_b64_tr_b16 a[170:171], v240 offset:4864
    buffer_load_dwordx4 v243, s[12:15], s66 offen offset:0 lds
    v_mfma_f32_16x16x32_bf16 v[144:147], a[176:179], v[24:27], v[144:147]
    ds_read_b64_tr_b16 a[172:173], v240 offset:4640
    v_accvgpr_write_b32 a16, v176
    v_mfma_f32_16x16x32_bf16 v[148:151], a[176:179], v[28:31], v[148:151]
    ds_read_b64_tr_b16 a[174:175], v240 offset:4896
    v_accvgpr_write_b32 a17, v177
    v_mfma_f32_16x16x32_bf16 v[152:155], a[180:183], v[24:27], v[152:155]
    ds_read_b64_tr_b16 a[176:177], v240 offset:5120
    v_accvgpr_write_b32 a18, v178
    v_mfma_f32_16x16x32_bf16 v[156:159], a[180:183], v[28:31], v[156:159]
    ds_read_b64_tr_b16 a[178:179], v240 offset:5376
    s_waitcnt lgkmcnt(8)
    v_mfma_f32_16x16x32_bf16 v[160:163], a[184:187], v[24:27], v[160:163]
    ds_read_b64_tr_b16 a[180:181], v240 offset:5152
    v_accvgpr_write_b32 a19, v179
    v_mfma_f32_16x16x32_bf16 v[164:167], a[184:187], v[28:31], v[164:167]
    ds_read_b64_tr_b16 a[182:183], v240 offset:5408
    buffer_load_dwordx4 v244, s[12:15], s66 offen offset:1024 lds
    v_mfma_f32_16x16x32_bf16 v[168:171], a[188:191], v[24:27], v[168:171]
    ds_read_b64_tr_b16 a[184:185], v240 offset:5632
    v_mfma_f32_16x16x32_bf16 v[172:175], a[188:191], v[28:31], v[172:175]
    ds_read_b64_tr_b16 a[186:187], v240 offset:5888
    v_mfma_f32_16x16x32_bf16 v[144:147], a[192:195], v[32:35], v[144:147]
    ds_read_b64_tr_b16 a[188:189], v240 offset:5664
    buffer_store_dwordx4 v[176:179], v254, s[20:23], s72 offen offset:0 sc1
    v_mfma_f32_16x16x32_bf16 v[148:151], a[192:195], v[36:39], v[148:151]
    ds_read_b64_tr_b16 a[190:191], v240 offset:5920
    s_waitcnt lgkmcnt(8)
    v_mfma_f32_16x16x32_bf16 v[152:155], a[196:199], v[32:35], v[152:155]
    s_waitcnt vmcnt(19)
    s_barrier
    v_accvgpr_read_b32 v249, a213
    buffer_load_dword v250, v249, s[20:23], 0 offen sc1
    ds_read_b64_tr_b16 a[192:193], v240 offset:24704
    v_mfma_f32_16x16x32_bf16 v[156:159], a[196:199], v[36:39], v[156:159]
    ds_read_b64_tr_b16 a[194:195], v240 offset:24960
    buffer_load_dwordx4 v245, s[12:15], s66 offen offset:2048 lds
    v_mfma_f32_16x16x32_bf16 v[160:163], a[168:171], v[32:35], v[160:163]
    ds_read_b64_tr_b16 a[196:197], v240 offset:24736
    s_add_u32 m0, s64, 77184
    v_mfma_f32_16x16x32_bf16 v[164:167], a[168:171], v[36:39], v[164:167]
    ds_read_b64_tr_b16 a[198:199], v240 offset:24992
    s_add_u32 s66, s66, 884736
    v_mfma_f32_16x16x32_bf16 v[168:171], a[172:175], v[32:35], v[168:171]
    ds_read_b64_tr_b16 a[168:169], v240 offset:25216
    v_mul_f32 v180, v180, v212
    v_mfma_f32_16x16x32_bf16 v[172:175], a[172:175], v[36:39], v[172:175]
    ds_read_b64_tr_b16 a[170:171], v240 offset:25472
    s_waitcnt lgkmcnt(8)
    v_mfma_f32_16x16x32_bf16 v[144:147], a[176:179], v[40:43], v[144:147]
    ds_read_b64_tr_b16 a[172:173], v240 offset:25248
    v_mul_f32 v181, v181, v213
    v_mfma_f32_16x16x32_bf16 v[148:151], a[176:179], v[44:47], v[148:151]
    ds_read_b64_tr_b16 a[174:175], v240 offset:25504
    buffer_load_dwordx4 v243, s[12:15], s66 offen offset:0 lds
    v_mfma_f32_16x16x32_bf16 v[152:155], a[180:183], v[40:43], v[152:155]
    ds_read_b64_tr_b16 a[176:177], v240 offset:25728
    v_mul_f32_e64 v182, v182, v214
    v_mfma_f32_16x16x32_bf16 v[156:159], a[180:183], v[44:47], v[156:159]
    ds_read_b64_tr_b16 a[178:179], v240 offset:25984
    v_mul_f32_e64 v183, v183, v215
    v_mfma_f32_16x16x32_bf16 v[160:163], a[184:187], v[40:43], v[160:163]
    ds_read_b64_tr_b16 a[180:181], v240 offset:25760
    v_mul_f32_e64 v188, v188, v220
    v_mfma_f32_16x16x32_bf16 v[164:167], a[184:187], v[44:47], v[164:167]
    ds_read_b64_tr_b16 a[182:183], v240 offset:26016
    s_waitcnt lgkmcnt(8)
    v_mfma_f32_16x16x32_bf16 v[168:171], a[188:191], v[40:43], v[168:171]
    ds_read_b64_tr_b16 a[184:185], v240 offset:26240
    v_mul_f32 v189, v189, v221
    v_mfma_f32_16x16x32_bf16 v[172:175], a[188:191], v[44:47], v[172:175]
    ds_read_b64_tr_b16 a[186:187], v240 offset:26496
    buffer_load_dwordx4 v244, s[12:15], s66 offen offset:1024 lds
    v_mfma_f32_16x16x32_bf16 v[144:147], a[192:195], v[48:51], v[144:147]
    ds_read_b64_tr_b16 a[188:189], v240 offset:26272
    v_mul_f32_e64 v190, v190, v222
    v_mfma_f32_16x16x32_bf16 v[148:151], a[192:195], v[52:55], v[148:151]
    ds_read_b64_tr_b16 a[190:191], v240 offset:26528
    v_mul_f32_e64 v191, v191, v223
    v_mfma_f32_16x16x32_bf16 v[152:155], a[196:199], v[48:51], v[152:155]
    ds_read_b64_tr_b16 a[192:193], v240 offset:26752
    v_cvt_pk_bf16_f32 v180, v180, v181
    v_mfma_f32_16x16x32_bf16 v[156:159], a[196:199], v[52:55], v[156:159]
    ds_read_b64_tr_b16 a[194:195], v240 offset:27008
    s_waitcnt lgkmcnt(8)
    v_mfma_f32_16x16x32_bf16 v[160:163], a[168:171], v[48:51], v[160:163]
    ds_read_b64_tr_b16 a[196:197], v240 offset:26784
    v_cvt_pk_bf16_f32 v181, v182, v183
    v_mfma_f32_16x16x32_bf16 v[164:167], a[168:171], v[52:55], v[164:167]
    ds_read_b64_tr_b16 a[198:199], v240 offset:27040
    buffer_load_dwordx4 v245, s[12:15], s66 offen offset:2048 lds
    v_mfma_f32_16x16x32_bf16 v[168:171], a[172:175], v[48:51], v[168:171]
    ds_read_b64_tr_b16 a[168:169], v240 offset:27264
    s_add_u32 m0, s64, 98816
L_w5:
    s_cbranch_execz L_wret1
    v_mfma_f32_16x16x32_bf16 v[172:175], a[172:175], v[52:55], v[172:175]
    ds_read_b64_tr_b16 a[170:171], v240 offset:27520
    s_add_u32 s66, s61, s97
    v_mfma_f32_16x16x32_bf16 v[144:147], a[176:179], v[56:59], v[144:147]
    ds_read_b64_tr_b16 a[172:173], v240 offset:27296
    v_cvt_pk_bf16_f32 v182, v188, v189
    v_mfma_f32_16x16x32_bf16 v[148:151], a[176:179], v[60:63], v[148:151]
    ds_read_b64_tr_b16 a[174:175], v240 offset:27552
    s_waitcnt lgkmcnt(8)
    v_mfma_f32_16x16x32_bf16 v[152:155], a[180:183], v[56:59], v[152:155]
    ds_read_b64_tr_b16 a[176:177], v240 offset:27776
    v_cvt_pk_bf16_f32 v183, v190, v191
    v_mfma_f32_16x16x32_bf16 v[156:159], a[180:183], v[60:63], v[156:159]
    ds_read_b64_tr_b16 a[178:179], v240 offset:28032
    buffer_load_dwordx4 v243, s[12:15], s66 offen offset:0 lds
    v_mfma_f32_16x16x32_bf16 v[160:163], a[184:187], v[56:59], v[160:163]
    ds_read_b64_tr_b16 a[180:181], v240 offset:27808
    v_accvgpr_write_b32 a20, v180
    v_mfma_f32_16x16x32_bf16 v[164:167], a[184:187], v[60:63], v[164:167]
    ds_read_b64_tr_b16 a[182:183], v240 offset:28064
    v_accvgpr_write_b32 a21, v181
    v_mfma_f32_16x16x32_bf16 v[168:171], a[188:191], v[56:59], v[168:171]
    ds_read_b64_tr_b16 a[184:185], v240 offset:28288
    v_accvgpr_write_b32 a22, v182
    v_mfma_f32_16x16x32_bf16 v[172:175], a[188:191], v[60:63], v[172:175]
    ds_read_b64_tr_b16 a[186:187], v240 offset:28544
    s_waitcnt lgkmcnt(8)
    v_mfma_f32_16x16x32_bf16 v[144:147], a[192:195], v[64:67], v[144:147]
    ds_read_b64_tr_b16 a[188:189], v240 offset:28320
    v_accvgpr_write_b32 a23, v183
    v_mfma_f32_16x16x32_bf16 v[148:151], a[192:195], v[68:71], v[148:151]
    ds_read_b64_tr_b16 a[190:191], v240 offset:28576
    buffer_load_dwordx4 v244, s[12:15], s66 offen offset:1024 lds
    v_mfma_f32_16x16x32_bf16 v[152:155], a[196:199], v[64:67], v[152:155]
    ds_read_b64_tr_b16 a[192:193], v240 offset:28800
    v_mfma_f32_16x16x32_bf16 v[156:159], a[196:199], v[68:71], v[156:159]
    ds_read_b64_tr_b16 a[194:195], v240 offset:29056
    v_mfma_f32_16x16x32_bf16 v[160:163], a[168:171], v[64:67], v[160:163]
    ds_read_b64_tr_b16 a[196:197], v240 offset:28832
    buffer_store_dwordx4 v[180:183], v254, s[20:23], s72 offen offset:1024 sc1
    v_mfma_f32_16x16x32_bf16 v[164:167], a[168:171], v[68:71], v[164:167]
    ds_read_b64_tr_b16 a[198:199], v240 offset:29088
    s_waitcnt lgkmcnt(8)
    v_mfma_f32_16x16x32_bf16 v[168:171], a[172:175], v[64:67], v[168:171]
    ds_read_b64_tr_b16 a[168:169], v240 offset:29312
    s_add_u32 s72, s74, 6144
    v_mfma_f32_16x16x32_bf16 v[172:175], a[172:175], v[68:71], v[172:175]
    ds_read_b64_tr_b16 a[170:171], v240 offset:29568
    buffer_load_dwordx4 v245, s[12:15], s66 offen offset:2048 lds
    v_mfma_f32_16x16x32_bf16 v[144:147], a[176:179], v[72:75], v[144:147]
    ds_read_b64_tr_b16 a[172:173], v240 offset:29344
    s_add_u32 m0, s64, 101888
    v_mfma_f32_16x16x32_bf16 v[148:151], a[176:179], v[76:79], v[148:151]
    ds_read_b64_tr_b16 a[174:175], v240 offset:29600
    s_add_u32 s66, s66, 884736
    v_mfma_f32_16x16x32_bf16 v[152:155], a[180:183], v[72:75], v[152:155]
    ds_read_b64_tr_b16 a[176:177], v240 offset:29824
    v_mul_f32 v192, v192, v224
    v_mfma_f32_16x16x32_bf16 v[156:159], a[180:183], v[76:79], v[156:159]
    ds_read_b64_tr_b16 a[178:179], v240 offset:30080
    s_waitcnt lgkmcnt(8)
    v_mfma_f32_16x16x32_bf16 v[160:163], a[184:187], v[72:75], v[160:163]
    ds_read_b64_tr_b16 a[180:181], v240 offset:29856
    v_mul_f32 v193, v193, v225
    v_mfma_f32_16x16x32_bf16 v[164:167], a[184:187], v[76:79], v[164:167]
    ds_read_b64_tr_b16 a[182:183], v240 offset:30112
    buffer_load_dwordx4 v243, s[12:15], s66 offen offset:0 lds
    v_mfma_f32_16x16x32_bf16 v[168:171], a[188:191], v[72:75], v[168:171]
    ds_read_b64_tr_b16 a[184:185], v240 offset:30336
    v_mul_f32_e64 v194, v194, v226
    v_mfma_f32_16x16x32_bf16 v[172:175], a[188:191], v[76:79], v[172:175]
    ds_read_b64_tr_b16 a[186:187], v240 offset:30592
    v_mul_f32_e64 v195, v195, v227
    v_mfma_f32_16x16x32_bf16 v[144:147], a[192:195], v[80:83], v[144:147]
    ds_read_b64_tr_b16 a[188:189], v240 offset:30368
    v_mul_f32_e64 v200, v200, v232
    v_mfma_f32_16x16x32_bf16 v[148:151], a[192:195], v[84:87], v[148:151]
    ds_read_b64_tr_b16 a[190:191], v240 offset:30624
    s_waitcnt lgkmcnt(8)
    v_mfma_f32_16x16x32_bf16 v[152:155], a[196:199], v[80:83], v[152:155]
    s_waitcnt vmcnt(13)
    s_barrier
    ds_read_b64_tr_b16 a[192:193], v241 offset:0
    v_mfma_f32_16x16x32_bf16 v[156:159], a[196:199], v[84:87], v[156:159]
    ds_read_b64_tr_b16 a[194:195], v241 offset:256
    buffer_load_dwordx4 v244, s[12:15], s66 offen offset:1024 lds
    v_mfma_f32_16x16x32_bf16 v[160:163], a[168:171], v[80:83], v[160:163]
    ds_read_b64_tr_b16 a[196:197], v241 offset:32
    v_mul_f32 v201, v201, v233
    v_mfma_f32_16x16x32_bf16 v[164:167], a[168:171], v[84:87], v[164:167]
    ds_read_b64_tr_b16 a[198:199], v241 offset:288
    v_mul_f32_e64 v202, v202, v234
    v_mfma_f32_16x16x32_bf16 v[168:171], a[172:175], v[80:83], v[168:171]
    ds_read_b64_tr_b16 a[168:169], v241 offset:512
    v_mul_f32_e64 v203, v203, v235
    v_mfma_f32_16x16x32_bf16 v[172:175], a[172:175], v[84:87], v[172:175]
    ds_read_b64_tr_b16 a[170:171], v241 offset:768
    s_waitcnt lgkmcnt(8)
    v_mfma_f32_16x16x32_bf16 v[144:147], a[176:179], v[88:91], v[144:147]
    ds_read_b64_tr_b16 a[172:173], v241 offset:544
    v_cvt_pk_bf16_f32 v192, v192, v193
    v_mfma_f32_16x16x32_bf16 v[148:151], a[176:179], v[92:95], v[148:151]
    ds_read_b64_tr_b16 a[174:175], v241 offset:800
    buffer_load_dwordx4 v245, s[12:15], s66 offen offset:2048 lds
    v_mfma_f32_16x16x32_bf16 v[152:155], a[180:183], v[88:91], v[152:155]
    ds_read_b64_tr_b16 a[176:177], v241 offset:1024
    s_add_u32 m0, s64, 123520
    v_mfma_f32_16x16x32_bf16 v[156:159], a[180:183], v[92:95], v[156:159]
    ds_read_b64_tr_b16 a[178:179], v241 offset:1280
    s_add_u32 s66, s61, s98
    v_mfma_f32_16x16x32_bf16 v[160:163], a[184:187], v[88:91], v[160:163]
    ds_read_b64_tr_b16 a[180:181], v241 offset:1056
    v_cvt_pk_bf16_f32 v193, v194, v195
    v_mfma_f32_16x16x32_bf16 v[164:167], a[184:187], v[92:95], v[164:167]
    ds_read_b64_tr_b16 a[182:183], v241 offset:1312
    s_waitcnt lgkmcnt(8)
    v_mfma_f32_16x16x32_bf16 v[168:171], a[188:191], v[88:91], v[168:171]
    ds_read_b64_tr_b16 a[184:185], v241 offset:1536
    v_cvt_pk_bf16_f32 v194, v200, v201
    v_mfma_f32_16x16x32_bf16 v[172:175], a[188:191], v[92:95], v[172:175]
    ds_read_b64_tr_b16 a[186:187], v241 offset:1792
    buffer_load_dwordx4 v243, s[12:15], s66 offen offset:0 lds
    v_mfma_f32_16x16x32_bf16 v[144:147], a[192:195], v[96:99], v[144:147]
    ds_read_b64_tr_b16 a[188:189], v241 offset:1568
    v_cvt_pk_bf16_f32 v195, v202, v203
    v_mfma_f32_16x16x32_bf16 v[148:151], a[192:195], v[100:103], v[148:151]
    ds_read_b64_tr_b16 a[190:191], v241 offset:1824
    v_accvgpr_write_b32 a24, v192
    v_mfma_f32_16x16x32_bf16 v[152:155], a[196:199], v[96:99], v[152:155]
    ds_read_b64_tr_b16 a[192:193], v241 offset:2048
    v_accvgpr_write_b32 a25, v193
    v_mfma_f32_16x16x32_bf16 v[156:159], a[196:199], v[100:103], v[156:159]
    ds_read_b64_tr_b16 a[194:195], v241 offset:2304
    s_waitcnt lgkmcnt(8)
    v_mfma_f32_16x16x32_bf16 v[160:163], a[168:171], v[96:99], v[160:163]
    ds_read_b64_tr_b16 a[196:197], v241 offset:2080
    v_accvgpr_write_b32 a26, v194
    v_mfma_f32_16x16x32_bf16 v[164:167], a[168:171], v[100:103], v[164:167]
    ds_read_b64_tr_b16 a[198:199], v241 offset:2336
    buffer_load_dwordx4 v244, s[12:15], s66 offen offset:1024 lds
    v_mfma_f32_16x16x32_bf16 v[168:171], a[172:175], v[96:99], v[168:171]
    ds_read_b64_tr_b16 a[168:169], v241 offset:2560
    v_accvgpr_write_b32 a27, v195
    v_mfma_f32_16x16x32_bf16 v[172:175], a[172:175], v[100:103], v[172:175]
    ds_read_b64_tr_b16 a[170:171], v241 offset:2816
    v_mfma_f32_16x16x32_bf16 v[144:147], a[176:179], v[104:107], v[144:147]
    ds_read_b64_tr_b16 a[172:173], v241 offset:2592
    buffer_store_dwordx4 v[192:195], v254, s[20:23], s72 offen offset:0 sc1
    v_mfma_f32_16x16x32_bf16 v[148:151], a[176:179], v[108:111], v[148:151]
    ds_read_b64_tr_b16 a[174:175], v241 offset:2848
    s_waitcnt lgkmcnt(8)
    v_mfma_f32_16x16x32_bf16 v[152:155], a[180:183], v[104:107], v[152:155]
    ds_read_b64_tr_b16 a[176:177], v241 offset:3072
    v_mul_f32 v196, v196, v228
    v_mfma_f32_16x16x32_bf16 v[156:159], a[180:183], v[108:111], v[156:159]
    ds_read_b64_tr_b16 a[178:179], v241 offset:3328
    buffer_load_dwordx4 v245, s[12:15], s66 offen offset:2048 lds
    v_mfma_f32_16x16x32_bf16 v[160:163], a[184:187], v[104:107], v[160:163]
    ds_read_b64_tr_b16 a[180:181], v241 offset:3104
    s_add_u32 m0, s64, 126592
    v_mfma_f32_16x16x32_bf16 v[164:167], a[184:187], v[108:111], v[164:167]
    ds_read_b64_tr_b16 a[182:183], v241 offset:3360
    s_add_u32 s66, s66, 884736
    v_mfma_f32_16x16x32_bf16 v[168:171], a[188:191], v[104:107], v[168:171]
    ds_read_b64_tr_b16 a[184:185], v241 offset:3584
    v_mul_f32_e64 v197, v197, v229
    v_mfma_f32_16x16x32_bf16 v[172:175], a[188:191], v[108:111], v[172:175]
    ds_read_b64_tr_b16 a[186:187], v241 offset:3840
    s_waitcnt lgkmcnt(8)
    v_mfma_f32_16x16x32_bf16 v[144:147], a[192:195], v[112:115], v[144:147]
    ds_read_b64_tr_b16 a[188:189], v241 offset:3616
    v_mul_f32 v198, v198, v230
    v_mfma_f32_16x16x32_bf16 v[148:151], a[192:195], v[116:119], v[148:151]
    ds_read_b64_tr_b16 a[190:191], v241 offset:3872
    buffer_load_dwordx4 v243, s[12:15], s66 offen offset:0 lds
    v_mfma_f32_16x16x32_bf16 v[152:155], a[196:199], v[112:115], v[152:155]
    ds_read_b64_tr_b16 a[192:193], v241 offset:4096
    v_mul_f32_e64 v199, v199, v231
    v_mfma_f32_16x16x32_bf16 v[156:159], a[196:199], v[116:119], v[156:159]
    ds_read_b64_tr_b16 a[194:195], v241 offset:4352
    v_mul_f32_e64 v204, v204, v236
    v_mfma_f32_16x16x32_bf16 v[160:163], a[168:171], v[112:115], v[160:163]
    ds_read_b64_tr_b16 a[196:197], v241 offset:4128
    v_mul_f32_e64 v205, v205, v237
    v_mfma_f32_16x16x32_bf16 v[164:167], a[168:171], v[116:119], v[164:167]
    ds_read_b64_tr_b16 a[198:199], v241 offset:4384
    s_waitcnt lgkmcnt(8)
    v_mfma_f32_16x16x32_bf16 v[168:171], a[172:175], v[112:115], v[168:171]
    ds_read_b64_tr_b16 a[168:169], v241 offset:4608
    v_mul_f32 v206, v206, v238
    v_mfma_f32_16x16x32_bf16 v[172:175], a[172:175], v[116:119], v[172:175]
    ds_read_b64_tr_b16 a[170:171], v241 offset:4864
    buffer_load_dwordx4 v244, s[12:15], s66 offen offset:1024 lds
    v_mfma_f32_16x16x32_bf16 v[144:147], a[176:179], v[120:123], v[144:147]
    ds_read_b64_tr_b16 a[172:173], v241 offset:4640
    v_mul_f32_e64 v207, v207, v239
    v_mfma_f32_16x16x32_bf16 v[148:151], a[176:179], v[124:127], v[148:151]
    ds_read_b64_tr_b16 a[174:175], v241 offset:4896
    v_cvt_pk_bf16_f32 v196, v196, v197
    v_mfma_f32_16x16x32_bf16 v[152:155], a[180:183], v[120:123], v[152:155]
    ds_read_b64_tr_b16 a[176:177], v241 offset:5120
    v_cvt_pk_bf16_f32 v197, v198, v199
    v_mfma_f32_16x16x32_bf16 v[156:159], a[180:183], v[124:127], v[156:159]
    ds_read_b64_tr_b16 a[178:179], v241 offset:5376
    s_waitcnt lgkmcnt(8)
    v_mfma_f32_16x16x32_bf16 v[160:163], a[184:187], v[120:123], v[160:163]
    ds_read_b64_tr_b16 a[180:181], v241 offset:5152
    v_cvt_pk_bf16_f32 v198, v204, v205
    v_mfma_f32_16x16x32_bf16 v[164:167], a[184:187], v[124:127], v[164:167]
    ds_read_b64_tr_b16 a[182:183], v241 offset:5408
    buffer_load_dwordx4 v245, s[12:15], s66 offen offset:2048 lds
    v_mfma_f32_16x16x32_bf16 v[168:171], a[188:191], v[120:123], v[168:171]
    ds_read_b64_tr_b16 a[184:185], v241 offset:5632
    s_add_u32 m0, s64, 0
    v_mfma_f32_16x16x32_bf16 v[172:175], a[188:191], v[124:127], v[172:175]
    ds_read_b64_tr_b16 a[186:187], v241 offset:5888
    s_add_u32 s66, s62, s96
    v_mfma_f32_16x16x32_bf16 v[144:147], a[192:195], v[128:131], v[144:147]
    ds_read_b64_tr_b16 a[188:189], v241 offset:5664
    v_cvt_pk_bf16_f32 v199, v206, v207
    v_mfma_f32_16x16x32_bf16 v[148:151], a[192:195], v[132:135], v[148:151]
    ds_read_b64_tr_b16 a[190:191], v241 offset:5920
    s_waitcnt lgkmcnt(8)
    v_mfma_f32_16x16x32_bf16 v[152:155], a[196:199], v[128:131], v[152:155]
    s_waitcnt vmcnt(14)
    s_barrier
    v_cmp_ne_u32 vcc, s51, v250
    s_nop 0
    s_cmp_lg_u64 vcc, 0
    s_cbranch_scc1 L_spin_kv
L_back_kv:
    ds_read_b64_tr_b16 a[192:193], v241 offset:24704
    v_mfma_f32_16x16x32_bf16 v[156:159], a[196:199], v[132:135], v[156:159]
    ds_read_b64_tr_b16 a[194:195], v241 offset:24960
    buffer_load_dwordx4 v243, s[8:11], s66 offen offset:0 lds
    v_mfma_f32_16x16x32_bf16 v[160:163], a[168:171], v[128:131], v[160:163]
    ds_read_b64_tr_b16 a[196:197], v241 offset:24736
    v_accvgpr_write_b32 a28, v196
    v_mfma_f32_16x16x32_bf16 v[164:167], a[168:171], v[132:135], v[164:167]
    ds_read_b64_tr_b16 a[198:199], v241 offset:24992
    v_accvgpr_write_b32 a29, v197
    v_mfma_f32_16x16x32_bf16 v[168:171], a[172:175], v[128:131], v[168:171]
    ds_read_b64_tr_b16 a[168:169], v241 offset:25216
    v_accvgpr_write_b32 a30, v198
    v_mfma_f32_16x16x32_bf16 v[172:175], a[172:175], v[132:135], v[172:175]
    ds_read_b64_tr_b16 a[170:171], v241 offset:25472
    s_waitcnt lgkmcnt(8)
    v_mfma_f32_16x16x32_bf16 v[144:147], a[176:179], v[136:139], v[144:147]
    ds_read_b64_tr_b16 a[172:173], v241 offset:25248
    v_accvgpr_write_b32 a31, v199
    v_mfma_f32_16x16x32_bf16 v[148:151], a[176:179], v[140:143], v[148:151]
    ds_read_b64_tr_b16 a[174:175], v241 offset:25504
    buffer_load_dwordx4 v244, s[8:11], s66 offen offset:1024 lds
    v_mfma_f32_16x16x32_bf16 v[152:155], a[180:183], v[136:139], v[152:155]
    ds_read_b64_tr_b16 a[176:177], v241 offset:25728
    v_accvgpr_read_b32 v251, a209
    v_mfma_f32_16x16x32_bf16 v[156:159], a[180:183], v[140:143], v[156:159]
    ds_read_b64_tr_b16 a[178:179], v241 offset:25984
    v_mfma_f32_16x16x32_bf16 v[160:163], a[184:187], v[136:139], v[160:163]
    ds_read_b64_tr_b16 a[180:181], v241 offset:25760
    buffer_store_dwordx4 v[196:199], v254, s[20:23], s72 offen offset:1024 sc1
    v_mfma_f32_16x16x32_bf16 v[164:167], a[184:187], v[140:143], v[164:167]
    ds_read_b64_tr_b16 a[182:183], v241 offset:26016
    s_waitcnt lgkmcnt(8)
    v_mfma_f32_16x16x32_bf16 v[168:171], a[188:191], v[136:139], v[168:171]
    ds_read_b64_tr_b16 a[184:185], v241 offset:26240
    v_mfma_f32_16x16x32_bf16 v[172:175], a[188:191], v[140:143], v[172:175]
    ds_read_b64_tr_b16 a[186:187], v241 offset:26496
    buffer_load_dwordx4 v245, s[8:11], s66 offen offset:2048 lds
    v_mfma_f32_16x16x32_bf16 v[176:179], a[192:195], v[0:3], 0
    ds_read_b64_tr_b16 a[188:189], v241 offset:26272
    s_add_u32 m0, s64, 3072
    v_mfma_f32_16x16x32_bf16 v[180:183], a[192:195], v[4:7], 0
    ds_read_b64_tr_b16 a[190:191], v241 offset:26528
    s_add_u32 s66, s66, 884736
    v_mfma_f32_16x16x32_bf16 v[184:187], a[196:199], v[0:3], 0
    ds_read_b64_tr_b16 a[192:193], v241 offset:26752
    buffer_load_dwordx2 a[136:137], v251, s[20:23], s55 offen offset:0 sc1
    v_mfma_f32_16x16x32_bf16 v[188:191], a[196:199], v[4:7], 0
    ds_read_b64_tr_b16 a[194:195], v241 offset:27008
    s_waitcnt lgkmcnt(8)
    v_mfma_f32_16x16x32_bf16 v[192:195], a[168:171], v[0:3], 0
    ds_read_b64_tr_b16 a[196:197], v241 offset:26784
    v_mul_f32 v144, v252, v144
    v_mfma_f32_16x16x32_bf16 v[196:199], a[168:171], v[4:7], 0
    ds_read_b64_tr_b16 a[198:199], v241 offset:27040
    buffer_load_dwordx4 v243, s[8:11], s66 offen offset:0 lds
    v_mfma_f32_16x16x32_bf16 v[200:203], a[172:175], v[0:3], 0
    ds_read_b64_tr_b16 a[168:169], v241 offset:27264
    v_mul_f32_e64 v145, v252, v145
    v_mfma_f32_16x16x32_bf16 v[204:207], a[172:175], v[4:7], 0
    ds_read_b64_tr_b16 a[170:171], v241 offset:27520
    v_mul_f32_e64 v146, v252, v146
    v_mfma_f32_16x16x32_bf16 v[176:179], a[176:179], v[8:11], v[176:179]
    ds_read_b64_tr_b16 a[172:173], v241 offset:27296
    v_mul_f32_e64 v147, v252, v147
    v_mfma_f32_16x16x32_bf16 v[180:183], a[176:179], v[12:15], v[180:183]
    ds_read_b64_tr_b16 a[174:175], v241 offset:27552
    s_waitcnt lgkmcnt(8)
    v_mfma_f32_16x16x32_bf16 v[184:187], a[180:183], v[8:11], v[184:187]
    ds_read_b64_tr_b16 a[176:177], v241 offset:27776
    v_mul_f32 v148, v253, v148
    v_mfma_f32_16x16x32_bf16 v[188:191], a[180:183], v[12:15], v[188:191]
    ds_read_b64_tr_b16 a[178:179], v241 offset:28032
    buffer_load_dwordx4 v244, s[8:11], s66 offen offset:1024 lds
    v_mfma_f32_16x16x32_bf16 v[192:195], a[184:187], v[8:11], v[192:195]
    ds_read_b64_tr_b16 a[180:181], v241 offset:27808
    v_mul_f32_e64 v149, v253, v149
    v_mfma_f32_16x16x32_bf16 v[196:199], a[184:187], v[12:15], v[196:199]
    ds_read_b64_tr_b16 a[182:183], v241 offset:28064
    v_mul_f32_e64 v150, v253, v150
    v_mfma_f32_16x16x32_bf16 v[200:203], a[188:191], v[8:11], v[200:203]
    ds_read_b64_tr_b16 a[184:185], v241 offset:28288
    v_mul_f32_e64 v151, v253, v151
    v_mfma_f32_16x16x32_bf16 v[204:207], a[188:191], v[12:15], v[204:207]
    ds_read_b64_tr_b16 a[186:187], v241 offset:28544
    s_waitcnt lgkmcnt(8)
    v_mfma_f32_16x16x32_bf16 v[176:179], a[192:195], v[16:19], v[176:179]
    ds_read_b64_tr_b16 a[188:189], v241 offset:28320
    v_mul_f32 v152, v252, v152
    v_mfma_f32_16x16x32_bf16 v[180:183], a[192:195], v[20:23], v[180:183]
    ds_read_b64_tr_b16 a[190:191], v241 offset:28576
    buffer_load_dwordx4 v245, s[8:11], s66 offen offset:2048 lds
    v_mfma_f32_16x16x32_bf16 v[184:187], a[196:199], v[16:19], v[184:187]
    ds_read_b64_tr_b16 a[192:193], v241 offset:28800
    s_add_u32 m0, s64, 24704
    v_mfma_f32_16x16x32_bf16 v[188:191], a[196:199], v[20:23], v[188:191]
    ds_read_b64_tr_b16 a[194:195], v241 offset:29056
    s_add_u32 s66, s62, s97
    v_mfma_f32_16x16x32_bf16 v[192:195], a[168:171], v[16:19], v[192:195]
    ds_read_b64_tr_b16 a[196:197], v241 offset:28832
    v_mul_f32 v153, v252, v153
    v_mfma_f32_16x16x32_bf16 v[196:199], a[168:171], v[20:23], v[196:199]
    ds_read_b64_tr_b16 a[198:199], v241 offset:29088
    s_waitcnt lgkmcnt(8)
    v_mfma_f32_16x16x32_bf16 v[200:203], a[172:175], v[16:19], v[200:203]
    ds_read_b64_tr_b16 a[168:169], v241 offset:29312
    v_mul_f32 v154, v252, v154
    v_mfma_f32_16x16x32_bf16 v[204:207], a[172:175], v[20:23], v[204:207]
    ds_read_b64_tr_b16 a[170:171], v241 offset:29568
    buffer_load_dwordx4 v243, s[8:11], s66 offen offset:0 lds
    v_mfma_f32_16x16x32_bf16 v[176:179], a[176:179], v[24:27], v[176:179]
    ds_read_b64_tr_b16 a[172:173], v241 offset:29344
    v_mul_f32_e64 v155, v252, v155
    v_mfma_f32_16x16x32_bf16 v[180:183], a[176:179], v[28:31], v[180:183]
    ds_read_b64_tr_b16 a[174:175], v241 offset:29600
    v_mul_f32_e64 v156, v253, v156
    v_mfma_f32_16x16x32_bf16 v[184:187], a[180:183], v[24:27], v[184:187]
    ds_read_b64_tr_b16 a[176:177], v241 offset:29824
    v_mul_f32_e64 v157, v253, v157
    v_mfma_f32_16x16x32_bf16 v[188:191], a[180:183], v[28:31], v[188:191]
    ds_read_b64_tr_b16 a[178:179], v241 offset:30080
    s_waitcnt lgkmcnt(8)
    v_mfma_f32_16x16x32_bf16 v[192:195], a[184:187], v[24:27], v[192:195]
    ds_read_b64_tr_b16 a[180:181], v241 offset:29856
    v_mul_f32 v158, v253, v158
    v_mfma_f32_16x16x32_bf16 v[196:199], a[184:187], v[28:31], v[196:199]
    ds_read_b64_tr_b16 a[182:183], v241 offset:30112
    buffer_load_dwordx4 v244, s[8:11], s66 offen offset:1024 lds
    v_mfma_f32_16x16x32_bf16 v[200:203], a[188:191], v[24:27], v[200:203]
    ds_read_b64_tr_b16 a[184:185], v241 offset:30336
    v_mul_f32_e64 v159, v253, v159
    v_mfma_f32_16x16x32_bf16 v[204:207], a[188:191], v[28:31], v[204:207]
    ds_read_b64_tr_b16 a[186:187], v241 offset:30592
    v_mul_f32_e64 v160, v252, v160
    v_mfma_f32_16x16x32_bf16 v[176:179], a[192:195], v[32:35], v[176:179]
    ds_read_b64_tr_b16 a[188:189], v241 offset:30368
    v_mul_f32_e64 v161, v252, v161
    v_mfma_f32_16x16x32_bf16 v[180:183], a[192:195], v[36:39], v[180:183]
    ds_read_b64_tr_b16 a[190:191], v241 offset:30624
    s_waitcnt lgkmcnt(8)
    v_mfma_f32_16x16x32_bf16 v[184:187], a[196:199], v[32:35], v[184:187]
    s_waitcnt vmcnt(17)
    s_barrier
    ds_read_b64_tr_b16 a[192:193], v242 offset:0
    v_mfma_f32_16x16x32_bf16 v[188:191], a[196:199], v[36:39], v[188:191]
    ds_read_b64_tr_b16 a[194:195], v242 offset:256
    buffer_load_dwordx4 v245, s[8:11], s66 offen offset:2048 lds
    v_mfma_f32_16x16x32_bf16 v[192:195], a[168:171], v[32:35], v[192:195]
    ds_read_b64_tr_b16 a[196:197], v242 offset:32
    s_add_u32 m0, s64, 27776
    v_mfma_f32_16x16x32_bf16 v[196:199], a[168:171], v[36:39], v[196:199]
    ds_read_b64_tr_b16 a[198:199], v242 offset:288
    s_add_u32 s66, s66, 884736
    v_mfma_f32_16x16x32_bf16 v[200:203], a[172:175], v[32:35], v[200:203]
    ds_read_b64_tr_b16 a[168:169], v242 offset:512
    v_mul_f32 v162, v252, v162
    v_mfma_f32_16x16x32_bf16 v[204:207], a[172:175], v[36:39], v[204:207]
    ds_read_b64_tr_b16 a[170:171], v242 offset:768
    s_waitcnt lgkmcnt(8)
    v_mfma_f32_16x16x32_bf16 v[176:179], a[176:179], v[40:43], v[176:179]
    ds_read_b64_tr_b16 a[172:173], v242 offset:544
    v_mul_f32 v163, v252, v163
    v_mfma_f32_16x16x32_bf16 v[180:183], a[176:179], v[44:47], v[180:183]
    ds_read_b64_tr_b16 a[174:175], v242 offset:800
    buffer_load_dwordx4 v243, s[8:11], s66 offen offset:0 lds
    v_mfma_f32_16x16x32_bf16 v[184:187], a[180:183], v[40:43], v[184:187]
    ds_read_b64_tr_b16 a[176:177], v242 offset:1024
    v_mul_f32_e64 v164, v253, v164
    v_mfma_f32_16x16x32_bf16 v[188:191], a[180:183], v[44:47], v[188:191]
    ds_read_b64_tr_b16 a[178:179], v242 offset:1280
    v_mul_f32_e64 v165, v253, v165
    v_mfma_f32_16x16x32_bf16 v[192:195], a[184:187], v[40:43], v[192:195]
    ds_read_b64_tr_b16 a[180:181], v242 offset:1056
    v_mul_f32_e64 v166, v253, v166
    v_mfma_f32_16x16x32_bf16 v[196:199], a[184:187], v[44:47], v[196:199]
    ds_read_b64_tr_b16 a[182:183], v242 offset:1312
    s_waitcnt lgkmcnt(8)
    v_mfma_f32_16x16x32_bf16 v[200:203], a[188:191], v[40:43], v[200:203]
    ds_read_b64_tr_b16 a[184:185], v242 offset:1536
    v_mul_f32 v167, v253, v167
    v_mfma_f32_16x16x32_bf16 v[204:207], a[188:191], v[44:47], v[204:207]
    ds_read_b64_tr_b16 a[186:187], v242 offset:1792
    buffer_load_dwordx4 v244, s[8:11], s66 offen offset:1024 lds
    v_mfma_f32_16x16x32_bf16 v[176:179], a[192:195], v[48:51], v[176:179]
    ds_read_b64_tr_b16 a[188:189], v242 offset:1568
    v_mul_f32_e64 v168, v252, v168
    v_mfma_f32_16x16x32_bf16 v[180:183], a[192:195], v[52:55], v[180:183]
    ds_read_b64_tr_b16 a[190:191], v242 offset:1824
    v_mul_f32_e64 v169, v252, v169
    v_mfma_f32_16x16x32_bf16 v[184:187], a[196:199], v[48:51], v[184:187]
    ds_read_b64_tr_b16 a[192:193], v242 offset:2048
    v_mul_f32_e64 v170, v252, v170
    v_mfma_f32_16x16x32_bf16 v[188:191], a[196:199], v[52:55], v[188:191]
    ds_read_b64_tr_b16 a[194:195], v242 offset:2304
    s_waitcnt lgkmcnt(8)
    v_mfma_f32_16x16x32_bf16 v[192:195], a[168:171], v[48:51], v[192:195]
    ds_read_b64_tr_b16 a[196:197], v242 offset:2080
    v_mul_f32 v171, v252, v171
    v_mfma_f32_16x16x32_bf16 v[196:199], a[168:171], v[52:55], v[196:199]
    ds_read_b64_tr_b16 a[198:199], v242 offset:2336
    buffer_load_dwordx4 v245, s[8:11], s66 offen offset:2048 lds
    v_mfma_f32_16x16x32_bf16 v[200:203], a[172:175], v[48:51], v[200:203]
    ds_read_b64_tr_b16 a[168:169], v242 offset:2560
    s_add_u32 m0, s64, 49408
    v_mfma_f32_16x16x32_bf16 v[204:207], a[172:175], v[52:55], v[204:207]
    ds_read_b64_tr_b16 a[170:171], v242 offset:2816
    s_add_u32 s66, s62, s98
    v_mfma_f32_16x16x32_bf16 v[176:179], a[176:179], v[56:59], v[176:179]
    ds_read_b64_tr_b16 a[172:173], v242 offset:2592
    v_mul_f32 v172, v253, v172
    v_mfma_f32_16x16x32_bf16 v[180:183], a[176:179], v[60:63], v[180:183]
    ds_read_b64_tr_b16 a[174:175], v242 offset:2848
    s_waitcnt lgkmcnt(8)
    v_mfma_f32_16x16x32_bf16 v[184:187], a[180:183], v[56:59], v[184:187]
    ds_read_b64_tr_b16 a[176:177], v242 offset:3072
    v_mul_f32 v173, v253, v173
    v_mfma_f32_16x16x32_bf16 v[188:191], a[180:183], v[60:63], v[188:191]
    ds_read_b64_tr_b16 a[178:179], v242 offset:3328
    buffer_load_dwordx4 v243, s[8:11], s66 offen offset:0 lds
    v_mfma_f32_16x16x32_bf16 v[192:195], a[184:187], v[56:59], v[192:195]
    ds_read_b64_tr_b16 a[180:181], v242 offset:3104
    v_mul_f32_e64 v174, v253, v174
    v_mfma_f32_16x16x32_bf16 v[196:199], a[184:187], v[60:63], v[196:199]
    ds_read_b64_tr_b16 a[182:183], v242 offset:3360
    v_mul_f32_e64 v175, v253, v175
    v_mfma_f32_16x16x32_bf16 v[200:203], a[188:191], v[56:59], v[200:203]
    ds_read_b64_tr_b16 a[184:185], v242 offset:3584
    buffer_load_dwordx2 a[138:139], v251, s[20:23], s55 offen offset:1024 sc1
    v_mfma_f32_16x16x32_bf16 v[204:207], a[188:191], v[60:63], v[204:207]
    ds_read_b64_tr_b16 a[186:187], v242 offset:3840
    s_waitcnt lgkmcnt(8)
    v_mfma_f32_16x16x32_bf16 v[176:179], a[192:195], v[64:67], v[176:179]
    ds_read_b64_tr_b16 a[188:189], v242 offset:3616
    v_bfe_u32 v209, v254, 4, 4
    v_mfma_f32_16x16x32_bf16 v[180:183], a[192:195], v[68:71], v[180:183]
    ds_read_b64_tr_b16 a[190:191], v242 offset:3872
    buffer_load_dwordx4 v244, s[8:11], s66 offen offset:1024 lds
    v_mfma_f32_16x16x32_bf16 v[184:187], a[196:199], v[64:67], v[184:187]
    ds_read_b64_tr_b16 a[192:193], v242 offset:4096
    v_lshrrev_b32 v208, 8, v254
    v_mfma_f32_16x16x32_bf16 v[188:191], a[196:199], v[68:71], v[188:191]
    ds_read_b64_tr_b16 a[194:195], v242 offset:4352
    v_lshlrev_b32_e64 v208, 2, v208
    v_mfma_f32_16x16x32_bf16 v[192:195], a[168:171], v[64:67], v[192:195]
    ds_read_b64_tr_b16 a[196:197], v242 offset:4128
    buffer_load_dwordx2 a[140:141], v251, s[20:23], s55 offen offset:128 sc1
    v_mfma_f32_16x16x32_bf16 v[196:199], a[168:171], v[68:71], v[196:199]
    ds_read_b64_tr_b16 a[198:199], v242 offset:4384
    s_waitcnt lgkmcnt(8)
    v_mfma_f32_16x16x32_bf16 v[200:203], a[172:175], v[64:67], v[200:203]
    ds_read_b64_tr_b16 a[168:169], v242 offset:4608
    v_sub_u32 v208, v209, v208
    v_mfma_f32_16x16x32_bf16 v[204:207], a[172:175], v[68:71], v[204:207]
    ds_read_b64_tr_b16 a[170:171], v242 offset:4864
    buffer_load_dwordx4 v245, s[8:11], s66 offen offset:2048 lds
    v_mfma_f32_16x16x32_bf16 v[176:179], a[176:179], v[72:75], v[176:179]
    ds_read_b64_tr_b16 a[172:173], v242 offset:4640
    s_add_u32 m0, s64, 52480
    v_mfma_f32_16x16x32_bf16 v[180:183], a[176:179], v[76:79], v[180:183]
    ds_read_b64_tr_b16 a[174:175], v242 offset:4896
    s_add_u32 s66, s66, 884736
    v_mfma_f32_16x16x32_bf16 v[184:187], a[180:183], v[72:75], v[184:187]
    ds_read_b64_tr_b16 a[176:177], v242 offset:5120
    buffer_load_dwordx2 a[142:143], v251, s[20:23], s55 offen offset:1152 sc1
    v_mfma_f32_16x16x32_bf16 v[188:191], a[180:183], v[76:79], v[188:191]
    ds_read_b64_tr_b16 a[178:179], v242 offset:5376
    s_waitcnt lgkmcnt(8)
    v_mfma_f32_16x16x32_bf16 v[192:195], a[184:187], v[72:75], v[192:195]
    ds_read_b64_tr_b16 a[180:181], v242 offset:5152
    v_accvgpr_read_b32 v251, a210
    v_mfma_f32_16x16x32_bf16 v[196:199], a[184:187], v[76:79], v[196:199]
    ds_read_b64_tr_b16 a[182:183], v242 offset:5408
    buffer_load_dwordx4 v243, s[8:11], s66 offen offset:0 lds
    v_mfma_f32_16x16x32_bf16 v[200:203], a[188:191], v[72:75], v[200:203]
    ds_read_b64_tr_b16 a[184:185], v242 offset:5632
    v_mov_b32 v209, 0xf149f2ca
    v_mfma_f32_16x16x32_bf16 v[204:207], a[188:191], v[76:79], v[204:207]
    ds_read_b64_tr_b16 a[186:187], v242 offset:5888
    v_cmp_le_i32 s[40:41], 0, v208
    v_mfma_f32_16x16x32_bf16 v[176:179], a[192:195], v[80:83], v[176:179]
    ds_read_b64_tr_b16 a[188:189], v242 offset:5664
    buffer_load_dwordx2 a[144:145], v251, s[20:23], s55 offen offset:0 sc1
    v_mfma_f32_16x16x32_bf16 v[180:183], a[192:195], v[84:87], v[180:183]
    ds_read_b64_tr_b16 a[190:191], v242 offset:5920
    s_waitcnt lgkmcnt(8)
    v_mfma_f32_16x16x32_bf16 v[184:187], a[196:199], v[80:83], v[184:187]
    s_waitcnt vmcnt(22)
    s_barrier
    ds_read_b64_tr_b16 a[192:193], v242 offset:24704
    v_mfma_f32_16x16x32_bf16 v[188:191], a[196:199], v[84:87], v[188:191]
    ds_read_b64_tr_b16 a[194:195], v242 offset:24960
    buffer_load_dwordx4 v244, s[8:11], s66 offen offset:1024 lds
    v_mfma_f32_16x16x32_bf16 v[192:195], a[168:171], v[80:83], v[192:195]
    ds_read_b64_tr_b16 a[196:197], v242 offset:24736
    v_cndmask_b32 v210, 0, v209, s[40:41]
    v_mfma_f32_16x16x32_bf16 v[196:199], a[168:171], v[84:87], v[196:199]
    ds_read_b64_tr_b16 a[198:199], v242 offset:24992
    v_accvgpr_write_b32 a219, v210
    v_mfma_f32_16x16x32_bf16 v[200:203], a[172:175], v[80:83], v[200:203]
    ds_read_b64_tr_b16 a[168:169], v242 offset:25216
    buffer_load_dwordx2 a[146:147], v251, s[20:23], s55 offen offset:1024 sc1
    v_mfma_f32_16x16x32_bf16 v[204:207], a[172:175], v[84:87], v[204:207]
    ds_read_b64_tr_b16 a[170:171], v242 offset:25472
    s_waitcnt lgkmcnt(8)
    v_mfma_f32_16x16x32_bf16 v[176:179], a[176:179], v[88:91], v[176:179]
    ds_read_b64_tr_b16 a[172:173], v242 offset:25248
    v_xor_b32 v210, v210, v209
    v_mfma_f32_16x16x32_bf16 v[180:183], a[176:179], v[92:95], v[180:183]
    ds_read_b64_tr_b16 a[174:175], v242 offset:25504
    buffer_load_dwordx4 v245, s[8:11], s66 offen offset:2048 lds
    v_mfma_f32_16x16x32_bf16 v[184:187], a[180:183], v[88:91], v[184:187]
    ds_read_b64_tr_b16 a[176:177], v242 offset:25728
    s_add_u32 m0, s64, 74112
    v_mfma_f32_16x16x32_bf16 v[188:191], a[180:183], v[92:95], v[188:191]
    ds_read_b64_tr_b16 a[178:179], v242 offset:25984
    s_add_u32 s66, s62, s96
    v_mfma_f32_16x16x32_bf16 v[192:195], a[184:187], v[88:91], v[192:195]
    ds_read_b64_tr_b16 a[180:181], v242 offset:25760
L_w6:
    s_cbranch_execz L_wret1
    buffer_load_dwordx2 a[148:149], v251, s[20:23], s55 offen offset:128 sc1
    v_mfma_f32_16x16x32_bf16 v[196:199], a[184:187], v[92:95], v[196:199]
    ds_read_b64_tr_b16 a[182:183], v242 offset:26016
    s_waitcnt lgkmcnt(8)
    v_mfma_f32_16x16x32_bf16 v[200:203], a[188:191], v[88:91], v[200:203]
    ds_read_b64_tr_b16 a[184:185], v242 offset:26240
    v_accvgpr_write_b32 a223, v210
    v_mfma_f32_16x16x32_bf16 v[204:207], a[188:191], v[92:95], v[204:207]
    ds_read_b64_tr_b16 a[186:187], v242 offset:26496
    buffer_load_dwordx4 v243, s[12:15], s66 offen offset:0 lds
    v_mfma_f32_16x16x32_bf16 v[176:179], a[192:195], v[96:99], v[176:179]
    ds_read_b64_tr_b16 a[188:189], v242 offset:26272
    v_cmp_le_i32 s[40:41], 1, v208
    v_mfma_f32_16x16x32_bf16 v[180:183], a[192:195], v[100:103], v[180:183]
    ds_read_b64_tr_b16 a[190:191], v242 offset:26528
    v_cndmask_b32 v210, 0, v209, s[40:41]
    v_mfma_f32_16x16x32_bf16 v[184:187], a[196:199], v[96:99], v[184:187]
    ds_read_b64_tr_b16 a[192:193], v242 offset:26752
    buffer_load_dwordx2 a[150:151], v251, s[20:23], s55 offen offset:1152 sc1
    v_mfma_f32_16x16x32_bf16 v[188:191], a[196:199], v[100:103], v[188:191]
    ds_read_b64_tr_b16 a[194:195], v242 offset:27008
    s_waitcnt lgkmcnt(8)
    v_mfma_f32_16x16x32_bf16 v[192:195], a[168:171], v[96:99], v[192:195]
    ds_read_b64_tr_b16 a[196:197], v242 offset:26784
    s_add_u32 s70, s74, 24576
    v_mfma_f32_16x16x32_bf16 v[196:199], a[168:171], v[100:103], v[196:199]
    ds_read_b64_tr_b16 a[198:199], v242 offset:27040
    buffer_load_dwordx4 v244, s[12:15], s66 offen offset:1024 lds
    v_mfma_f32_16x16x32_bf16 v[200:203], a[172:175], v[96:99], v[200:203]
    ds_read_b64_tr_b16 a[168:169], v242 offset:27264
    v_accvgpr_write_b32 a220, v210
    v_mfma_f32_16x16x32_bf16 v[204:207], a[172:175], v[100:103], v[204:207]
    ds_read_b64_tr_b16 a[170:171], v242 offset:27520
    buffer_store_dwordx4 a[120:123], v254, s[20:23], s70 offen offset:0 sc1
    v_mfma_f32_16x16x32_bf16 v[176:179], a[176:179], v[104:107], v[176:179]
    ds_read_b64_tr_b16 a[172:173], v242 offset:27296
    v_xor_b32 v210, v210, v209
    v_mfma_f32_16x16x32_bf16 v[180:183], a[176:179], v[108:111], v[180:183]
    ds_read_b64_tr_b16 a[174:175], v242 offset:27552
    s_waitcnt lgkmcnt(8)
    v_mfma_f32_16x16x32_bf16 v[184:187], a[180:183], v[104:107], v[184:187]
    ds_read_b64_tr_b16 a[176:177], v242 offset:27776
    buffer_store_dwordx4 a[120:123], v254, s[20:23], s70 offen offset:1024 sc1
    v_mfma_f32_16x16x32_bf16 v[188:191], a[180:183], v[108:111], v[188:191]
    ds_read_b64_tr_b16 a[178:179], v242 offset:28032
    v_accvgpr_write_b32 a224, v210
    v_mfma_f32_16x16x32_bf16 v[192:195], a[184:187], v[104:107], v[192:195]
    ds_read_b64_tr_b16 a[180:181], v242 offset:27808
    buffer_load_dwordx4 v245, s[12:15], s66 offen offset:2048 lds
    v_mfma_f32_16x16x32_bf16 v[196:199], a[184:187], v[108:111], v[196:199]
    ds_read_b64_tr_b16 a[182:183], v242 offset:28064
    s_add_u32 m0, s64, 77184
    v_mfma_f32_16x16x32_bf16 v[200:203], a[188:191], v[104:107], v[200:203]
    ds_read_b64_tr_b16 a[184:185], v242 offset:28288
    s_add_u32 s66, s66, 884736
    v_mfma_f32_16x16x32_bf16 v[204:207], a[188:191], v[108:111], v[204:207]
    ds_read_b64_tr_b16 a[186:187], v242 offset:28544
    s_waitcnt lgkmcnt(8)
    v_mfma_f32_16x16x32_bf16 v[176:179], a[192:195], v[112:115], v[176:179]
    ds_read_b64_tr_b16 a[188:189], v242 offset:28320
    v_cmp_le_i32 s[40:41], 2, v208
    v_mfma_f32_16x16x32_bf16 v[180:183], a[192:195], v[116:119], v[180:183]
    ds_read_b64_tr_b16 a[190:191], v242 offset:28576
    v_cndmask_b32 v210, 0, v209, s[40:41]
    v_mfma_f32_16x16x32_bf16 v[184:187], a[196:199], v[112:115], v[184:187]
    ds_read_b64_tr_b16 a[192:193], v242 offset:28800
    buffer_load_dwordx4 v243, s[12:15], s66 offen offset:0 lds
    v_mfma_f32_16x16x32_bf16 v[188:191], a[196:199], v[116:119], v[188:191]
    ds_read_b64_tr_b16 a[194:195], v242 offset:29056
    v_accvgpr_write_b32 a221, v210
    v_mfma_f32_16x16x32_bf16 v[192:195], a[168:171], v[112:115], v[192:195]
    ds_read_b64_tr_b16 a[196:197], v242 offset:28832
    v_xor_b32_e64 v210, v210, v209
    v_mfma_f32_16x16x32_bf16 v[196:199], a[168:171], v[116:119], v[196:199]
    ds_read_b64_tr_b16 a[198:199], v242 offset:29088
    s_waitcnt lgkmcnt(8)
    v_mfma_f32_16x16x32_bf16 v[200:203], a[172:175], v[112:115], v[200:203]
    ds_read_b64_tr_b16 a[168:169], v242 offset:29312
    v_accvgpr_write_b32 a225, v210
    v_mfma_f32_16x16x32_bf16 v[204:207], a[172:175], v[116:119], v[204:207]
    ds_read_b64_tr_b16 a[170:171], v242 offset:29568
    v_cmp_le_i32 s[40:41], 3, v208
    v_mfma_f32_16x16x32_bf16 v[176:179], a[176:179], v[120:123], v[176:179]
    ds_read_b64_tr_b16 a[172:173], v242 offset:29344
    buffer_load_dwordx4 v244, s[12:15], s66 offen offset:1024 lds
    v_mfma_f32_16x16x32_bf16 v[180:183], a[176:179], v[124:127], v[180:183]
    ds_read_b64_tr_b16 a[174:175], v242 offset:29600
    v_cndmask_b32 v210, 0, v209, s[40:41]
    v_mfma_f32_16x16x32_bf16 v[184:187], a[180:183], v[120:123], v[184:187]
    ds_read_b64_tr_b16 a[176:177], v242 offset:29824
    buffer_store_dwordx4 a[120:123], v254, s[20:23], s70 offen offset:2048 sc1
    v_mfma_f32_16x16x32_bf16 v[188:191], a[180:183], v[124:127], v[188:191]
    ds_read_b64_tr_b16 a[178:179], v242 offset:30080
    s_waitcnt lgkmcnt(8)
    v_mfma_f32_16x16x32_bf16 v[192:195], a[184:187], v[120:123], v[192:195]
    ds_read_b64_tr_b16 a[180:181], v242 offset:29856
    v_accvgpr_write_b32 a222, v210
    v_mfma_f32_16x16x32_bf16 v[196:199], a[184:187], v[124:127], v[196:199]
    ds_read_b64_tr_b16 a[182:183], v242 offset:30112
    v_xor_b32_e64 v210, v210, v209
    v_mfma_f32_16x16x32_bf16 v[200:203], a[188:191], v[120:123], v[200:203]
    ds_read_b64_tr_b16 a[184:185], v242 offset:30336
    buffer_load_dwordx4 v245, s[12:15], s66 offen offset:2048 lds
    v_mfma_f32_16x16x32_bf16 v[204:207], a[188:191], v[124:127], v[204:207]
    ds_read_b64_tr_b16 a[186:187], v242 offset:30592
    v_accvgpr_write_b32 a226, v210
    v_mfma_f32_16x16x32_bf16 v[176:179], a[192:195], v[128:131], v[176:179]
    ds_read_b64_tr_b16 a[188:189], v242 offset:30368
    v_and_b32_e64 v210, 1, v208
    v_mfma_f32_16x16x32_bf16 v[180:183], a[192:195], v[132:135], v[180:183]
    ds_read_b64_tr_b16 a[190:191], v242 offset:30624
    s_waitcnt lgkmcnt(8)
    v_mfma_f32_16x16x32_bf16 v[184:187], a[196:199], v[128:131], v[184:187]
    s_waitcnt vmcnt(28)
    s_barrier
    ds_read_b64_tr_b16 a[192:193], v240 offset:0
    v_mfma_f32_16x16x32_bf16 v[188:191], a[196:199], v[132:135], v[188:191]
    ds_read_b64_tr_b16 a[194:195], v240 offset:256
    v_accvgpr_read_b32 v249, a211
    v_mov_b32 v250, s51
    buffer_store_dword v250, v249, s[20:23], 0 offen offset:8 sc1
    v_mfma_f32_16x16x32_bf16 v[192:195], a[168:171], v[128:131], v[192:195]
    ds_read_b64_tr_b16 a[196:197], v240 offset:32
    v_lshlrev_b32_e64 v210, 4, v210
    v_mfma_f32_16x16x32_bf16 v[196:199], a[168:171], v[132:135], v[196:199]
    ds_read_b64_tr_b16 a[198:199], v240 offset:288
    v_mov_b32 v209, 0x3f80
    v_mfma_f32_16x16x32_bf16 v[200:203], a[172:175], v[128:131], v[200:203]
    ds_read_b64_tr_b16 a[168:169], v240 offset:512
    v_lshlrev_b32_e64 v209, v210, v209
    v_mfma_f32_16x16x32_bf16 v[204:207], a[172:175], v[132:135], v[204:207]
    ds_read_b64_tr_b16 a[170:171], v240 offset:768
    s_waitcnt lgkmcnt(8)
    v_mfma_f32_16x16x32_bf16 v[176:179], a[176:179], v[136:139], v[176:179]
    ds_read_b64_tr_b16 a[172:173], v240 offset:544
    v_ashrrev_i32 v208, 1, v208
    v_mfma_f32_16x16x32_bf16 v[180:183], a[176:179], v[140:143], v[180:183]
    ds_read_b64_tr_b16 a[174:175], v240 offset:800
    v_cmp_eq_u32 s[40:41], 0, v208
    v_mfma_f32_16x16x32_bf16 v[184:187], a[180:183], v[136:139], v[184:187]
    ds_read_b64_tr_b16 a[176:177], v240 offset:1024
    v_cndmask_b32 v211, 0, v209, s[40:41]
    v_mfma_f32_16x16x32_bf16 v[188:191], a[180:183], v[140:143], v[188:191]
    ds_read_b64_tr_b16 a[178:179], v240 offset:1280
    v_accvgpr_write_b32 a240, v211
    v_mfma_f32_16x16x32_bf16 v[192:195], a[184:187], v[136:139], v[192:195]
    ds_read_b64_tr_b16 a[180:181], v240 offset:1056
    v_cmp_eq_u32 s[40:41], 1, v208
    v_mfma_f32_16x16x32_bf16 v[196:199], a[184:187], v[140:143], v[196:199]
    ds_read_b64_tr_b16 a[182:183], v240 offset:1312
    s_waitcnt lgkmcnt(8)
    v_mfma_f32_16x16x32_bf16 v[200:203], a[188:191], v[136:139], v[200:203]
    ds_read_b64_tr_b16 a[184:185], v240 offset:1536
    v_cndmask_b32 v211, 0, v209, s[40:41]
    v_mfma_f32_16x16x32_bf16 v[204:207], a[188:191], v[140:143], v[204:207]
    ds_read_b64_tr_b16 a[186:187], v240 offset:1792
    v_accvgpr_write_b32 a241, v211
    v_accvgpr_write_b32 a238, 0
    v_accvgpr_write_b32 a239, 0
    v_accvgpr_write_b32 a242, 0
    v_accvgpr_write_b32 a243, 0
    s_nop 1
    v_mfma_f32_16x16x32_bf16 v[208:211], a[192:195], v[0:3], 0
    ds_read_b64_tr_b16 a[188:189], v240 offset:1568
    v_mfma_f32_16x16x32_bf16 v[212:215], a[192:195], v[4:7], 0
    ds_read_b64_tr_b16 a[190:191], v240 offset:1824
    v_mfma_f32_16x16x32_bf16 v[216:219], a[196:199], v[0:3], 0
    ds_read_b64_tr_b16 a[192:193], v240 offset:2048
    s_and_b32 s78, s57, 1
    v_mfma_f32_16x16x32_bf16 v[220:223], a[196:199], v[4:7], 0
    ds_read_b64_tr_b16 a[194:195], v240 offset:2304
    s_waitcnt lgkmcnt(8)
    v_mfma_f32_16x16x32_bf16 v[224:227], a[168:171], v[0:3], 0
    ds_read_b64_tr_b16 a[196:197], v240 offset:2080
    s_add_u32 s72, s74, 8192
    v_mfma_f32_16x16x32_bf16 v[228:231], a[168:171], v[4:7], 0
    ds_read_b64_tr_b16 a[198:199], v240 offset:2336
    v_mul_f32_e64 v144, v144, v176
    v_mfma_f32_16x16x32_bf16 v[232:235], a[172:175], v[0:3], 0
    ds_read_b64_tr_b16 a[168:169], v240 offset:2560
    v_mul_f32_e64 v145, v145, v177
    v_mfma_f32_16x16x32_bf16 v[236:239], a[172:175], v[4:7], 0
    ds_read_b64_tr_b16 a[170:171], v240 offset:2816
    v_mul_f32_e64 v146, v146, v178
    v_mfma_f32_16x16x32_bf16 v[208:211], a[176:179], v[8:11], v[208:211]
    ds_read_b64_tr_b16 a[172:173], v240 offset:2592
    v_mul_f32_e64 v147, v147, v179
    v_mfma_f32_16x16x32_bf16 v[212:215], a[176:179], v[12:15], v[212:215]
    ds_read_b64_tr_b16 a[174:175], v240 offset:2848
    s_waitcnt lgkmcnt(8)
    v_mfma_f32_16x16x32_bf16 v[216:219], a[180:183], v[8:11], v[216:219]
    ds_read_b64_tr_b16 a[176:177], v240 offset:3072
    v_mul_f32 v152, v152, v184
    v_mfma_f32_16x16x32_bf16 v[220:223], a[180:183], v[12:15], v[220:223]
    ds_read_b64_tr_b16 a[178:179], v240 offset:3328
    v_mul_f32_e64 v153, v153, v185
    v_mfma_f32_16x16x32_bf16 v[224:227], a[184:187], v[8:11], v[224:227]
    ds_read_b64_tr_b16 a[180:181], v240 offset:3104
    v_mul_f32_e64 v154, v154, v186
    v_mfma_f32_16x16x32_bf16 v[228:231], a[184:187], v[12:15], v[228:231]
    ds_read_b64_tr_b16 a[182:183], v240 offset:3360
    v_mul_f32_e64 v155, v155, v187
    v_mfma_f32_16x16x32_bf16 v[232:235], a[188:191], v[8:11], v[232:235]
    ds_read_b64_tr_b16 a[184:185], v240 offset:3584
    v_cvt_pk_bf16_f32 v144, v144, v145
    v_mfma_f32_16x16x32_bf16 v[236:239], a[188:191], v[12:15], v[236:239]
    ds_read_b64_tr_b16 a[186:187], v240 offset:3840
    s_waitcnt lgkmcnt(8)
    v_mfma_f32_16x16x32_bf16 v[208:211], a[192:195], v[16:19], v[208:211]
    ds_read_b64_tr_b16 a[188:189], v240 offset:3616
    v_cvt_pk_bf16_f32 v145, v146, v147
    v_mfma_f32_16x16x32_bf16 v[212:215], a[192:195], v[20:23], v[212:215]
    ds_read_b64_tr_b16 a[190:191], v240 offset:3872
    v_cvt_pk_bf16_f32 v146, v152, v153
    v_mfma_f32_16x16x32_bf16 v[216:219], a[196:199], v[16:19], v[216:219]
    ds_read_b64_tr_b16 a[192:193], v240 offset:4096
    v_cvt_pk_bf16_f32 v147, v154, v155
    v_mfma_f32_16x16x32_bf16 v[220:223], a[196:199], v[20:23], v[220:223]
    ds_read_b64_tr_b16 a[194:195], v240 offset:4352
    v_accvgpr_write_b32 a32, v144
    v_mfma_f32_16x16x32_bf16 v[224:227], a[168:171], v[16:19], v[224:227]
    ds_read_b64_tr_b16 a[196:197], v240 offset:4128
    v_accvgpr_write_b32 a33, v145
    v_mfma_f32_16x16x32_bf16 v[228:231], a[168:171], v[20:23], v[228:231]
    ds_read_b64_tr_b16 a[198:199], v240 offset:4384
    s_waitcnt lgkmcnt(8)
    v_mfma_f32_16x16x32_bf16 v[232:235], a[172:175], v[16:19], v[232:235]
    ds_read_b64_tr_b16 a[168:169], v240 offset:4608
    v_accvgpr_write_b32 a34, v146
    v_mfma_f32_16x16x32_bf16 v[236:239], a[172:175], v[20:23], v[236:239]
    ds_read_b64_tr_b16 a[170:171], v240 offset:4864
    v_accvgpr_write_b32 a35, v147
    v_mfma_f32_16x16x32_bf16 v[208:211], a[176:179], v[24:27], v[208:211]
    ds_read_b64_tr_b16 a[172:173], v240 offset:4640
    buffer_store_dwordx4 v[144:147], v254, s[20:23], s72 offen offset:0 sc1
    v_mfma_f32_16x16x32_bf16 v[212:215], a[176:179], v[28:31], v[212:215]
    ds_read_b64_tr_b16 a[174:175], v240 offset:4896
    v_mul_f32_e64 v148, v148, v180
    v_mfma_f32_16x16x32_bf16 v[216:219], a[180:183], v[24:27], v[216:219]
    ds_read_b64_tr_b16 a[176:177], v240 offset:5120
    v_mul_f32_e64 v149, v149, v181
    v_mfma_f32_16x16x32_bf16 v[220:223], a[180:183], v[28:31], v[220:223]
    ds_read_b64_tr_b16 a[178:179], v240 offset:5376
    s_waitcnt lgkmcnt(8)
    v_mfma_f32_16x16x32_bf16 v[224:227], a[184:187], v[24:27], v[224:227]
    ds_read_b64_tr_b16 a[180:181], v240 offset:5152
    v_mul_f32 v150, v150, v182
    v_mfma_f32_16x16x32_bf16 v[228:231], a[184:187], v[28:31], v[228:231]
    ds_read_b64_tr_b16 a[182:183], v240 offset:5408
    v_mul_f32_e64 v151, v151, v183
    v_mfma_f32_16x16x32_bf16 v[232:235], a[188:191], v[24:27], v[232:235]
    ds_read_b64_tr_b16 a[184:185], v240 offset:5632
    v_mul_f32_e64 v156, v156, v188
    v_mfma_f32_16x16x32_bf16 v[236:239], a[188:191], v[28:31], v[236:239]
    ds_read_b64_tr_b16 a[186:187], v240 offset:5888
    v_mul_f32_e64 v157, v157, v189
    v_mfma_f32_16x16x32_bf16 v[208:211], a[192:195], v[32:35], v[208:211]
    ds_read_b64_tr_b16 a[188:189], v240 offset:5664
    v_mul_f32_e64 v158, v158, v190
    v_mfma_f32_16x16x32_bf16 v[212:215], a[192:195], v[36:39], v[212:215]
    ds_read_b64_tr_b16 a[190:191], v240 offset:5920
    s_waitcnt lgkmcnt(8)
    v_mfma_f32_16x16x32_bf16 v[216:219], a[196:199], v[32:35], v[216:219]
    s_waitcnt vmcnt(24)
    s_barrier
    ds_read_b64_tr_b16 a[192:193], v240 offset:24704
    v_mfma_f32_16x16x32_bf16 v[220:223], a[196:199], v[36:39], v[220:223]
    ds_read_b64_tr_b16 a[194:195], v240 offset:24960
    s_mul_i32 s69, s56, 3136
    v_mfma_f32_16x16x32_bf16 v[224:227], a[168:171], v[32:35], v[224:227]
    ds_read_b64_tr_b16 a[196:197], v240 offset:24736
    s_add_u32 m0, s69, 101120
    v_mfma_f32_16x16x32_bf16 v[228:231], a[168:171], v[36:39], v[228:231]
    ds_read_b64_tr_b16 a[198:199], v240 offset:24992
    s_add_u32 s67, s48, 0
    v_mfma_f32_16x16x32_bf16 v[232:235], a[172:175], v[32:35], v[232:235]
    ds_read_b64_tr_b16 a[168:169], v240 offset:25216
    buffer_load_dwordx4 v254, s[20:23], s67 offen offset:0 sc1 lds
    v_mfma_f32_16x16x32_bf16 v[236:239], a[172:175], v[36:39], v[236:239]
    ds_read_b64_tr_b16 a[170:171], v240 offset:25472
    s_waitcnt lgkmcnt(8)
    v_mfma_f32_16x16x32_bf16 v[208:211], a[176:179], v[40:43], v[208:211]
    ds_read_b64_tr_b16 a[172:173], v240 offset:25248
    s_add_u32 s67, s49, 0
    v_mfma_f32_16x16x32_bf16 v[212:215], a[176:179], v[44:47], v[212:215]
    ds_read_b64_tr_b16 a[174:175], v240 offset:25504
    v_mul_f32_e64 v159, v159, v191
    v_mfma_f32_16x16x32_bf16 v[216:219], a[180:183], v[40:43], v[216:219]
    ds_read_b64_tr_b16 a[176:177], v240 offset:25728
    v_cvt_pk_bf16_f32 v148, v148, v149
    v_mfma_f32_16x16x32_bf16 v[220:223], a[180:183], v[44:47], v[220:223]
    ds_read_b64_tr_b16 a[178:179], v240 offset:25984
    v_cvt_pk_bf16_f32 v149, v150, v151
    v_mfma_f32_16x16x32_bf16 v[224:227], a[184:187], v[40:43], v[224:227]
    ds_read_b64_tr_b16 a[180:181], v240 offset:25760
    buffer_load_dwordx4 v254, s[20:23], s67 offen offset:1024 sc1 lds
    v_mfma_f32_16x16x32_bf16 v[228:231], a[184:187], v[44:47], v[228:231]
    ds_read_b64_tr_b16 a[182:183], v240 offset:26016
    s_waitcnt lgkmcnt(8)
    v_mfma_f32_16x16x32_bf16 v[232:235], a[188:191], v[40:43], v[232:235]
    ds_read_b64_tr_b16 a[184:185], v240 offset:26240
    s_add_u32 s67, s50, 0
    v_mfma_f32_16x16x32_bf16 v[236:239], a[188:191], v[44:47], v[236:239]
    ds_read_b64_tr_b16 a[186:187], v240 offset:26496
    v_cvt_pk_bf16_f32 v150, v156, v157
    v_mfma_f32_16x16x32_bf16 v[208:211], a[192:195], v[48:51], v[208:211]
    ds_read_b64_tr_b16 a[188:189], v240 offset:26272
    v_cvt_pk_bf16_f32 v151, v158, v159
    v_mfma_f32_16x16x32_bf16 v[212:215], a[192:195], v[52:55], v[212:215]
    ds_read_b64_tr_b16 a[190:191], v240 offset:26528
    v_accvgpr_write_b32 a36, v148
    v_mfma_f32_16x16x32_bf16 v[216:219], a[196:199], v[48:51], v[216:219]
    ds_read_b64_tr_b16 a[192:193], v240 offset:26752
    buffer_load_dwordx4 v254, s[20:23], s67 offen offset:2048 sc1 lds
    v_mfma_f32_16x16x32_bf16 v[220:223], a[196:199], v[52:55], v[220:223]
    ds_read_b64_tr_b16 a[194:195], v240 offset:27008
    s_waitcnt lgkmcnt(8)
    v_mfma_f32_16x16x32_bf16 v[224:227], a[168:171], v[48:51], v[224:227]
    ds_read_b64_tr_b16 a[196:197], v240 offset:26784
    s_min_u32 s68, s69, 3136
    v_mfma_f32_16x16x32_bf16 v[228:231], a[168:171], v[52:55], v[228:231]
    ds_read_b64_tr_b16 a[198:199], v240 offset:27040
    s_add_u32 s68, s68, s69
    v_mfma_f32_16x16x32_bf16 v[232:235], a[172:175], v[48:51], v[232:235]
    ds_read_b64_tr_b16 a[168:169], v240 offset:27264
    s_add_u32 m0, s68, 113664
    v_mfma_f32_16x16x32_bf16 v[236:239], a[172:175], v[52:55], v[236:239]
    ds_read_b64_tr_b16 a[170:171], v240 offset:27520
    s_add_u32 s67, s48, 4096
    v_mfma_f32_16x16x32_bf16 v[208:211], a[176:179], v[56:59], v[208:211]
    ds_read_b64_tr_b16 a[172:173], v240 offset:27296
    buffer_load_dwordx4 v254, s[20:23], s67 offen offset:0 sc1 lds
    v_mfma_f32_16x16x32_bf16 v[212:215], a[176:179], v[60:63], v[212:215]
    ds_read_b64_tr_b16 a[174:175], v240 offset:27552
    s_waitcnt lgkmcnt(8)
    v_mfma_f32_16x16x32_bf16 v[216:219], a[180:183], v[56:59], v[216:219]
    ds_read_b64_tr_b16 a[176:177], v240 offset:27776
    s_add_u32 s67, s49, 4096
    v_mfma_f32_16x16x32_bf16 v[220:223], a[180:183], v[60:63], v[220:223]
    ds_read_b64_tr_b16 a[178:179], v240 offset:28032
    v_accvgpr_write_b32 a37, v149
    v_mfma_f32_16x16x32_bf16 v[224:227], a[184:187], v[56:59], v[224:227]
    ds_read_b64_tr_b16 a[180:181], v240 offset:27808
    v_accvgpr_write_b32 a38, v150
    v_mfma_f32_16x16x32_bf16 v[228:231], a[184:187], v[60:63], v[228:231]
    ds_read_b64_tr_b16 a[182:183], v240 offset:28064
    v_accvgpr_write_b32 a39, v151
    v_mfma_f32_16x16x32_bf16 v[232:235], a[188:191], v[56:59], v[232:235]
    ds_read_b64_tr_b16 a[184:185], v240 offset:28288
    buffer_load_dwordx4 v254, s[20:23], s67 offen offset:1024 sc1 lds
    v_mfma_f32_16x16x32_bf16 v[236:239], a[188:191], v[60:63], v[236:239]
    ds_read_b64_tr_b16 a[186:187], v240 offset:28544
    s_waitcnt lgkmcnt(8)
    v_mfma_f32_16x16x32_bf16 v[208:211], a[192:195], v[64:67], v[208:211]
    ds_read_b64_tr_b16 a[188:189], v240 offset:28320
    s_add_u32 s67, s50, 4096
    v_mfma_f32_16x16x32_bf16 v[212:215], a[192:195], v[68:71], v[212:215]
    ds_read_b64_tr_b16 a[190:191], v240 offset:28576
    buffer_store_dwordx4 v[148:151], v254, s[20:23], s72 offen offset:1024 sc1
    v_mfma_f32_16x16x32_bf16 v[216:219], a[196:199], v[64:67], v[216:219]
    ds_read_b64_tr_b16 a[192:193], v240 offset:28800
    s_add_u32 s72, s74, 10240
    v_mfma_f32_16x16x32_bf16 v[220:223], a[196:199], v[68:71], v[220:223]
    ds_read_b64_tr_b16 a[194:195], v240 offset:29056
    v_mul_f32_e64 v160, v160, v192
    v_mfma_f32_16x16x32_bf16 v[224:227], a[168:171], v[64:67], v[224:227]
    ds_read_b64_tr_b16 a[196:197], v240 offset:28832
    buffer_load_dwordx4 v254, s[20:23], s67 offen offset:2048 sc1 lds
    v_mfma_f32_16x16x32_bf16 v[228:231], a[168:171], v[68:71], v[228:231]
    ds_read_b64_tr_b16 a[198:199], v240 offset:29088
    s_waitcnt lgkmcnt(8)
    v_mfma_f32_16x16x32_bf16 v[232:235], a[172:175], v[64:67], v[232:235]
    ds_read_b64_tr_b16 a[168:169], v240 offset:29312
    s_cmp_eq_u32 s56, 1
    s_cselect_b32 s67, s49, s50
    v_mfma_f32_16x16x32_bf16 v[236:239], a[172:175], v[68:71], v[236:239]
    ds_read_b64_tr_b16 a[170:171], v240 offset:29568
    s_cmp_eq_u32 s56, 0
    s_cselect_b32 s67, s48, s67
    v_mfma_f32_16x16x32_bf16 v[208:211], a[176:179], v[72:75], v[208:211]
    ds_read_b64_tr_b16 a[172:173], v240 offset:29344
    s_min_u32 s68, s56, 2
    v_mfma_f32_16x16x32_bf16 v[212:215], a[176:179], v[76:79], v[212:215]
    ds_read_b64_tr_b16 a[174:175], v240 offset:29600
    s_sub_u32 s69, s68, s56
    v_mfma_f32_16x16x32_bf16 v[216:219], a[180:183], v[72:75], v[216:219]
    ds_read_b64_tr_b16 a[176:177], v240 offset:29824
    s_lshl_b32 s69, s69, 10
    v_mfma_f32_16x16x32_bf16 v[220:223], a[180:183], v[76:79], v[220:223]
    ds_read_b64_tr_b16 a[178:179], v240 offset:30080
    s_waitcnt lgkmcnt(8)
    v_mfma_f32_16x16x32_bf16 v[224:227], a[184:187], v[72:75], v[224:227]
    ds_read_b64_tr_b16 a[180:181], v240 offset:29856
    s_add_u32 s67, s67, s69
    v_mfma_f32_16x16x32_bf16 v[228:231], a[184:187], v[76:79], v[228:231]
    ds_read_b64_tr_b16 a[182:183], v240 offset:30112
    s_lshl_b32 s68, s68, 10
    v_mfma_f32_16x16x32_bf16 v[232:235], a[188:191], v[72:75], v[232:235]
    ds_read_b64_tr_b16 a[184:185], v240 offset:30336
    s_add_u32 m0, s68, 129344
    v_mfma_f32_16x16x32_bf16 v[236:239], a[188:191], v[76:79], v[236:239]
    ds_read_b64_tr_b16 a[186:187], v240 offset:30592
    s_add_u32 s67, s67, 8192
    v_mfma_f32_16x16x32_bf16 v[208:211], a[192:195], v[80:83], v[208:211]
    ds_read_b64_tr_b16 a[188:189], v240 offset:30368
    buffer_load_dwordx4 v254, s[20:23], s67 offen sc1 lds
    v_mfma_f32_16x16x32_bf16 v[212:215], a[192:195], v[84:87], v[212:215]
    ds_read_b64_tr_b16 a[190:191], v240 offset:30624
    s_waitcnt lgkmcnt(8)
    v_mfma_f32_16x16x32_bf16 v[216:219], a[196:199], v[80:83], v[216:219]
    s_waitcnt vmcnt(21)
    s_barrier
    v_accvgpr_read_b32 v249, a212
    buffer_load_dword v250, v249, s[20:23], 0 offen offset:8 sc1
    ds_read_b64_tr_b16 a[192:193], v241 offset:0
    v_mfma_f32_16x16x32_bf16 v[220:223], a[196:199], v[84:87], v[220:223]
    ds_read_b64_tr_b16 a[194:195], v241 offset:256
    v_add_u32_e64 v251, s68, v254
    v_mfma_f32_16x16x32_bf16 v[224:227], a[168:171], v[80:83], v[224:227]
    ds_read_b64_tr_b16 a[196:197], v241 offset:32
    s_cmp_ge_u32 s67, 536870912
    s_cselect_b32 s67, 0xf149, 0
    v_mfma_f32_16x16x32_bf16 v[228:231], a[168:171], v[84:87], v[228:231]
    ds_read_b64_tr_b16 a[198:199], v241 offset:288
    v_accvgpr_write_b32 a128, s67
    v_mfma_f32_16x16x32_bf16 v[232:235], a[172:175], v[80:83], v[232:235]
    ds_read_b64_tr_b16 a[168:169], v241 offset:512
    v_accvgpr_write_b32 a129, 0
    v_mfma_f32_16x16x32_bf16 v[236:239], a[172:175], v[84:87], v[236:239]
    ds_read_b64_tr_b16 a[170:171], v241 offset:768
    s_waitcnt lgkmcnt(8)
    v_mfma_f32_16x16x32_bf16 v[208:211], a[176:179], v[88:91], v[208:211]
    ds_read_b64_tr_b16 a[172:173], v241 offset:544
    v_accvgpr_write_b32 a130, s67
    v_mfma_f32_16x16x32_bf16 v[212:215], a[176:179], v[92:95], v[212:215]
    ds_read_b64_tr_b16 a[174:175], v241 offset:800
    v_accvgpr_write_b32 a131, 0
    v_mfma_f32_16x16x32_bf16 v[216:219], a[180:183], v[88:91], v[216:219]
    ds_read_b64_tr_b16 a[176:177], v241 offset:1024
    v_add_u32 v251, 116800, v251
    v_mfma_f32_16x16x32_bf16 v[220:223], a[180:183], v[92:95], v[220:223]
    ds_read_b64_tr_b16 a[178:179], v241 offset:1280
    ds_write_b128 v251, a[128:131]
    v_mfma_f32_16x16x32_bf16 v[224:227], a[184:187], v[88:91], v[224:227]
    ds_read_b64_tr_b16 a[180:181], v241 offset:1056
    s_add_u32 m0, s64, 0
    v_mfma_f32_16x16x32_bf16 v[228:231], a[184:187], v[92:95], v[228:231]
    ds_read_b64_tr_b16 a[182:183], v241 offset:1312
    s_waitcnt lgkmcnt(9)
    v_mfma_f32_16x16x32_bf16 v[232:235], a[188:191], v[88:91], v[232:235]
    ds_read_b64_tr_b16 a[184:185], v241 offset:1536
    s_add_u32 s66, s62, s97
    v_mfma_f32_16x16x32_bf16 v[236:239], a[188:191], v[92:95], v[236:239]
    ds_read_b64_tr_b16 a[186:187], v241 offset:1792
    buffer_load_dwordx4 v243, s[12:15], s66 offen offset:0 lds
    v_mfma_f32_16x16x32_bf16 v[208:211], a[192:195], v[96:99], v[208:211]
    ds_read_b64_tr_b16 a[188:189], v241 offset:1568
    v_mul_f32_e64 v161, v161, v193
    v_mfma_f32_16x16x32_bf16 v[212:215], a[192:195], v[100:103], v[212:215]
    ds_read_b64_tr_b16 a[190:191], v241 offset:1824
    buffer_load_dwordx4 v244, s[12:15], s66 offen offset:1024 lds
    v_mfma_f32_16x16x32_bf16 v[216:219], a[196:199], v[96:99], v[216:219]
    ds_read_b64_tr_b16 a[192:193], v241 offset:2048
    v_mul_f32_e64 v162, v162, v194
    v_mfma_f32_16x16x32_bf16 v[220:223], a[196:199], v[100:103], v[220:223]
    ds_read_b64_tr_b16 a[194:195], v241 offset:2304
    s_waitcnt lgkmcnt(9)
    v_mfma_f32_16x16x32_bf16 v[224:227], a[168:171], v[96:99], v[224:227]
    ds_read_b64_tr_b16 a[196:197], v241 offset:2080
    buffer_load_dwordx4 v245, s[12:15], s66 offen offset:2048 lds
    v_mfma_f32_16x16x32_bf16 v[228:231], a[168:171], v[100:103], v[228:231]
    ds_read_b64_tr_b16 a[198:199], v241 offset:2336
    s_add_u32 m0, s64, 3072
    v_mfma_f32_16x16x32_bf16 v[232:235], a[172:175], v[96:99], v[232:235]
    ds_read_b64_tr_b16 a[168:169], v241 offset:2560
    s_add_u32 s66, s66, 884736
    v_mfma_f32_16x16x32_bf16 v[236:239], a[172:175], v[100:103], v[236:239]
    ds_read_b64_tr_b16 a[170:171], v241 offset:2816
    buffer_load_dwordx4 v243, s[12:15], s66 offen offset:0 lds
    v_mfma_f32_16x16x32_bf16 v[208:211], a[176:179], v[104:107], v[208:211]
    ds_read_b64_tr_b16 a[172:173], v241 offset:2592
    v_mul_f32 v163, v163, v195
    v_mfma_f32_16x16x32_bf16 v[212:215], a[176:179], v[108:111], v[212:215]
    ds_read_b64_tr_b16 a[174:175], v241 offset:2848
    s_waitcnt lgkmcnt(8)
    v_mfma_f32_16x16x32_bf16 v[216:219], a[180:183], v[104:107], v[216:219]
    ds_read_b64_tr_b16 a[176:177], v241 offset:3072
    buffer_load_dwordx4 v244, s[12:15], s66 offen offset:1024 lds
    v_mfma_f32_16x16x32_bf16 v[220:223], a[180:183], v[108:111], v[220:223]
    ds_read_b64_tr_b16 a[178:179], v241 offset:3328
    v_mul_f32 v168, v168, v200
    v_mfma_f32_16x16x32_bf16 v[224:227], a[184:187], v[104:107], v[224:227]
    ds_read_b64_tr_b16 a[180:181], v241 offset:3104
    buffer_load_dwordx4 v245, s[12:15], s66 offen offset:2048 lds
    v_mfma_f32_16x16x32_bf16 v[228:231], a[184:187], v[108:111], v[228:231]
    ds_read_b64_tr_b16 a[182:183], v241 offset:3360
    v_mul_f32_e64 v169, v169, v201
    v_mfma_f32_16x16x32_bf16 v[232:235], a[188:191], v[104:107], v[232:235]
    ds_read_b64_tr_b16 a[184:185], v241 offset:3584
    v_mul_f32_e64 v170, v170, v202
    v_mfma_f32_16x16x32_bf16 v[236:239], a[188:191], v[108:111], v[236:239]
    ds_read_b64_tr_b16 a[186:187], v241 offset:3840
    s_waitcnt lgkmcnt(8)
    v_mfma_f32_16x16x32_bf16 v[208:211], a[192:195], v[112:115], v[208:211]
    ds_read_b64_tr_b16 a[188:189], v241 offset:3616
    v_mul_f32 v171, v171, v203
    v_mfma_f32_16x16x32_bf16 v[212:215], a[192:195], v[116:119], v[212:215]
    ds_read_b64_tr_b16 a[190:191], v241 offset:3872
    v_cvt_pk_bf16_f32 v160, v160, v161
    v_mfma_f32_16x16x32_bf16 v[216:219], a[196:199], v[112:115], v[216:219]
    ds_read_b64_tr_b16 a[192:193], v241 offset:4096
    v_cvt_pk_bf16_f32 v161, v162, v163
    v_mfma_f32_16x16x32_bf16 v[220:223], a[196:199], v[116:119], v[220:223]
    ds_read_b64_tr_b16 a[194:195], v241 offset:4352
    v_cvt_pk_bf16_f32 v162, v168, v169
    v_mfma_f32_16x16x32_bf16 v[224:227], a[168:171], v[112:115], v[224:227]
    ds_read_b64_tr_b16 a[196:197], v241 offset:4128
    v_cvt_pk_bf16_f32 v163, v170, v171
    v_mfma_f32_16x16x32_bf16 v[228:231], a[168:171], v[116:119], v[228:231]
    ds_read_b64_tr_b16 a[198:199], v241 offset:4384
    s_waitcnt lgkmcnt(8)
    v_mfma_f32_16x16x32_bf16 v[232:235], a[172:175], v[112:115], v[232:235]
    ds_read_b64_tr_b16 a[168:169], v241 offset:4608
    v_accvgpr_write_b32 a40, v160
    v_mfma_f32_16x16x32_bf16 v[236:239], a[172:175], v[116:119], v[236:239]
    ds_read_b64_tr_b16 a[170:171], v241 offset:4864
    v_accvgpr_write_b32 a41, v161
    v_mfma_f32_16x16x32_bf16 v[208:211], a[176:179], v[120:123], v[208:211]
    ds_read_b64_tr_b16 a[172:173], v241 offset:4640
    v_accvgpr_write_b32 a42, v162
    v_mfma_f32_16x16x32_bf16 v[212:215], a[176:179], v[124:127], v[212:215]
    ds_read_b64_tr_b16 a[174:175], v241 offset:4896
    v_accvgpr_write_b32 a43, v163
    v_mfma_f32_16x16x32_bf16 v[216:219], a[180:183], v[120:123], v[216:219]
    ds_read_b64_tr_b16 a[176:177], v241 offset:5120
    buffer_store_dwordx4 v[160:163], v254, s[20:23], s72 offen offset:0 sc1
    v_mfma_f32_16x16x32_bf16 v[220:223], a[180:183], v[124:127], v[220:223]
    ds_read_b64_tr_b16 a[178:179], v241 offset:5376
    s_waitcnt lgkmcnt(8)
    v_mfma_f32_16x16x32_bf16 v[224:227], a[184:187], v[120:123], v[224:227]
    ds_read_b64_tr_b16 a[180:181], v241 offset:5152
L_w7:
    s_cbranch_execz L_wret1
    v_mul_f32_e64 v164, v164, v196
    v_mfma_f32_16x16x32_bf16 v[228:231], a[184:187], v[124:127], v[228:231]
    ds_read_b64_tr_b16 a[182:183], v241 offset:5408
    v_mul_f32_e64 v165, v165, v197
    v_mfma_f32_16x16x32_bf16 v[232:235], a[188:191], v[120:123], v[232:235]
    ds_read_b64_tr_b16 a[184:185], v241 offset:5632
    v_mul_f32_e64 v166, v166, v198
    v_mfma_f32_16x16x32_bf16 v[236:239], a[188:191], v[124:127], v[236:239]
    ds_read_b64_tr_b16 a[186:187], v241 offset:5888
    v_mul_f32_e64 v167, v167, v199
    v_mfma_f32_16x16x32_bf16 v[208:211], a[192:195], v[128:131], v[208:211]
    ds_read_b64_tr_b16 a[188:189], v241 offset:5664
    v_mul_f32_e64 v172, v172, v204
    v_mfma_f32_16x16x32_bf16 v[212:215], a[192:195], v[132:135], v[212:215]
    ds_read_b64_tr_b16 a[190:191], v241 offset:5920
    s_waitcnt lgkmcnt(8)
    v_mfma_f32_16x16x32_bf16 v[216:219], a[196:199], v[128:131], v[216:219]
    s_waitcnt vmcnt(18)
    s_barrier
    ds_read_b64_tr_b16 a[192:193], v241 offset:24704
    v_mfma_f32_16x16x32_bf16 v[220:223], a[196:199], v[132:135], v[220:223]
    ds_read_b64_tr_b16 a[194:195], v241 offset:24960
    s_add_u32 m0, s64, 24704
    v_mfma_f32_16x16x32_bf16 v[224:227], a[168:171], v[128:131], v[224:227]
    ds_read_b64_tr_b16 a[196:197], v241 offset:24736
    s_add_u32 s66, s62, s98
    v_mfma_f32_16x16x32_bf16 v[228:231], a[168:171], v[132:135], v[228:231]
    ds_read_b64_tr_b16 a[198:199], v241 offset:24992
    buffer_load_dwordx4 v243, s[12:15], s66 offen offset:0 lds
    v_mfma_f32_16x16x32_bf16 v[232:235], a[172:175], v[128:131], v[232:235]
    ds_read_b64_tr_b16 a[168:169], v241 offset:25216
    v_mul_f32_e64 v173, v173, v205
    v_mfma_f32_16x16x32_bf16 v[236:239], a[172:175], v[132:135], v[236:239]
    ds_read_b64_tr_b16 a[170:171], v241 offset:25472
    s_waitcnt lgkmcnt(8)
    v_mfma_f32_16x16x32_bf16 v[208:211], a[176:179], v[136:139], v[208:211]
    ds_read_b64_tr_b16 a[172:173], v241 offset:25248
    v_mul_f32 v174, v174, v206
    v_mfma_f32_16x16x32_bf16 v[212:215], a[176:179], v[140:143], v[212:215]
    ds_read_b64_tr_b16 a[174:175], v241 offset:25504
    buffer_load_dwordx4 v244, s[12:15], s66 offen offset:1024 lds
    v_mfma_f32_16x16x32_bf16 v[216:219], a[180:183], v[136:139], v[216:219]
    ds_read_b64_tr_b16 a[176:177], v241 offset:25728
    v_mul_f32_e64 v175, v175, v207
    v_mfma_f32_16x16x32_bf16 v[220:223], a[180:183], v[140:143], v[220:223]
    ds_read_b64_tr_b16 a[178:179], v241 offset:25984
    v_cvt_pk_bf16_f32 v164, v164, v165
    v_mfma_f32_16x16x32_bf16 v[224:227], a[184:187], v[136:139], v[224:227]
    ds_read_b64_tr_b16 a[180:181], v241 offset:25760
    v_cvt_pk_bf16_f32 v165, v166, v167
    v_mfma_f32_16x16x32_bf16 v[228:231], a[184:187], v[140:143], v[228:231]
    ds_read_b64_tr_b16 a[182:183], v241 offset:26016
    s_waitcnt lgkmcnt(8)
    v_mfma_f32_16x16x32_bf16 v[232:235], a[188:191], v[136:139], v[232:235]
    ds_read_b64_tr_b16 a[184:185], v241 offset:26240
    buffer_load_dwordx4 v245, s[12:15], s66 offen offset:2048 lds
    v_mfma_f32_16x16x32_bf16 v[236:239], a[188:191], v[140:143], v[236:239]
    ds_read_b64_tr_b16 a[186:187], v241 offset:26496
    s_add_u32 m0, s64, 27776
    v_cvt_pk_bf16_f32 v166, v172, v173
    v_cvt_pk_bf16_f32 v167, v174, v175
    v_accvgpr_write_b32 a44, v164
    v_accvgpr_write_b32 a45, v165
    v_accvgpr_write_b32 a46, v166
    v_accvgpr_write_b32 a47, v167
    buffer_store_dwordx4 v[164:167], v254, s[20:23], s72 offen offset:1024 sc1
    s_nop 1
    v_mfma_f32_16x16x32_bf16 v[144:147], a[192:195], v[0:3], 0
    ds_read_b64_tr_b16 a[188:189], v241 offset:26272
    s_add_u32 s66, s66, 884736
    v_mfma_f32_16x16x32_bf16 v[148:151], a[192:195], v[4:7], 0
    ds_read_b64_tr_b16 a[190:191], v241 offset:26528
    buffer_load_dwordx4 v243, s[12:15], s66 offen offset:0 lds
    v_mfma_f32_16x16x32_bf16 v[152:155], a[196:199], v[0:3], 0
    ds_read_b64_tr_b16 a[192:193], v241 offset:26752
    s_lshl_b32 s45, s78, 6
    v_mfma_f32_16x16x32_bf16 v[156:159], a[196:199], v[4:7], 0
    ds_read_b64_tr_b16 a[194:195], v241 offset:27008
    s_waitcnt lgkmcnt(8)
    v_mfma_f32_16x16x32_bf16 v[160:163], a[168:171], v[0:3], 0
    ds_read_b64_tr_b16 a[196:197], v241 offset:26784
    v_mul_f32_e64 v208, v252, v208
    v_mfma_f32_16x16x32_bf16 v[164:167], a[168:171], v[4:7], 0
    ds_read_b64_tr_b16 a[198:199], v241 offset:27040
    buffer_load_dwordx4 v244, s[12:15], s66 offen offset:1024 lds
    v_mfma_f32_16x16x32_bf16 v[168:171], a[172:175], v[0:3], 0
    ds_read_b64_tr_b16 a[168:169], v241 offset:27264
    v_mul_f32_e64 v209, v252, v209
    v_mfma_f32_16x16x32_bf16 v[172:175], a[172:175], v[4:7], 0
    ds_read_b64_tr_b16 a[170:171], v241 offset:27520
    v_mul_f32_e64 v210, v252, v210
    v_mfma_f32_16x16x32_bf16 v[144:147], a[176:179], v[8:11], v[144:147]
    ds_read_b64_tr_b16 a[172:173], v241 offset:27296
    v_mul_f32_e64 v211, v252, v211
    v_mfma_f32_16x16x32_bf16 v[148:151], a[176:179], v[12:15], v[148:151]
    ds_read_b64_tr_b16 a[174:175], v241 offset:27552
    s_waitcnt lgkmcnt(8)
    v_mfma_f32_16x16x32_bf16 v[152:155], a[180:183], v[8:11], v[152:155]
    ds_read_b64_tr_b16 a[176:177], v241 offset:27776
    buffer_load_dwordx4 v245, s[12:15], s66 offen offset:2048 lds
    v_mfma_f32_16x16x32_bf16 v[156:159], a[180:183], v[12:15], v[156:159]
    ds_read_b64_tr_b16 a[178:179], v241 offset:28032
    s_mul_i32 s69, s56, 3136
    v_mfma_f32_16x16x32_bf16 v[160:163], a[184:187], v[8:11], v[160:163]
    ds_read_b64_tr_b16 a[180:181], v241 offset:27808
    s_add_u32 m0, s69, 132480
    v_mfma_f32_16x16x32_bf16 v[164:167], a[184:187], v[12:15], v[164:167]
    ds_read_b64_tr_b16 a[182:183], v241 offset:28064
    s_add_u32 s67, s48, 147456
    v_mfma_f32_16x16x32_bf16 v[168:171], a[188:191], v[8:11], v[168:171]
    ds_read_b64_tr_b16 a[184:185], v241 offset:28288
    v_mul_f32 v212, v253, v212
    v_mfma_f32_16x16x32_bf16 v[172:175], a[188:191], v[12:15], v[172:175]
    ds_read_b64_tr_b16 a[186:187], v241 offset:28544
    s_waitcnt lgkmcnt(8)
    v_mfma_f32_16x16x32_bf16 v[144:147], a[192:195], v[16:19], v[144:147]
    ds_read_b64_tr_b16 a[188:189], v241 offset:28320
    buffer_load_dwordx4 v254, s[20:23], s67 offen offset:0 sc1 lds
    v_mfma_f32_16x16x32_bf16 v[148:151], a[192:195], v[20:23], v[148:151]
    ds_read_b64_tr_b16 a[190:191], v241 offset:28576
    s_add_u32 s67, s49, 147456
    v_mfma_f32_16x16x32_bf16 v[152:155], a[196:199], v[16:19], v[152:155]
    ds_read_b64_tr_b16 a[192:193], v241 offset:28800
    v_mul_f32 v213, v253, v213
    v_mfma_f32_16x16x32_bf16 v[156:159], a[196:199], v[20:23], v[156:159]
    ds_read_b64_tr_b16 a[194:195], v241 offset:29056
    v_mul_f32_e64 v214, v253, v214
    v_mfma_f32_16x16x32_bf16 v[160:163], a[168:171], v[16:19], v[160:163]
    ds_read_b64_tr_b16 a[196:197], v241 offset:28832
    v_mul_f32_e64 v215, v253, v215
    v_mfma_f32_16x16x32_bf16 v[164:167], a[168:171], v[20:23], v[164:167]
    ds_read_b64_tr_b16 a[198:199], v241 offset:29088
    s_waitcnt lgkmcnt(8)
    v_mfma_f32_16x16x32_bf16 v[168:171], a[172:175], v[16:19], v[168:171]
    ds_read_b64_tr_b16 a[168:169], v241 offset:29312
    buffer_load_dwordx4 v254, s[20:23], s67 offen offset:1024 sc1 lds
    v_mfma_f32_16x16x32_bf16 v[172:175], a[172:175], v[20:23], v[172:175]
    ds_read_b64_tr_b16 a[170:171], v241 offset:29568
    s_add_u32 s67, s50, 147456
    v_mfma_f32_16x16x32_bf16 v[144:147], a[176:179], v[24:27], v[144:147]
    ds_read_b64_tr_b16 a[172:173], v241 offset:29344
    v_mul_f32 v216, v252, v216
    v_mfma_f32_16x16x32_bf16 v[148:151], a[176:179], v[28:31], v[148:151]
    ds_read_b64_tr_b16 a[174:175], v241 offset:29600
    v_mul_f32_e64 v217, v252, v217
    v_mfma_f32_16x16x32_bf16 v[152:155], a[180:183], v[24:27], v[152:155]
    ds_read_b64_tr_b16 a[176:177], v241 offset:29824
    v_mul_f32_e64 v218, v252, v218
    v_mfma_f32_16x16x32_bf16 v[156:159], a[180:183], v[28:31], v[156:159]
    ds_read_b64_tr_b16 a[178:179], v241 offset:30080
    s_waitcnt lgkmcnt(8)
    v_mfma_f32_16x16x32_bf16 v[160:163], a[184:187], v[24:27], v[160:163]
    ds_read_b64_tr_b16 a[180:181], v241 offset:29856
    buffer_load_dwordx4 v254, s[20:23], s67 offen offset:2048 sc1 lds
    v_mfma_f32_16x16x32_bf16 v[164:167], a[184:187], v[28:31], v[164:167]
    ds_read_b64_tr_b16 a[182:183], v241 offset:30112
    s_min_u32 s68, s69, 3136
    v_mfma_f32_16x16x32_bf16 v[168:171], a[188:191], v[24:27], v[168:171]
    ds_read_b64_tr_b16 a[184:185], v241 offset:30336
    s_add_u32 s68, s68, s69
    v_mfma_f32_16x16x32_bf16 v[172:175], a[188:191], v[28:31], v[172:175]
    ds_read_b64_tr_b16 a[186:187], v241 offset:30592
    s_add_u32 m0, s68, 145024
    v_mfma_f32_16x16x32_bf16 v[144:147], a[192:195], v[32:35], v[144:147]
    ds_read_b64_tr_b16 a[188:189], v241 offset:30368
    s_add_u32 s67, s48, 151552
    v_mfma_f32_16x16x32_bf16 v[148:151], a[192:195], v[36:39], v[148:151]
    ds_read_b64_tr_b16 a[190:191], v241 offset:30624
    s_waitcnt lgkmcnt(8)
    v_mfma_f32_16x16x32_bf16 v[152:155], a[196:199], v[32:35], v[152:155]
    s_waitcnt vmcnt(11)
    s_barrier
    v_cmp_ne_u32 vcc, s51, v250
    s_nop 0
    s_cmp_lg_u64 vcc, 0
    s_cbranch_scc1 L_spin_h1
L_back_h1:
    ds_read_b64_tr_b16 a[192:193], v240 offset:0
    v_mfma_f32_16x16x32_bf16 v[156:159], a[196:199], v[36:39], v[156:159]
    ds_read_b64_tr_b16 a[194:195], v240 offset:256
    buffer_load_dwordx4 v254, s[20:23], s67 offen offset:0 sc1 lds
    v_mfma_f32_16x16x32_bf16 v[160:163], a[168:171], v[32:35], v[160:163]
    ds_read_b64_tr_b16 a[196:197], v240 offset:32
    s_add_u32 s67, s49, 151552
    v_mfma_f32_16x16x32_bf16 v[164:167], a[168:171], v[36:39], v[164:167]
    ds_read_b64_tr_b16 a[198:199], v240 offset:288
    buffer_load_dwordx4 v254, s[20:23], s67 offen offset:1024 sc1 lds
    v_mfma_f32_16x16x32_bf16 v[168:171], a[172:175], v[32:35], v[168:171]
    ds_read_b64_tr_b16 a[168:169], v240 offset:512
    s_add_u32 s67, s50, 151552
    v_mfma_f32_16x16x32_bf16 v[172:175], a[172:175], v[36:39], v[172:175]
    ds_read_b64_tr_b16 a[170:171], v240 offset:768
    s_waitcnt lgkmcnt(8)
    v_mfma_f32_16x16x32_bf16 v[144:147], a[176:179], v[40:43], v[144:147]
    ds_read_b64_tr_b16 a[172:173], v240 offset:544
    buffer_load_dwordx4 v254, s[20:23], s67 offen offset:2048 sc1 lds
    v_mfma_f32_16x16x32_bf16 v[148:151], a[176:179], v[44:47], v[148:151]
    ds_read_b64_tr_b16 a[174:175], v240 offset:800
    s_cmp_eq_u32 s56, 1
    s_cselect_b32 s67, s49, s50
    v_mfma_f32_16x16x32_bf16 v[152:155], a[180:183], v[40:43], v[152:155]
    ds_read_b64_tr_b16 a[176:177], v240 offset:1024
    s_cmp_eq_u32 s56, 0
    s_cselect_b32 s67, s48, s67
    v_mfma_f32_16x16x32_bf16 v[156:159], a[180:183], v[44:47], v[156:159]
    ds_read_b64_tr_b16 a[178:179], v240 offset:1280
    s_min_u32 s68, s56, 2
    v_mfma_f32_16x16x32_bf16 v[160:163], a[184:187], v[40:43], v[160:163]
    ds_read_b64_tr_b16 a[180:181], v240 offset:1056
    s_sub_u32 s69, s68, s56
    v_mfma_f32_16x16x32_bf16 v[164:167], a[184:187], v[44:47], v[164:167]
    ds_read_b64_tr_b16 a[182:183], v240 offset:1312
    s_waitcnt lgkmcnt(8)
    v_mfma_f32_16x16x32_bf16 v[168:171], a[188:191], v[40:43], v[168:171]
    ds_read_b64_tr_b16 a[184:185], v240 offset:1536
    s_lshl_b32 s69, s69, 10
    v_mfma_f32_16x16x32_bf16 v[172:175], a[188:191], v[44:47], v[172:175]
    ds_read_b64_tr_b16 a[186:187], v240 offset:1792
    s_add_u32 s67, s67, s69
    v_mfma_f32_16x16x32_bf16 v[144:147], a[192:195], v[48:51], v[144:147]
    ds_read_b64_tr_b16 a[188:189], v240 offset:1568
    s_lshl_b32 s68, s68, 10
    v_mfma_f32_16x16x32_bf16 v[148:151], a[192:195], v[52:55], v[148:151]
    ds_read_b64_tr_b16 a[190:191], v240 offset:1824
    s_add_u32 m0, s68, 160704
    v_mfma_f32_16x16x32_bf16 v[152:155], a[196:199], v[48:51], v[152:155]
    ds_read_b64_tr_b16 a[192:193], v240 offset:2048
    s_add_u32 s67, s67, 155648
    v_mfma_f32_16x16x32_bf16 v[156:159], a[196:199], v[52:55], v[156:159]
    ds_read_b64_tr_b16 a[194:195], v240 offset:2304
    s_waitcnt lgkmcnt(8)
    v_mfma_f32_16x16x32_bf16 v[160:163], a[168:171], v[48:51], v[160:163]
    ds_read_b64_tr_b16 a[196:197], v240 offset:2080
    buffer_load_dwordx4 v254, s[20:23], s67 offen sc1 lds
    v_mfma_f32_16x16x32_bf16 v[164:167], a[168:171], v[52:55], v[164:167]
    ds_read_b64_tr_b16 a[198:199], v240 offset:2336
    v_add_u32 v251, s68, v254
    v_mfma_f32_16x16x32_bf16 v[168:171], a[172:175], v[48:51], v[168:171]
    ds_read_b64_tr_b16 a[168:169], v240 offset:2560
    v_accvgpr_write_b32 a132, s76
    v_mfma_f32_16x16x32_bf16 v[172:175], a[172:175], v[52:55], v[172:175]
    ds_read_b64_tr_b16 a[170:171], v240 offset:2816
    v_accvgpr_write_b32 a133, s76
    v_mfma_f32_16x16x32_bf16 v[144:147], a[176:179], v[56:59], v[144:147]
    ds_read_b64_tr_b16 a[172:173], v240 offset:2592
    v_accvgpr_write_b32 a134, s76
    v_mfma_f32_16x16x32_bf16 v[148:151], a[176:179], v[60:63], v[148:151]
    ds_read_b64_tr_b16 a[174:175], v240 offset:2848
    s_waitcnt lgkmcnt(8)
    v_mfma_f32_16x16x32_bf16 v[152:155], a[180:183], v[56:59], v[152:155]
    ds_read_b64_tr_b16 a[176:177], v240 offset:3072
    v_accvgpr_write_b32 a135, s76
    v_mfma_f32_16x16x32_bf16 v[156:159], a[180:183], v[60:63], v[156:159]
    ds_read_b64_tr_b16 a[178:179], v240 offset:3328
    v_add_u32 v251, 148160, v251
    v_mfma_f32_16x16x32_bf16 v[160:163], a[184:187], v[56:59], v[160:163]
    ds_read_b64_tr_b16 a[180:181], v240 offset:3104
    ds_write_b128 v251, a[132:135]
    v_mfma_f32_16x16x32_bf16 v[164:167], a[184:187], v[60:63], v[164:167]
    ds_read_b64_tr_b16 a[182:183], v240 offset:3360
    v_accvgpr_read_b32 v246, a200
    v_mfma_f32_16x16x32_bf16 v[168:171], a[188:191], v[56:59], v[168:171]
    ds_read_b64_tr_b16 a[184:185], v240 offset:3584
    v_accvgpr_read_b32 v247, a201
    v_mfma_f32_16x16x32_bf16 v[172:175], a[188:191], v[60:63], v[172:175]
    ds_read_b64_tr_b16 a[186:187], v240 offset:3840
    s_waitcnt lgkmcnt(9)
    v_mfma_f32_16x16x32_bf16 v[144:147], a[192:195], v[64:67], v[144:147]
    ds_read_b64_tr_b16 a[188:189], v240 offset:3616
    v_accvgpr_read_b32 v248, a202
    v_mfma_f32_16x16x32_bf16 v[148:151], a[192:195], v[68:71], v[148:151]
    ds_read_b64_tr_b16 a[190:191], v240 offset:3872
    s_add_u32 m0, s64, 49408
    v_mfma_f32_16x16x32_bf16 v[152:155], a[196:199], v[64:67], v[152:155]
    ds_read_b64_tr_b16 a[192:193], v240 offset:4096
    s_add_u32 s66, s63, s96
    v_mfma_f32_16x16x32_bf16 v[156:159], a[196:199], v[68:71], v[156:159]
    ds_read_b64_tr_b16 a[194:195], v240 offset:4352
    buffer_load_dwordx4 v246, s[8:11], s66 offen offset:0 lds
    v_mfma_f32_16x16x32_bf16 v[160:163], a[168:171], v[64:67], v[160:163]
    ds_read_b64_tr_b16 a[196:197], v240 offset:4128
    v_mul_f32 v219, v252, v219
    v_mfma_f32_16x16x32_bf16 v[164:167], a[168:171], v[68:71], v[164:167]
    ds_read_b64_tr_b16 a[198:199], v240 offset:4384
    s_waitcnt lgkmcnt(8)
    v_mfma_f32_16x16x32_bf16 v[168:171], a[172:175], v[64:67], v[168:171]
    ds_read_b64_tr_b16 a[168:169], v240 offset:4608
    buffer_load_dwordx4 v247, s[8:11], s66 offen offset:1024 lds
    v_mfma_f32_16x16x32_bf16 v[172:175], a[172:175], v[68:71], v[172:175]
    ds_read_b64_tr_b16 a[170:171], v240 offset:4864
    v_mul_f32 v220, v253, v220
    v_mfma_f32_16x16x32_bf16 v[144:147], a[176:179], v[72:75], v[144:147]
    ds_read_b64_tr_b16 a[172:173], v240 offset:4640
    buffer_load_dwordx4 v248, s[8:11], s66 offen offset:2048 lds
    v_mfma_f32_16x16x32_bf16 v[148:151], a[176:179], v[76:79], v[148:151]
    ds_read_b64_tr_b16 a[174:175], v240 offset:4896
    s_add_u32 m0, s64, 52480
    v_mfma_f32_16x16x32_bf16 v[152:155], a[180:183], v[72:75], v[152:155]
    ds_read_b64_tr_b16 a[176:177], v240 offset:5120
    buffer_load_dwordx4 v246, s[12:15], s66 offen offset:0 lds
    v_mfma_f32_16x16x32_bf16 v[156:159], a[180:183], v[76:79], v[156:159]
    ds_read_b64_tr_b16 a[178:179], v240 offset:5376
    s_waitcnt lgkmcnt(8)
    v_mfma_f32_16x16x32_bf16 v[160:163], a[184:187], v[72:75], v[160:163]
    ds_read_b64_tr_b16 a[180:181], v240 offset:5152
    buffer_load_dwordx4 v247, s[12:15], s66 offen offset:1024 lds
    v_mfma_f32_16x16x32_bf16 v[164:167], a[184:187], v[76:79], v[164:167]
    ds_read_b64_tr_b16 a[182:183], v240 offset:5408
    v_mul_f32 v221, v253, v221
    v_mfma_f32_16x16x32_bf16 v[168:171], a[188:191], v[72:75], v[168:171]
    ds_read_b64_tr_b16 a[184:185], v240 offset:5632
    buffer_load_dwordx4 v248, s[12:15], s66 offen offset:2048 lds
    v_mfma_f32_16x16x32_bf16 v[172:175], a[188:191], v[76:79], v[172:175]
    ds_read_b64_tr_b16 a[186:187], v240 offset:5888
    v_mul_f32_e64 v222, v253, v222
    v_mfma_f32_16x16x32_bf16 v[144:147], a[192:195], v[80:83], v[144:147]
    ds_read_b64_tr_b16 a[188:189], v240 offset:5664
    v_mul_f32_e64 v223, v253, v223
    v_mfma_f32_16x16x32_bf16 v[148:151], a[192:195], v[84:87], v[148:151]
    ds_read_b64_tr_b16 a[190:191], v240 offset:5920
    s_waitcnt lgkmcnt(8)
    v_mfma_f32_16x16x32_bf16 v[152:155], a[196:199], v[80:83], v[152:155]
    s_waitcnt vmcnt(13)
    s_barrier
    ds_read_b64_tr_b16 a[192:193], v240 offset:24704
    v_mfma_f32_16x16x32_bf16 v[156:159], a[196:199], v[84:87], v[156:159]
    ds_read_b64_tr_b16 a[194:195], v240 offset:24960
    s_add_u32 m0, s64, 74112
    v_mfma_f32_16x16x32_bf16 v[160:163], a[168:171], v[80:83], v[160:163]
    ds_read_b64_tr_b16 a[196:197], v240 offset:24736
    s_add_u32 s66, s63, s97
    v_mfma_f32_16x16x32_bf16 v[164:167], a[168:171], v[84:87], v[164:167]
    ds_read_b64_tr_b16 a[198:199], v240 offset:24992
    buffer_load_dwordx4 v246, s[8:11], s66 offen offset:0 lds
    v_mfma_f32_16x16x32_bf16 v[168:171], a[172:175], v[80:83], v[168:171]
    ds_read_b64_tr_b16 a[168:169], v240 offset:25216
    v_mul_f32_e64 v224, v252, v224
    v_mfma_f32_16x16x32_bf16 v[172:175], a[172:175], v[84:87], v[172:175]
    ds_read_b64_tr_b16 a[170:171], v240 offset:25472
    s_waitcnt lgkmcnt(8)
    v_mfma_f32_16x16x32_bf16 v[144:147], a[176:179], v[88:91], v[144:147]
    ds_read_b64_tr_b16 a[172:173], v240 offset:25248
    v_mul_f32 v225, v252, v225
    v_mfma_f32_16x16x32_bf16 v[148:151], a[176:179], v[92:95], v[148:151]
    ds_read_b64_tr_b16 a[174:175], v240 offset:25504
    buffer_load_dwordx4 v247, s[8:11], s66 offen offset:1024 lds
    v_mfma_f32_16x16x32_bf16 v[152:155], a[180:183], v[88:91], v[152:155]
    ds_read_b64_tr_b16 a[176:177], v240 offset:25728
    v_mul_f32_e64 v226, v252, v226
    v_mfma_f32_16x16x32_bf16 v[156:159], a[180:183], v[92:95], v[156:159]
    ds_read_b64_tr_b16 a[178:179], v240 offset:25984
    v_mul_f32_e64 v227, v252, v227
    v_mfma_f32_16x16x32_bf16 v[160:163], a[184:187], v[88:91], v[160:163]
    ds_read_b64_tr_b16 a[180:181], v240 offset:25760
    v_mul_f32_e64 v228, v253, v228
    v_mfma_f32_16x16x32_bf16 v[164:167], a[184:187], v[92:95], v[164:167]
    ds_read_b64_tr_b16 a[182:183], v240 offset:26016
    s_waitcnt lgkmcnt(8)
    v_mfma_f32_16x16x32_bf16 v[168:171], a[188:191], v[88:91], v[168:171]
    ds_read_b64_tr_b16 a[184:185], v240 offset:26240
    buffer_load_dwordx4 v248, s[8:11], s66 offen offset:2048 lds
    v_mfma_f32_16x16x32_bf16 v[172:175], a[188:191], v[92:95], v[172:175]
    ds_read_b64_tr_b16 a[186:187], v240 offset:26496
    s_add_u32 m0, s64, 77184
    v_mfma_f32_16x16x32_bf16 v[144:147], a[192:195], v[96:99], v[144:147]
    ds_read_b64_tr_b16 a[188:189], v240 offset:26272
    v_mul_f32 v229, v253, v229
    v_mfma_f32_16x16x32_bf16 v[148:151], a[192:195], v[100:103], v[148:151]
    ds_read_b64_tr_b16 a[190:191], v240 offset:26528
    buffer_load_dwordx4 v246, s[12:15], s66 offen offset:0 lds
    v_mfma_f32_16x16x32_bf16 v[152:155], a[196:199], v[96:99], v[152:155]
    ds_read_b64_tr_b16 a[192:193], v240 offset:26752
    v_mul_f32_e64 v230, v253, v230
    v_mfma_f32_16x16x32_bf16 v[156:159], a[196:199], v[100:103], v[156:159]
    ds_read_b64_tr_b16 a[194:195], v240 offset:27008
    s_waitcnt lgkmcnt(8)
    v_mfma_f32_16x16x32_bf16 v[160:163], a[168:171], v[96:99], v[160:163]
    ds_read_b64_tr_b16 a[196:197], v240 offset:26784
    v_mul_f32 v231, v253, v231
    v_mfma_f32_16x16x32_bf16 v[164:167], a[168:171], v[100:103], v[164:167]
    ds_read_b64_tr_b16 a[198:199], v240 offset:27040
    buffer_load_dwordx4 v247, s[12:15], s66 offen offset:1024 lds
    v_mfma_f32_16x16x32_bf16 v[168:171], a[172:175], v[96:99], v[168:171]
    ds_read_b64_tr_b16 a[168:169], v240 offset:27264
    v_mul_f32_e64 v232, v252, v232
    v_mfma_f32_16x16x32_bf16 v[172:175], a[172:175], v[100:103], v[172:175]
    ds_read_b64_tr_b16 a[170:171], v240 offset:27520
    v_mul_f32_e64 v233, v252, v233
    v_mfma_f32_16x16x32_bf16 v[144:147], a[176:179], v[104:107], v[144:147]
    ds_read_b64_tr_b16 a[172:173], v240 offset:27296
    v_mul_f32_e64 v234, v252, v234
    v_mfma_f32_16x16x32_bf16 v[148:151], a[176:179], v[108:111], v[148:151]
    ds_read_b64_tr_b16 a[174:175], v240 offset:27552
    s_waitcnt lgkmcnt(8)
    v_mfma_f32_16x16x32_bf16 v[152:155], a[180:183], v[104:107], v[152:155]
    ds_read_b64_tr_b16 a[176:177], v240 offset:27776
    buffer_load_dwordx4 v248, s[12:15], s66 offen offset:2048 lds
    v_mfma_f32_16x16x32_bf16 v[156:159], a[180:183], v[108:111], v[156:159]
    ds_read_b64_tr_b16 a[178:179], v240 offset:28032
    v_mul_f32 v235, v252, v235
    v_mfma_f32_16x16x32_bf16 v[160:163], a[184:187], v[104:107], v[160:163]
    ds_read_b64_tr_b16 a[180:181], v240 offset:27808
    v_mul_f32_e64 v236, v253, v236
    v_mfma_f32_16x16x32_bf16 v[164:167], a[184:187], v[108:111], v[164:167]
    ds_read_b64_tr_b16 a[182:183], v240 offset:28064
    v_mul_f32_e64 v237, v253, v237
    v_mfma_f32_16x16x32_bf16 v[168:171], a[188:191], v[104:107], v[168:171]
    ds_read_b64_tr_b16 a[184:185], v240 offset:28288
    v_mul_f32_e64 v238, v253, v238
    v_mfma_f32_16x16x32_bf16 v[172:175], a[188:191], v[108:111], v[172:175]
    ds_read_b64_tr_b16 a[186:187], v240 offset:28544
    s_waitcnt lgkmcnt(8)
    v_mfma_f32_16x16x32_bf16 v[144:147], a[192:195], v[112:115], v[144:147]
    ds_read_b64_tr_b16 a[188:189], v240 offset:28320
    v_mul_f32 v239, v253, v239
    v_mfma_f32_16x16x32_bf16 v[148:151], a[192:195], v[116:119], v[148:151]
    ds_read_b64_tr_b16 a[190:191], v240 offset:28576
    s_add_u32 s70, s75, 0
    v_mfma_f32_16x16x32_bf16 v[152:155], a[196:199], v[112:115], v[152:155]
    ds_read_b64_tr_b16 a[192:193], v240 offset:28800
    buffer_load_dwordx4 a[80:83], v254, s[20:23], s70 offen offset:0 sc1
    v_mfma_f32_16x16x32_bf16 v[156:159], a[196:199], v[116:119], v[156:159]
    ds_read_b64_tr_b16 a[194:195], v240 offset:29056
    s_add_u32 s40, s45, 512
    v_mfma_f32_16x16x32_bf16 v[160:163], a[168:171], v[112:115], v[160:163]
    ds_read_b64_tr_b16 a[196:197], v240 offset:28832
    s_mul_i32 s78, s78, 640
    v_mfma_f32_16x16x32_bf16 v[164:167], a[168:171], v[116:119], v[164:167]
    ds_read_b64_tr_b16 a[198:199], v240 offset:29088
    s_waitcnt lgkmcnt(8)
    v_mfma_f32_16x16x32_bf16 v[168:171], a[172:175], v[112:115], v[168:171]
    ds_read_b64_tr_b16 a[168:169], v240 offset:29312
    s_lshr_b32 s52, s65, 1
    v_mfma_f32_16x16x32_bf16 v[172:175], a[172:175], v[116:119], v[172:175]
    ds_read_b64_tr_b16 a[170:171], v240 offset:29568
    buffer_load_dwordx4 a[84:87], v254, s[20:23], s70 offen offset:1024 sc1
    v_mfma_f32_16x16x32_bf16 v[144:147], a[176:179], v[120:123], v[144:147]
    ds_read_b64_tr_b16 a[172:173], v240 offset:29344
    s_xor_b32 s45, s52, 3
    v_mfma_f32_16x16x32_bf16 v[148:151], a[176:179], v[124:127], v[148:151]
    ds_read_b64_tr_b16 a[174:175], v240 offset:29600
    s_lshl_b32 s45, s45, 7
    v_mfma_f32_16x16x32_bf16 v[152:155], a[180:183], v[120:123], v[152:155]
    ds_read_b64_tr_b16 a[176:177], v240 offset:29824
    s_add_u32 s41, s45, s78
    v_mfma_f32_16x16x32_bf16 v[156:159], a[180:183], v[124:127], v[156:159]
    ds_read_b64_tr_b16 a[178:179], v240 offset:30080
    s_waitcnt lgkmcnt(8)
    v_mfma_f32_16x16x32_bf16 v[160:163], a[184:187], v[120:123], v[160:163]
    ds_read_b64_tr_b16 a[180:181], v240 offset:29856
    buffer_load_dwordx4 a[88:91], v254, s[20:23], s70 offen offset:2048 sc1
    v_mfma_f32_16x16x32_bf16 v[164:167], a[184:187], v[124:127], v[164:167]
    ds_read_b64_tr_b16 a[182:183], v240 offset:30112
    s_xor_b32 s45, s52, 2
    v_mfma_f32_16x16x32_bf16 v[168:171], a[188:191], v[120:123], v[168:171]
    ds_read_b64_tr_b16 a[184:185], v240 offset:30336
    s_lshl_b32 s45, s45, 7
    v_mfma_f32_16x16x32_bf16 v[172:175], a[188:191], v[124:127], v[172:175]
    ds_read_b64_tr_b16 a[186:187], v240 offset:30592
    s_add_u32 s42, s45, s78
    v_mfma_f32_16x16x32_bf16 v[144:147], a[192:195], v[128:131], v[144:147]
    ds_read_b64_tr_b16 a[188:189], v240 offset:30368
    s_xor_b32 s45, s52, 1
    v_mfma_f32_16x16x32_bf16 v[148:151], a[192:195], v[132:135], v[148:151]
    ds_read_b64_tr_b16 a[190:191], v240 offset:30624
    s_waitcnt lgkmcnt(8)
    v_mfma_f32_16x16x32_bf16 v[152:155], a[196:199], v[128:131], v[152:155]
    s_waitcnt vmcnt(9)
    s_barrier
    ds_read_b64_tr_b16 a[192:193], v241 offset:0
    v_mfma_f32_16x16x32_bf16 v[156:159], a[196:199], v[132:135], v[156:159]
    ds_read_b64_tr_b16 a[194:195], v241 offset:256
    s_add_u32 m0, s64, 0
    v_mfma_f32_16x16x32_bf16 v[160:163], a[168:171], v[128:131], v[160:163]
    ds_read_b64_tr_b16 a[196:197], v241 offset:32
    s_add_u32 s66, s63, s98
    v_mfma_f32_16x16x32_bf16 v[164:167], a[168:171], v[132:135], v[164:167]
    ds_read_b64_tr_b16 a[198:199], v241 offset:288
    buffer_load_dwordx4 v246, s[8:11], s66 offen offset:0 lds
    v_mfma_f32_16x16x32_bf16 v[168:171], a[172:175], v[128:131], v[168:171]
    ds_read_b64_tr_b16 a[168:169], v241 offset:3072
    s_lshl_b32 s45, s45, 7
    v_mfma_f32_16x16x32_bf16 v[172:175], a[172:175], v[132:135], v[172:175]
    ds_read_b64_tr_b16 a[170:171], v241 offset:3328
    s_waitcnt lgkmcnt(8)
    v_mfma_f32_16x16x32_bf16 v[144:147], a[176:179], v[136:139], v[144:147]
    ds_read_b64_tr_b16 a[172:173], v241 offset:3104
    s_add_u32 s43, s45, s78
    v_mfma_f32_16x16x32_bf16 v[148:151], a[176:179], v[140:143], v[148:151]
    ds_read_b64_tr_b16 a[174:175], v241 offset:3360
    buffer_load_dwordx4 v247, s[8:11], s66 offen offset:1024 lds
    v_mfma_f32_16x16x32_bf16 v[152:155], a[180:183], v[136:139], v[152:155]
    ds_read_b64_tr_b16 a[176:177], v241 offset:512
    s_xor_b32 s45, s52, 0
    v_mfma_f32_16x16x32_bf16 v[156:159], a[180:183], v[140:143], v[156:159]
    ds_read_b64_tr_b16 a[178:179], v241 offset:768
    s_lshl_b32 s45, s45, 7
    v_mfma_f32_16x16x32_bf16 v[160:163], a[184:187], v[136:139], v[160:163]
    ds_read_b64_tr_b16 a[180:181], v241 offset:544
    s_add_u32 s44, s45, s78
    v_mfma_f32_16x16x32_bf16 v[164:167], a[184:187], v[140:143], v[164:167]
    ds_read_b64_tr_b16 a[182:183], v241 offset:800
    s_waitcnt lgkmcnt(8)
    v_mfma_f32_16x16x32_bf16 v[168:171], a[188:191], v[136:139], v[168:171]
    ds_read_b64_tr_b16 a[184:185], v241 offset:3584
    buffer_load_dwordx4 v248, s[8:11], s66 offen offset:2048 lds
    v_mfma_f32_16x16x32_bf16 v[172:175], a[188:191], v[140:143], v[172:175]
    ds_read_b64_tr_b16 a[186:187], v241 offset:3840
    s_add_u32 m0, s64, 3072
    v_mfma_f32_16x16x32_bf16 v[176:179], a[192:195], v[0:3], 0
    ds_read_b64_tr_b16 a[188:189], v241 offset:3616
    v_mfma_f32_16x16x32_bf16 v[180:183], a[192:195], v[4:7], 0
    ds_read_b64_tr_b16 a[190:191], v241 offset:3872
    buffer_load_dwordx4 v246, s[12:15], s66 offen offset:0 lds
    v_mfma_f32_16x16x32_bf16 v[184:187], a[196:199], v[0:3], 0
    ds_read_b64_tr_b16 a[192:193], v241 offset:1024
    v_mfma_f32_16x16x32_bf16 v[188:191], a[196:199], v[4:7], 0
    ds_read_b64_tr_b16 a[194:195], v241 offset:1280
    s_waitcnt lgkmcnt(8)
    v_mfma_f32_16x16x32_bf16 v[192:195], a[168:171], v[0:3], 0
    ds_read_b64_tr_b16 a[196:197], v241 offset:1056
    s_add_u32 s72, s74, 12288
    v_mfma_f32_16x16x32_bf16 v[196:199], a[168:171], v[4:7], 0
    ds_read_b64_tr_b16 a[198:199], v241 offset:1312
    buffer_load_dwordx4 v247, s[12:15], s66 offen offset:1024 lds
    v_mfma_f32_16x16x32_bf16 v[200:203], a[172:175], v[0:3], 0
    ds_read_b64_tr_b16 a[168:169], v241 offset:4096
    v_mul_f32_e64 v208, v208, v144
    v_mfma_f32_16x16x32_bf16 v[204:207], a[172:175], v[4:7], 0
    ds_read_b64_tr_b16 a[170:171], v241 offset:4352
    v_mul_f32_e64 v209, v209, v145
    v_mfma_f32_16x16x32_bf16 v[176:179], a[176:179], v[8:11], v[176:179]
    ds_read_b64_tr_b16 a[172:173], v241 offset:4128
    v_mul_f32_e64 v210, v210, v146
    v_mfma_f32_16x16x32_bf16 v[180:183], a[176:179], v[12:15], v[180:183]
    ds_read_b64_tr_b16 a[174:175], v241 offset:4384
    s_waitcnt lgkmcnt(8)
    v_mfma_f32_16x16x32_bf16 v[184:187], a[180:183], v[8:11], v[184:187]
    ds_read_b64_tr_b16 a[176:177], v241 offset:1536
    buffer_load_dwordx4 v248, s[12:15], s66 offen offset:2048 lds
    v_mfma_f32_16x16x32_bf16 v[188:191], a[180:183], v[12:15], v[188:191]
    ds_read_b64_tr_b16 a[178:179], v241 offset:1792
    v_mul_f32 v211, v211, v147
    v_mfma_f32_16x16x32_bf16 v[192:195], a[184:187], v[8:11], v[192:195]
    ds_read_b64_tr_b16 a[180:181], v241 offset:1568
    v_mul_f32_e64 v216, v216, v152
    v_mfma_f32_16x16x32_bf16 v[196:199], a[184:187], v[12:15], v[196:199]
    ds_read_b64_tr_b16 a[182:183], v241 offset:1824
    v_mul_f32_e64 v217, v217, v153
    v_mfma_f32_16x16x32_bf16 v[200:203], a[188:191], v[8:11], v[200:203]
    ds_read_b64_tr_b16 a[184:185], v241 offset:4608
    v_mul_f32_e64 v218, v218, v154
    v_mfma_f32_16x16x32_bf16 v[204:207], a[188:191], v[12:15], v[204:207]
    ds_read_b64_tr_b16 a[186:187], v241 offset:4864
    s_waitcnt lgkmcnt(8)
    v_mfma_f32_16x16x32_bf16 v[176:179], a[192:195], v[16:19], v[176:179]
    ds_read_b64_tr_b16 a[188:189], v241 offset:4640
L_w8:
    s_cbranch_execz L_wret2
    v_mul_f32 v219, v219, v155
    v_mfma_f32_16x16x32_bf16 v[180:183], a[192:195], v[20:23], v[180:183]
    ds_read_b64_tr_b16 a[190:191], v241 offset:4896
    v_cvt_pk_bf16_f32 v208, v208, v209
    v_mfma_f32_16x16x32_bf16 v[184:187], a[196:199], v[16:19], v[184:187]
    ds_read_b64_tr_b16 a[192:193], v241 offset:2048
    v_cvt_pk_bf16_f32 v209, v210, v211
    v_mfma_f32_16x16x32_bf16 v[188:191], a[196:199], v[20:23], v[188:191]
    ds_read_b64_tr_b16 a[194:195], v241 offset:2304
    v_cvt_pk_bf16_f32 v210, v216, v217
    v_mfma_f32_16x16x32_bf16 v[192:195], a[168:171], v[16:19], v[192:195]
    ds_read_b64_tr_b16 a[196:197], v241 offset:2080
    v_cvt_pk_bf16_f32 v211, v218, v219
    v_mfma_f32_16x16x32_bf16 v[196:199], a[168:171], v[20:23], v[196:199]
    ds_read_b64_tr_b16 a[198:199], v241 offset:2336
    s_waitcnt lgkmcnt(8)
    v_mfma_f32_16x16x32_bf16 v[200:203], a[172:175], v[16:19], v[200:203]
    ds_read_b64_tr_b16 a[168:169], v241 offset:5120
    v_accvgpr_write_b32 a48, v208
    v_mfma_f32_16x16x32_bf16 v[204:207], a[172:175], v[20:23], v[204:207]
    ds_read_b64_tr_b16 a[170:171], v241 offset:5376
    v_accvgpr_write_b32 a49, v209
    v_mfma_f32_16x16x32_bf16 v[176:179], a[176:179], v[24:27], v[176:179]
    ds_read_b64_tr_b16 a[172:173], v241 offset:5152
    v_accvgpr_write_b32 a50, v210
    v_mfma_f32_16x16x32_bf16 v[180:183], a[176:179], v[28:31], v[180:183]
    ds_read_b64_tr_b16 a[174:175], v241 offset:5408
    v_accvgpr_write_b32 a51, v211
    v_mfma_f32_16x16x32_bf16 v[184:187], a[180:183], v[24:27], v[184:187]
    ds_read_b64_tr_b16 a[176:177], v241 offset:2560
    buffer_store_dwordx4 v[208:211], v254, s[20:23], s72 offen offset:0 sc1
    v_mfma_f32_16x16x32_bf16 v[188:191], a[180:183], v[28:31], v[188:191]
    ds_read_b64_tr_b16 a[178:179], v241 offset:2816
    s_waitcnt lgkmcnt(8)
    v_mfma_f32_16x16x32_bf16 v[192:195], a[184:187], v[24:27], v[192:195]
    ds_read_b64_tr_b16 a[180:181], v241 offset:2592
    v_mul_f32_e64 v212, v212, v148
    v_mfma_f32_16x16x32_bf16 v[196:199], a[184:187], v[28:31], v[196:199]
    ds_read_b64_tr_b16 a[182:183], v241 offset:2848
    v_mul_f32_e64 v213, v213, v149
    v_mfma_f32_16x16x32_bf16 v[200:203], a[188:191], v[24:27], v[200:203]
    ds_read_b64_tr_b16 a[184:185], v241 offset:5632
    v_mul_f32_e64 v214, v214, v150
    v_mfma_f32_16x16x32_bf16 v[204:207], a[188:191], v[28:31], v[204:207]
    ds_read_b64_tr_b16 a[186:187], v241 offset:5888
    v_mul_f32_e64 v215, v215, v151
    v_mfma_f32_16x16x32_bf16 v[176:179], a[192:195], v[32:35], v[176:179]
    ds_read_b64_tr_b16 a[188:189], v241 offset:5664
    v_mul_f32_e64 v220, v220, v156
    v_mfma_f32_16x16x32_bf16 v[180:183], a[192:195], v[36:39], v[180:183]
    ds_read_b64_tr_b16 a[190:191], v241 offset:5920
    s_waitcnt lgkmcnt(8)
    v_mfma_f32_16x16x32_bf16 v[184:187], a[196:199], v[32:35], v[184:187]
    s_waitcnt vmcnt(10)
    s_barrier
    ds_read_b64_tr_b16 a[192:193], v241 offset:24704
    v_mfma_f32_16x16x32_bf16 v[188:191], a[196:199], v[36:39], v[188:191]
    ds_read_b64_tr_b16 a[194:195], v241 offset:24960
    s_add_u32 m0, s64, 24704
    v_mfma_f32_16x16x32_bf16 v[192:195], a[168:171], v[32:35], v[192:195]
    ds_read_b64_tr_b16 a[196:197], v241 offset:24736
    v_accvgpr_read_b32 v248, a203
    v_mfma_f32_16x16x32_bf16 v[196:199], a[168:171], v[36:39], v[196:199]
    ds_read_b64_tr_b16 a[198:199], v241 offset:24992
    v_add_u32 v248, s41, v248
    v_mfma_f32_16x16x32_bf16 v[200:203], a[172:175], v[32:35], v[200:203]
    ds_read_b64_tr_b16 a[168:169], v241 offset:27776
    v_add_u32 v246, 2048, v248
    v_mfma_f32_16x16x32_bf16 v[204:207], a[172:175], v[36:39], v[204:207]
    ds_read_b64_tr_b16 a[170:171], v241 offset:28032
    s_waitcnt lgkmcnt(8)
    v_mfma_f32_16x16x32_bf16 v[176:179], a[176:179], v[40:43], v[176:179]
    ds_read_b64_tr_b16 a[172:173], v241 offset:27808
    v_add_u32 v247, 1024, v248
    v_mfma_f32_16x16x32_bf16 v[180:183], a[176:179], v[44:47], v[180:183]
    ds_read_b64_tr_b16 a[174:175], v241 offset:28064
    buffer_load_dwordx4 v246, s[16:19], s84 offen offset:0 lds
    v_mfma_f32_16x16x32_bf16 v[184:187], a[180:183], v[40:43], v[184:187]
    ds_read_b64_tr_b16 a[176:177], v241 offset:25216
    v_accvgpr_read_b32 v245, a204
    v_mfma_f32_16x16x32_bf16 v[188:191], a[180:183], v[44:47], v[188:191]
    ds_read_b64_tr_b16 a[178:179], v241 offset:25472
    v_add_u32 v245, s40, v245
    v_mfma_f32_16x16x32_bf16 v[192:195], a[184:187], v[40:43], v[192:195]
    ds_read_b64_tr_b16 a[180:181], v241 offset:25248
    v_add_u32 v243, 2048, v245
    v_mfma_f32_16x16x32_bf16 v[196:199], a[184:187], v[44:47], v[196:199]
    ds_read_b64_tr_b16 a[182:183], v241 offset:25504
    s_waitcnt lgkmcnt(8)
    v_mfma_f32_16x16x32_bf16 v[200:203], a[188:191], v[40:43], v[200:203]
    ds_read_b64_tr_b16 a[184:185], v241 offset:28288
    v_add_u32 v244, 1024, v245
    v_mfma_f32_16x16x32_bf16 v[204:207], a[188:191], v[44:47], v[204:207]
    ds_read_b64_tr_b16 a[186:187], v241 offset:28544
    buffer_load_dwordx4 v244, s[16:19], s84 offen offset:1024 lds
    v_mfma_f32_16x16x32_bf16 v[176:179], a[192:195], v[48:51], v[176:179]
    ds_read_b64_tr_b16 a[188:189], v241 offset:28320
    v_mul_f32 v221, v221, v157
    v_mfma_f32_16x16x32_bf16 v[180:183], a[192:195], v[52:55], v[180:183]
    ds_read_b64_tr_b16 a[190:191], v241 offset:28576
    v_mul_f32_e64 v222, v222, v158
    v_mfma_f32_16x16x32_bf16 v[184:187], a[196:199], v[48:51], v[184:187]
    ds_read_b64_tr_b16 a[192:193], v241 offset:25728
    v_mul_f32_e64 v223, v223, v159
    v_mfma_f32_16x16x32_bf16 v[188:191], a[196:199], v[52:55], v[188:191]
    ds_read_b64_tr_b16 a[194:195], v241 offset:25984
    s_waitcnt lgkmcnt(8)
    v_mfma_f32_16x16x32_bf16 v[192:195], a[168:171], v[48:51], v[192:195]
    ds_read_b64_tr_b16 a[196:197], v241 offset:25760
    v_cvt_pk_bf16_f32 v212, v212, v213
    v_mfma_f32_16x16x32_bf16 v[196:199], a[168:171], v[52:55], v[196:199]
    ds_read_b64_tr_b16 a[198:199], v241 offset:26016
    buffer_load_dwordx4 v248, s[16:19], s24 offen offset:2048 lds
    v_mfma_f32_16x16x32_bf16 v[200:203], a[172:175], v[48:51], v[200:203]
    ds_read_b64_tr_b16 a[168:169], v241 offset:28800
    s_add_u32 m0, s64, 27776
    v_mfma_f32_16x16x32_bf16 v[204:207], a[172:175], v[52:55], v[204:207]
    ds_read_b64_tr_b16 a[170:171], v241 offset:29056
    v_cvt_pk_bf16_f32 v213, v214, v215
    v_mfma_f32_16x16x32_bf16 v[176:179], a[176:179], v[56:59], v[176:179]
    ds_read_b64_tr_b16 a[172:173], v241 offset:28832
    v_cvt_pk_bf16_f32 v214, v220, v221
    v_mfma_f32_16x16x32_bf16 v[180:183], a[176:179], v[60:63], v[180:183]
    ds_read_b64_tr_b16 a[174:175], v241 offset:29088
    s_waitcnt lgkmcnt(8)
    v_mfma_f32_16x16x32_bf16 v[184:187], a[180:183], v[56:59], v[184:187]
    ds_read_b64_tr_b16 a[176:177], v241 offset:26240
    v_cvt_pk_bf16_f32 v215, v222, v223
    v_mfma_f32_16x16x32_bf16 v[188:191], a[180:183], v[60:63], v[188:191]
    ds_read_b64_tr_b16 a[178:179], v241 offset:26496
    buffer_load_dwordx4 v243, s[16:19], s24 offen offset:0 lds
    v_mfma_f32_16x16x32_bf16 v[192:195], a[184:187], v[56:59], v[192:195]
    ds_read_b64_tr_b16 a[180:181], v241 offset:26272
    v_accvgpr_write_b32 a52, v212
    v_mfma_f32_16x16x32_bf16 v[196:199], a[184:187], v[60:63], v[196:199]
    ds_read_b64_tr_b16 a[182:183], v241 offset:26528
    v_accvgpr_write_b32 a53, v213
    v_mfma_f32_16x16x32_bf16 v[200:203], a[188:191], v[56:59], v[200:203]
    ds_read_b64_tr_b16 a[184:185], v241 offset:29312
    v_accvgpr_write_b32 a54, v214
    v_mfma_f32_16x16x32_bf16 v[204:207], a[188:191], v[60:63], v[204:207]
    ds_read_b64_tr_b16 a[186:187], v241 offset:29568
    s_waitcnt lgkmcnt(8)
    v_mfma_f32_16x16x32_bf16 v[176:179], a[192:195], v[64:67], v[176:179]
    ds_read_b64_tr_b16 a[188:189], v241 offset:29344
    v_accvgpr_write_b32 a55, v215
    v_mfma_f32_16x16x32_bf16 v[180:183], a[192:195], v[68:71], v[180:183]
    ds_read_b64_tr_b16 a[190:191], v241 offset:29600
    buffer_load_dwordx4 v247, s[16:19], s85 offen offset:1024 lds
    v_mfma_f32_16x16x32_bf16 v[184:187], a[196:199], v[64:67], v[184:187]
    ds_read_b64_tr_b16 a[192:193], v241 offset:26752
    v_accvgpr_read_b32 v24, a214
    v_mfma_f32_16x16x32_bf16 v[188:191], a[196:199], v[68:71], v[188:191]
    ds_read_b64_tr_b16 a[194:195], v241 offset:27008
    v_accvgpr_read_b32 v25, a215
    v_mfma_f32_16x16x32_bf16 v[192:195], a[168:171], v[64:67], v[192:195]
    ds_read_b64_tr_b16 a[196:197], v241 offset:26784
    buffer_store_dwordx4 v[212:215], v254, s[20:23], s72 offen offset:1024 sc1
    v_mfma_f32_16x16x32_bf16 v[196:199], a[168:171], v[68:71], v[196:199]
    ds_read_b64_tr_b16 a[198:199], v241 offset:27040
    s_waitcnt lgkmcnt(8)
    v_mfma_f32_16x16x32_bf16 v[200:203], a[172:175], v[64:67], v[200:203]
    ds_read_b64_tr_b16 a[168:169], v241 offset:29824
    s_add_u32 s72, s74, 14336
    v_mfma_f32_16x16x32_bf16 v[204:207], a[172:175], v[68:71], v[204:207]
    ds_read_b64_tr_b16 a[170:171], v241 offset:30080
    buffer_load_dwordx4 v245, s[16:19], s85 offen offset:2048 lds
    v_mfma_f32_16x16x32_bf16 v[176:179], a[176:179], v[72:75], v[176:179]
    ds_read_b64_tr_b16 a[172:173], v241 offset:29856
    v_mul_f32_e64 v224, v224, v160
    v_mfma_f32_16x16x32_bf16 v[180:183], a[176:179], v[76:79], v[180:183]
    ds_read_b64_tr_b16 a[174:175], v241 offset:30112
    v_mul_f32_e64 v225, v225, v161
    v_mfma_f32_16x16x32_bf16 v[184:187], a[180:183], v[72:75], v[184:187]
    ds_read_b64_tr_b16 a[176:177], v241 offset:27264
    v_mul_f32_e64 v226, v226, v162
    v_mfma_f32_16x16x32_bf16 v[188:191], a[180:183], v[76:79], v[188:191]
    ds_read_b64_tr_b16 a[178:179], v241 offset:27520
    s_waitcnt lgkmcnt(8)
    v_mfma_f32_16x16x32_bf16 v[192:195], a[184:187], v[72:75], v[192:195]
    ds_read_b64_tr_b16 a[180:181], v241 offset:27296
    v_mul_f32 v227, v227, v163
    v_mfma_f32_16x16x32_bf16 v[196:199], a[184:187], v[76:79], v[196:199]
    ds_read_b64_tr_b16 a[182:183], v241 offset:27552
    v_mul_f32_e64 v232, v232, v168
    v_mfma_f32_16x16x32_bf16 v[200:203], a[188:191], v[72:75], v[200:203]
    ds_read_b64_tr_b16 a[184:185], v241 offset:30336
    v_mul_f32_e64 v233, v233, v169
    v_mfma_f32_16x16x32_bf16 v[204:207], a[188:191], v[76:79], v[204:207]
    ds_read_b64_tr_b16 a[186:187], v241 offset:30592
    v_mul_f32_e64 v234, v234, v170
    v_mfma_f32_16x16x32_bf16 v[176:179], a[192:195], v[80:83], v[176:179]
    ds_read_b64_tr_b16 a[188:189], v241 offset:30368
    v_mul_f32_e64 v235, v235, v171
    v_mfma_f32_16x16x32_bf16 v[180:183], a[192:195], v[84:87], v[180:183]
    ds_read_b64_tr_b16 a[190:191], v241 offset:30624
    s_waitcnt lgkmcnt(8)
    v_mfma_f32_16x16x32_bf16 v[184:187], a[196:199], v[80:83], v[184:187]
    s_waitcnt vmcnt(8)
    s_barrier
    ds_read_b64_tr_b16 a[192:193], v240 offset:0
    v_mfma_f32_16x16x32_bf16 v[188:191], a[196:199], v[84:87], v[188:191]
    ds_read_b64_tr_b16 a[194:195], v240 offset:256
    s_add_u32 m0, s64, 49408
    v_mfma_f32_16x16x32_bf16 v[192:195], a[168:171], v[80:83], v[192:195]
    ds_read_b64_tr_b16 a[196:197], v240 offset:32
    buffer_load_dwordx4 v246, s[16:19], s25 offen offset:0 lds
    v_mfma_f32_16x16x32_bf16 v[196:199], a[168:171], v[84:87], v[196:199]
    ds_read_b64_tr_b16 a[198:199], v240 offset:288
    v_cvt_pk_bf16_f32 v224, v224, v225
    v_mfma_f32_16x16x32_bf16 v[200:203], a[172:175], v[80:83], v[200:203]
    ds_read_b64_tr_b16 a[168:169], v240 offset:3072
    v_cvt_pk_bf16_f32 v225, v226, v227
    v_mfma_f32_16x16x32_bf16 v[204:207], a[172:175], v[84:87], v[204:207]
    ds_read_b64_tr_b16 a[170:171], v240 offset:3328
    s_waitcnt lgkmcnt(8)
    v_mfma_f32_16x16x32_bf16 v[176:179], a[176:179], v[88:91], v[176:179]
    ds_read_b64_tr_b16 a[172:173], v240 offset:3104
    v_cvt_pk_bf16_f32 v226, v232, v233
    v_mfma_f32_16x16x32_bf16 v[180:183], a[176:179], v[92:95], v[180:183]
    ds_read_b64_tr_b16 a[174:175], v240 offset:3360
    v_cvt_pk_bf16_f32 v227, v234, v235
    v_mfma_f32_16x16x32_bf16 v[184:187], a[180:183], v[88:91], v[184:187]
    ds_read_b64_tr_b16 a[176:177], v240 offset:512
    buffer_load_dwordx4 v244, s[16:19], s25 offen offset:1024 lds
    v_mfma_f32_16x16x32_bf16 v[188:191], a[180:183], v[92:95], v[188:191]
    ds_read_b64_tr_b16 a[178:179], v240 offset:768
    v_accvgpr_write_b32 a56, v224
    v_mfma_f32_16x16x32_bf16 v[192:195], a[184:187], v[88:91], v[192:195]
    ds_read_b64_tr_b16 a[180:181], v240 offset:544
    v_accvgpr_write_b32 a57, v225
    v_mfma_f32_16x16x32_bf16 v[196:199], a[184:187], v[92:95], v[196:199]
    ds_read_b64_tr_b16 a[182:183], v240 offset:800
    s_waitcnt lgkmcnt(8)
    v_mfma_f32_16x16x32_bf16 v[200:203], a[188:191], v[88:91], v[200:203]
    ds_read_b64_tr_b16 a[184:185], v240 offset:3584
    v_accvgpr_write_b32 a58, v226
    v_mfma_f32_16x16x32_bf16 v[204:207], a[188:191], v[92:95], v[204:207]
    ds_read_b64_tr_b16 a[186:187], v240 offset:3840
    v_accvgpr_write_b32 a59, v227
    v_mfma_f32_16x16x32_bf16 v[176:179], a[192:195], v[96:99], v[176:179]
    ds_read_b64_tr_b16 a[188:189], v240 offset:3616
    buffer_load_dwordx4 v248, s[16:19], s86 offen offset:2048 lds
    v_mfma_f32_16x16x32_bf16 v[180:183], a[192:195], v[100:103], v[180:183]
    ds_read_b64_tr_b16 a[190:191], v240 offset:3872
    s_add_u32 m0, s64, 52480
    v_mfma_f32_16x16x32_bf16 v[184:187], a[196:199], v[96:99], v[184:187]
    ds_read_b64_tr_b16 a[192:193], v240 offset:1024
    v_accvgpr_read_b32 v26, a216
    v_mfma_f32_16x16x32_bf16 v[188:191], a[196:199], v[100:103], v[188:191]
    ds_read_b64_tr_b16 a[194:195], v240 offset:1280
    s_waitcnt lgkmcnt(8)
    v_mfma_f32_16x16x32_bf16 v[192:195], a[168:171], v[96:99], v[192:195]
    ds_read_b64_tr_b16 a[196:197], v240 offset:1056
    buffer_store_dwordx4 v[224:227], v254, s[20:23], s72 offen offset:0 sc1
    v_mfma_f32_16x16x32_bf16 v[196:199], a[168:171], v[100:103], v[196:199]
    ds_read_b64_tr_b16 a[198:199], v240 offset:1312
    v_mul_f32_e64 v228, v228, v164
    v_mfma_f32_16x16x32_bf16 v[200:203], a[172:175], v[96:99], v[200:203]
    ds_read_b64_tr_b16 a[168:169], v240 offset:4096
    buffer_load_dwordx4 v243, s[16:19], s86 offen offset:0 lds
    v_mfma_f32_16x16x32_bf16 v[204:207], a[172:175], v[100:103], v[204:207]
    ds_read_b64_tr_b16 a[170:171], v240 offset:4352
    v_mul_f32_e64 v229, v229, v165
    v_mfma_f32_16x16x32_bf16 v[176:179], a[176:179], v[104:107], v[176:179]
    ds_read_b64_tr_b16 a[172:173], v240 offset:4128
    v_mul_f32_e64 v230, v230, v166
    v_mfma_f32_16x16x32_bf16 v[180:183], a[176:179], v[108:111], v[180:183]
    ds_read_b64_tr_b16 a[174:175], v240 offset:4384
    s_waitcnt lgkmcnt(8)
    v_mfma_f32_16x16x32_bf16 v[184:187], a[180:183], v[104:107], v[184:187]
    ds_read_b64_tr_b16 a[176:177], v240 offset:1536
    v_mul_f32 v231, v231, v167
    v_mfma_f32_16x16x32_bf16 v[188:191], a[180:183], v[108:111], v[188:191]
    ds_read_b64_tr_b16 a[178:179], v240 offset:1792
    v_mul_f32_e64 v236, v236, v172
    v_mfma_f32_16x16x32_bf16 v[192:195], a[184:187], v[104:107], v[192:195]
    ds_read_b64_tr_b16 a[180:181], v240 offset:1568
    buffer_load_dwordx4 v247, s[16:19], s26 offen offset:1024 lds
    v_mfma_f32_16x16x32_bf16 v[196:199], a[184:187], v[108:111], v[196:199]
    ds_read_b64_tr_b16 a[182:183], v240 offset:1824
    v_mul_f32_e64 v237, v237, v173
    v_mfma_f32_16x16x32_bf16 v[200:203], a[188:191], v[104:107], v[200:203]
    ds_read_b64_tr_b16 a[184:185], v240 offset:4608
    v_mul_f32_e64 v238, v238, v174
    v_mfma_f32_16x16x32_bf16 v[204:207], a[188:191], v[108:111], v[204:207]
    ds_read_b64_tr_b16 a[186:187], v240 offset:4864
    s_waitcnt lgkmcnt(8)
    v_mfma_f32_16x16x32_bf16 v[176:179], a[192:195], v[112:115], v[176:179]
    ds_read_b64_tr_b16 a[188:189], v240 offset:4640
    v_mul_f32 v239, v239, v175
    v_mfma_f32_16x16x32_bf16 v[180:183], a[192:195], v[116:119], v[180:183]
    ds_read_b64_tr_b16 a[190:191], v240 offset:4896
    v_cvt_pk_bf16_f32 v228, v228, v229
    v_mfma_f32_16x16x32_bf16 v[184:187], a[196:199], v[112:115], v[184:187]
    ds_read_b64_tr_b16 a[192:193], v240 offset:2048
    buffer_load_dwordx4 v245, s[16:19], s26 offen offset:2048 lds
    v_mfma_f32_16x16x32_bf16 v[188:191], a[196:199], v[116:119], v[188:191]
    ds_read_b64_tr_b16 a[194:195], v240 offset:2304
    v_cvt_pk_bf16_f32 v229, v230, v231
    v_mfma_f32_16x16x32_bf16 v[192:195], a[168:171], v[112:115], v[192:195]
    ds_read_b64_tr_b16 a[196:197], v240 offset:2080
    v_cvt_pk_bf16_f32 v230, v236, v237
    v_mfma_f32_16x16x32_bf16 v[196:199], a[168:171], v[116:119], v[196:199]
    ds_read_b64_tr_b16 a[198:199], v240 offset:2336
    s_waitcnt lgkmcnt(8)
    v_mfma_f32_16x16x32_bf16 v[200:203], a[172:175], v[112:115], v[200:203]
    ds_read_b64_tr_b16 a[168:169], v240 offset:5120
    v_cvt_pk_bf16_f32 v231, v238, v239
    v_mfma_f32_16x16x32_bf16 v[204:207], a[172:175], v[116:119], v[204:207]
    ds_read_b64_tr_b16 a[170:171], v240 offset:5376
    v_accvgpr_write_b32 a60, v228
    v_mfma_f32_16x16x32_bf16 v[176:179], a[176:179], v[120:123], v[176:179]
    ds_read_b64_tr_b16 a[172:173], v240 offset:5152
    v_accvgpr_write_b32 a61, v229
    v_mfma_f32_16x16x32_bf16 v[180:183], a[176:179], v[124:127], v[180:183]
    ds_read_b64_tr_b16 a[174:175], v240 offset:5408
    v_accvgpr_write_b32 a62, v230
    v_mfma_f32_16x16x32_bf16 v[184:187], a[180:183], v[120:123], v[184:187]
    ds_read_b64_tr_b16 a[176:177], v240 offset:2560
    v_accvgpr_write_b32 a63, v231
    v_mfma_f32_16x16x32_bf16 v[188:191], a[180:183], v[124:127], v[188:191]
    ds_read_b64_tr_b16 a[178:179], v240 offset:2816
    s_waitcnt lgkmcnt(8)
    v_mfma_f32_16x16x32_bf16 v[192:195], a[184:187], v[120:123], v[192:195]
    ds_read_b64_tr_b16 a[180:181], v240 offset:2592
    buffer_store_dwordx4 v[228:231], v254, s[20:23], s72 offen offset:1024 sc1
    v_mfma_f32_16x16x32_bf16 v[196:199], a[184:187], v[124:127], v[196:199]
    ds_read_b64_tr_b16 a[182:183], v240 offset:2848
    v_accvgpr_read_b32 v27, a217
    v_mfma_f32_16x16x32_bf16 v[200:203], a[188:191], v[120:123], v[200:203]
    ds_read_b64_tr_b16 a[184:185], v240 offset:5632
    v_accvgpr_read_b32 v16, a219
    v_mfma_f32_16x16x32_bf16 v[204:207], a[188:191], v[124:127], v[204:207]
    ds_read_b64_tr_b16 a[186:187], v240 offset:5888
    v_accvgpr_read_b32 v20, a223
    v_mfma_f32_16x16x32_bf16 v[176:179], a[192:195], v[128:131], v[176:179]
    ds_read_b64_tr_b16 a[188:189], v240 offset:5664
    v_accvgpr_read_b32 v17, a220
    v_mfma_f32_16x16x32_bf16 v[180:183], a[192:195], v[132:135], v[180:183]
    ds_read_b64_tr_b16 a[190:191], v240 offset:5920
    s_waitcnt lgkmcnt(8)
    v_mfma_f32_16x16x32_bf16 v[184:187], a[196:199], v[128:131], v[184:187]
    buffer_load_dwordx4 a[92:95], v254, s[20:23], s70 offen offset:3072 sc1
    v_mfma_f32_16x16x32_bf16 v[188:191], a[196:199], v[132:135], v[188:191]
    s_add_u32 s70, s75, 4096
    v_mfma_f32_16x16x32_bf16 v[192:195], a[168:171], v[128:131], v[192:195]
    v_accvgpr_read_b32 v21, a224
    v_mfma_f32_16x16x32_bf16 v[196:199], a[168:171], v[132:135], v[196:199]
    v_accvgpr_read_b32 v18, a221
    v_mfma_f32_16x16x32_bf16 v[200:203], a[172:175], v[128:131], v[200:203]
    v_accvgpr_read_b32 v22, a225
    v_mfma_f32_16x16x32_bf16 v[204:207], a[172:175], v[132:135], v[204:207]
    s_waitcnt lgkmcnt(2)
    v_mfma_f32_16x16x32_bf16 v[176:179], a[176:179], v[136:139], v[176:179]
    buffer_load_dwordx4 a[96:99], v254, s[20:23], s70 offen offset:0 sc1
    v_mfma_f32_16x16x32_bf16 v[180:183], a[176:179], v[140:143], v[180:183]
    v_accvgpr_read_b32 v19, a222
    v_mfma_f32_16x16x32_bf16 v[184:187], a[180:183], v[136:139], v[184:187]
    v_accvgpr_read_b32 v23, a226
    v_mfma_f32_16x16x32_bf16 v[188:191], a[180:183], v[140:143], v[188:191]
    v_lshrrev_b32_e64 v28, 8, v254
    v_mfma_f32_16x16x32_bf16 v[192:195], a[184:187], v[136:139], v[192:195]
    v_add_u32_e64 v29, -2, v28
    v_mfma_f32_16x16x32_bf16 v[196:199], a[184:187], v[140:143], v[196:199]
    s_waitcnt lgkmcnt(0)
    v_mfma_f32_16x16x32_bf16 v[200:203], a[188:191], v[136:139], v[200:203]
    buffer_load_dwordx4 a[100:103], v254, s[20:23], s70 offen offset:1024 sc1
    v_mfma_f32_16x16x32_bf16 v[204:207], a[188:191], v[140:143], v[204:207]
    v_ashrrev_i32 v29, 31, v29
    s_nop 7
    v_mul_f32 v176, v252, v176
    v_mul_f32 v177, v252, v177
    v_mul_f32 v178, v252, v178
    v_mul_f32 v179, v252, v179
    v_mul_f32 v180, v253, v180
    v_mul_f32 v181, v253, v181
    v_mul_f32 v182, v253, v182
    v_mul_f32 v183, v253, v183
    v_mul_f32 v184, v252, v184
    v_mul_f32 v185, v252, v185
    v_mul_f32 v186, v252, v186
    v_mul_f32 v187, v252, v187
    v_mul_f32 v188, v253, v188
    v_mul_f32 v189, v253, v189
    v_mul_f32 v190, v253, v190
    v_mul_f32_e64 v191, v253, v191
    s_add_u32 s72, s74, 16384
    v_mul_f32 v176, v176, v192
    v_mul_f32 v177, v177, v193
    v_mul_f32 v178, v178, v194
    v_mul_f32 v179, v179, v195
    v_mul_f32 v184, v184, v200
    v_mul_f32 v185, v185, v201
    v_mul_f32 v186, v186, v202
    v_mul_f32 v187, v187, v203
    v_cvt_pk_bf16_f32 v176, v176, v177
    v_cvt_pk_bf16_f32 v177, v178, v179
    v_cvt_pk_bf16_f32 v178, v184, v185
    v_cvt_pk_bf16_f32 v179, v186, v187
    v_accvgpr_write_b32 a64, v176
    v_accvgpr_write_b32 a65, v177
    v_accvgpr_write_b32 a66, v178
    v_accvgpr_write_b32 a67, v179
    buffer_store_dwordx4 v[176:179], v254, s[20:23], s72 offen offset:0 sc1
    v_mul_f32 v180, v180, v196
    v_mul_f32 v181, v181, v197
    v_mul_f32 v182, v182, v198
    v_mul_f32 v183, v183, v199
    v_mul_f32 v188, v188, v204
    v_mul_f32 v189, v189, v205
    v_mul_f32 v190, v190, v206
    v_mul_f32 v191, v191, v207
    v_cvt_pk_bf16_f32 v180, v180, v181
    v_cvt_pk_bf16_f32 v181, v182, v183
    v_cvt_pk_bf16_f32 v182, v188, v189
    v_cvt_pk_bf16_f32 v183, v190, v191
    v_accvgpr_write_b32 a68, v180
    v_accvgpr_write_b32 a69, v181
    v_accvgpr_write_b32 a70, v182
    v_accvgpr_write_b32 a71, v183
    buffer_store_dwordx4 v[180:183], v254, s[20:23], s72 offen offset:1024 sc1
    buffer_load_dwordx4 a[104:107], v254, s[20:23], s70 offen offset:2048 sc1
    buffer_load_dwordx4 a[108:111], v254, s[20:23], s70 offen offset:3072 sc1
    v_add_u32 v30, -3, v28
    v_ashrrev_i32 v30, 31, v30
    v_xor_b32_e64 v31, v29, v30
    v_and_b32 v31, 0x3f80, v31
    v_accvgpr_read_b32 v0, a136
    v_accvgpr_read_b32 v1, a137
    v_accvgpr_read_b32 v2, a138
    v_accvgpr_read_b32 v3, a139
    v_and_b32 v0, v30, v0
    v_and_b32 v1, v29, v1
    v_and_or_b32 v2, v2, v29, v31
    v_and_b32_e64 v3, v29, v3
    v_accvgpr_read_b32 v4, a140
    v_accvgpr_read_b32 v5, a141
    v_accvgpr_read_b32 v6, a142
    v_accvgpr_read_b32 v7, a143
    v_and_b32 v4, v30, v4
    v_and_b32 v5, v29, v5
    v_and_or_b32 v6, v6, v29, v31
    v_and_b32_e64 v7, v29, v7
    v_accvgpr_read_b32 v8, a144
    v_accvgpr_read_b32 v9, a145
    v_accvgpr_read_b32 v10, a146
    v_accvgpr_read_b32 v11, a147
    v_and_b32 v8, v29, v8
    v_and_b32 v9, v30, v9
    v_and_or_b32 v10, v10, v29, v31
    v_and_b32_e64 v11, v29, v11
    v_accvgpr_read_b32 v12, a148
    v_accvgpr_read_b32 v13, a149
    v_accvgpr_read_b32 v14, a150
    v_accvgpr_read_b32 v15, a151
    v_and_b32 v12, v29, v12
    v_and_b32 v13, v30, v13
    v_and_or_b32 v14, v14, v29, v31
    v_and_b32 v15, v29, v15
    s_barrier
    ds_read_b64 a[168:169], v24 offset:0
    ds_read_b64 a[170:171], v24 offset:3136
    ds_read_b64 a[172:173], v24 offset:128
    ds_read_b64 a[174:175], v24 offset:3264
    ds_read_b64 a[184:185], v25 offset:0
    ds_read_b64 a[186:187], v25 offset:3136
    ds_read_b64 a[188:189], v25 offset:128
    ds_read_b64 a[190:191], v25 offset:3264
    s_waitcnt lgkmcnt(4)
    v_mfma_f32_16x16x32_bf16 v[32:35], a[168:171], v[0:3], v[16:19]
    v_mfma_f32_16x16x32_bf16 v[36:39], a[172:175], v[0:3], 0
    v_mfma_f32_16x16x32_bf16 v[44:47], a[172:175], v[4:7], v[16:19]
    s_nop 5
    ds_read_b64 a[172:173], v24 offset:256
    ds_read_b64 a[174:175], v24 offset:3392
    ds_read_b64 a[176:177], v24 offset:384
    ds_read_b64 a[178:179], v24 offset:3520
    ds_read_b64_tr_b16 a[168:169], v26 offset:0
    s_waitcnt lgkmcnt(5)
    v_mfma_f32_16x16x32_bf16 v[48:51], a[184:187], v[8:11], v[16:19]
    ds_read_b64_tr_b16 a[170:171], v26 offset:128
    v_exp_f32 v32, v32
    v_exp_f32 v33, v33
    v_exp_f32 v34, v34
    v_exp_f32 v35, v35
    v_exp_f32 v36, v36
    v_exp_f32_e64 v37, v37
    v_mfma_f32_16x16x32_bf16 v[52:55], a[188:191], v[8:11], 0
    ds_read_b64_tr_b16 a[192:193], v27 offset:0
    v_exp_f32 v38, v38
    v_exp_f32 v39, v39
    v_exp_f32 v44, v44
    v_exp_f32 v45, v45
    v_exp_f32 v46, v46
    v_exp_f32 v47, v47
    v_mfma_f32_16x16x32_bf16 v[60:63], a[188:191], v[12:15], v[16:19]
    ds_read_b64_tr_b16 a[194:195], v27 offset:128
    v_cvt_pk_bf16_f32 v32, v32, v33
    v_cvt_pk_bf16_f32 v33, v34, v35
    v_cvt_pk_bf16_f32 v34, v36, v37
    v_cvt_pk_bf16_f32 v35, v38, v39
    v_mov_b32 v40, 0
    v_mov_b32 v41, 0
    v_cvt_pk_bf16_f32 v42, v44, v45
    v_cvt_pk_bf16_f32 v43, v46, v47
    s_waitcnt lgkmcnt(4)
    v_mfma_f32_16x16x32_bf16 v[64:67], a[172:175], v[0:3], 0
    ds_read_b64 a[184:185], v25 offset:256
    v_exp_f32 v48, v48
    v_exp_f32_e64 v49, v49
    v_mfma_f32_16x16x32_bf16 v[72:75], a[172:175], v[4:7], 0
    ds_read_b64 a[186:187], v25 offset:3392
    v_exp_f32 v50, v50
    v_exp_f32 v51, v51
    v_mfma_f32_16x16x32_bf16 v[68:71], a[176:179], v[0:3], 0
    ds_read_b64 a[188:189], v25 offset:384
    v_exp_f32 v52, v52
    v_exp_f32 v53, v53
    v_exp_f32_e64 v54, v54
    v_mfma_f32_16x16x32_bf16 v[76:79], a[176:179], v[4:7], 0
    ds_read_b64 a[190:191], v25 offset:3520
    s_add_u32 m0, s64, 74112
    s_nop 0
    buffer_load_dwordx4 v246, s[16:19], s87 offen offset:0 lds
    v_exp_f32 v55, v55
    v_exp_f32 v60, v60
    s_waitcnt lgkmcnt(4)
    v_mfma_f32_16x16x32_bf16 v[208:211], a[168:171], v[32:35], 0
    ds_read_b64_tr_b16 a[180:181], v26 offset:18816
    v_exp_f32 v61, v61
    v_exp_f32 v62, v62
    v_mfma_f32_16x16x32_bf16 v[216:219], a[168:171], v[40:43], 0
    ds_read_b64_tr_b16 a[182:183], v26 offset:18944
    v_exp_f32_e64 v63, v63
    v_cvt_pk_bf16_f32 v48, v48, v49
    v_cvt_pk_bf16_f32 v49, v50, v51
    v_mfma_f32_16x16x32_bf16 v[212:215], a[192:195], v[32:35], 0
    v_cvt_pk_bf16_f32 v50, v52, v53
    v_cvt_pk_bf16_f32 v51, v54, v55
    v_mfma_f32_16x16x32_bf16 v[220:223], a[192:195], v[40:43], 0
    buffer_load_dwordx4 v244, s[16:19], s87 offen offset:1024 lds
    v_mov_b32 v56, 0
    v_mov_b32 v57, 0
    v_cvt_pk_bf16_f32 v58, v60, v61
    v_cvt_pk_bf16_f32 v59, v62, v63
    s_waitcnt lgkmcnt(2)
    v_mfma_f32_16x16x32_bf16 v[32:35], a[184:187], v[8:11], 0
    ds_read_b64 a[172:173], v24 offset:512
    v_exp_f32 v64, v64
    v_exp_f32_e64 v65, v65
    v_mfma_f32_16x16x32_bf16 v[40:43], a[184:187], v[12:15], 0
    ds_read_b64 a[174:175], v24 offset:3648
    v_exp_f32 v66, v66
    v_exp_f32 v67, v67
    v_exp_f32_e64 v68, v68
    v_mfma_f32_16x16x32_bf16 v[36:39], a[188:191], v[8:11], 0
    ds_read_b64 a[176:177], v24 offset:640
    v_exp_f32 v69, v69
    v_exp_f32 v70, v70
    v_exp_f32_e64 v71, v71
    v_mfma_f32_16x16x32_bf16 v[44:47], a[188:191], v[12:15], 0
    ds_read_b64 a[178:179], v24 offset:3776
    buffer_load_dwordx4 v248, s[16:19], s27 offen offset:2048 lds
    v_exp_f32 v72, v72
    v_exp_f32 v73, v73
    v_exp_f32 v74, v74
    s_waitcnt lgkmcnt(4)
    v_mfma_f32_16x16x32_bf16 v[224:227], a[180:183], v[48:51], 0
    ds_read_b64_tr_b16 a[168:169], v26 offset:256
L_w9:
    s_cbranch_execz L_wret2
    v_exp_f32 v75, v75
    v_exp_f32 v76, v76
    v_exp_f32_e64 v77, v77
    v_mfma_f32_16x16x32_bf16 v[232:235], a[180:183], v[56:59], 0
    ds_read_b64_tr_b16 a[170:171], v26 offset:384
    v_exp_f32 v78, v78
    v_exp_f32 v79, v79
    v_cvt_pk_bf16_f32 v64, v64, v65
    v_mfma_f32_16x16x32_bf16 v[228:231], a[192:195], v[48:51], 0
    ds_read_b64_tr_b16 a[196:197], v27 offset:256
    v_cvt_pk_bf16_f32 v65, v66, v67
    v_cvt_pk_bf16_f32 v66, v68, v69
    v_cvt_pk_bf16_f32 v67, v70, v71
    v_mfma_f32_16x16x32_bf16 v[236:239], a[192:195], v[56:59], 0
    ds_read_b64_tr_b16 a[198:199], v27 offset:384
    s_add_u32 m0, s64, 77184
    s_nop 0
    buffer_load_dwordx4 v243, s[16:19], s27 offen offset:0 lds
    v_cvt_pk_bf16_f32 v72, v72, v73
    v_cvt_pk_bf16_f32 v73, v74, v75
    v_cvt_pk_bf16_f32 v74, v76, v77
    v_cvt_pk_bf16_f32 v75, v78, v79
    s_waitcnt lgkmcnt(4)
    v_mfma_f32_16x16x32_bf16 v[48:51], a[172:175], v[0:3], 0
    ds_read_b64 a[184:185], v25 offset:512
    v_exp_f32 v32, v32
    v_exp_f32 v33, v33
    v_mfma_f32_16x16x32_bf16 v[56:59], a[172:175], v[4:7], 0
    ds_read_b64 a[186:187], v25 offset:3648
    v_exp_f32 v34, v34
    v_exp_f32 v35, v35
    v_exp_f32_e64 v36, v36
    v_mfma_f32_16x16x32_bf16 v[52:55], a[176:179], v[0:3], 0
    ds_read_b64 a[188:189], v25 offset:640
    v_exp_f32 v37, v37
    v_exp_f32 v38, v38
    v_exp_f32_e64 v39, v39
    v_mfma_f32_16x16x32_bf16 v[60:63], a[176:179], v[4:7], 0
    ds_read_b64 a[190:191], v25 offset:3776
    buffer_load_dwordx4 v247, s[16:19], s88 offen offset:1024 lds
    v_exp_f32 v40, v40
    v_exp_f32 v41, v41
    v_exp_f32 v42, v42
    s_waitcnt lgkmcnt(4)
    v_mfma_f32_16x16x32_bf16 v[208:211], a[168:171], v[64:67], v[208:211]
    ds_read_b64_tr_b16 a[180:181], v26 offset:19072
    v_exp_f32 v43, v43
    v_exp_f32 v44, v44
    v_exp_f32_e64 v45, v45
    v_mfma_f32_16x16x32_bf16 v[216:219], a[168:171], v[72:75], v[216:219]
    ds_read_b64_tr_b16 a[182:183], v26 offset:19200
    v_exp_f32 v46, v46
    v_exp_f32 v47, v47
    v_cvt_pk_bf16_f32 v32, v32, v33
    v_mfma_f32_16x16x32_bf16 v[212:215], a[196:199], v[64:67], v[212:215]
    v_cvt_pk_bf16_f32 v33, v34, v35
    v_cvt_pk_bf16_f32 v34, v36, v37
    v_cvt_pk_bf16_f32 v35, v38, v39
    v_mfma_f32_16x16x32_bf16 v[220:223], a[196:199], v[72:75], v[220:223]
    buffer_load_dwordx4 v245, s[16:19], s88 offen offset:2048 lds
    v_cvt_pk_bf16_f32 v40, v40, v41
    v_cvt_pk_bf16_f32 v41, v42, v43
    v_cvt_pk_bf16_f32 v42, v44, v45
    v_cvt_pk_bf16_f32 v43, v46, v47
    s_waitcnt vmcnt(8)
    v_accvgpr_read_b32 v249, a211
    v_mov_b32 v250, s51
    buffer_store_dword v250, v249, s[20:23], 0 offen offset:0 sc1
    s_waitcnt lgkmcnt(2)
    v_mfma_f32_16x16x32_bf16 v[64:67], a[184:187], v[8:11], 0
    ds_read_b64 a[172:173], v24 offset:768
    v_exp_f32 v48, v48
    v_exp_f32_e64 v49, v49
    v_mfma_f32_16x16x32_bf16 v[72:75], a[184:187], v[12:15], 0
    ds_read_b64 a[174:175], v24 offset:3904
    v_exp_f32 v50, v50
    v_exp_f32 v51, v51
    v_exp_f32_e64 v52, v52
    v_mfma_f32_16x16x32_bf16 v[68:71], a[188:191], v[8:11], 0
    ds_read_b64 a[176:177], v24 offset:896
    v_exp_f32 v53, v53
    v_exp_f32 v54, v54
    v_exp_f32_e64 v55, v55
    v_mfma_f32_16x16x32_bf16 v[76:79], a[188:191], v[12:15], 0
    ds_read_b64 a[178:179], v24 offset:4032
    v_bfe_u32 v197, v254, 4, 4
    v_mul_u32_u24 v197, 1152, v197
    v_lshrrev_b32_e64 v196, 8, v254
    v_lshl_add_u32 v198, v196, 3, v197
    s_and_b32 s69, s57, 1
    s_mul_i32 s67, s69, 640
    s_lshl_b32 s68, s65, 6
    s_add_u32 s67, s67, s68
    s_add_u32 s67, s67, s71
    buffer_load_dwordx2 a[228:229], v198, s[4:7], s67 offen offset:0
    v_exp_f32 v56, v56
    v_exp_f32 v57, v57
    v_exp_f32 v58, v58
    s_waitcnt lgkmcnt(4)
    v_mfma_f32_16x16x32_bf16 v[224:227], a[180:183], v[32:35], v[224:227]
    ds_read_b64_tr_b16 a[168:169], v26 offset:512
    v_exp_f32 v59, v59
    v_exp_f32 v60, v60
    v_exp_f32_e64 v61, v61
    v_mfma_f32_16x16x32_bf16 v[232:235], a[180:183], v[40:43], v[232:235]
    ds_read_b64_tr_b16 a[170:171], v26 offset:640
    v_exp_f32 v62, v62
    v_exp_f32 v63, v63
    v_cvt_pk_bf16_f32 v48, v48, v49
    v_mfma_f32_16x16x32_bf16 v[228:231], a[196:199], v[32:35], v[228:231]
    ds_read_b64_tr_b16 a[192:193], v27 offset:512
    v_cvt_pk_bf16_f32 v49, v50, v51
    v_cvt_pk_bf16_f32 v50, v52, v53
    v_cvt_pk_bf16_f32 v51, v54, v55
    v_mfma_f32_16x16x32_bf16 v[236:239], a[196:199], v[40:43], v[236:239]
    ds_read_b64_tr_b16 a[194:195], v27 offset:640
    buffer_load_dwordx2 a[230:231], v198, s[4:7], s67 offen offset:32
    v_cvt_pk_bf16_f32 v56, v56, v57
    v_cvt_pk_bf16_f32 v57, v58, v59
    v_cvt_pk_bf16_f32 v58, v60, v61
    v_cvt_pk_bf16_f32 v59, v62, v63
    s_waitcnt lgkmcnt(4)
    v_mfma_f32_16x16x32_bf16 v[32:35], a[172:175], v[0:3], 0
    ds_read_b64 a[184:185], v25 offset:768
    v_exp_f32 v64, v64
    v_exp_f32_e64 v65, v65
    v_mfma_f32_16x16x32_bf16 v[40:43], a[172:175], v[4:7], 0
    ds_read_b64 a[186:187], v25 offset:3904
    v_exp_f32 v66, v66
    v_exp_f32 v67, v67
    v_exp_f32_e64 v68, v68
    v_mfma_f32_16x16x32_bf16 v[36:39], a[176:179], v[0:3], 0
    ds_read_b64 a[188:189], v25 offset:896
    v_exp_f32 v69, v69
    v_exp_f32 v70, v70
    v_exp_f32_e64 v71, v71
    v_mfma_f32_16x16x32_bf16 v[44:47], a[176:179], v[4:7], 0
    ds_read_b64 a[190:191], v25 offset:4032
    s_add_u32 s67, s67, 18432
    buffer_load_dwordx2 a[232:233], v198, s[4:7], s67 offen offset:0
    v_exp_f32 v72, v72
    v_exp_f32 v73, v73
    v_exp_f32 v74, v74
    s_waitcnt lgkmcnt(4)
    v_mfma_f32_16x16x32_bf16 v[208:211], a[168:171], v[48:51], v[208:211]
    ds_read_b64_tr_b16 a[180:181], v26 offset:19328
    v_exp_f32 v75, v75
    v_exp_f32 v76, v76
    v_exp_f32_e64 v77, v77
    v_mfma_f32_16x16x32_bf16 v[216:219], a[168:171], v[56:59], v[216:219]
    ds_read_b64_tr_b16 a[182:183], v26 offset:19456
    v_exp_f32 v78, v78
    v_exp_f32 v79, v79
    v_cvt_pk_bf16_f32 v64, v64, v65
    v_mfma_f32_16x16x32_bf16 v[212:215], a[192:195], v[48:51], v[212:215]
    v_cvt_pk_bf16_f32 v65, v66, v67
    v_cvt_pk_bf16_f32 v66, v68, v69
    v_cvt_pk_bf16_f32 v67, v70, v71
    v_mfma_f32_16x16x32_bf16 v[220:223], a[192:195], v[56:59], v[220:223]
    buffer_load_dwordx2 a[234:235], v198, s[4:7], s67 offen offset:32
    v_cvt_pk_bf16_f32 v72, v72, v73
    v_cvt_pk_bf16_f32 v73, v74, v75
    v_cvt_pk_bf16_f32 v74, v76, v77
    v_cvt_pk_bf16_f32 v75, v78, v79
    s_waitcnt lgkmcnt(2)
    v_mfma_f32_16x16x32_bf16 v[48:51], a[184:187], v[8:11], 0
    ds_read_b64 a[172:173], v24 offset:1024
    v_exp_f32 v32, v32
    v_exp_f32_e64 v33, v33
    v_mfma_f32_16x16x32_bf16 v[56:59], a[184:187], v[12:15], 0
    ds_read_b64 a[174:175], v24 offset:4160
    v_exp_f32 v34, v34
    v_exp_f32 v35, v35
    v_exp_f32_e64 v36, v36
    v_mfma_f32_16x16x32_bf16 v[52:55], a[188:191], v[8:11], 0
    ds_read_b64 a[176:177], v24 offset:1152
    v_exp_f32 v37, v37
    v_exp_f32 v38, v38
    v_exp_f32_e64 v39, v39
    v_mfma_f32_16x16x32_bf16 v[60:63], a[188:191], v[12:15], 0
    ds_read_b64 a[178:179], v24 offset:4288
    v_and_b32_e64 v196, 1, v196
    v_lshl_add_u32 v198, v196, 5, v197
    s_lshr_b32 s67, s65, 2
    s_mul_i32 s67, s67, 18432
    s_and_b32 s68, s65, 3
    s_lshl_b32 s68, s68, 3
    s_add_u32 s67, s67, s68
    s_lshl_b32 s69, s69, 6
    s_add_u32 s67, s67, s69
    s_add_u32 s67, s67, s71
    buffer_load_dwordx2 a[236:237], v198, s[4:7], s67 offen offset:512
    v_exp_f32 v40, v40
    v_exp_f32 v41, v41
    v_exp_f32_e64 v42, v42
    s_waitcnt lgkmcnt(4)
    v_mfma_f32_16x16x32_bf16 v[224:227], a[180:183], v[64:67], v[224:227]
    ds_read_b64_tr_b16 a[168:169], v26 offset:768
    v_exp_f32 v43, v43
    v_exp_f32 v44, v44
    v_exp_f32_e64 v45, v45
    v_mfma_f32_16x16x32_bf16 v[232:235], a[180:183], v[72:75], v[232:235]
    ds_read_b64_tr_b16 a[170:171], v26 offset:896
    v_exp_f32 v46, v46
    v_exp_f32 v47, v47
    v_cvt_pk_bf16_f32 v32, v32, v33
    v_mfma_f32_16x16x32_bf16 v[228:231], a[192:195], v[64:67], v[228:231]
    ds_read_b64_tr_b16 a[196:197], v27 offset:768
    v_cvt_pk_bf16_f32 v33, v34, v35
    v_cvt_pk_bf16_f32 v34, v36, v37
    v_cvt_pk_bf16_f32 v35, v38, v39
    v_mfma_f32_16x16x32_bf16 v[236:239], a[192:195], v[72:75], v[236:239]
    ds_read_b64_tr_b16 a[198:199], v27 offset:896
    s_add_u32 m0, s64, 0
    v_accvgpr_read_b32 v253, a205
    v_add_u32 v253, 2048, v253
    s_add_u32 s66, s94, s41
    buffer_load_dwordx4 v253, s[28:31], s66 offen offset:0 lds
    v_cvt_pk_bf16_f32 v40, v40, v41
    v_cvt_pk_bf16_f32 v41, v42, v43
    v_cvt_pk_bf16_f32 v42, v44, v45
    v_cvt_pk_bf16_f32 v43, v46, v47
    s_waitcnt lgkmcnt(4)
    v_mfma_f32_16x16x32_bf16 v[64:67], a[172:175], v[0:3], 0
    ds_read_b64 a[184:185], v25 offset:1024
    v_exp_f32 v48, v48
    v_exp_f32_e64 v49, v49
    v_mfma_f32_16x16x32_bf16 v[72:75], a[172:175], v[4:7], 0
    ds_read_b64 a[186:187], v25 offset:4160
    v_exp_f32 v50, v50
    v_exp_f32 v51, v51
    v_exp_f32_e64 v52, v52
    v_mfma_f32_16x16x32_bf16 v[68:71], a[176:179], v[0:3], 0
    ds_read_b64 a[188:189], v25 offset:1152
    v_exp_f32 v53, v53
    v_exp_f32 v54, v54
    v_exp_f32_e64 v55, v55
    v_mfma_f32_16x16x32_bf16 v[76:79], a[176:179], v[4:7], 0
    ds_read_b64 a[190:191], v25 offset:4288
    v_accvgpr_read_b32 v253, a206
    v_add_u32 v253, 1024, v253
    s_add_u32 s66, s94, s40
    buffer_load_dwordx4 v253, s[28:31], s66 offen offset:1024 lds
    v_exp_f32 v56, v56
    v_exp_f32 v57, v57
    v_exp_f32_e64 v58, v58
    s_waitcnt lgkmcnt(4)
    v_mfma_f32_16x16x32_bf16 v[208:211], a[168:171], v[32:35], v[208:211]
    ds_read_b64_tr_b16 a[180:181], v26 offset:19584
    v_exp_f32 v59, v59
    v_exp_f32 v60, v60
    v_exp_f32_e64 v61, v61
    v_mfma_f32_16x16x32_bf16 v[216:219], a[168:171], v[40:43], v[216:219]
    ds_read_b64_tr_b16 a[182:183], v26 offset:19712
    v_exp_f32 v62, v62
    v_exp_f32 v63, v63
    v_cvt_pk_bf16_f32 v48, v48, v49
    v_mfma_f32_16x16x32_bf16 v[212:215], a[196:199], v[32:35], v[212:215]
    v_cvt_pk_bf16_f32 v49, v50, v51
    v_cvt_pk_bf16_f32 v50, v52, v53
    v_cvt_pk_bf16_f32 v51, v54, v55
    v_mfma_f32_16x16x32_bf16 v[220:223], a[196:199], v[40:43], v[220:223]
    buffer_load_dwordx4 v248, s[16:19], s89 offen offset:2048 lds
    v_cvt_pk_bf16_f32 v56, v56, v57
    v_cvt_pk_bf16_f32 v57, v58, v59
    v_cvt_pk_bf16_f32 v58, v60, v61
    v_cvt_pk_bf16_f32 v59, v62, v63
    s_waitcnt lgkmcnt(2)
    v_mfma_f32_16x16x32_bf16 v[32:35], a[184:187], v[8:11], 0
    ds_read_b64 a[172:173], v24 offset:1280
    v_exp_f32 v64, v64
    v_exp_f32_e64 v65, v65
    v_mfma_f32_16x16x32_bf16 v[40:43], a[184:187], v[12:15], 0
    ds_read_b64 a[174:175], v24 offset:4416
    v_exp_f32 v66, v66
    v_exp_f32 v67, v67
    v_exp_f32_e64 v68, v68
    v_mfma_f32_16x16x32_bf16 v[36:39], a[188:191], v[8:11], 0
    ds_read_b64 a[176:177], v24 offset:1408
    v_exp_f32 v69, v69
    v_exp_f32 v70, v70
    v_exp_f32_e64 v71, v71
    v_mfma_f32_16x16x32_bf16 v[44:47], a[188:191], v[12:15], 0
    ds_read_b64 a[178:179], v24 offset:4544
    s_add_u32 m0, s64, 3072
    s_nop 0
    buffer_load_dwordx4 v243, s[16:19], s89 offen offset:0 lds
    v_exp_f32 v72, v72
    v_exp_f32 v73, v73
    v_exp_f32_e64 v74, v74
    s_waitcnt lgkmcnt(4)
    v_mfma_f32_16x16x32_bf16 v[224:227], a[180:183], v[48:51], v[224:227]
    ds_read_b64_tr_b16 a[168:169], v26 offset:1024
    v_exp_f32 v75, v75
    v_exp_f32 v76, v76
    v_exp_f32_e64 v77, v77
    v_mfma_f32_16x16x32_bf16 v[232:235], a[180:183], v[56:59], v[232:235]
    ds_read_b64_tr_b16 a[170:171], v26 offset:1152
    v_exp_f32 v78, v78
    v_exp_f32 v79, v79
    v_cvt_pk_bf16_f32 v64, v64, v65
    v_mfma_f32_16x16x32_bf16 v[228:231], a[196:199], v[48:51], v[228:231]
    ds_read_b64_tr_b16 a[192:193], v27 offset:1024
    v_cvt_pk_bf16_f32 v65, v66, v67
    v_cvt_pk_bf16_f32 v66, v68, v69
    v_cvt_pk_bf16_f32 v67, v70, v71
    v_mfma_f32_16x16x32_bf16 v[236:239], a[196:199], v[56:59], v[236:239]
    ds_read_b64_tr_b16 a[194:195], v27 offset:1152
    buffer_load_dwordx4 v247, s[16:19], s99 offen offset:1024 lds
    v_cvt_pk_bf16_f32 v72, v72, v73
    v_cvt_pk_bf16_f32 v73, v74, v75
    v_cvt_pk_bf16_f32 v74, v76, v77
    v_cvt_pk_bf16_f32 v75, v78, v79
    v_accvgpr_read_b32 v249, a212
    buffer_load_dword v250, v249, s[20:23], 0 offen sc1
    s_waitcnt lgkmcnt(4)
    v_mfma_f32_16x16x32_bf16 v[48:51], a[172:175], v[0:3], 0
    ds_read_b64 a[184:185], v25 offset:1280
    v_exp_f32 v32, v32
    v_exp_f32_e64 v33, v33
    v_mfma_f32_16x16x32_bf16 v[56:59], a[172:175], v[4:7], 0
    ds_read_b64 a[186:187], v25 offset:4416
    v_exp_f32 v34, v34
    v_exp_f32 v35, v35
    v_exp_f32_e64 v36, v36
    v_mfma_f32_16x16x32_bf16 v[52:55], a[176:179], v[0:3], 0
    ds_read_b64 a[188:189], v25 offset:1408
    v_exp_f32 v37, v37
    v_exp_f32 v38, v38
    v_exp_f32_e64 v39, v39
    v_mfma_f32_16x16x32_bf16 v[60:63], a[176:179], v[4:7], 0
    ds_read_b64 a[190:191], v25 offset:4544
    buffer_load_dwordx4 v245, s[16:19], s99 offen offset:2048 lds
    v_exp_f32 v40, v40
    v_exp_f32 v41, v41
    v_exp_f32 v42, v42
    s_waitcnt lgkmcnt(4)
    v_mfma_f32_16x16x32_bf16 v[208:211], a[168:171], v[64:67], v[208:211]
    ds_read_b64_tr_b16 a[180:181], v26 offset:19840
    v_exp_f32 v43, v43
    v_exp_f32 v44, v44
    v_exp_f32_e64 v45, v45
    v_mfma_f32_16x16x32_bf16 v[216:219], a[168:171], v[72:75], v[216:219]
    ds_read_b64_tr_b16 a[182:183], v26 offset:19968
    v_exp_f32 v46, v46
    v_exp_f32 v47, v47
    v_cvt_pk_bf16_f32 v32, v32, v33
    v_mfma_f32_16x16x32_bf16 v[212:215], a[192:195], v[64:67], v[212:215]
    v_cvt_pk_bf16_f32 v33, v34, v35
    v_cvt_pk_bf16_f32 v34, v36, v37
    v_cvt_pk_bf16_f32 v35, v38, v39
    v_mfma_f32_16x16x32_bf16 v[220:223], a[192:195], v[72:75], v[220:223]
    v_cvt_pk_bf16_f32 v40, v40, v41
    v_cvt_pk_bf16_f32 v41, v42, v43
    v_cvt_pk_bf16_f32 v42, v44, v45
    v_cvt_pk_bf16_f32 v43, v46, v47
    s_waitcnt lgkmcnt(2)
    v_mfma_f32_16x16x32_bf16 v[64:67], a[184:187], v[8:11], 0
    ds_read_b64 a[172:173], v24 offset:1536
    v_exp_f32 v48, v48
    v_exp_f32_e64 v49, v49
    v_mfma_f32_16x16x32_bf16 v[72:75], a[184:187], v[12:15], 0
    ds_read_b64 a[174:175], v24 offset:4672
    v_exp_f32 v50, v50
    v_exp_f32 v51, v51
    v_exp_f32_e64 v52, v52
    v_mfma_f32_16x16x32_bf16 v[68:71], a[188:191], v[8:11], 0
    ds_read_b64 a[176:177], v24 offset:1664
    v_exp_f32 v53, v53
    v_exp_f32 v54, v54
    v_exp_f32_e64 v55, v55
    v_mfma_f32_16x16x32_bf16 v[76:79], a[188:191], v[12:15], 0
    ds_read_b64 a[178:179], v24 offset:4800
    v_exp_f32 v56, v56
    v_exp_f32 v57, v57
    v_exp_f32 v58, v58
    s_waitcnt lgkmcnt(4)
    v_mfma_f32_16x16x32_bf16 v[224:227], a[180:183], v[32:35], v[224:227]
    ds_read_b64_tr_b16 a[168:169], v26 offset:1280
    v_exp_f32 v59, v59
    v_exp_f32 v60, v60
    v_exp_f32_e64 v61, v61
    v_mfma_f32_16x16x32_bf16 v[232:235], a[180:183], v[40:43], v[232:235]
    ds_read_b64_tr_b16 a[170:171], v26 offset:1408
    v_exp_f32 v62, v62
    v_exp_f32 v63, v63
    v_cvt_pk_bf16_f32 v48, v48, v49
    v_mfma_f32_16x16x32_bf16 v[228:231], a[192:195], v[32:35], v[228:231]
    ds_read_b64_tr_b16 a[196:197], v27 offset:1280
    v_cvt_pk_bf16_f32 v49, v50, v51
    v_cvt_pk_bf16_f32 v50, v52, v53
    v_cvt_pk_bf16_f32 v51, v54, v55
    v_mfma_f32_16x16x32_bf16 v[236:239], a[192:195], v[40:43], v[236:239]
    ds_read_b64_tr_b16 a[198:199], v27 offset:1408
    v_cvt_pk_bf16_f32 v56, v56, v57
    v_cvt_pk_bf16_f32 v57, v58, v59
    v_cvt_pk_bf16_f32 v58, v60, v61
    v_cvt_pk_bf16_f32 v59, v62, v63
    s_waitcnt lgkmcnt(4)
    v_mfma_f32_16x16x32_bf16 v[32:35], a[172:175], v[0:3], 0
    ds_read_b64 a[184:185], v25 offset:1536
    v_exp_f32 v64, v64
    v_exp_f32_e64 v65, v65
    v_mfma_f32_16x16x32_bf16 v[40:43], a[172:175], v[4:7], 0
    ds_read_b64 a[186:187], v25 offset:4672
    v_exp_f32 v66, v66
    v_exp_f32 v67, v67
    v_exp_f32_e64 v68, v68
    v_mfma_f32_16x16x32_bf16 v[36:39], a[176:179], v[0:3], 0
    ds_read_b64 a[188:189], v25 offset:1664
    v_exp_f32 v69, v69
    v_exp_f32 v70, v70
    v_exp_f32_e64 v71, v71
    v_mfma_f32_16x16x32_bf16 v[44:47], a[176:179], v[4:7], 0
    ds_read_b64 a[190:191], v25 offset:4800
    v_exp_f32 v72, v72
    v_exp_f32 v73, v73
    v_exp_f32 v74, v74
    s_waitcnt lgkmcnt(4)
    v_mfma_f32_16x16x32_bf16 v[208:211], a[168:171], v[48:51], v[208:211]
    ds_read_b64_tr_b16 a[180:181], v26 offset:20096
    v_exp_f32 v75, v75
    v_exp_f32 v76, v76
    v_exp_f32_e64 v77, v77
    v_mfma_f32_16x16x32_bf16 v[216:219], a[168:171], v[56:59], v[216:219]
    ds_read_b64_tr_b16 a[182:183], v26 offset:20224
    v_exp_f32 v78, v78
    v_exp_f32 v79, v79
    v_cvt_pk_bf16_f32 v64, v64, v65
    v_mfma_f32_16x16x32_bf16 v[212:215], a[196:199], v[48:51], v[212:215]
    v_cvt_pk_bf16_f32 v65, v66, v67
    v_cvt_pk_bf16_f32 v66, v68, v69
    v_cvt_pk_bf16_f32 v67, v70, v71
    v_mfma_f32_16x16x32_bf16 v[220:223], a[196:199], v[56:59], v[220:223]
    v_cvt_pk_bf16_f32 v72, v72, v73
    v_cvt_pk_bf16_f32 v73, v74, v75
    v_cvt_pk_bf16_f32 v74, v76, v77
    v_cvt_pk_bf16_f32 v75, v78, v79
    s_waitcnt lgkmcnt(2)
    v_mfma_f32_16x16x32_bf16 v[48:51], a[184:187], v[8:11], 0
    ds_read_b64 a[172:173], v24 offset:1792
    v_exp_f32 v32, v32
    v_exp_f32_e64 v33, v33
    v_mfma_f32_16x16x32_bf16 v[56:59], a[184:187], v[12:15], 0
    ds_read_b64 a[174:175], v24 offset:4928
    v_exp_f32 v34, v34
    v_exp_f32 v35, v35
    v_exp_f32_e64 v36, v36
    v_mfma_f32_16x16x32_bf16 v[52:55], a[188:191], v[8:11], 0
    ds_read_b64 a[176:177], v24 offset:1920
    v_exp_f32 v37, v37
    v_exp_f32 v38, v38
    v_exp_f32_e64 v39, v39
    v_mfma_f32_16x16x32_bf16 v[60:63], a[188:191], v[12:15], 0
    ds_read_b64 a[178:179], v24 offset:5056
    v_exp_f32 v40, v40
    v_exp_f32 v41, v41
    v_exp_f32 v42, v42
    s_waitcnt lgkmcnt(4)
    v_mfma_f32_16x16x32_bf16 v[224:227], a[180:183], v[64:67], v[224:227]
    ds_read_b64_tr_b16 a[168:169], v26 offset:1536
    v_exp_f32 v43, v43
    v_exp_f32 v44, v44
    v_exp_f32_e64 v45, v45
    v_mfma_f32_16x16x32_bf16 v[232:235], a[180:183], v[72:75], v[232:235]
    ds_read_b64_tr_b16 a[170:171], v26 offset:1664
    v_exp_f32 v46, v46
    v_exp_f32 v47, v47
    v_cvt_pk_bf16_f32 v32, v32, v33
    v_mfma_f32_16x16x32_bf16 v[228:231], a[196:199], v[64:67], v[228:231]
    ds_read_b64_tr_b16 a[192:193], v27 offset:1536
    v_cvt_pk_bf16_f32 v33, v34, v35
    v_cvt_pk_bf16_f32 v34, v36, v37
    v_cvt_pk_bf16_f32 v35, v38, v39
    v_mfma_f32_16x16x32_bf16 v[236:239], a[196:199], v[72:75], v[236:239]
    ds_read_b64_tr_b16 a[194:195], v27 offset:1664
    v_cvt_pk_bf16_f32 v40, v40, v41
    v_cvt_pk_bf16_f32 v41, v42, v43
    v_cvt_pk_bf16_f32 v42, v44, v45
    v_cvt_pk_bf16_f32 v43, v46, v47
    s_waitcnt vmcnt(1)
    v_cmp_ne_u32 vcc, s51, v250
    s_nop 0
    s_cmp_lg_u64 vcc, 0
    s_cbranch_scc1 L_spin_hp
L_back_hp:
    s_waitcnt lgkmcnt(4)
    v_mfma_f32_16x16x32_bf16 v[64:67], a[172:175], v[0:3], 0
    ds_read_b64 a[184:185], v25 offset:1792
    v_exp_f32 v48, v48
    v_exp_f32 v49, v49
    v_mfma_f32_16x16x32_bf16 v[72:75], a[172:175], v[4:7], 0
    ds_read_b64 a[186:187], v25 offset:4928
    v_exp_f32 v50, v50
    v_exp_f32 v51, v51
    v_exp_f32_e64 v52, v52
    v_mfma_f32_16x16x32_bf16 v[68:71], a[176:179], v[0:3], 0
    ds_read_b64 a[188:189], v25 offset:1920
    v_exp_f32 v53, v53
    v_exp_f32 v54, v54
    v_exp_f32_e64 v55, v55
    v_mfma_f32_16x16x32_bf16 v[76:79], a[176:179], v[4:7], 0
    ds_read_b64 a[190:191], v25 offset:5056
    s_add_u32 s72, s75, 8192
    buffer_load_dwordx4 a[112:115], v254, s[20:23], s72 offen offset:0 sc1
    v_exp_f32 v56, v56
    v_exp_f32 v57, v57
    v_exp_f32 v58, v58
    s_waitcnt lgkmcnt(4)
    v_mfma_f32_16x16x32_bf16 v[208:211], a[168:171], v[32:35], v[208:211]
    ds_read_b64_tr_b16 a[180:181], v26 offset:20352
    v_exp_f32 v59, v59
    v_exp_f32 v60, v60
    v_exp_f32_e64 v61, v61
    v_mfma_f32_16x16x32_bf16 v[216:219], a[168:171], v[40:43], v[216:219]
    ds_read_b64_tr_b16 a[182:183], v26 offset:20480
    v_exp_f32 v62, v62
    v_exp_f32 v63, v63
    v_cvt_pk_bf16_f32 v48, v48, v49
    v_mfma_f32_16x16x32_bf16 v[212:215], a[192:195], v[32:35], v[212:215]
    v_cvt_pk_bf16_f32 v49, v50, v51
    v_cvt_pk_bf16_f32 v50, v52, v53
    v_cvt_pk_bf16_f32 v51, v54, v55
    v_mfma_f32_16x16x32_bf16 v[220:223], a[192:195], v[40:43], v[220:223]
    buffer_load_dwordx4 a[116:119], v254, s[20:23], s72 offen offset:1024 sc1
    v_cvt_pk_bf16_f32 v56, v56, v57
    v_cvt_pk_bf16_f32 v57, v58, v59
    v_cvt_pk_bf16_f32 v58, v60, v61
    v_cvt_pk_bf16_f32 v59, v62, v63
    s_waitcnt lgkmcnt(2)
    v_mfma_f32_16x16x32_bf16 v[32:35], a[184:187], v[8:11], 0
    ds_read_b64 a[172:173], v24 offset:2048
    v_exp_f32 v64, v64
    v_exp_f32_e64 v65, v65
    v_mfma_f32_16x16x32_bf16 v[40:43], a[184:187], v[12:15], 0
    ds_read_b64 a[174:175], v24 offset:5184
    v_exp_f32 v66, v66
    v_exp_f32 v67, v67
    v_exp_f32_e64 v68, v68
    v_mfma_f32_16x16x32_bf16 v[36:39], a[188:191], v[8:11], 0
    ds_read_b64 a[176:177], v24 offset:2176
    v_exp_f32 v69, v69
    v_exp_f32 v70, v70
    v_exp_f32_e64 v71, v71
    v_mfma_f32_16x16x32_bf16 v[44:47], a[188:191], v[12:15], 0
    ds_read_b64 a[178:179], v24 offset:5312
    buffer_load_dwordx4 a[120:123], v254, s[20:23], s72 offen offset:2048 sc1
    v_exp_f32 v72, v72
    v_exp_f32 v73, v73
    v_exp_f32 v74, v74
    s_waitcnt lgkmcnt(4)
    v_mfma_f32_16x16x32_bf16 v[224:227], a[180:183], v[48:51], v[224:227]
    ds_read_b64_tr_b16 a[168:169], v26 offset:1792
    v_exp_f32 v75, v75
    v_exp_f32 v76, v76
    v_exp_f32_e64 v77, v77
    v_mfma_f32_16x16x32_bf16 v[232:235], a[180:183], v[56:59], v[232:235]
    ds_read_b64_tr_b16 a[170:171], v26 offset:1920
    v_exp_f32 v78, v78
    v_exp_f32 v79, v79
    v_cvt_pk_bf16_f32 v64, v64, v65
    v_mfma_f32_16x16x32_bf16 v[228:231], a[192:195], v[48:51], v[228:231]
    ds_read_b64_tr_b16 a[196:197], v27 offset:1792
    v_cvt_pk_bf16_f32 v65, v66, v67
    v_cvt_pk_bf16_f32 v66, v68, v69
    v_cvt_pk_bf16_f32 v67, v70, v71
    v_mfma_f32_16x16x32_bf16 v[236:239], a[192:195], v[56:59], v[236:239]
    ds_read_b64_tr_b16 a[198:199], v27 offset:1920
    buffer_load_dwordx4 a[124:127], v254, s[20:23], s72 offen offset:3072 sc1
    v_cvt_pk_bf16_f32 v72, v72, v73
    v_cvt_pk_bf16_f32 v73, v74, v75
    v_cvt_pk_bf16_f32 v74, v76, v77
    v_cvt_pk_bf16_f32 v75, v78, v79
    s_waitcnt lgkmcnt(2)
    v_mfma_f32_16x16x32_bf16 v[48:51], a[172:175], v[0:3], v[20:23]
    ds_read_b64 a[184:185], v25 offset:2048
    v_exp_f32 v32, v32
    v_exp_f32 v33, v33
    v_exp_f32 v34, v34
    v_mfma_f32_16x16x32_bf16 v[56:59], a[172:175], v[4:7], 0
    ds_read_b64 a[186:187], v25 offset:5184
    v_exp_f32 v35, v35
    v_exp_f32 v36, v36
    v_exp_f32_e64 v37, v37
    v_mfma_f32_16x16x32_bf16 v[60:63], a[176:179], v[4:7], v[20:23]
    ds_read_b64 a[188:189], v25 offset:2176
    v_exp_f32 v38, v38
    v_exp_f32 v39, v39
    v_exp_f32_e64 v40, v40
    v_mfma_f32_16x16x32_bf16 v[208:211], a[168:171], v[64:67], v[208:211]
    ds_read_b64 a[190:191], v25 offset:5312
    s_add_u32 s72, s75, 12288
    buffer_load_dwordx4 a[128:131], v254, s[20:23], s72 offen offset:0 sc1
    v_exp_f32 v41, v41
    v_exp_f32 v42, v42
    v_exp_f32 v43, v43
    v_exp_f32 v44, v44
    v_mfma_f32_16x16x32_bf16 v[216:219], a[168:171], v[72:75], v[216:219]
    ds_read_b64_tr_b16 a[180:181], v26 offset:20608
    v_exp_f32 v45, v45
    v_exp_f32 v46, v46
    v_exp_f32 v47, v47
    s_waitcnt lgkmcnt(5)
    v_mfma_f32_16x16x32_bf16 v[212:215], a[196:199], v[64:67], v[212:215]
    ds_read_b64_tr_b16 a[182:183], v26 offset:20736
    v_cvt_pk_bf16_f32 v32, v32, v33
    v_cvt_pk_bf16_f32 v33, v34, v35
    v_cvt_pk_bf16_f32 v34, v36, v37
    v_mfma_f32_16x16x32_bf16 v[220:223], a[196:199], v[72:75], v[220:223]
    v_cvt_pk_bf16_f32 v35, v38, v39
    v_cvt_pk_bf16_f32 v40, v40, v41
    v_cvt_pk_bf16_f32 v41, v42, v43
    v_cvt_pk_bf16_f32 v42, v44, v45
    v_cvt_pk_bf16_f32 v43, v46, v47
    s_waitcnt lgkmcnt(0)
    v_mfma_f32_16x16x32_bf16 v[64:67], a[184:187], v[8:11], v[20:23]
    ds_read_b64_tr_b16 a[168:169], v26 offset:2048
L_w10:
    s_cbranch_execz L_wret2
    v_exp_f32 v48, v48
    v_exp_f32_e64 v49, v49
    v_mfma_f32_16x16x32_bf16 v[72:75], a[184:187], v[12:15], 0
    ds_read_b64_tr_b16 a[170:171], v26 offset:2176
    v_exp_f32 v50, v50
    v_exp_f32 v51, v51
    v_exp_f32_e64 v56, v56
    v_mfma_f32_16x16x32_bf16 v[76:79], a[188:191], v[12:15], v[20:23]
    ds_read_b64_tr_b16 a[192:193], v27 offset:2048
    v_exp_f32 v57, v57
    v_exp_f32 v58, v58
    v_exp_f32_e64 v59, v59
    v_mfma_f32_16x16x32_bf16 v[224:227], a[180:183], v[32:35], v[224:227]
    ds_read_b64_tr_b16 a[194:195], v27 offset:2176
    buffer_load_dwordx4 a[132:135], v254, s[20:23], s72 offen offset:1024 sc1
    v_exp_f32 v60, v60
    v_exp_f32 v61, v61
    v_mfma_f32_16x16x32_bf16 v[232:235], a[180:183], v[40:43], v[232:235]
    v_exp_f32 v62, v62
    v_exp_f32 v63, v63
    v_cvt_pk_bf16_f32 v48, v48, v49
    v_mfma_f32_16x16x32_bf16 v[228:231], a[196:199], v[32:35], v[228:231]
    v_cvt_pk_bf16_f32 v49, v50, v51
    v_mov_b32 v50, 0
    v_mov_b32 v51, 0
    v_mfma_f32_16x16x32_bf16 v[236:239], a[196:199], v[40:43], v[236:239]
    v_cvt_pk_bf16_f32 v56, v56, v57
    v_cvt_pk_bf16_f32 v57, v58, v59
    v_cvt_pk_bf16_f32 v58, v60, v61
    v_cvt_pk_bf16_f32 v59, v62, v63
    s_waitcnt lgkmcnt(0)
    v_mfma_f32_16x16x32_bf16 v[208:211], a[168:171], v[48:51], v[208:211]
    ds_read_b64_tr_b16 a[172:173], v26 offset:20864
    v_exp_f32 v64, v64
    v_exp_f32 v65, v65
    v_exp_f32 v66, v66
    v_exp_f32_e64 v67, v67
    v_mfma_f32_16x16x32_bf16 v[216:219], a[168:171], v[56:59], v[216:219]
    ds_read_b64_tr_b16 a[174:175], v26 offset:20992
    v_exp_f32 v72, v72
    v_exp_f32 v73, v73
    v_exp_f32 v74, v74
    v_exp_f32 v75, v75
    v_exp_f32_e64 v76, v76
    v_mfma_f32_16x16x32_bf16 v[212:215], a[192:195], v[48:51], v[212:215]
    v_exp_f32 v77, v77
    v_exp_f32 v78, v78
    v_exp_f32_e64 v79, v79
    v_cvt_pk_bf16_f32 v64, v64, v65
    v_cvt_pk_bf16_f32 v65, v66, v67
    v_mfma_f32_16x16x32_bf16 v[220:223], a[192:195], v[56:59], v[220:223]
    buffer_load_dwordx4 a[136:139], v254, s[20:23], s72 offen offset:2048 sc1
    v_mov_b32 v66, 0
    v_mov_b32 v67, 0
    v_cvt_pk_bf16_f32 v72, v72, v73
    v_cvt_pk_bf16_f32 v73, v74, v75
    v_cvt_pk_bf16_f32 v74, v76, v77
    v_cvt_pk_bf16_f32 v75, v78, v79
    s_nop 1
    s_waitcnt lgkmcnt(0)
    v_mfma_f32_16x16x32_bf16 v[224:227], a[172:175], v[64:67], v[224:227]
    v_mfma_f32_16x16x32_bf16 v[232:235], a[172:175], v[72:75], v[232:235]
    v_mfma_f32_16x16x32_bf16 v[228:231], a[192:195], v[64:67], v[228:231]
    buffer_load_dwordx4 a[140:143], v254, s[20:23], s72 offen offset:3072 sc1
    v_mfma_f32_16x16x32_bf16 v[236:239], a[192:195], v[72:75], v[236:239]
    s_add_u32 s72, s75, 16384
    buffer_load_dwordx4 a[144:147], v254, s[20:23], s72 offen offset:0 sc1
    buffer_load_dwordx4 a[148:151], v254, s[20:23], s72 offen offset:1024 sc1
    s_nop 7
    v_mov_b32 v84, v212
    v_mov_b32 v88, v212
    v_mov_b32 v85, v220
    v_mov_b32 v89, v220
    v_mov_b32 v86, v228
    v_mov_b32 v90, v228
    v_mov_b32 v87, v236
    v_mov_b32_e64 v91, v236
    s_nop 1
    v_permlane16_swap_b32 v88, v84
    v_permlane16_swap_b32 v89, v85
    v_permlane16_swap_b32 v90, v86
    v_permlane16_swap_b32 v91, v87
    s_nop 0
    v_min3_f32 v88, v84, v85, v86
    v_add_f32 v89, v84, v85
    v_add_f32 v90, v86, v87
    v_min_f32 v88, v88, v87
    v_add_f32 v89, v89, v90
    v_cmp_nle_f32 vcc, 0x2b800000, v88
    s_mov_b64 s[68:69], vcc
    v_cmp_nge_f32 vcc, 0x53800000, v89
    s_nop 0
    s_or_b64 vcc, vcc, s[68:69]
    s_cbranch_scc1 L_Tslow
L_Tnorm:
    v_mul_f32 v84, 0x3f154857, v84
    v_mul_f32 v85, 0x3f154857, v85
    v_mul_f32 v86, 0x3f154857, v86
    v_mul_f32 v87, 0x3f154857, v87
    v_rcp_f32 v84, v84
    v_rcp_f32 v85, v85
    v_rcp_f32 v86, v86
    v_rcp_f32 v87, v87
    v_add_u32 v29, -1, v28
    v_ashrrev_i32 v29, 31, v29
    s_add_u32 s72, s74, 18432
    v_mul_f32 v208, v84, v208
    v_mul_f32 v209, v84, v209
    v_mul_f32 v210, v84, v210
    v_mul_f32 v211, v84, v211
    v_mul_f32 v212, v84, v212
    v_mul_f32 v213, v84, v213
    v_mul_f32 v224, v86, v224
    v_mul_f32 v225, v86, v225
    v_mul_f32 v226, v86, v226
    v_mul_f32 v227, v86, v227
    v_mul_f32 v230, v86, v230
    v_mul_f32 v231, v86, v231
    v_cvt_pk_bf16_f32 v92, v212, v213
    v_cvt_pk_bf16_f32 v93, v230, v231
    v_cvt_pk_bf16_f32 v208, v208, v209
    v_cvt_pk_bf16_f32 v209, v210, v211
    v_cvt_pk_bf16_f32 v210, v224, v225
    v_cvt_pk_bf16_f32 v211, v226, v227
    v_and_b32 v92, v29, v92
    v_and_b32 v93, v29, v93
    buffer_store_dwordx4 v[208:211], v254, s[20:23], s72 offen offset:0 sc1
    v_mul_f32 v216, v85, v216
    v_mul_f32 v217, v85, v217
    v_mul_f32 v218, v85, v218
    v_mul_f32 v219, v85, v219
    v_mul_f32 v220, v85, v220
    v_mul_f32 v221, v85, v221
    v_mul_f32 v232, v87, v232
    v_mul_f32 v233, v87, v233
    v_mul_f32 v234, v87, v234
    v_mul_f32 v235, v87, v235
    v_mul_f32 v238, v87, v238
    v_mul_f32 v239, v87, v239
    v_cvt_pk_bf16_f32 v94, v220, v221
    v_cvt_pk_bf16_f32 v95, v238, v239
    v_cvt_pk_bf16_f32 v216, v216, v217
    v_cvt_pk_bf16_f32 v217, v218, v219
    v_cvt_pk_bf16_f32 v218, v232, v233
    v_cvt_pk_bf16_f32 v219, v234, v235
    v_and_b32 v94, v29, v94
    v_and_b32 v95, v29, v95
    buffer_store_dwordx4 v[216:219], v254, s[20:23], s72 offen offset:1024 sc1
    buffer_store_dwordx4 v[92:95], v254, s[20:23], s72 offen offset:2048 sc1
    v_accvgpr_write_b32 a72, v208
    v_accvgpr_write_b32 a73, v209
    v_accvgpr_write_b32 a74, v210
    v_accvgpr_write_b32 a75, v211
    v_accvgpr_write_b32 a160, v92
    v_accvgpr_write_b32 a161, v93
    s_barrier
    ds_read_b64_tr_b16 a[168:169], v240 offset:24704
    ds_read_b64_tr_b16 a[170:171], v240 offset:24960
    ds_read_b64_tr_b16 a[172:173], v240 offset:24736
    ds_read_b64_tr_b16 a[174:175], v240 offset:24992
    ds_read_b64_tr_b16 a[176:177], v240 offset:25216
    ds_read_b64_tr_b16 a[178:179], v240 offset:25472
    ds_read_b64_tr_b16 a[180:181], v240 offset:25248
    ds_read_b64_tr_b16 a[182:183], v240 offset:25504
    ds_read_b64_tr_b16 a[184:185], v240 offset:25728
    ds_read_b64_tr_b16 a[186:187], v240 offset:25984
    ds_read_b64_tr_b16 a[188:189], v240 offset:25760
    ds_read_b64_tr_b16 a[190:191], v240 offset:26016
    ds_read_b64_tr_b16 a[192:193], v240 offset:26752
    ds_read_b64_tr_b16 a[194:195], v240 offset:27008
    s_waitcnt lgkmcnt(10)
    v_mfma_f32_16x16x32_bf16 v[176:179], a[168:171], a[0:3], 0
    ds_read_b64_tr_b16 a[196:197], v240 offset:26784
    s_add_u32 m0, s64, 98816
    v_mfma_f32_16x16x32_bf16 v[180:183], a[168:171], a[4:7], 0
    ds_read_b64_tr_b16 a[198:199], v240 offset:27040
    buffer_load_dwordx4 v246, s[16:19], s90 offen offset:0 lds
    v_mfma_f32_16x16x32_bf16 v[184:187], a[172:175], a[0:3], 0
    ds_read_b64_tr_b16 a[168:169], v240 offset:27264
    v_accvgpr_write_b32 a76, v216
    v_mfma_f32_16x16x32_bf16 v[188:191], a[172:175], a[4:7], 0
    ds_read_b64_tr_b16 a[170:171], v240 offset:27520
    s_waitcnt lgkmcnt(8)
    v_mfma_f32_16x16x32_bf16 v[192:195], a[176:179], a[0:3], 0
    ds_read_b64_tr_b16 a[172:173], v240 offset:27296
    v_accvgpr_write_b32 a77, v217
    v_mfma_f32_16x16x32_bf16 v[196:199], a[176:179], a[4:7], 0
    ds_read_b64_tr_b16 a[174:175], v240 offset:27552
    v_accvgpr_write_b32 a78, v218
    v_mfma_f32_16x16x32_bf16 v[200:203], a[180:183], a[0:3], 0
    ds_read_b64_tr_b16 a[176:177], v240 offset:27776
    v_accvgpr_write_b32 a79, v219
    v_mfma_f32_16x16x32_bf16 v[204:207], a[180:183], a[4:7], 0
    ds_read_b64_tr_b16 a[178:179], v240 offset:28032
    buffer_load_dwordx4 v244, s[16:19], s90 offen offset:1024 lds
    v_mfma_f32_16x16x32_bf16 v[144:147], a[184:187], a[0:3], 0
    ds_read_b64_tr_b16 a[180:181], v240 offset:27808
    v_accvgpr_write_b32 a164, v94
    v_mfma_f32_16x16x32_bf16 v[148:151], a[184:187], a[4:7], 0
    ds_read_b64_tr_b16 a[182:183], v240 offset:28064
    s_waitcnt lgkmcnt(8)
    v_mfma_f32_16x16x32_bf16 v[152:155], a[188:191], a[0:3], 0
    ds_read_b64_tr_b16 a[184:185], v240 offset:28800
    v_accvgpr_write_b32 a165, v95
    v_mfma_f32_16x16x32_bf16 v[156:159], a[188:191], a[4:7], 0
    ds_read_b64_tr_b16 a[186:187], v240 offset:29056
    v_mfma_f32_16x16x32_bf16 v[176:179], a[192:195], a[8:11], v[176:179]
    ds_read_b64_tr_b16 a[188:189], v240 offset:28832
    v_bfe_u32 v136, v254, 4, 4
    v_mfma_f32_16x16x32_bf16 v[180:183], a[192:195], a[12:15], v[180:183]
    ds_read_b64_tr_b16 a[190:191], v240 offset:29088
    buffer_load_dwordx4 v248, s[16:19], s100 offen offset:2048 lds
    v_mfma_f32_16x16x32_bf16 v[184:187], a[196:199], a[8:11], v[184:187]
    ds_read_b64_tr_b16 a[192:193], v240 offset:29312
    s_add_u32 m0, s64, 101888
    v_mfma_f32_16x16x32_bf16 v[188:191], a[196:199], a[12:15], v[188:191]
    ds_read_b64_tr_b16 a[194:195], v240 offset:29568
    s_waitcnt lgkmcnt(8)
    v_mfma_f32_16x16x32_bf16 v[192:195], a[168:171], a[8:11], v[192:195]
    ds_read_b64_tr_b16 a[196:197], v240 offset:29344
    v_lshrrev_b32 v137, 8, v254
    v_mfma_f32_16x16x32_bf16 v[196:199], a[168:171], a[12:15], v[196:199]
    ds_read_b64_tr_b16 a[198:199], v240 offset:29600
    v_mul_u32_u24 v134, 221184, v137
    v_mfma_f32_16x16x32_bf16 v[200:203], a[172:175], a[8:11], v[200:203]
    ds_read_b64_tr_b16 a[168:169], v240 offset:29824
    v_lshl_add_u32 v134, v136, 4, v134
    v_mfma_f32_16x16x32_bf16 v[204:207], a[172:175], a[12:15], v[204:207]
    ds_read_b64_tr_b16 a[170:171], v240 offset:30080
    buffer_load_dwordx4 v243, s[16:19], s100 offen offset:0 lds
    v_mfma_f32_16x16x32_bf16 v[144:147], a[176:179], a[8:11], v[144:147]
    ds_read_b64_tr_b16 a[172:173], v240 offset:29856
    s_lshl_b32 s59, s65, 8
    v_mfma_f32_16x16x32_bf16 v[148:151], a[176:179], a[12:15], v[148:151]
    ds_read_b64_tr_b16 a[174:175], v240 offset:30112
    s_waitcnt lgkmcnt(8)
    v_mfma_f32_16x16x32_bf16 v[152:155], a[180:183], a[8:11], v[152:155]
    s_barrier
    ds_read_b64_tr_b16 a[176:177], v241 offset:0
    v_mfma_f32_16x16x32_bf16 v[156:159], a[180:183], a[12:15], v[156:159]
    ds_read_b64_tr_b16 a[178:179], v241 offset:256
    s_add_u32 s59, s59, s79
    v_mfma_f32_16x16x32_bf16 v[176:179], a[184:187], a[16:19], v[176:179]
    ds_read_b64_tr_b16 a[180:181], v241 offset:32
    s_add_u32 s59, s59, 16384
    v_mfma_f32_16x16x32_bf16 v[180:183], a[184:187], a[20:23], v[180:183]
    ds_read_b64_tr_b16 a[182:183], v241 offset:288
    buffer_load_dwordx4 v247, s[16:19], s91 offen offset:1024 lds
    v_mfma_f32_16x16x32_bf16 v[184:187], a[188:191], a[16:19], v[184:187]
    ds_read_b64_tr_b16 a[184:185], v241 offset:512
    v_mul_u32_u24 v135, 1152, v136
    v_mfma_f32_16x16x32_bf16 v[188:191], a[188:191], a[20:23], v[188:191]
    ds_read_b64_tr_b16 a[186:187], v241 offset:768
    s_waitcnt lgkmcnt(8)
    v_mfma_f32_16x16x32_bf16 v[192:195], a[192:195], a[16:19], v[192:195]
    ds_read_b64_tr_b16 a[188:189], v241 offset:544
    v_lshl_add_u32 v135, v137, 5, v135
    v_mfma_f32_16x16x32_bf16 v[196:199], a[192:195], a[20:23], v[196:199]
    ds_read_b64_tr_b16 a[190:191], v241 offset:800
    v_lshrrev_b32 v138, 1, v137
    v_mfma_f32_16x16x32_bf16 v[200:203], a[196:199], a[16:19], v[200:203]
    ds_read_b64_tr_b16 a[192:193], v241 offset:1024
    v_lshl_add_u32 v135, v138, 29, v135
    v_mfma_f32_16x16x32_bf16 v[204:207], a[196:199], a[20:23], v[204:207]
    ds_read_b64_tr_b16 a[194:195], v241 offset:1280
    buffer_load_dwordx4 v245, s[16:19], s91 offen offset:2048 lds
    v_mfma_f32_16x16x32_bf16 v[144:147], a[168:171], a[16:19], v[144:147]
    ds_read_b64_tr_b16 a[196:197], v241 offset:1056
    s_add_u32 m0, s64, 123520
    v_mfma_f32_16x16x32_bf16 v[148:151], a[168:171], a[20:23], v[148:151]
    ds_read_b64_tr_b16 a[198:199], v241 offset:1312
    s_waitcnt lgkmcnt(8)
    v_mfma_f32_16x16x32_bf16 v[152:155], a[172:175], a[16:19], v[152:155]
    ds_read_b64_tr_b16 a[168:169], v241 offset:2048
    s_lshr_b32 s69, s65, 2
    v_mfma_f32_16x16x32_bf16 v[156:159], a[172:175], a[20:23], v[156:159]
    ds_read_b64_tr_b16 a[170:171], v241 offset:2304
    s_mul_i32 s52, s69, 18432
    v_mfma_f32_16x16x32_bf16 v[176:179], a[176:179], a[24:27], v[176:179]
    ds_read_b64_tr_b16 a[172:173], v241 offset:2080
    s_and_b32 s69, s65, 3
    v_mfma_f32_16x16x32_bf16 v[180:183], a[176:179], a[28:31], v[180:183]
    ds_read_b64_tr_b16 a[174:175], v241 offset:2336
    buffer_load_dwordx4 v246, s[16:19], s101 offen offset:0 lds
    v_mfma_f32_16x16x32_bf16 v[184:187], a[180:183], a[24:27], v[184:187]
    ds_read_b64_tr_b16 a[176:177], v241 offset:2560
    s_lshl_b32 s69, s69, 3
    v_mfma_f32_16x16x32_bf16 v[188:191], a[180:183], a[28:31], v[188:191]
    ds_read_b64_tr_b16 a[178:179], v241 offset:2816
    s_waitcnt lgkmcnt(8)
    v_mfma_f32_16x16x32_bf16 v[192:195], a[184:187], a[24:27], v[192:195]
    ds_read_b64_tr_b16 a[180:181], v241 offset:2592
    s_add_u32 s52, s52, s69
    v_mfma_f32_16x16x32_bf16 v[196:199], a[184:187], a[28:31], v[196:199]
    ds_read_b64_tr_b16 a[182:183], v241 offset:2848
    s_add_u32 s52, s52, s40
    v_mfma_f32_16x16x32_bf16 v[200:203], a[188:191], a[24:27], v[200:203]
    ds_read_b64_tr_b16 a[184:185], v241 offset:3072
    s_add_u32 s52, s52, s71
    v_mfma_f32_16x16x32_bf16 v[204:207], a[188:191], a[28:31], v[204:207]
    ds_read_b64_tr_b16 a[186:187], v241 offset:3328
    buffer_load_dwordx4 v244, s[16:19], s101 offen offset:1024 lds
    v_mfma_f32_16x16x32_bf16 v[144:147], a[192:195], a[24:27], v[144:147]
    ds_read_b64_tr_b16 a[188:189], v241 offset:3104
    s_add_u32 s45, s3, 1024
    v_mfma_f32_16x16x32_bf16 v[148:151], a[192:195], a[28:31], v[148:151]
    ds_read_b64_tr_b16 a[190:191], v241 offset:3360
    s_waitcnt lgkmcnt(8)
    v_mfma_f32_16x16x32_bf16 v[152:155], a[196:199], a[24:27], v[152:155]
    ds_read_b64_tr_b16 a[192:193], v241 offset:4096
    v_and_b32 v138, 1, v136
    v_mfma_f32_16x16x32_bf16 v[156:159], a[196:199], a[28:31], v[156:159]
    ds_read_b64_tr_b16 a[194:195], v241 offset:4352
    v_lshlrev_b32_e64 v138, 4, v138
    v_mfma_f32_16x16x32_bf16 v[176:179], a[168:171], a[32:35], v[176:179]
    ds_read_b64_tr_b16 a[196:197], v241 offset:4128
    v_mov_b32 v139, 0x3f80
    v_mfma_f32_16x16x32_bf16 v[180:183], a[168:171], a[36:39], v[180:183]
    ds_read_b64_tr_b16 a[198:199], v241 offset:4384
    buffer_load_dwordx4 v248, s[16:19], s92 offen offset:2048 lds
    v_mfma_f32_16x16x32_bf16 v[184:187], a[172:175], a[32:35], v[184:187]
    ds_read_b64_tr_b16 a[168:169], v241 offset:4608
    s_add_u32 m0, s64, 126592
    v_mfma_f32_16x16x32_bf16 v[188:191], a[172:175], a[36:39], v[188:191]
    ds_read_b64_tr_b16 a[170:171], v241 offset:4864
    s_waitcnt lgkmcnt(8)
    v_mfma_f32_16x16x32_bf16 v[192:195], a[176:179], a[32:35], v[192:195]
    ds_read_b64_tr_b16 a[172:173], v241 offset:4640
    v_lshlrev_b32 v139, v138, v139
    v_mfma_f32_16x16x32_bf16 v[196:199], a[176:179], a[36:39], v[196:199]
    ds_read_b64_tr_b16 a[174:175], v241 offset:4896
    v_lshrrev_b32_e64 v138, 1, v136
    v_mfma_f32_16x16x32_bf16 v[200:203], a[180:183], a[32:35], v[200:203]
    ds_read_b64_tr_b16 a[176:177], v241 offset:5120
    v_cmp_eq_u32 vcc, 0, v138
    v_mfma_f32_16x16x32_bf16 v[204:207], a[180:183], a[36:39], v[204:207]
    ds_read_b64_tr_b16 a[178:179], v241 offset:5376
    buffer_load_dwordx4 v243, s[16:19], s92 offen offset:0 lds
    v_mfma_f32_16x16x32_bf16 v[144:147], a[184:187], a[32:35], v[144:147]
    ds_read_b64_tr_b16 a[180:181], v241 offset:5152
    v_cndmask_b32 v120, 0, v139, vcc
    v_mfma_f32_16x16x32_bf16 v[148:151], a[184:187], a[36:39], v[148:151]
    ds_read_b64_tr_b16 a[182:183], v241 offset:5408
    s_waitcnt lgkmcnt(8)
    v_mfma_f32_16x16x32_bf16 v[152:155], a[188:191], a[32:35], v[152:155]
    s_barrier
    ds_read_b64_tr_b16 a[184:185], v241 offset:24704
    v_mfma_f32_16x16x32_bf16 v[156:159], a[188:191], a[36:39], v[156:159]
    ds_read_b64_tr_b16 a[186:187], v241 offset:24960
    v_cmp_eq_u32 vcc, 1, v138
    v_mfma_f32_16x16x32_bf16 v[176:179], a[192:195], a[40:43], v[176:179]
    ds_read_b64_tr_b16 a[188:189], v241 offset:24736
    v_cndmask_b32 v121, 0, v139, vcc
    v_mfma_f32_16x16x32_bf16 v[180:183], a[192:195], a[44:47], v[180:183]
    ds_read_b64_tr_b16 a[190:191], v241 offset:24992
    buffer_load_dwordx4 v247, s[16:19], s77 offen offset:1024 lds
    v_mfma_f32_16x16x32_bf16 v[184:187], a[196:199], a[40:43], v[184:187]
    ds_read_b64_tr_b16 a[192:193], v241 offset:25216
    v_cmp_eq_u32 vcc, 2, v138
    v_mfma_f32_16x16x32_bf16 v[188:191], a[196:199], a[44:47], v[188:191]
    ds_read_b64_tr_b16 a[194:195], v241 offset:25472
    s_waitcnt lgkmcnt(8)
    v_mfma_f32_16x16x32_bf16 v[192:195], a[168:171], a[40:43], v[192:195]
    ds_read_b64_tr_b16 a[196:197], v241 offset:25248
    v_cndmask_b32_e64 v122, 0, v139, vcc
    v_mfma_f32_16x16x32_bf16 v[196:199], a[168:171], a[44:47], v[196:199]
    ds_read_b64_tr_b16 a[198:199], v241 offset:25504
    v_cmp_eq_u32 vcc, 3, v138
    v_mfma_f32_16x16x32_bf16 v[200:203], a[172:175], a[40:43], v[200:203]
    ds_read_b64_tr_b16 a[168:169], v241 offset:25728
    v_cndmask_b32 v123, 0, v139, vcc
    v_mfma_f32_16x16x32_bf16 v[204:207], a[172:175], a[44:47], v[204:207]
    ds_read_b64_tr_b16 a[170:171], v241 offset:25984
    buffer_load_dwordx4 v245, s[16:19], s77 offen offset:2048 lds
    v_mfma_f32_16x16x32_bf16 v[144:147], a[176:179], a[40:43], v[144:147]
    ds_read_b64_tr_b16 a[172:173], v241 offset:25760
    s_add_u32 m0, s64, 24704
    v_mfma_f32_16x16x32_bf16 v[148:151], a[176:179], a[44:47], v[148:151]
    ds_read_b64_tr_b16 a[174:175], v241 offset:26016
    s_waitcnt lgkmcnt(8)
    v_mfma_f32_16x16x32_bf16 v[152:155], a[180:183], a[40:43], v[152:155]
    ds_read_b64_tr_b16 a[176:177], v241 offset:26752
    v_accvgpr_read_b32 v132, a236
    v_mfma_f32_16x16x32_bf16 v[156:159], a[180:183], a[44:47], v[156:159]
    ds_read_b64_tr_b16 a[178:179], v241 offset:27008
    v_accvgpr_read_b32 v133, a237
    v_mfma_f32_16x16x32_bf16 v[176:179], a[184:187], a[48:51], v[176:179]
    ds_read_b64_tr_b16 a[180:181], v241 offset:26784
    v_accvgpr_read_b32 v252, a218
    v_mfma_f32_16x16x32_bf16 v[180:183], a[184:187], a[52:55], v[180:183]
    ds_read_b64_tr_b16 a[182:183], v241 offset:27040
    buffer_load_dwordx4 v246, s[16:19], s93 offen offset:0 lds
    v_mfma_f32_16x16x32_bf16 v[184:187], a[188:191], a[48:51], v[184:187]
    ds_read_b64_tr_b16 a[184:185], v241 offset:27264
    s_lshl_b32 s54, s65, 11
    v_mfma_f32_16x16x32_bf16 v[188:191], a[188:191], a[52:55], v[188:191]
    ds_read_b64_tr_b16 a[186:187], v241 offset:27520
    s_waitcnt lgkmcnt(8)
    v_mfma_f32_16x16x32_bf16 v[192:195], a[192:195], a[48:51], v[192:195]
    ds_read_b64_tr_b16 a[188:189], v241 offset:27296
    s_add_u32 s54, s54, s79
    v_mfma_f32_16x16x32_bf16 v[196:199], a[192:195], a[52:55], v[196:199]
    ds_read_b64_tr_b16 a[190:191], v241 offset:27552
    s_and_b32 s69, s57, 1
    v_mfma_f32_16x16x32_bf16 v[200:203], a[196:199], a[48:51], v[200:203]
    ds_read_b64_tr_b16 a[192:193], v241 offset:27776
    s_mul_i32 s69, s69, 640
    v_mfma_f32_16x16x32_bf16 v[204:207], a[196:199], a[52:55], v[204:207]
    ds_read_b64_tr_b16 a[194:195], v241 offset:28032
    buffer_load_dwordx4 v244, s[16:19], s93 offen offset:1024 lds
    v_mfma_f32_16x16x32_bf16 v[144:147], a[168:171], a[48:51], v[144:147]
    ds_read_b64_tr_b16 a[196:197], v241 offset:27808
    s_waitcnt vmcnt(14)
    v_accvgpr_read_b32 v249, a211
    v_mov_b32_e64 v250, s51
    buffer_store_dword v250, v249, s[20:23], 0 offen offset:4 sc1
    v_mfma_f32_16x16x32_bf16 v[148:151], a[168:171], a[52:55], v[148:151]
    ds_read_b64_tr_b16 a[198:199], v241 offset:28064
    s_waitcnt lgkmcnt(8)
    v_mfma_f32_16x16x32_bf16 v[152:155], a[172:175], a[48:51], v[152:155]
    ds_read_b64_tr_b16 a[168:169], v241 offset:28800
    v_accvgpr_read_b32 v248, a203
    v_mfma_f32_16x16x32_bf16 v[156:159], a[172:175], a[52:55], v[156:159]
    ds_read_b64_tr_b16 a[170:171], v241 offset:29056
    v_add_u32 v248, s42, v248
    v_mfma_f32_16x16x32_bf16 v[176:179], a[176:179], a[56:59], v[176:179]
    ds_read_b64_tr_b16 a[172:173], v241 offset:28832
    v_add_u32 v246, 2048, v248
    v_mfma_f32_16x16x32_bf16 v[180:183], a[176:179], a[60:63], v[180:183]
    ds_read_b64_tr_b16 a[174:175], v241 offset:29088
    v_add_u32 v247, 1024, v248
    v_mfma_f32_16x16x32_bf16 v[184:187], a[180:183], a[56:59], v[184:187]
    ds_read_b64_tr_b16 a[176:177], v241 offset:29312
    buffer_load_dwordx4 v248, s[16:19], s84 offen offset:2048 lds
    v_mfma_f32_16x16x32_bf16 v[188:191], a[180:183], a[60:63], v[188:191]
    ds_read_b64_tr_b16 a[178:179], v241 offset:29568
    s_waitcnt lgkmcnt(8)
    v_mfma_f32_16x16x32_bf16 v[192:195], a[184:187], a[56:59], v[192:195]
    ds_read_b64_tr_b16 a[180:181], v241 offset:29344
    s_add_u32 m0, s64, 27776
    v_mfma_f32_16x16x32_bf16 v[196:199], a[184:187], a[60:63], v[196:199]
    ds_read_b64_tr_b16 a[182:183], v241 offset:29600
    s_lshl_b32 s70, s65, 6
    v_mfma_f32_16x16x32_bf16 v[200:203], a[188:191], a[56:59], v[200:203]
    ds_read_b64_tr_b16 a[184:185], v241 offset:29824
    s_add_u32 s69, s69, s70
    v_mfma_f32_16x16x32_bf16 v[204:207], a[188:191], a[60:63], v[204:207]
    ds_read_b64_tr_b16 a[186:187], v241 offset:30080
    s_add_u32 s49, s69, s71
    v_mfma_f32_16x16x32_bf16 v[144:147], a[192:195], a[56:59], v[144:147]
    ds_read_b64_tr_b16 a[188:189], v241 offset:29856
    buffer_load_dwordx4 v246, s[16:19], s24 offen offset:0 lds
    v_mfma_f32_16x16x32_bf16 v[148:151], a[192:195], a[60:63], v[148:151]
    ds_read_b64_tr_b16 a[190:191], v241 offset:30112
    s_waitcnt lgkmcnt(8)
    v_mfma_f32_16x16x32_bf16 v[152:155], a[196:199], a[56:59], v[152:155]
    s_barrier
    ds_read_b64_tr_b16 a[192:193], v240 offset:0
    v_mfma_f32_16x16x32_bf16 v[156:159], a[196:199], a[60:63], v[156:159]
    ds_read_b64_tr_b16 a[194:195], v240 offset:256
    s_add_u32 s50, s49, 18432
    v_mfma_f32_16x16x32_bf16 v[176:179], a[168:171], a[64:67], v[176:179]
    ds_read_b64_tr_b16 a[196:197], v240 offset:32
    s_lshr_b32 s48, s65, 1
    v_mfma_f32_16x16x32_bf16 v[180:183], a[168:171], a[68:71], v[180:183]
    ds_read_b64_tr_b16 a[198:199], v240 offset:288
    s_lshl_b32 s48, s48, 8
    v_mfma_f32_16x16x32_bf16 v[184:187], a[172:175], a[64:67], v[184:187]
    ds_read_b64_tr_b16 a[168:169], v240 offset:512
    buffer_load_dwordx4 v247, s[16:19], s85 offen offset:1024 lds
    v_mfma_f32_16x16x32_bf16 v[188:191], a[172:175], a[68:71], v[188:191]
    ds_read_b64_tr_b16 a[170:171], v240 offset:768
    s_waitcnt lgkmcnt(8)
    v_mfma_f32_16x16x32_bf16 v[192:195], a[176:179], a[64:67], v[192:195]
    ds_read_b64_tr_b16 a[172:173], v240 offset:544
    s_add_u32 s48, s48, s3
    v_mfma_f32_16x16x32_bf16 v[196:199], a[176:179], a[68:71], v[196:199]
    ds_read_b64_tr_b16 a[174:175], v240 offset:800
    s_add_u32 s55, s74, 21504
    v_mfma_f32_16x16x32_bf16 v[200:203], a[180:183], a[64:67], v[200:203]
    ds_read_b64_tr_b16 a[176:177], v240 offset:1024
    s_xor_b32 s70, s65, 1
    v_mfma_f32_16x16x32_bf16 v[204:207], a[180:183], a[68:71], v[204:207]
    ds_read_b64_tr_b16 a[178:179], v240 offset:1280
    s_sub_u32 s70, s70, s65
    v_mfma_f32_16x16x32_bf16 v[144:147], a[184:187], a[64:67], v[144:147]
    ds_read_b64_tr_b16 a[180:181], v240 offset:1056
    buffer_load_dwordx4 v248, s[16:19], s25 offen offset:2048 lds
    v_mfma_f32_16x16x32_bf16 v[148:151], a[184:187], a[68:71], v[148:151]
    ds_read_b64_tr_b16 a[182:183], v240 offset:1312
    s_waitcnt lgkmcnt(8)
    v_mfma_f32_16x16x32_bf16 v[152:155], a[188:191], a[64:67], v[152:155]
    ds_read_b64_tr_b16 a[184:185], v240 offset:2048
    s_add_u32 m0, s64, 49408
    v_mfma_f32_16x16x32_bf16 v[156:159], a[188:191], a[68:71], v[156:159]
    ds_read_b64_tr_b16 a[186:187], v240 offset:2304
    s_mul_i32 s70, s70, 221184
    v_mfma_f32_16x16x32_bf16 v[176:179], a[192:195], a[72:75], v[176:179]
    ds_read_b64_tr_b16 a[188:189], v240 offset:2080
    s_add_u32 s62, s70, s55
    v_mfma_f32_16x16x32_bf16 v[180:183], a[192:195], a[76:79], v[180:183]
    ds_read_b64_tr_b16 a[190:191], v240 offset:2336
    s_add_u32 s60, s74, 23552
    v_mfma_f32_16x16x32_bf16 v[184:187], a[196:199], a[72:75], v[184:187]
    ds_read_b64_tr_b16 a[192:193], v240 offset:2560
    buffer_load_dwordx4 v246, s[16:19], s86 offen offset:0 lds
    v_mfma_f32_16x16x32_bf16 v[188:191], a[196:199], a[76:79], v[188:191]
    ds_read_b64_tr_b16 a[194:195], v240 offset:2816
    s_waitcnt lgkmcnt(8)
    v_mfma_f32_16x16x32_bf16 v[192:195], a[168:171], a[72:75], v[192:195]
    ds_read_b64_tr_b16 a[196:197], v240 offset:2592
    s_xor_b32 s70, s65, 2
    v_mfma_f32_16x16x32_bf16 v[196:199], a[168:171], a[76:79], v[196:199]
    ds_read_b64_tr_b16 a[198:199], v240 offset:2848
    s_sub_u32 s70, s70, s65
    v_mfma_f32_16x16x32_bf16 v[200:203], a[172:175], a[72:75], v[200:203]
    ds_read_b64_tr_b16 a[168:169], v240 offset:3072
    s_mul_i32 s70, s70, 221184
    v_mfma_f32_16x16x32_bf16 v[204:207], a[172:175], a[76:79], v[204:207]
    ds_read_b64_tr_b16 a[170:171], v240 offset:3328
    s_add_u32 s63, s70, s60
    v_mfma_f32_16x16x32_bf16 v[144:147], a[176:179], a[72:75], v[144:147]
    ds_read_b64_tr_b16 a[172:173], v240 offset:3104
    buffer_load_dwordx4 v247, s[16:19], s26 offen offset:1024 lds
    v_mfma_f32_16x16x32_bf16 v[148:151], a[176:179], a[76:79], v[148:151]
    ds_read_b64_tr_b16 a[174:175], v240 offset:3360
    s_waitcnt lgkmcnt(8)
    v_mfma_f32_16x16x32_bf16 v[152:155], a[180:183], a[72:75], v[152:155]
    ds_read_b64_tr_b16 a[176:177], v240 offset:4096
    v_accvgpr_read_b32 v253, a205
    v_mfma_f32_16x16x32_bf16 v[156:159], a[180:183], a[76:79], v[156:159]
    ds_read_b64_tr_b16 a[178:179], v240 offset:4352
    v_add_u32 v253, 0, v253
    v_mfma_f32_16x16x32_bf16 v[176:179], a[184:187], a[80:83], v[176:179]
    ds_read_b64_tr_b16 a[180:181], v240 offset:4128
    s_add_u32 s66, s95, s41
    v_mfma_f32_16x16x32_bf16 v[180:183], a[184:187], a[84:87], v[180:183]
    ds_read_b64_tr_b16 a[182:183], v240 offset:4384
    s_add_u32 s61, s74, 25600
    v_mfma_f32_16x16x32_bf16 v[184:187], a[188:191], a[80:83], v[184:187]
    ds_read_b64_tr_b16 a[184:185], v240 offset:4608
    buffer_load_dwordx4 v253, s[28:31], s66 offen offset:2048 lds
    v_mfma_f32_16x16x32_bf16 v[188:191], a[188:191], a[84:87], v[188:191]
    ds_read_b64_tr_b16 a[186:187], v240 offset:4864
    s_waitcnt lgkmcnt(8)
    v_mfma_f32_16x16x32_bf16 v[192:195], a[192:195], a[80:83], v[192:195]
    ds_read_b64_tr_b16 a[188:189], v240 offset:4640
    s_add_u32 m0, s64, 52480
    v_mfma_f32_16x16x32_bf16 v[196:199], a[192:195], a[84:87], v[196:199]
    ds_read_b64_tr_b16 a[190:191], v240 offset:4896
    v_accvgpr_read_b32 v253, a206
    v_mfma_f32_16x16x32_bf16 v[200:203], a[196:199], a[80:83], v[200:203]
    ds_read_b64_tr_b16 a[192:193], v240 offset:5120
    v_add_u32 v253, 2048, v253
    v_mfma_f32_16x16x32_bf16 v[204:207], a[196:199], a[84:87], v[204:207]
    ds_read_b64_tr_b16 a[194:195], v240 offset:5376
    s_add_u32 s66, s95, s40
    v_mfma_f32_16x16x32_bf16 v[144:147], a[168:171], a[80:83], v[144:147]
    ds_read_b64_tr_b16 a[196:197], v240 offset:5152
    buffer_load_dwordx4 v253, s[28:31], s66 offen offset:0 lds
    v_mfma_f32_16x16x32_bf16 v[148:151], a[168:171], a[84:87], v[148:151]
    ds_read_b64_tr_b16 a[198:199], v240 offset:5408
    s_waitcnt lgkmcnt(8)
    v_mfma_f32_16x16x32_bf16 v[152:155], a[172:175], a[80:83], v[152:155]
    s_waitcnt vmcnt(17)
    s_barrier
    ds_read_b64_tr_b16 a[168:169], v242 offset:0
    v_mfma_f32_16x16x32_bf16 v[156:159], a[172:175], a[84:87], v[156:159]
    ds_read_b64_tr_b16 a[170:171], v242 offset:256
    v_accvgpr_read_b32 v253, a207
    v_mfma_f32_16x16x32_bf16 v[176:179], a[176:179], a[88:91], v[176:179]
    ds_read_b64_tr_b16 a[172:173], v242 offset:32
    v_add_u32 v253, 1024, v253
    v_mfma_f32_16x16x32_bf16 v[180:183], a[176:179], a[92:95], v[180:183]
    ds_read_b64_tr_b16 a[174:175], v242 offset:288
    s_xor_b32 s70, s65, 3
    v_mfma_f32_16x16x32_bf16 v[184:187], a[180:183], a[88:91], v[184:187]
    ds_read_b64_tr_b16 a[176:177], v242 offset:512
    buffer_load_dwordx4 v253, s[28:31], s41 offen offset:1024 lds
    v_mfma_f32_16x16x32_bf16 v[188:191], a[180:183], a[92:95], v[188:191]
    ds_read_b64_tr_b16 a[178:179], v242 offset:768
    s_waitcnt lgkmcnt(8)
    v_mfma_f32_16x16x32_bf16 v[192:195], a[184:187], a[88:91], v[192:195]
    ds_read_b64_tr_b16 a[180:181], v242 offset:544
    v_accvgpr_read_b32 v253, a208
    v_mfma_f32_16x16x32_bf16 v[196:199], a[184:187], a[92:95], v[196:199]
    ds_read_b64_tr_b16 a[182:183], v242 offset:800
    v_add_u32_e64 v253, 0, v253
L_w11:
    s_cbranch_execz L_wret2
    v_mfma_f32_16x16x32_bf16 v[200:203], a[188:191], a[88:91], v[200:203]
    ds_read_b64_tr_b16 a[184:185], v242 offset:1024
    s_sub_u32 s70, s70, s65
    v_mfma_f32_16x16x32_bf16 v[204:207], a[188:191], a[92:95], v[204:207]
    ds_read_b64_tr_b16 a[186:187], v242 offset:1280
    s_mul_i32 s70, s70, 221184
    v_mfma_f32_16x16x32_bf16 v[144:147], a[192:195], a[88:91], v[144:147]
    ds_read_b64_tr_b16 a[188:189], v242 offset:1056
    buffer_load_dwordx4 v253, s[28:31], s40 offen offset:2048 lds
    v_mfma_f32_16x16x32_bf16 v[148:151], a[192:195], a[92:95], v[148:151]
    ds_read_b64_tr_b16 a[190:191], v242 offset:1312
    s_waitcnt lgkmcnt(8)
    v_mfma_f32_16x16x32_bf16 v[152:155], a[196:199], a[88:91], v[152:155]
    ds_read_b64_tr_b16 a[192:193], v242 offset:2048
    s_add_u32 m0, s64, 74112
    v_mfma_f32_16x16x32_bf16 v[156:159], a[196:199], a[92:95], v[156:159]
    ds_read_b64_tr_b16 a[194:195], v242 offset:2304
    s_add_u32 s78, s70, s61
    v_mfma_f32_16x16x32_bf16 v[176:179], a[168:171], a[96:99], v[176:179]
    ds_read_b64_tr_b16 a[196:197], v242 offset:2080
    v_mfma_f32_16x16x32_bf16 v[180:183], a[168:171], a[100:103], v[180:183]
    ds_read_b64_tr_b16 a[198:199], v242 offset:2336
    v_mfma_f32_16x16x32_bf16 v[184:187], a[172:175], a[96:99], v[184:187]
    ds_read_b64_tr_b16 a[168:169], v242 offset:2560
    buffer_load_dwordx4 v246, s[16:19], s87 offen offset:0 lds
    v_mfma_f32_16x16x32_bf16 v[188:191], a[172:175], a[100:103], v[188:191]
    ds_read_b64_tr_b16 a[170:171], v242 offset:2816
    s_waitcnt lgkmcnt(8)
    v_mfma_f32_16x16x32_bf16 v[192:195], a[176:179], a[96:99], v[192:195]
    ds_read_b64_tr_b16 a[172:173], v242 offset:2592
    v_mfma_f32_16x16x32_bf16 v[196:199], a[176:179], a[100:103], v[196:199]
    ds_read_b64_tr_b16 a[174:175], v242 offset:2848
    v_mfma_f32_16x16x32_bf16 v[200:203], a[180:183], a[96:99], v[200:203]
    ds_read_b64_tr_b16 a[176:177], v242 offset:3072
    v_mfma_f32_16x16x32_bf16 v[204:207], a[180:183], a[100:103], v[204:207]
    ds_read_b64_tr_b16 a[178:179], v242 offset:3328
    v_mfma_f32_16x16x32_bf16 v[144:147], a[184:187], a[96:99], v[144:147]
    ds_read_b64_tr_b16 a[180:181], v242 offset:3104
    buffer_load_dwordx4 v247, s[16:19], s27 offen offset:1024 lds
    v_mfma_f32_16x16x32_bf16 v[148:151], a[184:187], a[100:103], v[148:151]
    ds_read_b64_tr_b16 a[182:183], v242 offset:3360
    s_waitcnt lgkmcnt(8)
    v_mfma_f32_16x16x32_bf16 v[152:155], a[188:191], a[96:99], v[152:155]
    ds_read_b64_tr_b16 a[184:185], v242 offset:4096
    v_mfma_f32_16x16x32_bf16 v[156:159], a[188:191], a[100:103], v[156:159]
    ds_read_b64_tr_b16 a[186:187], v242 offset:4352
    v_accvgpr_read_b32 v80, a212
    buffer_load_dword v81, v80, s[20:23], 0 offen offset:4 sc1
    v_mfma_f32_16x16x32_bf16 v[176:179], a[192:195], a[104:107], v[176:179]
    ds_read_b64_tr_b16 a[188:189], v242 offset:4128
    v_mfma_f32_16x16x32_bf16 v[180:183], a[192:195], a[108:111], v[180:183]
    ds_read_b64_tr_b16 a[190:191], v242 offset:4384
    v_mfma_f32_16x16x32_bf16 v[184:187], a[196:199], a[104:107], v[184:187]
    ds_read_b64_tr_b16 a[192:193], v242 offset:4608
    buffer_load_dwordx4 v248, s[16:19], s88 offen offset:2048 lds
    v_mfma_f32_16x16x32_bf16 v[188:191], a[196:199], a[108:111], v[188:191]
    ds_read_b64_tr_b16 a[194:195], v242 offset:4864
    s_waitcnt lgkmcnt(8)
    v_mfma_f32_16x16x32_bf16 v[192:195], a[168:171], a[104:107], v[192:195]
    ds_read_b64_tr_b16 a[196:197], v242 offset:4640
    s_add_u32 m0, s64, 77184
    v_mfma_f32_16x16x32_bf16 v[196:199], a[168:171], a[108:111], v[196:199]
    ds_read_b64_tr_b16 a[198:199], v242 offset:4896
    v_accvgpr_read_b32 v253, a205
    v_mfma_f32_16x16x32_bf16 v[200:203], a[172:175], a[104:107], v[200:203]
    ds_read_b64_tr_b16 a[168:169], v242 offset:5120
    v_add_u32 v253, 2048, v253
    v_mfma_f32_16x16x32_bf16 v[204:207], a[172:175], a[108:111], v[204:207]
    ds_read_b64_tr_b16 a[170:171], v242 offset:5376
    s_add_u32 s66, s94, s42
    v_mfma_f32_16x16x32_bf16 v[144:147], a[176:179], a[104:107], v[144:147]
    ds_read_b64_tr_b16 a[172:173], v242 offset:5152
    buffer_load_dwordx4 v253, s[28:31], s66 offen offset:0 lds
    v_mfma_f32_16x16x32_bf16 v[148:151], a[176:179], a[108:111], v[148:151]
    ds_read_b64_tr_b16 a[174:175], v242 offset:5408
    s_waitcnt lgkmcnt(8)
    v_mfma_f32_16x16x32_bf16 v[152:155], a[180:183], a[104:107], v[152:155]
    s_waitcnt vmcnt(18)
    s_barrier
    ds_read_b64_tr_b16 a[176:177], v242 offset:24704
    v_mfma_f32_16x16x32_bf16 v[156:159], a[180:183], a[108:111], v[156:159]
    ds_read_b64_tr_b16 a[178:179], v242 offset:24960
    v_mfma_f32_16x16x32_bf16 v[176:179], a[184:187], a[112:115], v[176:179]
    ds_read_b64_tr_b16 a[180:181], v242 offset:24736
    v_mfma_f32_16x16x32_bf16 v[180:183], a[184:187], a[116:119], v[180:183]
    ds_read_b64_tr_b16 a[182:183], v242 offset:24992
    v_mfma_f32_16x16x32_bf16 v[184:187], a[188:191], a[112:115], v[184:187]
    ds_read_b64_tr_b16 a[184:185], v242 offset:25216
    buffer_load_dwordx4 v247, s[16:19], s89 offen offset:1024 lds
    v_mfma_f32_16x16x32_bf16 v[188:191], a[188:191], a[116:119], v[188:191]
    ds_read_b64_tr_b16 a[186:187], v242 offset:25472
    s_waitcnt lgkmcnt(8)
    v_mfma_f32_16x16x32_bf16 v[192:195], a[192:195], a[112:115], v[192:195]
    ds_read_b64_tr_b16 a[188:189], v242 offset:25248
    v_mfma_f32_16x16x32_bf16 v[196:199], a[192:195], a[116:119], v[196:199]
    ds_read_b64_tr_b16 a[190:191], v242 offset:25504
    v_mfma_f32_16x16x32_bf16 v[200:203], a[196:199], a[112:115], v[200:203]
    ds_read_b64_tr_b16 a[192:193], v242 offset:25728
    v_mfma_f32_16x16x32_bf16 v[204:207], a[196:199], a[116:119], v[204:207]
    ds_read_b64_tr_b16 a[194:195], v242 offset:25984
    v_mfma_f32_16x16x32_bf16 v[144:147], a[168:171], a[112:115], v[144:147]
    ds_read_b64_tr_b16 a[196:197], v242 offset:25760
    buffer_load_dwordx4 v248, s[16:19], s99 offen offset:2048 lds
    v_mfma_f32_16x16x32_bf16 v[148:151], a[168:171], a[116:119], v[148:151]
    ds_read_b64_tr_b16 a[198:199], v242 offset:26016
    s_waitcnt lgkmcnt(8)
    v_mfma_f32_16x16x32_bf16 v[152:155], a[172:175], a[112:115], v[152:155]
    ds_read_b64_tr_b16 a[168:169], v242 offset:26752
    s_add_u32 m0, s64, 0
    v_mfma_f32_16x16x32_bf16 v[156:159], a[172:175], a[116:119], v[156:159]
    ds_read_b64_tr_b16 a[170:171], v242 offset:27008
    v_mfma_f32_16x16x32_bf16 v[176:179], a[176:179], a[120:123], v[176:179]
    ds_read_b64_tr_b16 a[172:173], v242 offset:26784
    v_mfma_f32_16x16x32_bf16 v[180:183], a[176:179], a[124:127], v[180:183]
    ds_read_b64_tr_b16 a[174:175], v242 offset:27040
    v_mfma_f32_16x16x32_bf16 v[184:187], a[180:183], a[120:123], v[184:187]
    ds_read_b64_tr_b16 a[176:177], v242 offset:27264
    buffer_load_dwordx4 v246, s[16:19], s90 offen offset:0 lds
    v_mfma_f32_16x16x32_bf16 v[188:191], a[180:183], a[124:127], v[188:191]
    ds_read_b64_tr_b16 a[178:179], v242 offset:27520
    s_waitcnt lgkmcnt(8)
    v_mfma_f32_16x16x32_bf16 v[192:195], a[184:187], a[120:123], v[192:195]
    ds_read_b64_tr_b16 a[180:181], v242 offset:27296
    v_mfma_f32_16x16x32_bf16 v[196:199], a[184:187], a[124:127], v[196:199]
    ds_read_b64_tr_b16 a[182:183], v242 offset:27552
    v_mfma_f32_16x16x32_bf16 v[200:203], a[188:191], a[120:123], v[200:203]
    ds_read_b64_tr_b16 a[184:185], v242 offset:27776
    v_mfma_f32_16x16x32_bf16 v[204:207], a[188:191], a[124:127], v[204:207]
    ds_read_b64_tr_b16 a[186:187], v242 offset:28032
    v_mfma_f32_16x16x32_bf16 v[144:147], a[192:195], a[120:123], v[144:147]
    ds_read_b64_tr_b16 a[188:189], v242 offset:27808
    buffer_load_dwordx4 v247, s[16:19], s100 offen offset:1024 lds
    v_mfma_f32_16x16x32_bf16 v[148:151], a[192:195], a[124:127], v[148:151]
    ds_read_b64_tr_b16 a[190:191], v242 offset:28064
    s_waitcnt lgkmcnt(8)
    v_mfma_f32_16x16x32_bf16 v[152:155], a[196:199], a[120:123], v[152:155]
    ds_read_b64_tr_b16 a[192:193], v242 offset:28800
    v_mfma_f32_16x16x32_bf16 v[156:159], a[196:199], a[124:127], v[156:159]
    ds_read_b64_tr_b16 a[194:195], v242 offset:29056
    v_mfma_f32_16x16x32_bf16 v[176:179], a[168:171], a[128:131], v[176:179]
    ds_read_b64_tr_b16 a[196:197], v242 offset:28832
    v_mfma_f32_16x16x32_bf16 v[180:183], a[168:171], a[132:135], v[180:183]
    ds_read_b64_tr_b16 a[198:199], v242 offset:29088
    v_mfma_f32_16x16x32_bf16 v[184:187], a[172:175], a[128:131], v[184:187]
    ds_read_b64_tr_b16 a[168:169], v242 offset:29312
    buffer_load_dwordx4 v248, s[16:19], s91 offen offset:2048 lds
    v_mfma_f32_16x16x32_bf16 v[188:191], a[172:175], a[132:135], v[188:191]
    ds_read_b64_tr_b16 a[170:171], v242 offset:29568
    s_waitcnt lgkmcnt(8)
    v_mfma_f32_16x16x32_bf16 v[192:195], a[176:179], a[128:131], v[192:195]
    ds_read_b64_tr_b16 a[172:173], v242 offset:29344
    s_add_u32 m0, s64, 3072
    v_mfma_f32_16x16x32_bf16 v[196:199], a[176:179], a[132:135], v[196:199]
    ds_read_b64_tr_b16 a[174:175], v242 offset:29600
    v_mfma_f32_16x16x32_bf16 v[200:203], a[180:183], a[128:131], v[200:203]
    ds_read_b64_tr_b16 a[176:177], v242 offset:29824
    v_mfma_f32_16x16x32_bf16 v[204:207], a[180:183], a[132:135], v[204:207]
    ds_read_b64_tr_b16 a[178:179], v242 offset:30080
    v_mfma_f32_16x16x32_bf16 v[144:147], a[184:187], a[128:131], v[144:147]
    ds_read_b64_tr_b16 a[180:181], v242 offset:29856
    buffer_load_dwordx4 v246, s[16:19], s101 offen offset:0 lds
    v_mfma_f32_16x16x32_bf16 v[148:151], a[184:187], a[132:135], v[148:151]
    ds_read_b64_tr_b16 a[182:183], v242 offset:30112
    s_waitcnt lgkmcnt(8)
    v_mfma_f32_16x16x32_bf16 v[152:155], a[188:191], a[128:131], v[152:155]
    s_waitcnt vmcnt(17)
    s_barrier
    ds_read_b64_tr_b16 a[184:185], v240 offset:24704
    v_mfma_f32_16x16x32_bf16 v[156:159], a[188:191], a[132:135], v[156:159]
    ds_read_b64_tr_b16 a[186:187], v240 offset:24960
    v_mfma_f32_16x16x32_bf16 v[176:179], a[192:195], a[136:139], v[176:179]
    ds_read_b64_tr_b16 a[188:189], v240 offset:24736
    v_mfma_f32_16x16x32_bf16 v[180:183], a[192:195], a[140:143], v[180:183]
    ds_read_b64_tr_b16 a[190:191], v240 offset:24992
    v_mfma_f32_16x16x32_bf16 v[184:187], a[196:199], a[136:139], v[184:187]
    ds_read_b64_tr_b16 a[192:193], v240 offset:25216
    buffer_load_dwordx4 v247, s[16:19], s92 offen offset:1024 lds
    v_mfma_f32_16x16x32_bf16 v[188:191], a[196:199], a[140:143], v[188:191]
    ds_read_b64_tr_b16 a[194:195], v240 offset:25472
    s_waitcnt lgkmcnt(8)
    v_mfma_f32_16x16x32_bf16 v[192:195], a[168:171], a[136:139], v[192:195]
    ds_read_b64_tr_b16 a[196:197], v240 offset:25248
    v_mfma_f32_16x16x32_bf16 v[196:199], a[168:171], a[140:143], v[196:199]
    ds_read_b64_tr_b16 a[198:199], v240 offset:25504
    v_mfma_f32_16x16x32_bf16 v[200:203], a[172:175], a[136:139], v[200:203]
    ds_read_b64_tr_b16 a[168:169], v240 offset:25728
    v_mfma_f32_16x16x32_bf16 v[204:207], a[172:175], a[140:143], v[204:207]
    ds_read_b64_tr_b16 a[170:171], v240 offset:25984
    v_mfma_f32_16x16x32_bf16 v[144:147], a[176:179], a[136:139], v[144:147]
    ds_read_b64_tr_b16 a[172:173], v240 offset:25760
    buffer_load_dwordx4 v248, s[16:19], s77 offen offset:2048 lds
    v_mfma_f32_16x16x32_bf16 v[148:151], a[176:179], a[140:143], v[148:151]
    ds_read_b64_tr_b16 a[174:175], v240 offset:26016
    s_waitcnt lgkmcnt(8)
    v_mfma_f32_16x16x32_bf16 v[152:155], a[180:183], a[136:139], v[152:155]
    ds_read_b64_tr_b16 a[176:177], v240 offset:26752
    s_add_u32 m0, s64, 98816
    v_mfma_f32_16x16x32_bf16 v[156:159], a[180:183], a[140:143], v[156:159]
    ds_read_b64_tr_b16 a[178:179], v240 offset:27008
    s_waitcnt vmcnt(10)
    v_cmp_ne_u32 vcc, s51, v81
    s_nop 0
    s_cmp_lg_u64 vcc, 0
    s_cbranch_scc1 L_spin_op
L_back_op:
    s_add_u32 s67, s75, 18432
    buffer_load_dwordx4 a[152:155], v254, s[20:23], s67 offen offset:0 sc1
    buffer_load_dwordx4 a[156:159], v254, s[20:23], s67 offen offset:1024 sc1
    buffer_load_dwordx2 a[162:163], v254, s[20:23], s67 offen offset:2048 sc1
    buffer_load_dwordx2 a[166:167], v254, s[20:23], s67 offen offset:2056 sc1
    v_mfma_f32_16x16x32_bf16 v[176:179], a[184:187], a[144:147], v[176:179]
    ds_read_b64_tr_b16 a[180:181], v240 offset:26784
    v_mfma_f32_16x16x32_bf16 v[180:183], a[184:187], a[148:151], v[180:183]
    ds_read_b64_tr_b16 a[182:183], v240 offset:27040
    v_mfma_f32_16x16x32_bf16 v[184:187], a[188:191], a[144:147], v[184:187]
    ds_read_b64_tr_b16 a[184:185], v240 offset:27264
    buffer_load_dwordx4 v246, s[16:19], s93 offen offset:0 lds
    v_mfma_f32_16x16x32_bf16 v[188:191], a[188:191], a[148:151], v[188:191]
    ds_read_b64_tr_b16 a[186:187], v240 offset:27520
    s_waitcnt lgkmcnt(8)
    v_mfma_f32_16x16x32_bf16 v[192:195], a[192:195], a[144:147], v[192:195]
    ds_read_b64_tr_b16 a[188:189], v240 offset:27296
    v_accvgpr_read_b32 v253, a205
    v_mfma_f32_16x16x32_bf16 v[196:199], a[192:195], a[148:151], v[196:199]
    ds_read_b64_tr_b16 a[190:191], v240 offset:27552
    v_add_u32 v253, 1024, v253
    v_mfma_f32_16x16x32_bf16 v[200:203], a[196:199], a[144:147], v[200:203]
    ds_read_b64_tr_b16 a[192:193], v240 offset:27776
    s_add_u32 s66, s95, s42
    v_mfma_f32_16x16x32_bf16 v[204:207], a[196:199], a[148:151], v[204:207]
    ds_read_b64_tr_b16 a[194:195], v240 offset:28032
    v_mfma_f32_16x16x32_bf16 v[144:147], a[168:171], a[144:147], v[144:147]
    ds_read_b64_tr_b16 a[196:197], v240 offset:27808
    buffer_load_dwordx4 v253, s[28:31], s66 offen offset:1024 lds
    v_mfma_f32_16x16x32_bf16 v[148:151], a[168:171], a[148:151], v[148:151]
    ds_read_b64_tr_b16 a[198:199], v240 offset:28064
    s_waitcnt lgkmcnt(8)
    v_mfma_f32_16x16x32_bf16 v[152:155], a[172:175], a[144:147], v[152:155]
    ds_read_b64_tr_b16 a[168:169], v240 offset:28288
    v_accvgpr_read_b32 v253, a207
    v_mfma_f32_16x16x32_bf16 v[156:159], a[172:175], a[148:151], v[156:159]
    ds_read_b64_tr_b16 a[170:171], v240 offset:28544
    v_add_u32 v253, 0, v253
    v_mfma_f32_16x16x32_bf16 v[208:211], a[176:179], a[0:3], 0
    ds_read_b64_tr_b16 a[172:173], v240 offset:28320
    v_mfma_f32_16x16x32_bf16 v[212:215], a[176:179], a[4:7], 0
    ds_read_b64_tr_b16 a[174:175], v240 offset:28576
    v_mfma_f32_16x16x32_bf16 v[216:219], a[180:183], a[0:3], 0
    ds_read_b64_tr_b16 a[176:177], v240 offset:28800
    buffer_load_dwordx4 v253, s[28:31], s42 offen offset:2048 lds
    v_mfma_f32_16x16x32_bf16 v[220:223], a[180:183], a[4:7], 0
    ds_read_b64_tr_b16 a[178:179], v240 offset:29056
    s_waitcnt lgkmcnt(8)
    v_mfma_f32_16x16x32_bf16 v[224:227], a[184:187], a[0:3], 0
    ds_read_b64_tr_b16 a[180:181], v240 offset:28832
    s_add_u32 m0, s64, 101888
    v_mfma_f32_16x16x32_bf16 v[228:231], a[184:187], a[4:7], 0
    ds_read_b64_tr_b16 a[182:183], v240 offset:29088
    v_accvgpr_read_b32 v248, a203
    v_mfma_f32_16x16x32_bf16 v[232:235], a[188:191], a[0:3], 0
    ds_read_b64_tr_b16 a[184:185], v240 offset:29312
    v_add_u32 v248, s43, v248
    v_mfma_f32_16x16x32_bf16 v[236:239], a[188:191], a[4:7], 0
    ds_read_b64_tr_b16 a[186:187], v240 offset:29568
    v_add_u32 v246, 2048, v248
    v_mfma_f32_16x16x32_bf16 v[208:211], a[192:195], a[8:11], v[208:211]
    ds_read_b64_tr_b16 a[188:189], v240 offset:29344
    v_add_u32 v247, 1024, v248
    v_mfma_f32_16x16x32_bf16 v[212:215], a[192:195], a[12:15], v[212:215]
    ds_read_b64_tr_b16 a[190:191], v240 offset:29600
    s_waitcnt lgkmcnt(8)
    v_mfma_f32_16x16x32_bf16 v[216:219], a[196:199], a[8:11], v[216:219]
    ds_read_b64_tr_b16 a[192:193], v240 offset:29824
    buffer_load_dwordx4 v246, s[16:19], s84 offen offset:0 lds
    v_mfma_f32_16x16x32_bf16 v[220:223], a[196:199], a[12:15], v[220:223]
    ds_read_b64_tr_b16 a[194:195], v240 offset:30080
    v_mfma_f32_16x16x32_bf16 v[224:227], a[168:171], a[8:11], v[224:227]
    ds_read_b64_tr_b16 a[196:197], v240 offset:29856
    v_mfma_f32_16x16x32_bf16 v[228:231], a[168:171], a[12:15], v[228:231]
    ds_read_b64_tr_b16 a[198:199], v240 offset:30112
    v_mfma_f32_16x16x32_bf16 v[232:235], a[172:175], a[8:11], v[232:235]
    ds_read_b64_tr_b16 a[168:169], v240 offset:30336
    v_mfma_f32_16x16x32_bf16 v[236:239], a[172:175], a[12:15], v[236:239]
    ds_read_b64_tr_b16 a[170:171], v240 offset:30592
    s_waitcnt lgkmcnt(8)
    v_mfma_f32_16x16x32_bf16 v[208:211], a[176:179], a[16:19], v[208:211]
    ds_read_b64_tr_b16 a[172:173], v240 offset:30368
    buffer_load_dwordx4 v247, s[16:19], s24 offen offset:1024 lds
    v_mfma_f32_16x16x32_bf16 v[212:215], a[176:179], a[20:23], v[212:215]
    ds_read_b64_tr_b16 a[174:175], v240 offset:30624
    v_mfma_f32_16x16x32_bf16 v[216:219], a[180:183], a[16:19], v[216:219]
    s_barrier
    ds_read_b64_tr_b16 a[176:177], v241 offset:0
    v_mfma_f32_16x16x32_bf16 v[220:223], a[180:183], a[20:23], v[220:223]
    ds_read_b64_tr_b16 a[178:179], v241 offset:256
    v_mfma_f32_16x16x32_bf16 v[224:227], a[184:187], a[16:19], v[224:227]
    ds_read_b64_tr_b16 a[180:181], v241 offset:32
    v_mfma_f32_16x16x32_bf16 v[228:231], a[184:187], a[20:23], v[228:231]
    ds_read_b64_tr_b16 a[182:183], v241 offset:288
    s_waitcnt lgkmcnt(8)
    v_mfma_f32_16x16x32_bf16 v[232:235], a[188:191], a[16:19], v[232:235]
    ds_read_b64_tr_b16 a[184:185], v241 offset:512
    buffer_load_dwordx4 v248, s[16:19], s85 offen offset:2048 lds
    v_mfma_f32_16x16x32_bf16 v[236:239], a[188:191], a[20:23], v[236:239]
    ds_read_b64_tr_b16 a[186:187], v241 offset:768
    s_add_u32 m0, s64, 123520
    v_mfma_f32_16x16x32_bf16 v[208:211], a[192:195], a[24:27], v[208:211]
    ds_read_b64_tr_b16 a[188:189], v241 offset:544
    v_mfma_f32_16x16x32_bf16 v[212:215], a[192:195], a[28:31], v[212:215]
    ds_read_b64_tr_b16 a[190:191], v241 offset:800
    v_mfma_f32_16x16x32_bf16 v[216:219], a[196:199], a[24:27], v[216:219]
    ds_read_b64_tr_b16 a[192:193], v241 offset:1024
    v_mfma_f32_16x16x32_bf16 v[220:223], a[196:199], a[28:31], v[220:223]
    ds_read_b64_tr_b16 a[194:195], v241 offset:1280
    s_waitcnt lgkmcnt(8)
    v_mfma_f32_16x16x32_bf16 v[224:227], a[168:171], a[24:27], v[224:227]
    ds_read_b64_tr_b16 a[196:197], v241 offset:1056
    buffer_load_dwordx4 v246, s[16:19], s25 offen offset:0 lds
    v_mfma_f32_16x16x32_bf16 v[228:231], a[168:171], a[28:31], v[228:231]
    ds_read_b64_tr_b16 a[198:199], v241 offset:1312
    v_mfma_f32_16x16x32_bf16 v[232:235], a[172:175], a[24:27], v[232:235]
    ds_read_b64_tr_b16 a[168:169], v241 offset:1536
    v_mfma_f32_16x16x32_bf16 v[236:239], a[172:175], a[28:31], v[236:239]
    ds_read_b64_tr_b16 a[170:171], v241 offset:1792
    v_mfma_f32_16x16x32_bf16 v[208:211], a[176:179], a[32:35], v[208:211]
    ds_read_b64_tr_b16 a[172:173], v241 offset:1568
    v_mfma_f32_16x16x32_bf16 v[212:215], a[176:179], a[36:39], v[212:215]
    ds_read_b64_tr_b16 a[174:175], v241 offset:1824
    s_waitcnt lgkmcnt(8)
    v_mfma_f32_16x16x32_bf16 v[216:219], a[180:183], a[32:35], v[216:219]
    ds_read_b64_tr_b16 a[176:177], v241 offset:2048
    buffer_load_dwordx4 v247, s[16:19], s86 offen offset:1024 lds
    v_mfma_f32_16x16x32_bf16 v[220:223], a[180:183], a[36:39], v[220:223]
    ds_read_b64_tr_b16 a[178:179], v241 offset:2304
    v_mfma_f32_16x16x32_bf16 v[224:227], a[184:187], a[32:35], v[224:227]
    ds_read_b64_tr_b16 a[180:181], v241 offset:2080
    v_mfma_f32_16x16x32_bf16 v[228:231], a[184:187], a[36:39], v[228:231]
    ds_read_b64_tr_b16 a[182:183], v241 offset:2336
    v_mfma_f32_16x16x32_bf16 v[232:235], a[188:191], a[32:35], v[232:235]
    ds_read_b64_tr_b16 a[184:185], v241 offset:2560
    v_mfma_f32_16x16x32_bf16 v[236:239], a[188:191], a[36:39], v[236:239]
    ds_read_b64_tr_b16 a[186:187], v241 offset:2816
    s_waitcnt lgkmcnt(8)
    v_mfma_f32_16x16x32_bf16 v[208:211], a[192:195], a[40:43], v[208:211]
    ds_read_b64_tr_b16 a[188:189], v241 offset:2592
    buffer_load_dwordx4 v248, s[16:19], s26 offen offset:2048 lds
    v_mfma_f32_16x16x32_bf16 v[212:215], a[192:195], a[44:47], v[212:215]
    ds_read_b64_tr_b16 a[190:191], v241 offset:2848
    s_add_u32 m0, s64, 126592
    v_mfma_f32_16x16x32_bf16 v[216:219], a[196:199], a[40:43], v[216:219]
    ds_read_b64_tr_b16 a[192:193], v241 offset:3072
    v_mfma_f32_16x16x32_bf16 v[220:223], a[196:199], a[44:47], v[220:223]
    ds_read_b64_tr_b16 a[194:195], v241 offset:3328
    v_mfma_f32_16x16x32_bf16 v[224:227], a[168:171], a[40:43], v[224:227]
    ds_read_b64_tr_b16 a[196:197], v241 offset:3104
    v_mfma_f32_16x16x32_bf16 v[228:231], a[168:171], a[44:47], v[228:231]
    ds_read_b64_tr_b16 a[198:199], v241 offset:3360
    s_waitcnt lgkmcnt(8)
    v_mfma_f32_16x16x32_bf16 v[232:235], a[172:175], a[40:43], v[232:235]
    ds_read_b64_tr_b16 a[168:169], v241 offset:4096
    buffer_load_dwordx4 v246, s[16:19], s87 offen offset:0 lds
    v_mfma_f32_16x16x32_bf16 v[236:239], a[172:175], a[44:47], v[236:239]
    ds_read_b64_tr_b16 a[170:171], v241 offset:4352
    s_waitcnt vmcnt(10)
    v_mfma_f32_16x16x32_bf16 v[176:179], a[176:179], a[152:155], v[176:179]
    ds_read_b64_tr_b16 a[172:173], v241 offset:4128
    v_mfma_f32_16x16x32_bf16 v[180:183], a[176:179], a[156:159], v[180:183]
    ds_read_b64_tr_b16 a[174:175], v241 offset:4384
    v_mfma_f32_16x16x32_bf16 v[184:187], a[180:183], a[152:155], v[184:187]
    ds_read_b64_tr_b16 a[176:177], v241 offset:4608
    v_mfma_f32_16x16x32_bf16 v[188:191], a[180:183], a[156:159], v[188:191]
    ds_read_b64_tr_b16 a[178:179], v241 offset:4864
    s_waitcnt lgkmcnt(8)
    v_mfma_f32_16x16x32_bf16 v[192:195], a[184:187], a[152:155], v[192:195]
    ds_read_b64_tr_b16 a[180:181], v241 offset:4640
    buffer_load_dwordx4 v247, s[16:19], s27 offen offset:1024 lds
    v_mfma_f32_16x16x32_bf16 v[196:199], a[184:187], a[156:159], v[196:199]
    ds_read_b64_tr_b16 a[182:183], v241 offset:4896
    v_mfma_f32_16x16x32_bf16 v[200:203], a[188:191], a[152:155], v[200:203]
    ds_read_b64_tr_b16 a[184:185], v241 offset:5120
    v_mfma_f32_16x16x32_bf16 v[204:207], a[188:191], a[156:159], v[204:207]
    ds_read_b64_tr_b16 a[186:187], v241 offset:5376
    v_mfma_f32_16x16x32_bf16 v[144:147], a[192:195], a[152:155], v[144:147]
    ds_read_b64_tr_b16 a[188:189], v241 offset:5152
    v_mfma_f32_16x16x32_bf16 v[148:151], a[192:195], a[156:159], v[148:151]
    ds_read_b64_tr_b16 a[190:191], v241 offset:5408
    s_waitcnt lgkmcnt(8)
    v_mfma_f32_16x16x32_bf16 v[152:155], a[196:199], a[152:155], v[152:155]
    s_barrier
    ds_read_b64_tr_b16 a[192:193], v241 offset:24704
    v_mfma_f32_16x16x32_bf16 v[156:159], a[196:199], a[156:159], v[156:159]
    ds_read_b64_tr_b16 a[194:195], v241 offset:24960
    buffer_load_dwordx4 v248, s[16:19], s88 offen offset:2048 lds
    v_mfma_f32_16x16x32_bf16 v[176:179], a[168:171], a[160:163], v[176:179]
    ds_read_b64_tr_b16 a[196:197], v241 offset:24736
    s_add_u32 m0, s64, 24704
    v_mfma_f32_16x16x32_bf16 v[180:183], a[168:171], a[164:167], v[180:183]
    ds_read_b64_tr_b16 a[198:199], v241 offset:24992
    v_accvgpr_read_b32 v253, a205
    v_mfma_f32_16x16x32_bf16 v[184:187], a[172:175], a[160:163], v[184:187]
    ds_read_b64_tr_b16 a[168:169], v241 offset:25216
    v_add_u32 v253, 2048, v253
    v_mfma_f32_16x16x32_bf16 v[188:191], a[172:175], a[164:167], v[188:191]
    ds_read_b64_tr_b16 a[170:171], v241 offset:25472
    s_waitcnt lgkmcnt(8)
    v_mfma_f32_16x16x32_bf16 v[192:195], a[176:179], a[160:163], v[192:195]
    ds_read_b64_tr_b16 a[172:173], v241 offset:25248
    s_add_u32 s66, s94, s43
    v_mfma_f32_16x16x32_bf16 v[196:199], a[176:179], a[164:167], v[196:199]
    ds_read_b64_tr_b16 a[174:175], v241 offset:25504
    buffer_load_dwordx4 v253, s[28:31], s66 offen offset:0 lds
    v_mfma_f32_16x16x32_bf16 v[200:203], a[180:183], a[160:163], v[200:203]
    ds_read_b64_tr_b16 a[176:177], v241 offset:25728
    v_mfma_f32_16x16x32_bf16 v[204:207], a[180:183], a[164:167], v[204:207]
    ds_read_b64_tr_b16 a[178:179], v241 offset:25984
    v_mfma_f32_16x16x32_bf16 v[144:147], a[184:187], a[160:163], v[144:147]
    ds_read_b64_tr_b16 a[180:181], v241 offset:25760
    v_mfma_f32_16x16x32_bf16 v[148:151], a[184:187], a[164:167], v[148:151]
    ds_read_b64_tr_b16 a[182:183], v241 offset:26016
    s_waitcnt lgkmcnt(8)
    v_mfma_f32_16x16x32_bf16 v[152:155], a[188:191], a[160:163], v[152:155]
    ds_read_b64_tr_b16 a[184:185], v241 offset:26240
    v_mfma_f32_16x16x32_bf16 v[156:159], a[188:191], a[164:167], v[156:159]
    ds_read_b64_tr_b16 a[186:187], v241 offset:26496
    buffer_load_dwordx4 v247, s[16:19], s89 offen offset:1024 lds
    v_mfma_f32_16x16x32_bf16 v[208:211], a[192:195], a[48:51], v[208:211]
    ds_read_b64_tr_b16 a[188:189], v241 offset:26272
    s_lshl_b32 s72, s41, 5
    v_mfma_f32_16x16x32_bf16 v[212:215], a[192:195], a[52:55], v[212:215]
    ds_read_b64_tr_b16 a[190:191], v241 offset:26528
    s_add_u32 s72, s72, s82
    v_mfma_f32_16x16x32_bf16 v[216:219], a[196:199], a[48:51], v[216:219]
    ds_read_b64_tr_b16 a[192:193], v241 offset:26752
    v_cvt_pk_bf16_f32 v176, v176, v177
    v_mfma_f32_16x16x32_bf16 v[220:223], a[196:199], a[52:55], v[220:223]
    ds_read_b64_tr_b16 a[194:195], v241 offset:27008
    s_waitcnt lgkmcnt(8)
    v_mfma_f32_16x16x32_bf16 v[224:227], a[168:171], a[48:51], v[224:227]
    ds_read_b64_tr_b16 a[196:197], v241 offset:26784
    v_cvt_pk_bf16_f32 v177, v178, v179
    v_mfma_f32_16x16x32_bf16 v[228:231], a[168:171], a[52:55], v[228:231]
    ds_read_b64_tr_b16 a[198:199], v241 offset:27040
    buffer_load_dwordx4 v248, s[16:19], s99 offen offset:2048 lds
    v_mfma_f32_16x16x32_bf16 v[232:235], a[172:175], a[48:51], v[232:235]
    ds_read_b64_tr_b16 a[168:169], v241 offset:27264
    s_add_u32 m0, s64, 27776
    v_mfma_f32_16x16x32_bf16 v[236:239], a[172:175], a[52:55], v[236:239]
    ds_read_b64_tr_b16 a[170:171], v241 offset:27520
    v_cvt_pk_bf16_f32 v178, v184, v185
    v_mfma_f32_16x16x32_bf16 v[208:211], a[176:179], a[56:59], v[208:211]
    ds_read_b64_tr_b16 a[172:173], v241 offset:27296
    v_cvt_pk_bf16_f32 v179, v186, v187
    v_mfma_f32_16x16x32_bf16 v[212:215], a[176:179], a[60:63], v[212:215]
    ds_read_b64_tr_b16 a[174:175], v241 offset:27552
    s_waitcnt lgkmcnt(8)
    v_mfma_f32_16x16x32_bf16 v[216:219], a[180:183], a[56:59], v[216:219]
    ds_read_b64_tr_b16 a[176:177], v241 offset:27776
    buffer_store_dwordx4 v[176:179], v254, s[20:23], s72 offen offset:0 sc1
    v_mfma_f32_16x16x32_bf16 v[220:223], a[180:183], a[60:63], v[220:223]
    ds_read_b64_tr_b16 a[178:179], v241 offset:28032
    v_cvt_pk_bf16_f32 v180, v180, v181
    v_mfma_f32_16x16x32_bf16 v[224:227], a[184:187], a[56:59], v[224:227]
    ds_read_b64_tr_b16 a[180:181], v241 offset:27808
    buffer_load_dwordx4 v246, s[16:19], s90 offen offset:0 lds
    v_mfma_f32_16x16x32_bf16 v[228:231], a[184:187], a[60:63], v[228:231]
    ds_read_b64_tr_b16 a[182:183], v241 offset:28064
    v_cvt_pk_bf16_f32 v181, v182, v183
    v_mfma_f32_16x16x32_bf16 v[232:235], a[188:191], a[56:59], v[232:235]
    ds_read_b64_tr_b16 a[184:185], v241 offset:28288
    v_cvt_pk_bf16_f32 v182, v188, v189
    v_mfma_f32_16x16x32_bf16 v[236:239], a[188:191], a[60:63], v[236:239]
    ds_read_b64_tr_b16 a[186:187], v241 offset:28544
    s_waitcnt lgkmcnt(8)
    v_mfma_f32_16x16x32_bf16 v[208:211], a[192:195], a[64:67], v[208:211]
    ds_read_b64_tr_b16 a[188:189], v241 offset:28320
    v_cvt_pk_bf16_f32 v183, v190, v191
    v_mfma_f32_16x16x32_bf16 v[212:215], a[192:195], a[68:71], v[212:215]
    ds_read_b64_tr_b16 a[190:191], v241 offset:28576
    buffer_store_dwordx4 v[180:183], v254, s[20:23], s72 offen offset:1024 sc1
    v_mfma_f32_16x16x32_bf16 v[216:219], a[196:199], a[64:67], v[216:219]
    ds_read_b64_tr_b16 a[192:193], v241 offset:28800
    s_lshl_b32 s72, s41, 5
    v_mfma_f32_16x16x32_bf16 v[220:223], a[196:199], a[68:71], v[220:223]
    ds_read_b64_tr_b16 a[194:195], v241 offset:29056
    buffer_load_dwordx4 v247, s[16:19], s100 offen offset:1024 lds
    v_mfma_f32_16x16x32_bf16 v[224:227], a[168:171], a[64:67], v[224:227]
    ds_read_b64_tr_b16 a[196:197], v241 offset:28832
    s_add_u32 s72, s72, s83
    v_mfma_f32_16x16x32_bf16 v[228:231], a[168:171], a[68:71], v[228:231]
    ds_read_b64_tr_b16 a[198:199], v241 offset:29088
    s_waitcnt lgkmcnt(8)
    v_mfma_f32_16x16x32_bf16 v[232:235], a[172:175], a[64:67], v[232:235]
    ds_read_b64_tr_b16 a[168:169], v241 offset:29312
    v_cvt_pk_bf16_f32 v192, v192, v193
    v_mfma_f32_16x16x32_bf16 v[236:239], a[172:175], a[68:71], v[236:239]
    ds_read_b64_tr_b16 a[170:171], v241 offset:29568
    v_cvt_pk_bf16_f32 v193, v194, v195
    v_mfma_f32_16x16x32_bf16 v[208:211], a[176:179], a[72:75], v[208:211]
    ds_read_b64_tr_b16 a[172:173], v241 offset:29344
    v_cvt_pk_bf16_f32 v194, v200, v201
    v_mfma_f32_16x16x32_bf16 v[212:215], a[176:179], a[76:79], v[212:215]
    ds_read_b64_tr_b16 a[174:175], v241 offset:29600
    buffer_load_dwordx4 v248, s[16:19], s91 offen offset:2048 lds
    v_mfma_f32_16x16x32_bf16 v[216:219], a[180:183], a[72:75], v[216:219]
    ds_read_b64_tr_b16 a[176:177], v241 offset:29824
    v_cvt_pk_bf16_f32 v195, v202, v203
    v_mfma_f32_16x16x32_bf16 v[220:223], a[180:183], a[76:79], v[220:223]
    ds_read_b64_tr_b16 a[178:179], v241 offset:30080
    s_waitcnt lgkmcnt(8)
    v_mfma_f32_16x16x32_bf16 v[224:227], a[184:187], a[72:75], v[224:227]
    ds_read_b64_tr_b16 a[180:181], v241 offset:29856
    buffer_store_dwordx4 v[192:195], v254, s[20:23], s72 offen offset:0 sc1
    v_mfma_f32_16x16x32_bf16 v[228:231], a[184:187], a[76:79], v[228:231]
    ds_read_b64_tr_b16 a[182:183], v241 offset:30112
    v_cvt_pk_bf16_f32 v196, v196, v197
    v_mfma_f32_16x16x32_bf16 v[232:235], a[188:191], a[72:75], v[232:235]
    ds_read_b64_tr_b16 a[184:185], v241 offset:30336
    v_cvt_pk_bf16_f32 v197, v198, v199
    v_mfma_f32_16x16x32_bf16 v[236:239], a[188:191], a[76:79], v[236:239]
    ds_read_b64_tr_b16 a[186:187], v241 offset:30592
    v_cvt_pk_bf16_f32 v198, v204, v205
    v_mfma_f32_16x16x32_bf16 v[208:211], a[192:195], a[80:83], v[208:211]
    ds_read_b64_tr_b16 a[188:189], v241 offset:30368
    v_cvt_pk_bf16_f32 v199, v206, v207
    v_mfma_f32_16x16x32_bf16 v[212:215], a[192:195], a[84:87], v[212:215]
    ds_read_b64_tr_b16 a[190:191], v241 offset:30624
    s_waitcnt lgkmcnt(8)
    v_mfma_f32_16x16x32_bf16 v[216:219], a[196:199], a[80:83], v[216:219]
    s_barrier
    ds_read_b64_tr_b16 a[192:193], v240 offset:0
    v_mfma_f32_16x16x32_bf16 v[220:223], a[196:199], a[84:87], v[220:223]
    ds_read_b64_tr_b16 a[194:195], v240 offset:256
    s_add_u32 m0, s64, 49408
    v_mfma_f32_16x16x32_bf16 v[224:227], a[168:171], a[80:83], v[224:227]
    ds_read_b64_tr_b16 a[196:197], v240 offset:32
    buffer_load_dwordx4 v246, s[16:19], s101 offen offset:0 lds
    v_mfma_f32_16x16x32_bf16 v[228:231], a[168:171], a[84:87], v[228:231]
    ds_read_b64_tr_b16 a[198:199], v240 offset:288
    v_mfma_f32_16x16x32_bf16 v[232:235], a[172:175], a[80:83], v[232:235]
    ds_read_b64_tr_b16 a[168:169], v240 offset:512
    buffer_store_dwordx4 v[196:199], v254, s[20:23], s72 offen offset:1024 sc1
L_w12:
    s_cbranch_execz L_wret3
    v_mfma_f32_16x16x32_bf16 v[236:239], a[172:175], a[84:87], v[236:239]
    ds_read_b64_tr_b16 a[170:171], v240 offset:768
    s_waitcnt lgkmcnt(8)
    v_mfma_f32_16x16x32_bf16 v[208:211], a[176:179], a[88:91], v[208:211]
    ds_read_b64_tr_b16 a[172:173], v240 offset:544
    s_add_u32 s72, s75, 16384
    v_mfma_f32_16x16x32_bf16 v[212:215], a[176:179], a[92:95], v[212:215]
    ds_read_b64_tr_b16 a[174:175], v240 offset:800
    v_cvt_pk_bf16_f32 v144, v144, v145
    v_mfma_f32_16x16x32_bf16 v[216:219], a[180:183], a[88:91], v[216:219]
    ds_read_b64_tr_b16 a[176:177], v240 offset:1024
    buffer_load_dwordx4 v247, s[16:19], s92 offen offset:1024 lds
    v_mfma_f32_16x16x32_bf16 v[220:223], a[180:183], a[92:95], v[220:223]
    ds_read_b64_tr_b16 a[178:179], v240 offset:1280
    v_cvt_pk_bf16_f32 v145, v146, v147
    v_mfma_f32_16x16x32_bf16 v[224:227], a[184:187], a[88:91], v[224:227]
    ds_read_b64_tr_b16 a[180:181], v240 offset:1056
    v_cvt_pk_bf16_f32 v146, v152, v153
    v_mfma_f32_16x16x32_bf16 v[228:231], a[184:187], a[92:95], v[228:231]
    ds_read_b64_tr_b16 a[182:183], v240 offset:1312
    s_waitcnt lgkmcnt(8)
    v_mfma_f32_16x16x32_bf16 v[232:235], a[188:191], a[88:91], v[232:235]
    ds_read_b64_tr_b16 a[184:185], v240 offset:1536
    v_cvt_pk_bf16_f32 v147, v154, v155
    v_mfma_f32_16x16x32_bf16 v[236:239], a[188:191], a[92:95], v[236:239]
    ds_read_b64_tr_b16 a[186:187], v240 offset:1792
    buffer_store_dwordx4 v[144:147], v254, s[20:23], s72 offen offset:0 sc1
    v_mfma_f32_16x16x32_bf16 v[208:211], a[192:195], a[96:99], v[208:211]
    ds_read_b64_tr_b16 a[188:189], v240 offset:1568
    v_cvt_pk_bf16_f32 v148, v148, v149
    v_mfma_f32_16x16x32_bf16 v[212:215], a[192:195], a[100:103], v[212:215]
    ds_read_b64_tr_b16 a[190:191], v240 offset:1824
    buffer_load_dwordx4 v248, s[16:19], s77 offen offset:2048 lds
    v_mfma_f32_16x16x32_bf16 v[216:219], a[196:199], a[96:99], v[216:219]
    ds_read_b64_tr_b16 a[192:193], v240 offset:2048
    s_add_u32 m0, s64, 52480
    v_mfma_f32_16x16x32_bf16 v[220:223], a[196:199], a[100:103], v[220:223]
    ds_read_b64_tr_b16 a[194:195], v240 offset:2304
    s_waitcnt lgkmcnt(8)
    v_mfma_f32_16x16x32_bf16 v[224:227], a[168:171], a[96:99], v[224:227]
    ds_read_b64_tr_b16 a[196:197], v240 offset:2080
    v_cvt_pk_bf16_f32 v149, v150, v151
    v_mfma_f32_16x16x32_bf16 v[228:231], a[168:171], a[100:103], v[228:231]
    ds_read_b64_tr_b16 a[198:199], v240 offset:2336
    v_cvt_pk_bf16_f32 v150, v156, v157
    v_mfma_f32_16x16x32_bf16 v[232:235], a[172:175], a[96:99], v[232:235]
    ds_read_b64_tr_b16 a[168:169], v240 offset:2560
    v_cvt_pk_bf16_f32 v151, v158, v159
    v_mfma_f32_16x16x32_bf16 v[236:239], a[172:175], a[100:103], v[236:239]
    ds_read_b64_tr_b16 a[170:171], v240 offset:2816
    buffer_load_dwordx4 v246, s[16:19], s93 offen offset:0 lds
    v_mfma_f32_16x16x32_bf16 v[208:211], a[176:179], a[104:107], v[208:211]
    ds_read_b64_tr_b16 a[172:173], v240 offset:2592
    v_accvgpr_read_b32 v253, a205
    v_mfma_f32_16x16x32_bf16 v[212:215], a[176:179], a[108:111], v[212:215]
    ds_read_b64_tr_b16 a[174:175], v240 offset:2848
    s_waitcnt lgkmcnt(8)
    v_mfma_f32_16x16x32_bf16 v[216:219], a[180:183], a[104:107], v[216:219]
    ds_read_b64_tr_b16 a[176:177], v240 offset:3072
    v_add_u32 v253, 1024, v253
    v_mfma_f32_16x16x32_bf16 v[220:223], a[180:183], a[108:111], v[220:223]
    ds_read_b64_tr_b16 a[178:179], v240 offset:3328
    s_add_u32 s66, s95, s43
    v_mfma_f32_16x16x32_bf16 v[224:227], a[184:187], a[104:107], v[224:227]
    ds_read_b64_tr_b16 a[180:181], v240 offset:3104
    buffer_store_dwordx4 v[148:151], v254, s[20:23], s72 offen offset:1024 sc1
    v_mfma_f32_16x16x32_bf16 v[228:231], a[184:187], a[108:111], v[228:231]
    ds_read_b64_tr_b16 a[182:183], v240 offset:3360
    v_mfma_f32_16x16x32_bf16 v[232:235], a[188:191], a[104:107], v[232:235]
    ds_read_b64_tr_b16 a[184:185], v240 offset:3584
    buffer_load_dwordx4 v253, s[28:31], s66 offen offset:1024 lds
    v_mfma_f32_16x16x32_bf16 v[236:239], a[188:191], a[108:111], v[236:239]
    ds_read_b64_tr_b16 a[186:187], v240 offset:3840
    s_waitcnt lgkmcnt(8)
    v_mfma_f32_16x16x32_bf16 v[208:211], a[192:195], a[112:115], v[208:211]
    ds_read_b64_tr_b16 a[188:189], v240 offset:3616
    v_accvgpr_read_b32 v253, a207
    v_mfma_f32_16x16x32_bf16 v[212:215], a[192:195], a[116:119], v[212:215]
    ds_read_b64_tr_b16 a[190:191], v240 offset:3872
    v_add_u32_e64 v253, 0, v253
    v_mfma_f32_16x16x32_bf16 v[216:219], a[196:199], a[112:115], v[216:219]
    ds_read_b64_tr_b16 a[192:193], v240 offset:4096
    v_mfma_f32_16x16x32_bf16 v[220:223], a[196:199], a[116:119], v[220:223]
    ds_read_b64_tr_b16 a[194:195], v240 offset:4352
    v_mfma_f32_16x16x32_bf16 v[224:227], a[168:171], a[112:115], v[224:227]
    ds_read_b64_tr_b16 a[196:197], v240 offset:4128
    buffer_load_dwordx4 v253, s[28:31], s43 offen offset:2048 lds
    v_mfma_f32_16x16x32_bf16 v[228:231], a[168:171], a[116:119], v[228:231]
    ds_read_b64_tr_b16 a[198:199], v240 offset:4384
    s_waitcnt lgkmcnt(8)
    v_mfma_f32_16x16x32_bf16 v[232:235], a[172:175], a[112:115], v[232:235]
    ds_read_b64_tr_b16 a[168:169], v240 offset:4608
    v_mfma_f32_16x16x32_bf16 v[236:239], a[172:175], a[116:119], v[236:239]
    ds_read_b64_tr_b16 a[170:171], v240 offset:4864
    v_mfma_f32_16x16x32_bf16 v[208:211], a[176:179], a[120:123], v[208:211]
    ds_read_b64_tr_b16 a[172:173], v240 offset:4640
    v_mfma_f32_16x16x32_bf16 v[212:215], a[176:179], a[124:127], v[212:215]
    ds_read_b64_tr_b16 a[174:175], v240 offset:4896
    v_mfma_f32_16x16x32_bf16 v[216:219], a[180:183], a[120:123], v[216:219]
    ds_read_b64_tr_b16 a[176:177], v240 offset:5120
    v_mfma_f32_16x16x32_bf16 v[220:223], a[180:183], a[124:127], v[220:223]
    ds_read_b64_tr_b16 a[178:179], v240 offset:5376
    s_waitcnt lgkmcnt(8)
    v_mfma_f32_16x16x32_bf16 v[224:227], a[184:187], a[120:123], v[224:227]
    ds_read_b64_tr_b16 a[180:181], v240 offset:5152
    v_mfma_f32_16x16x32_bf16 v[228:231], a[184:187], a[124:127], v[228:231]
    ds_read_b64_tr_b16 a[182:183], v240 offset:5408
    v_mfma_f32_16x16x32_bf16 v[232:235], a[188:191], a[120:123], v[232:235]
    ds_read_b64_tr_b16 a[184:185], v240 offset:5632
    v_mfma_f32_16x16x32_bf16 v[236:239], a[188:191], a[124:127], v[236:239]
    ds_read_b64_tr_b16 a[186:187], v240 offset:5888
    v_mfma_f32_16x16x32_bf16 v[208:211], a[192:195], a[128:131], v[208:211]
    ds_read_b64_tr_b16 a[188:189], v240 offset:5664
    v_mfma_f32_16x16x32_bf16 v[212:215], a[192:195], a[132:135], v[212:215]
    ds_read_b64_tr_b16 a[190:191], v240 offset:5920
    s_waitcnt lgkmcnt(8)
    v_mfma_f32_16x16x32_bf16 v[216:219], a[196:199], a[128:131], v[216:219]
    s_waitcnt vmcnt(24)
    s_barrier
    ds_read_b64_tr_b16 a[192:193], v242 offset:0
    v_mfma_f32_16x16x32_bf16 v[220:223], a[196:199], a[132:135], v[220:223]
    ds_read_b64_tr_b16 a[194:195], v242 offset:256
    s_add_u32 m0, s64, 74112
    v_mfma_f32_16x16x32_bf16 v[224:227], a[168:171], a[128:131], v[224:227]
    ds_read_b64_tr_b16 a[196:197], v242 offset:32
    v_accvgpr_read_b32 v248, a203
    v_mfma_f32_16x16x32_bf16 v[228:231], a[168:171], a[132:135], v[228:231]
    ds_read_b64_tr_b16 a[198:199], v242 offset:288
    v_add_u32 v248, s44, v248
    v_mfma_f32_16x16x32_bf16 v[232:235], a[172:175], a[128:131], v[232:235]
    ds_read_b64_tr_b16 a[168:169], v242 offset:512
    v_add_u32 v246, 2048, v248
    v_mfma_f32_16x16x32_bf16 v[236:239], a[172:175], a[132:135], v[236:239]
    ds_read_b64_tr_b16 a[170:171], v242 offset:768
    s_waitcnt lgkmcnt(8)
    v_mfma_f32_16x16x32_bf16 v[208:211], a[176:179], a[136:139], v[208:211]
    ds_read_b64_tr_b16 a[172:173], v242 offset:544
    v_add_u32 v247, 1024, v248
    v_mfma_f32_16x16x32_bf16 v[212:215], a[176:179], a[140:143], v[212:215]
    ds_read_b64_tr_b16 a[174:175], v242 offset:800
    buffer_load_dwordx4 v246, s[16:19], s84 offen offset:0 lds
    v_mfma_f32_16x16x32_bf16 v[216:219], a[180:183], a[136:139], v[216:219]
    ds_read_b64_tr_b16 a[176:177], v242 offset:1024
    v_mfma_f32_16x16x32_bf16 v[220:223], a[180:183], a[140:143], v[220:223]
    ds_read_b64_tr_b16 a[178:179], v242 offset:1280
    v_mfma_f32_16x16x32_bf16 v[224:227], a[184:187], a[136:139], v[224:227]
    ds_read_b64_tr_b16 a[180:181], v242 offset:1056
    v_mfma_f32_16x16x32_bf16 v[228:231], a[184:187], a[140:143], v[228:231]
    ds_read_b64_tr_b16 a[182:183], v242 offset:1312
    s_waitcnt lgkmcnt(8)
    v_mfma_f32_16x16x32_bf16 v[232:235], a[188:191], a[136:139], v[232:235]
    ds_read_b64_tr_b16 a[184:185], v242 offset:1536
    v_mfma_f32_16x16x32_bf16 v[236:239], a[188:191], a[140:143], v[236:239]
    ds_read_b64_tr_b16 a[186:187], v242 offset:1792
    buffer_load_dwordx4 v247, s[16:19], s24 offen offset:1024 lds
    v_mfma_f32_16x16x32_bf16 v[208:211], a[192:195], a[144:147], v[208:211]
    ds_read_b64_tr_b16 a[188:189], v242 offset:1568
    v_mfma_f32_16x16x32_bf16 v[212:215], a[192:195], a[148:151], v[212:215]
    ds_read_b64_tr_b16 a[190:191], v242 offset:1824
    v_mfma_f32_16x16x32_bf16 v[216:219], a[196:199], a[144:147], v[216:219]
    ds_read_b64_tr_b16 a[192:193], v242 offset:2048
    v_mfma_f32_16x16x32_bf16 v[220:223], a[196:199], a[148:151], v[220:223]
    ds_read_b64_tr_b16 a[194:195], v242 offset:2304
    s_waitcnt lgkmcnt(8)
    v_mfma_f32_16x16x32_bf16 v[224:227], a[168:171], a[144:147], v[224:227]
    ds_read_b64_tr_b16 a[196:197], v242 offset:2080
    s_waitcnt vmcnt(9)
    s_lshr_b32 s67, s65, 1
    s_xor_b32 s67, s67, 3
    s_lshl_b32 s67, s67, 8
    s_add_u32 s67, s67, s3
    s_lshl_b32 s68, s65, 2
    v_mov_b32 v249, s68
    v_mov_b32_e64 v250, s51
    buffer_store_dword v250, v249, s[20:23], s67 offen offset:0 sc1
    v_mfma_f32_16x16x32_bf16 v[228:231], a[168:171], a[148:151], v[228:231]
    ds_read_b64_tr_b16 a[198:199], v242 offset:2336
    buffer_load_dwordx4 v248, s[16:19], s85 offen offset:2048 lds
    v_mfma_f32_16x16x32_bf16 v[232:235], a[172:175], a[144:147], v[232:235]
    ds_read_b64_tr_b16 a[168:169], v242 offset:2560
    s_add_u32 m0, s64, 77184
    v_mfma_f32_16x16x32_bf16 v[236:239], a[172:175], a[148:151], v[236:239]
    ds_read_b64_tr_b16 a[170:171], v242 offset:2816
    v_mfma_f32_16x16x32_bf16 v[208:211], a[176:179], a[152:155], v[208:211]
    ds_read_b64_tr_b16 a[172:173], v242 offset:2592
    v_mfma_f32_16x16x32_bf16 v[212:215], a[176:179], a[156:159], v[212:215]
    ds_read_b64_tr_b16 a[174:175], v242 offset:2848
    s_waitcnt lgkmcnt(8)
    v_mfma_f32_16x16x32_bf16 v[216:219], a[180:183], a[152:155], v[216:219]
    ds_read_b64_tr_b16 a[176:177], v242 offset:3072
    v_mfma_f32_16x16x32_bf16 v[220:223], a[180:183], a[156:159], v[220:223]
    ds_read_b64_tr_b16 a[178:179], v242 offset:3328
    buffer_load_dwordx4 v246, s[16:19], s25 offen offset:0 lds
    v_mfma_f32_16x16x32_bf16 v[224:227], a[184:187], a[152:155], v[224:227]
    ds_read_b64_tr_b16 a[180:181], v242 offset:3104
    v_mfma_f32_16x16x32_bf16 v[228:231], a[184:187], a[156:159], v[228:231]
    ds_read_b64_tr_b16 a[182:183], v242 offset:3360
    v_mfma_f32_16x16x32_bf16 v[232:235], a[188:191], a[152:155], v[232:235]
    ds_read_b64_tr_b16 a[184:185], v242 offset:4096
    v_mfma_f32_16x16x32_bf16 v[236:239], a[188:191], a[156:159], v[236:239]
    ds_read_b64_tr_b16 a[186:187], v242 offset:4352
    s_waitcnt lgkmcnt(8)
    v_mfma_f32_16x16x32_bf16 v[208:211], a[192:195], a[160:163], v[208:211]
    ds_read_b64_tr_b16 a[188:189], v242 offset:4128
    v_mfma_f32_16x16x32_bf16 v[212:215], a[192:195], a[164:167], v[212:215]
    ds_read_b64_tr_b16 a[190:191], v242 offset:4384
    buffer_load_dwordx4 v247, s[16:19], s86 offen offset:1024 lds
    v_mfma_f32_16x16x32_bf16 v[216:219], a[196:199], a[160:163], v[216:219]
    ds_read_b64_tr_b16 a[192:193], v242 offset:5120
    v_mfma_f32_16x16x32_bf16 v[220:223], a[196:199], a[164:167], v[220:223]
    ds_read_b64_tr_b16 a[194:195], v242 offset:5376
    v_mfma_f32_16x16x32_bf16 v[224:227], a[168:171], a[160:163], v[224:227]
    ds_read_b64_tr_b16 a[196:197], v242 offset:5152
    v_mfma_f32_16x16x32_bf16 v[228:231], a[168:171], a[164:167], v[228:231]
    ds_read_b64_tr_b16 a[198:199], v242 offset:5408
    s_waitcnt lgkmcnt(8)
    v_mfma_f32_16x16x32_bf16 v[232:235], a[172:175], a[160:163], v[232:235]
    s_barrier
    ds_read_b64_tr_b16 a[168:169], v242 offset:24704
    v_mfma_f32_16x16x32_bf16 v[236:239], a[172:175], a[164:167], v[236:239]
    ds_read_b64_tr_b16 a[170:171], v242 offset:24960
    buffer_load_dwordx4 v248, s[16:19], s26 offen offset:2048 lds
    v_mfma_f32_16x16x32_bf16 v[144:147], a[176:179], a[0:3], 0
    ds_read_b64_tr_b16 a[172:173], v242 offset:24736
    s_waitcnt vmcnt(9)
    s_add_u32 s67, s3, 1024
    s_lshl_b32 s68, s65, 2
    v_mov_b32 v249, s68
    v_mov_b32 v250, s51
    buffer_store_dword v250, v249, s[20:23], s67 offen offset:0 sc1
    v_mfma_f32_16x16x32_bf16 v[148:151], a[176:179], a[4:7], 0
    ds_read_b64_tr_b16 a[174:175], v242 offset:24992
    s_add_u32 m0, s64, 0
    v_mfma_f32_16x16x32_bf16 v[152:155], a[180:183], a[0:3], 0
    ds_read_b64_tr_b16 a[176:177], v242 offset:25728
    v_mfma_f32_16x16x32_bf16 v[156:159], a[180:183], a[4:7], 0
    ds_read_b64_tr_b16 a[178:179], v242 offset:25984
    s_waitcnt lgkmcnt(8)
    v_mfma_f32_16x16x32_bf16 v[144:147], a[184:187], a[8:11], v[144:147]
    ds_read_b64_tr_b16 a[180:181], v242 offset:25760
    s_lshl_b32 s72, s42, 5
    v_mfma_f32_16x16x32_bf16 v[148:151], a[184:187], a[12:15], v[148:151]
    ds_read_b64_tr_b16 a[182:183], v242 offset:26016
    buffer_load_dwordx4 v246, s[16:19], s87 offen offset:0 lds
    v_mfma_f32_16x16x32_bf16 v[152:155], a[188:191], a[8:11], v[152:155]
    ds_read_b64_tr_b16 a[184:185], v242 offset:26752
    s_add_u32 s72, s72, s82
    v_mfma_f32_16x16x32_bf16 v[156:159], a[188:191], a[12:15], v[156:159]
    ds_read_b64_tr_b16 a[186:187], v242 offset:27008
    v_cvt_pk_bf16_f32 v208, v208, v209
    v_mfma_f32_16x16x32_bf16 v[144:147], a[192:195], a[16:19], v[144:147]
    ds_read_b64_tr_b16 a[188:189], v242 offset:26784
    v_cvt_pk_bf16_f32 v209, v210, v211
    v_mfma_f32_16x16x32_bf16 v[148:151], a[192:195], a[20:23], v[148:151]
    ds_read_b64_tr_b16 a[190:191], v242 offset:27040
    s_waitcnt lgkmcnt(8)
    v_mfma_f32_16x16x32_bf16 v[152:155], a[196:199], a[16:19], v[152:155]
    ds_read_b64_tr_b16 a[192:193], v242 offset:27776
    v_cvt_pk_bf16_f32 v210, v216, v217
    v_mfma_f32_16x16x32_bf16 v[156:159], a[196:199], a[20:23], v[156:159]
    ds_read_b64_tr_b16 a[194:195], v242 offset:28032
    buffer_load_dwordx4 v247, s[16:19], s27 offen offset:1024 lds
    v_mfma_f32_16x16x32_bf16 v[144:147], a[168:171], a[24:27], v[144:147]
    ds_read_b64_tr_b16 a[196:197], v242 offset:27808
    v_cvt_pk_bf16_f32 v211, v218, v219
    v_mfma_f32_16x16x32_bf16 v[148:151], a[168:171], a[28:31], v[148:151]
    ds_read_b64_tr_b16 a[198:199], v242 offset:28064
    buffer_store_dwordx4 v[208:211], v254, s[20:23], s72 offen offset:0 sc1
    v_mfma_f32_16x16x32_bf16 v[152:155], a[172:175], a[24:27], v[152:155]
    ds_read_b64_tr_b16 a[168:169], v242 offset:28800
    v_cvt_pk_bf16_f32 v212, v212, v213
    v_mfma_f32_16x16x32_bf16 v[156:159], a[172:175], a[28:31], v[156:159]
    ds_read_b64_tr_b16 a[170:171], v242 offset:29056
    s_waitcnt lgkmcnt(8)
    v_mfma_f32_16x16x32_bf16 v[144:147], a[176:179], a[32:35], v[144:147]
    ds_read_b64_tr_b16 a[172:173], v242 offset:28832
    v_cvt_pk_bf16_f32 v213, v214, v215
    v_mfma_f32_16x16x32_bf16 v[148:151], a[176:179], a[36:39], v[148:151]
    ds_read_b64_tr_b16 a[174:175], v242 offset:29088
    buffer_load_dwordx4 v248, s[16:19], s88 offen offset:2048 lds
    v_mfma_f32_16x16x32_bf16 v[152:155], a[180:183], a[32:35], v[152:155]
    ds_read_b64_tr_b16 a[176:177], v242 offset:29824
    s_add_u32 m0, s64, 3072
    v_mfma_f32_16x16x32_bf16 v[156:159], a[180:183], a[36:39], v[156:159]
    ds_read_b64_tr_b16 a[178:179], v242 offset:30080
    v_accvgpr_read_b32 v253, a205
    v_mfma_f32_16x16x32_bf16 v[144:147], a[184:187], a[40:43], v[144:147]
    ds_read_b64_tr_b16 a[180:181], v242 offset:29856
    v_add_u32 v253, 2048, v253
    v_mfma_f32_16x16x32_bf16 v[148:151], a[184:187], a[44:47], v[148:151]
    ds_read_b64_tr_b16 a[182:183], v242 offset:30112
    s_waitcnt lgkmcnt(8)
    v_mfma_f32_16x16x32_bf16 v[152:155], a[188:191], a[40:43], v[152:155]
    s_barrier
    ds_read_b64_tr_b16 a[184:185], v240 offset:24704
    v_mfma_f32_16x16x32_bf16 v[156:159], a[188:191], a[44:47], v[156:159]
    ds_read_b64_tr_b16 a[186:187], v240 offset:24960
    s_add_u32 s66, s94, s44
    v_mfma_f32_16x16x32_bf16 v[144:147], a[192:195], a[48:51], v[144:147]
    ds_read_b64_tr_b16 a[188:189], v240 offset:24736
    buffer_load_dwordx4 v253, s[28:31], s66 offen offset:0 lds
    v_mfma_f32_16x16x32_bf16 v[148:151], a[192:195], a[52:55], v[148:151]
    ds_read_b64_tr_b16 a[190:191], v240 offset:24992
    v_cvt_pk_bf16_f32 v214, v220, v221
    v_mfma_f32_16x16x32_bf16 v[152:155], a[196:199], a[48:51], v[152:155]
    ds_read_b64_tr_b16 a[192:193], v240 offset:25728
    v_cvt_pk_bf16_f32 v215, v222, v223
    v_mfma_f32_16x16x32_bf16 v[156:159], a[196:199], a[52:55], v[156:159]
    ds_read_b64_tr_b16 a[194:195], v240 offset:25984
    s_waitcnt lgkmcnt(8)
    v_mfma_f32_16x16x32_bf16 v[144:147], a[168:171], a[56:59], v[144:147]
    ds_read_b64_tr_b16 a[196:197], v240 offset:25760
    buffer_store_dwordx4 v[212:215], v254, s[20:23], s72 offen offset:1024 sc1
    v_mfma_f32_16x16x32_bf16 v[148:151], a[168:171], a[60:63], v[148:151]
    ds_read_b64_tr_b16 a[198:199], v240 offset:26016
    s_lshl_b32 s72, s42, 5
    v_mfma_f32_16x16x32_bf16 v[152:155], a[172:175], a[56:59], v[152:155]
    ds_read_b64_tr_b16 a[168:169], v240 offset:26752
    buffer_load_dwordx4 v247, s[16:19], s89 offen offset:1024 lds
    v_mfma_f32_16x16x32_bf16 v[156:159], a[172:175], a[60:63], v[156:159]
    ds_read_b64_tr_b16 a[170:171], v240 offset:27008
    s_add_u32 s72, s72, s83
    v_mfma_f32_16x16x32_bf16 v[144:147], a[176:179], a[64:67], v[144:147]
    ds_read_b64_tr_b16 a[172:173], v240 offset:26784
    v_cvt_pk_bf16_f32 v224, v224, v225
    v_mfma_f32_16x16x32_bf16 v[148:151], a[176:179], a[68:71], v[148:151]
    ds_read_b64_tr_b16 a[174:175], v240 offset:27040
    s_waitcnt lgkmcnt(8)
    v_mfma_f32_16x16x32_bf16 v[152:155], a[180:183], a[64:67], v[152:155]
    ds_read_b64_tr_b16 a[176:177], v240 offset:27776
    v_cvt_pk_bf16_f32 v225, v226, v227
    v_mfma_f32_16x16x32_bf16 v[156:159], a[180:183], a[68:71], v[156:159]
    ds_read_b64_tr_b16 a[178:179], v240 offset:28032
    v_cvt_pk_bf16_f32 v226, v232, v233
    v_mfma_f32_16x16x32_bf16 v[144:147], a[184:187], a[72:75], v[144:147]
    ds_read_b64_tr_b16 a[180:181], v240 offset:27808
    buffer_load_dwordx4 v248, s[16:19], s99 offen offset:2048 lds
    v_mfma_f32_16x16x32_bf16 v[148:151], a[184:187], a[76:79], v[148:151]
    ds_read_b64_tr_b16 a[182:183], v240 offset:28064
    s_add_u32 m0, s64, 98816
    v_mfma_f32_16x16x32_bf16 v[152:155], a[188:191], a[72:75], v[152:155]
    ds_read_b64_tr_b16 a[184:185], v240 offset:28800
    v_cvt_pk_bf16_f32 v227, v234, v235
    v_mfma_f32_16x16x32_bf16 v[156:159], a[188:191], a[76:79], v[156:159]
    ds_read_b64_tr_b16 a[186:187], v240 offset:29056
    s_waitcnt lgkmcnt(8)
    v_mfma_f32_16x16x32_bf16 v[144:147], a[192:195], a[80:83], v[144:147]
    ds_read_b64_tr_b16 a[188:189], v240 offset:28832
    buffer_store_dwordx4 v[224:227], v254, s[20:23], s72 offen offset:0 sc1
    v_mfma_f32_16x16x32_bf16 v[148:151], a[192:195], a[84:87], v[148:151]
    ds_read_b64_tr_b16 a[190:191], v240 offset:29088
    v_cvt_pk_bf16_f32 v228, v228, v229
    v_mfma_f32_16x16x32_bf16 v[152:155], a[196:199], a[80:83], v[152:155]
    ds_read_b64_tr_b16 a[192:193], v240 offset:29824
    buffer_load_dwordx4 v246, s[16:19], s93 offen offset:0 lds
    v_mfma_f32_16x16x32_bf16 v[156:159], a[196:199], a[84:87], v[156:159]
    ds_read_b64_tr_b16 a[194:195], v240 offset:30080
    v_accvgpr_read_b32 v253, a205
    v_mfma_f32_16x16x32_bf16 v[144:147], a[168:171], a[88:91], v[144:147]
    ds_read_b64_tr_b16 a[196:197], v240 offset:29856
    v_add_u32 v253, 1024, v253
    v_mfma_f32_16x16x32_bf16 v[148:151], a[168:171], a[92:95], v[148:151]
    ds_read_b64_tr_b16 a[198:199], v240 offset:30112
    s_waitcnt lgkmcnt(8)
    v_mfma_f32_16x16x32_bf16 v[152:155], a[172:175], a[88:91], v[152:155]
    s_waitcnt vmcnt(18)
    s_barrier
    ds_read_b64_tr_b16 a[168:169], v241 offset:0
    v_mfma_f32_16x16x32_bf16 v[156:159], a[172:175], a[92:95], v[156:159]
    ds_read_b64_tr_b16 a[170:171], v241 offset:256
    s_add_u32 s66, s95, s44
    v_mfma_f32_16x16x32_bf16 v[144:147], a[176:179], a[96:99], v[144:147]
    ds_read_b64_tr_b16 a[172:173], v241 offset:32
    buffer_load_dwordx4 v253, s[28:31], s66 offen offset:1024 lds
    v_mfma_f32_16x16x32_bf16 v[148:151], a[176:179], a[100:103], v[148:151]
    ds_read_b64_tr_b16 a[174:175], v241 offset:288
    v_accvgpr_read_b32 v253, a207
    v_mfma_f32_16x16x32_bf16 v[152:155], a[180:183], a[96:99], v[152:155]
    ds_read_b64_tr_b16 a[176:177], v241 offset:1024
    v_add_u32_e64 v253, 0, v253
    v_mfma_f32_16x16x32_bf16 v[156:159], a[180:183], a[100:103], v[156:159]
    ds_read_b64_tr_b16 a[178:179], v241 offset:1280
    s_waitcnt lgkmcnt(8)
    v_mfma_f32_16x16x32_bf16 v[144:147], a[184:187], a[104:107], v[144:147]
    ds_read_b64_tr_b16 a[180:181], v241 offset:1056
    v_cvt_pk_bf16_f32 v229, v230, v231
    v_mfma_f32_16x16x32_bf16 v[148:151], a[184:187], a[108:111], v[148:151]
    ds_read_b64_tr_b16 a[182:183], v241 offset:1312
    v_cvt_pk_bf16_f32 v230, v236, v237
    v_mfma_f32_16x16x32_bf16 v[152:155], a[188:191], a[104:107], v[152:155]
    ds_read_b64_tr_b16 a[184:185], v241 offset:2048
    buffer_load_dwordx4 v253, s[28:31], s44 offen offset:2048 lds
    v_mfma_f32_16x16x32_bf16 v[156:159], a[188:191], a[108:111], v[156:159]
    ds_read_b64_tr_b16 a[186:187], v241 offset:2304
    v_cvt_pk_bf16_f32 v231, v238, v239
    v_mfma_f32_16x16x32_bf16 v[144:147], a[192:195], a[112:115], v[144:147]
    ds_read_b64_tr_b16 a[188:189], v241 offset:2080
    buffer_store_dwordx4 v[228:231], v254, s[20:23], s72 offen offset:1024 sc1
    v_mfma_f32_16x16x32_bf16 v[148:151], a[192:195], a[116:119], v[148:151]
    ds_read_b64_tr_b16 a[190:191], v241 offset:2336
    s_waitcnt lgkmcnt(8)
    v_mfma_f32_16x16x32_bf16 v[152:155], a[196:199], a[112:115], v[152:155]
    ds_read_b64_tr_b16 a[192:193], v241 offset:3072
    v_mfma_f32_16x16x32_bf16 v[156:159], a[196:199], a[116:119], v[156:159]
    ds_read_b64_tr_b16 a[194:195], v241 offset:3328
    v_mfma_f32_16x16x32_bf16 v[144:147], a[168:171], a[120:123], v[144:147]
    ds_read_b64_tr_b16 a[196:197], v241 offset:3104
    v_bfe_u32 v80, v254, 4, 3
    v_mfma_f32_16x16x32_bf16 v[148:151], a[168:171], a[124:127], v[148:151]
    ds_read_b64_tr_b16 a[198:199], v241 offset:3360
    v_bfe_u32 v81, v254, 7, 1
    v_mfma_f32_16x16x32_bf16 v[152:155], a[172:175], a[120:123], v[152:155]
    ds_read_b64_tr_b16 a[168:169], v241 offset:4096
    v_mul_u32_u24 v82, 6, v81
    v_mfma_f32_16x16x32_bf16 v[156:159], a[172:175], a[124:127], v[156:159]
    ds_read_b64_tr_b16 a[170:171], v241 offset:4352
    s_waitcnt lgkmcnt(8)
    v_mfma_f32_16x16x32_bf16 v[144:147], a[176:179], a[128:131], v[144:147]
    ds_read_b64_tr_b16 a[172:173], v241 offset:4128
    v_or_b32_e64 v80, v80, v82
    v_mfma_f32_16x16x32_bf16 v[148:151], a[176:179], a[132:135], v[148:151]
    ds_read_b64_tr_b16 a[174:175], v241 offset:4384
    v_xor_b32_e64 v80, s65, v80
    v_mfma_f32_16x16x32_bf16 v[152:155], a[180:183], a[128:131], v[152:155]
    ds_read_b64_tr_b16 a[176:177], v241 offset:5120
    v_lshlrev_b32_e64 v80, 2, v80
    v_mfma_f32_16x16x32_bf16 v[156:159], a[180:183], a[132:135], v[156:159]
    ds_read_b64_tr_b16 a[178:179], v241 offset:5376
    s_sub_u32 s69, s45, s48
    v_mfma_f32_16x16x32_bf16 v[144:147], a[184:187], a[136:139], v[144:147]
    ds_read_b64_tr_b16 a[180:181], v241 offset:5152
    v_xor_b32 v81, 1, v81
    v_mfma_f32_16x16x32_bf16 v[148:151], a[184:187], a[140:143], v[148:151]
    ds_read_b64_tr_b16 a[182:183], v241 offset:5408
    s_waitcnt lgkmcnt(8)
    v_mfma_f32_16x16x32_bf16 v[152:155], a[188:191], a[136:139], v[152:155]
    ds_read_b64_tr_b16 a[184:185], v242 offset:25216
    v_mad_u32_u24 v80, v81, s69, v80
    v_mfma_f32_16x16x32_bf16 v[156:159], a[188:191], a[140:143], v[156:159]
    ds_read_b64_tr_b16 a[186:187], v242 offset:25472
    buffer_load_dword v81, v80, s[20:23], s48 offen sc1
    v_mfma_f32_16x16x32_bf16 v[144:147], a[192:195], a[144:147], v[144:147]
    ds_read_b64_tr_b16 a[188:189], v242 offset:25248
    v_mfma_f32_16x16x32_bf16 v[148:151], a[192:195], a[148:151], v[148:151]
    ds_read_b64_tr_b16 a[190:191], v242 offset:25504
    v_mfma_f32_16x16x32_bf16 v[152:155], a[196:199], a[144:147], v[152:155]
    ds_read_b64_tr_b16 a[192:193], v242 offset:26240
    v_mfma_f32_16x16x32_bf16 v[156:159], a[196:199], a[148:151], v[156:159]
    ds_read_b64_tr_b16 a[194:195], v242 offset:26496
    s_waitcnt lgkmcnt(8)
    v_mfma_f32_16x16x32_bf16 v[144:147], a[168:171], a[152:155], v[144:147]
    ds_read_b64_tr_b16 a[196:197], v242 offset:26272
    v_mfma_f32_16x16x32_bf16 v[148:151], a[168:171], a[156:159], v[148:151]
    ds_read_b64_tr_b16 a[198:199], v242 offset:26528
    v_mfma_f32_16x16x32_bf16 v[152:155], a[172:175], a[152:155], v[152:155]
    ds_read_b64_tr_b16 a[168:169], v242 offset:27264
    v_mfma_f32_16x16x32_bf16 v[156:159], a[172:175], a[156:159], v[156:159]
    ds_read_b64_tr_b16 a[170:171], v242 offset:27520
    v_mfma_f32_16x16x32_bf16 v[144:147], a[176:179], a[160:163], v[144:147]
    ds_read_b64_tr_b16 a[172:173], v242 offset:27296
    v_mfma_f32_16x16x32_bf16 v[148:151], a[176:179], a[164:167], v[148:151]
    ds_read_b64_tr_b16 a[174:175], v242 offset:27552
    s_waitcnt lgkmcnt(8)
    v_mfma_f32_16x16x32_bf16 v[152:155], a[180:183], a[160:163], v[152:155]
    ds_read_b64_tr_b16 a[176:177], v242 offset:28288
    v_mfma_f32_16x16x32_bf16 v[156:159], a[180:183], a[164:167], v[156:159]
    ds_read_b64_tr_b16 a[178:179], v242 offset:28544
    v_mfma_f32_16x16x32_bf16 v[160:163], a[184:187], a[24:27], 0
    ds_read_b64_tr_b16 a[180:181], v242 offset:28320
    v_mfma_f32_16x16x32_bf16 v[164:167], a[184:187], a[28:31], 0
    ds_read_b64_tr_b16 a[182:183], v242 offset:28576
    v_mfma_f32_16x16x32_bf16 v[168:171], a[188:191], a[24:27], 0
    ds_read_b64_tr_b16 a[184:185], v242 offset:29312
    v_mfma_f32_16x16x32_bf16 v[172:175], a[188:191], a[28:31], 0
    ds_read_b64_tr_b16 a[186:187], v242 offset:29568
    s_waitcnt lgkmcnt(8)
    v_mfma_f32_16x16x32_bf16 v[160:163], a[192:195], a[32:35], v[160:163]
    ds_read_b64_tr_b16 a[188:189], v242 offset:29344
    v_cvt_pk_bf16_f32 v144, v144, v145
    v_mfma_f32_16x16x32_bf16 v[164:167], a[192:195], a[36:39], v[164:167]
    ds_read_b64_tr_b16 a[190:191], v242 offset:29600
    v_cvt_pk_bf16_f32 v145, v146, v147
    v_mfma_f32_16x16x32_bf16 v[168:171], a[196:199], a[32:35], v[168:171]
    ds_read_b64_tr_b16 a[192:193], v242 offset:30336
    v_cvt_pk_bf16_f32 v146, v148, v149
    v_mfma_f32_16x16x32_bf16 v[172:175], a[196:199], a[36:39], v[172:175]
    ds_read_b64_tr_b16 a[194:195], v242 offset:30592
    v_cvt_pk_bf16_f32 v147, v150, v151
    v_mfma_f32_16x16x32_bf16 v[160:163], a[168:171], a[40:43], v[160:163]
    ds_read_b64_tr_b16 a[196:197], v242 offset:30368
    buffer_store_dwordx4 v[144:147], v254, s[20:23], s61 offen offset:0 sc1
    v_mfma_f32_16x16x32_bf16 v[164:167], a[168:171], a[44:47], v[164:167]
    ds_read_b64_tr_b16 a[198:199], v242 offset:30624
    s_waitcnt lgkmcnt(8)
    v_mfma_f32_16x16x32_bf16 v[168:171], a[172:175], a[40:43], v[168:171]
    ds_read_b64_tr_b16 a[168:169], v240 offset:25216
    v_cvt_pk_bf16_f32 v152, v152, v153
    v_mfma_f32_16x16x32_bf16 v[172:175], a[172:175], a[44:47], v[172:175]
    ds_read_b64_tr_b16 a[170:171], v240 offset:25472
    v_cvt_pk_bf16_f32 v153, v154, v155
    v_mfma_f32_16x16x32_bf16 v[160:163], a[176:179], a[48:51], v[160:163]
    ds_read_b64_tr_b16 a[172:173], v240 offset:25248
    v_cvt_pk_bf16_f32 v154, v156, v157
    v_mfma_f32_16x16x32_bf16 v[164:167], a[176:179], a[52:55], v[164:167]
    ds_read_b64_tr_b16 a[174:175], v240 offset:25504
    v_cvt_pk_bf16_f32 v155, v158, v159
    v_mfma_f32_16x16x32_bf16 v[168:171], a[180:183], a[48:51], v[168:171]
    ds_read_b64_tr_b16 a[176:177], v240 offset:26240
    buffer_store_dwordx4 v[152:155], v254, s[20:23], s61 offen offset:1024 sc1
    v_mfma_f32_16x16x32_bf16 v[172:175], a[180:183], a[52:55], v[172:175]
    ds_read_b64_tr_b16 a[178:179], v240 offset:26496
    s_waitcnt lgkmcnt(8)
    v_mfma_f32_16x16x32_bf16 v[160:163], a[184:187], a[56:59], v[160:163]
    ds_read_b64_tr_b16 a[180:181], v240 offset:26272
    v_mfma_f32_16x16x32_bf16 v[164:167], a[184:187], a[60:63], v[164:167]
    ds_read_b64_tr_b16 a[182:183], v240 offset:26528
    v_mfma_f32_16x16x32_bf16 v[168:171], a[188:191], a[56:59], v[168:171]
    ds_read_b64_tr_b16 a[184:185], v240 offset:27264
    v_mfma_f32_16x16x32_bf16 v[172:175], a[188:191], a[60:63], v[172:175]
    ds_read_b64_tr_b16 a[186:187], v240 offset:27520
    v_mfma_f32_16x16x32_bf16 v[160:163], a[192:195], a[64:67], v[160:163]
    ds_read_b64_tr_b16 a[188:189], v240 offset:27296
    v_mfma_f32_16x16x32_bf16 v[164:167], a[192:195], a[68:71], v[164:167]
    ds_read_b64_tr_b16 a[190:191], v240 offset:27552
    s_waitcnt lgkmcnt(8)
    v_mfma_f32_16x16x32_bf16 v[168:171], a[196:199], a[64:67], v[168:171]
    ds_read_b64_tr_b16 a[192:193], v240 offset:28288
    v_mfma_f32_16x16x32_bf16 v[172:175], a[196:199], a[68:71], v[172:175]
    ds_read_b64_tr_b16 a[194:195], v240 offset:28544
    s_barrier
    v_mfma_f32_16x16x32_bf16 v[160:163], a[168:171], a[72:75], v[160:163]
    ds_read_b64_tr_b16 a[196:197], v240 offset:28320
    s_add_u32 m0, s64, 123520
    v_mfma_f32_16x16x32_bf16 v[164:167], a[168:171], a[76:79], v[164:167]
    ds_read_b64_tr_b16 a[198:199], v240 offset:28576
    buffer_load_dwordx4 v246, s[16:19], s90 offen offset:0 lds
    v_mfma_f32_16x16x32_bf16 v[168:171], a[172:175], a[72:75], v[168:171]
    ds_read_b64_tr_b16 a[168:169], v240 offset:29312
    v_mfma_f32_16x16x32_bf16 v[172:175], a[172:175], a[76:79], v[172:175]
    ds_read_b64_tr_b16 a[170:171], v240 offset:29568
    s_waitcnt lgkmcnt(8)
    v_mfma_f32_16x16x32_bf16 v[160:163], a[176:179], a[80:83], v[160:163]
    ds_read_b64_tr_b16 a[172:173], v240 offset:29344
L_w13:
    s_cbranch_execz L_wret3
    buffer_load_dwordx4 v247, s[16:19], s100 offen offset:1024 lds
    v_mfma_f32_16x16x32_bf16 v[164:167], a[176:179], a[84:87], v[164:167]
    ds_read_b64_tr_b16 a[174:175], v240 offset:29600
    v_mfma_f32_16x16x32_bf16 v[168:171], a[180:183], a[80:83], v[168:171]
    ds_read_b64_tr_b16 a[176:177], v240 offset:30336
    buffer_load_dwordx4 v248, s[16:19], s91 offen offset:2048 lds
    v_mfma_f32_16x16x32_bf16 v[172:175], a[180:183], a[84:87], v[172:175]
    ds_read_b64_tr_b16 a[178:179], v240 offset:30592
    s_add_u32 m0, s64, 126592
    v_mfma_f32_16x16x32_bf16 v[160:163], a[184:187], a[88:91], v[160:163]
    ds_read_b64_tr_b16 a[180:181], v240 offset:30368
    buffer_load_dwordx4 v246, s[16:19], s101 offen offset:0 lds
    v_mfma_f32_16x16x32_bf16 v[164:167], a[184:187], a[92:95], v[164:167]
    ds_read_b64_tr_b16 a[182:183], v240 offset:30624
    s_waitcnt lgkmcnt(8)
    v_mfma_f32_16x16x32_bf16 v[168:171], a[188:191], a[88:91], v[168:171]
    ds_read_b64_tr_b16 a[184:185], v241 offset:512
    s_waitcnt vmcnt(7)
    s_lshr_b32 s67, s65, 1
    s_xor_b32 s67, s67, 2
    s_lshl_b32 s67, s67, 8
    s_add_u32 s67, s67, s3
    s_lshl_b32 s68, s65, 2
    v_mov_b32 v249, s68
    v_mov_b32 v250, s51
    buffer_store_dword v250, v249, s[20:23], s67 offen offset:0 sc1
    v_mfma_f32_16x16x32_bf16 v[172:175], a[188:191], a[92:95], v[172:175]
    ds_read_b64_tr_b16 a[186:187], v241 offset:768
    buffer_load_dwordx4 v247, s[16:19], s92 offen offset:1024 lds
    v_mfma_f32_16x16x32_bf16 v[160:163], a[192:195], a[96:99], v[160:163]
    ds_read_b64_tr_b16 a[188:189], v241 offset:544
    v_mfma_f32_16x16x32_bf16 v[164:167], a[192:195], a[100:103], v[164:167]
    ds_read_b64_tr_b16 a[190:191], v241 offset:800
    buffer_load_dwordx4 v248, s[16:19], s77 offen offset:2048 lds
    v_mfma_f32_16x16x32_bf16 v[168:171], a[196:199], a[96:99], v[168:171]
    ds_read_b64_tr_b16 a[192:193], v241 offset:1536
    v_mfma_f32_16x16x32_bf16 v[172:175], a[196:199], a[100:103], v[172:175]
    ds_read_b64_tr_b16 a[194:195], v241 offset:1792
    s_waitcnt lgkmcnt(8)
    s_waitcnt vmcnt(9)
    v_cmp_ne_u32 vcc, s51, v81
    s_nop 0
    s_cmp_lg_u64 vcc, 0
    s_cbranch_scc1 L_spin_mp
L_back_mp:
    buffer_load_dwordx4 v[124:127], v134, s[20:23], s59 offen sc1
    s_add_u32 s59, s59, 884736
    buffer_load_dwordx4 v[128:131], v134, s[20:23], s59 offen sc1
    v_mfma_f32_16x16x32_bf16 v[160:163], a[168:171], a[104:107], v[160:163]
    ds_read_b64_tr_b16 a[196:197], v241 offset:1568
    v_lshlrev_b32_e64 v136, 16, v132
    v_mfma_f32_16x16x32_bf16 v[164:167], a[168:171], a[108:111], v[164:167]
    ds_read_b64_tr_b16 a[198:199], v241 offset:1824
    v_and_b32 v137, 0xffff0000, v132
    v_mfma_f32_16x16x32_bf16 v[168:171], a[172:175], a[104:107], v[168:171]
    ds_read_b64_tr_b16 a[168:169], v241 offset:2560
    v_lshlrev_b32_e64 v138, 16, v133
    v_mfma_f32_16x16x32_bf16 v[172:175], a[172:175], a[108:111], v[172:175]
    ds_read_b64_tr_b16 a[170:171], v241 offset:2816
    v_and_b32 v139, 0xffff0000, v133
    v_mfma_f32_16x16x32_bf16 v[160:163], a[176:179], a[112:115], v[160:163]
    ds_read_b64_tr_b16 a[172:173], v241 offset:2592
    s_xor_b32 s67, s65, 6
    s_mul_i32 s67, s67, 221184
    s_add_u32 s67, s67, s54
    buffer_load_dwordx4 v[48:51], v254, s[20:23], s67 offen offset:0 sc1
    buffer_load_dwordx4 v[52:55], v254, s[20:23], s67 offen offset:1024 sc1
    v_mfma_f32_16x16x32_bf16 v[164:167], a[176:179], a[116:119], v[164:167]
    ds_read_b64_tr_b16 a[174:175], v241 offset:2848
    s_waitcnt lgkmcnt(8)
    v_mfma_f32_16x16x32_bf16 v[168:171], a[180:183], a[112:115], v[168:171]
    ds_read_b64_tr_b16 a[176:177], v241 offset:3584
    v_mfma_f32_16x16x32_bf16 v[172:175], a[180:183], a[116:119], v[172:175]
    ds_read_b64_tr_b16 a[178:179], v241 offset:3840
    v_mfma_f32_16x16x32_bf16 v[160:163], a[184:187], a[120:123], v[160:163]
    ds_read_b64_tr_b16 a[180:181], v241 offset:3616
    v_mfma_f32_16x16x32_bf16 v[164:167], a[184:187], a[124:127], v[164:167]
    ds_read_b64_tr_b16 a[182:183], v241 offset:3872
    v_mfma_f32_16x16x32_bf16 v[168:171], a[188:191], a[120:123], v[168:171]
    ds_read_b64_tr_b16 a[184:185], v241 offset:4608
    s_xor_b32 s67, s65, 7
    s_mul_i32 s67, s67, 221184
    s_add_u32 s67, s67, s54
    buffer_load_dwordx4 v[56:59], v254, s[20:23], s67 offen offset:0 sc1
    buffer_load_dwordx4 v[60:63], v254, s[20:23], s67 offen offset:1024 sc1
    v_mfma_f32_16x16x32_bf16 v[172:175], a[188:191], a[124:127], v[172:175]
    ds_read_b64_tr_b16 a[186:187], v241 offset:4864
    s_waitcnt lgkmcnt(8)
    v_mfma_f32_16x16x32_bf16 v[160:163], a[192:195], a[128:131], v[160:163]
    ds_read_b64_tr_b16 a[188:189], v241 offset:4640
    v_mfma_f32_16x16x32_bf16 v[164:167], a[192:195], a[132:135], v[164:167]
    ds_read_b64_tr_b16 a[190:191], v241 offset:4896
    v_mfma_f32_16x16x32_bf16 v[168:171], a[196:199], a[128:131], v[168:171]
    ds_read_b64_tr_b16 a[192:193], v241 offset:5632
    v_mfma_f32_16x16x32_bf16 v[172:175], a[196:199], a[132:135], v[172:175]
    ds_read_b64_tr_b16 a[194:195], v241 offset:5888
    v_mfma_f32_16x16x32_bf16 v[160:163], a[168:171], a[136:139], v[160:163]
    ds_read_b64_tr_b16 a[196:197], v241 offset:5664
    v_mfma_f32_16x16x32_bf16 v[164:167], a[168:171], a[140:143], v[164:167]
    ds_read_b64_tr_b16 a[198:199], v241 offset:5920
    s_waitcnt lgkmcnt(8)
    v_mfma_f32_16x16x32_bf16 v[168:171], a[172:175], a[136:139], v[168:171]
    ds_read_b64_tr_b16 a[168:169], v242 offset:3584
    v_mfma_f32_16x16x32_bf16 v[172:175], a[172:175], a[140:143], v[172:175]
    ds_read_b64_tr_b16 a[170:171], v242 offset:3840
    v_mfma_f32_16x16x32_bf16 v[160:163], a[176:179], a[144:147], v[160:163]
    ds_read_b64_tr_b16 a[172:173], v242 offset:3616
    v_mfma_f32_16x16x32_bf16 v[164:167], a[176:179], a[148:151], v[164:167]
    ds_read_b64_tr_b16 a[174:175], v242 offset:3872
    v_mfma_f32_16x16x32_bf16 v[168:171], a[180:183], a[144:147], v[168:171]
    ds_read_b64_tr_b16 a[176:177], v242 offset:4608
    v_mfma_f32_16x16x32_bf16 v[172:175], a[180:183], a[148:151], v[172:175]
    ds_read_b64_tr_b16 a[178:179], v242 offset:4864
    s_waitcnt lgkmcnt(8)
    v_mfma_f32_16x16x32_bf16 v[160:163], a[184:187], a[152:155], v[160:163]
    ds_read_b64_tr_b16 a[180:181], v242 offset:4640
    v_mfma_f32_16x16x32_bf16 v[164:167], a[184:187], a[156:159], v[164:167]
    ds_read_b64_tr_b16 a[182:183], v242 offset:4896
    v_mfma_f32_16x16x32_bf16 v[168:171], a[188:191], a[152:155], v[168:171]
    ds_read_b64_tr_b16 a[184:185], v242 offset:5632
    v_mfma_f32_16x16x32_bf16 v[172:175], a[188:191], a[156:159], v[172:175]
    ds_read_b64_tr_b16 a[186:187], v242 offset:5888
    v_mfma_f32_16x16x32_bf16 v[160:163], a[192:195], a[160:163], v[160:163]
    ds_read_b64_tr_b16 a[188:189], v242 offset:5664
    v_mfma_f32_16x16x32_bf16 v[164:167], a[192:195], a[164:167], v[164:167]
    ds_read_b64_tr_b16 a[190:191], v242 offset:5920
    s_waitcnt lgkmcnt(8)
    v_mfma_f32_16x16x32_bf16 v[168:171], a[196:199], a[160:163], v[168:171]
    s_barrier
    ds_read_b64_tr_b16 a[192:193], v241 offset:24704
    v_mfma_f32_16x16x32_bf16 v[172:175], a[196:199], a[164:167], v[172:175]
    ds_read_b64_tr_b16 a[194:195], v241 offset:24960
    v_mfma_f32_16x16x32_bf16 v[160:163], a[168:171], a[0:3], v[160:163]
    ds_read_b64_tr_b16 a[196:197], v241 offset:25728
    v_mfma_f32_16x16x32_bf16 v[164:167], a[168:171], a[4:7], v[164:167]
    ds_read_b64_tr_b16 a[198:199], v241 offset:25984
    v_mfma_f32_16x16x32_bf16 v[168:171], a[172:175], a[0:3], v[168:171]
    ds_read_b64_tr_b16 a[168:169], v241 offset:26752
    v_mfma_f32_16x16x32_bf16 v[172:175], a[172:175], a[4:7], v[172:175]
    ds_read_b64_tr_b16 a[170:171], v241 offset:27008
    s_waitcnt lgkmcnt(8)
    v_mfma_f32_16x16x32_bf16 v[160:163], a[176:179], a[8:11], v[160:163]
    ds_read_b64_tr_b16 a[172:173], v241 offset:27776
    v_mfma_f32_16x16x32_bf16 v[164:167], a[176:179], a[12:15], v[164:167]
    ds_read_b64_tr_b16 a[174:175], v241 offset:28032
    v_mfma_f32_16x16x32_bf16 v[168:171], a[180:183], a[8:11], v[168:171]
    ds_read_b64_tr_b16 a[176:177], v241 offset:28800
    v_mfma_f32_16x16x32_bf16 v[172:175], a[180:183], a[12:15], v[172:175]
    ds_read_b64_tr_b16 a[178:179], v241 offset:29056
    v_bfe_u32 v80, v254, 4, 1
    v_or_b32 v80, 4, v80
    v_xor_b32 v80, s65, v80
    v_lshlrev_b32 v80, 2, v80
    buffer_load_dword v81, v80, s[20:23], s48 offen sc1
    v_mfma_f32_16x16x32_bf16 v[160:163], a[184:187], a[16:19], v[160:163]
    ds_read_b64_tr_b16 a[180:181], v241 offset:29824
    v_mfma_f32_16x16x32_bf16 v[164:167], a[184:187], a[20:23], v[164:167]
    ds_read_b64_tr_b16 a[182:183], v241 offset:30080
    s_waitcnt lgkmcnt(8)
    v_mfma_f32_16x16x32_bf16 v[168:171], a[188:191], a[16:19], v[168:171]
    s_barrier
    ds_read_b64_tr_b16 a[184:185], v240 offset:0
    v_mfma_f32_16x16x32_bf16 v[172:175], a[188:191], a[20:23], v[172:175]
    ds_read_b64_tr_b16 a[186:187], v240 offset:256
    v_mfma_f32_16x16x32_bf16 v[176:179], a[192:195], a[0:3], 0
    ds_read_b64_tr_b16 a[188:189], v240 offset:1024
    v_mfma_f32_16x16x32_bf16 v[180:183], a[192:195], a[4:7], 0
    ds_read_b64_tr_b16 a[190:191], v240 offset:1280
    v_mfma_f32_16x16x32_bf16 v[176:179], a[196:199], a[8:11], v[176:179]
    ds_read_b64_tr_b16 a[192:193], v240 offset:2048
    v_mfma_f32_16x16x32_bf16 v[180:183], a[196:199], a[12:15], v[180:183]
    ds_read_b64_tr_b16 a[194:195], v240 offset:2304
    s_waitcnt lgkmcnt(8)
    v_mfma_f32_16x16x32_bf16 v[176:179], a[168:171], a[16:19], v[176:179]
    ds_read_b64_tr_b16 a[196:197], v240 offset:3072
    v_cvt_pk_bf16_f32 v160, v160, v161
    v_mfma_f32_16x16x32_bf16 v[180:183], a[168:171], a[20:23], v[180:183]
    ds_read_b64_tr_b16 a[198:199], v240 offset:3328
    v_cvt_pk_bf16_f32 v161, v162, v163
    v_mfma_f32_16x16x32_bf16 v[176:179], a[172:175], a[24:27], v[176:179]
    ds_read_b64_tr_b16 a[168:169], v240 offset:4096
    v_cvt_pk_bf16_f32 v162, v164, v165
    v_mfma_f32_16x16x32_bf16 v[180:183], a[172:175], a[28:31], v[180:183]
    ds_read_b64_tr_b16 a[170:171], v240 offset:4352
    v_cvt_pk_bf16_f32 v163, v166, v167
    v_mfma_f32_16x16x32_bf16 v[176:179], a[176:179], a[32:35], v[176:179]
    ds_read_b64_tr_b16 a[172:173], v240 offset:5120
    buffer_store_dwordx4 v[160:163], v254, s[20:23], s60 offen offset:0 sc1
    v_mfma_f32_16x16x32_bf16 v[180:183], a[176:179], a[36:39], v[180:183]
    ds_read_b64_tr_b16 a[174:175], v240 offset:5376
    s_waitcnt lgkmcnt(8)
    v_mfma_f32_16x16x32_bf16 v[176:179], a[180:183], a[40:43], v[176:179]
    s_barrier
    ds_read_b64_tr_b16 a[176:177], v242 offset:0
    v_mfma_f32_16x16x32_bf16 v[180:183], a[180:183], a[44:47], v[180:183]
    ds_read_b64_tr_b16 a[178:179], v242 offset:256
    v_cvt_pk_bf16_f32 v168, v168, v169
    v_mfma_f32_16x16x32_bf16 v[176:179], a[184:187], a[48:51], v[176:179]
    ds_read_b64_tr_b16 a[180:181], v242 offset:1024
    v_cvt_pk_bf16_f32 v169, v170, v171
    v_mfma_f32_16x16x32_bf16 v[180:183], a[184:187], a[52:55], v[180:183]
    ds_read_b64_tr_b16 a[182:183], v242 offset:1280
    v_cvt_pk_bf16_f32 v170, v172, v173
    v_mfma_f32_16x16x32_bf16 v[176:179], a[188:191], a[56:59], v[176:179]
    ds_read_b64_tr_b16 a[184:185], v242 offset:2048
    v_cvt_pk_bf16_f32 v171, v174, v175
    v_mfma_f32_16x16x32_bf16 v[180:183], a[188:191], a[60:63], v[180:183]
    ds_read_b64_tr_b16 a[186:187], v242 offset:2304
    s_waitcnt lgkmcnt(8)
    v_mfma_f32_16x16x32_bf16 v[176:179], a[192:195], a[64:67], v[176:179]
    s_waitcnt vmcnt(8)
    s_barrier
    ds_read_b64_tr_b16 a[188:189], v242 offset:24704
    v_mfma_f32_16x16x32_bf16 v[180:183], a[192:195], a[68:71], v[180:183]
    ds_read_b64_tr_b16 a[190:191], v242 offset:24960
    buffer_store_dwordx4 v[168:171], v254, s[20:23], s60 offen offset:1024 sc1
    v_mfma_f32_16x16x32_bf16 v[176:179], a[196:199], a[72:75], v[176:179]
    ds_read_b64_tr_b16 a[192:193], v242 offset:25728
    v_mfma_f32_16x16x32_bf16 v[180:183], a[196:199], a[76:79], v[180:183]
    ds_read_b64_tr_b16 a[194:195], v242 offset:25984
    v_mfma_f32_16x16x32_bf16 v[176:179], a[168:171], a[80:83], v[176:179]
    ds_read_b64_tr_b16 a[196:197], v242 offset:26752
    v_mfma_f32_16x16x32_bf16 v[180:183], a[168:171], a[84:87], v[180:183]
    ds_read_b64_tr_b16 a[198:199], v242 offset:27008
    s_waitcnt lgkmcnt(8)
    v_mfma_f32_16x16x32_bf16 v[176:179], a[172:175], a[88:91], v[176:179]
    ds_read_b64_tr_b16 a[168:169], v242 offset:27776
    v_mfma_f32_16x16x32_bf16 v[180:183], a[172:175], a[92:95], v[180:183]
    ds_read_b64_tr_b16 a[170:171], v242 offset:28032
    v_mfma_f32_16x16x32_bf16 v[176:179], a[176:179], a[144:147], v[176:179]
    ds_read_b64_tr_b16 a[172:173], v242 offset:28800
    v_mfma_f32_16x16x32_bf16 v[180:183], a[176:179], a[148:151], v[180:183]
    ds_read_b64_tr_b16 a[174:175], v242 offset:29056
    v_mfma_f32_16x16x32_bf16 v[176:179], a[180:183], a[152:155], v[176:179]
    ds_read_b64_tr_b16 a[176:177], v242 offset:29824
    v_mfma_f32_16x16x32_bf16 v[180:183], a[180:183], a[156:159], v[180:183]
    ds_read_b64_tr_b16 a[178:179], v242 offset:30080
    s_waitcnt lgkmcnt(8)
    v_mfma_f32_16x16x32_bf16 v[176:179], a[184:187], a[160:163], v[176:179]
    ds_read_b64_tr_b16 a[180:181], v241 offset:24736
    v_mfma_f32_16x16x32_bf16 v[180:183], a[184:187], a[164:167], v[180:183]
    ds_read_b64_tr_b16 a[182:183], v241 offset:24992
    v_mfma_f32_16x16x32_bf16 v[176:179], a[188:191], a[96:99], v[176:179]
    ds_read_b64_tr_b16 a[184:185], v241 offset:25760
    v_mfma_f32_16x16x32_bf16 v[180:183], a[188:191], a[100:103], v[180:183]
    ds_read_b64_tr_b16 a[186:187], v241 offset:26016
    v_mfma_f32_16x16x32_bf16 v[176:179], a[192:195], a[104:107], v[176:179]
    ds_read_b64_tr_b16 a[188:189], v241 offset:26784
    v_mfma_f32_16x16x32_bf16 v[180:183], a[192:195], a[108:111], v[180:183]
    ds_read_b64_tr_b16 a[190:191], v241 offset:27040
    s_waitcnt lgkmcnt(8)
    v_mfma_f32_16x16x32_bf16 v[176:179], a[196:199], a[112:115], v[176:179]
    ds_read_b64_tr_b16 a[192:193], v241 offset:27808
    v_mfma_f32_16x16x32_bf16 v[180:183], a[196:199], a[116:119], v[180:183]
    ds_read_b64_tr_b16 a[194:195], v241 offset:28064
    v_mfma_f32_16x16x32_bf16 v[176:179], a[168:171], a[120:123], v[176:179]
    ds_read_b64_tr_b16 a[196:197], v241 offset:28832
    v_mfma_f32_16x16x32_bf16 v[180:183], a[168:171], a[124:127], v[180:183]
    ds_read_b64_tr_b16 a[198:199], v241 offset:29088
    v_mfma_f32_16x16x32_bf16 v[176:179], a[172:175], a[128:131], v[176:179]
    ds_read_b64_tr_b16 a[168:169], v241 offset:29856
    v_mfma_f32_16x16x32_bf16 v[180:183], a[172:175], a[132:135], v[180:183]
    ds_read_b64_tr_b16 a[170:171], v241 offset:30112
    s_waitcnt lgkmcnt(8)
    v_mfma_f32_16x16x32_bf16 v[176:179], a[176:179], a[136:139], v[176:179]
    ds_read_b64_tr_b16 a[172:173], v240 offset:32
    v_mfma_f32_16x16x32_bf16 v[180:183], a[176:179], a[140:143], v[180:183]
    ds_read_b64_tr_b16 a[174:175], v240 offset:288
    v_mfma_f32_16x16x32_bf16 v[184:187], a[180:183], a[0:3], 0
    ds_read_b64_tr_b16 a[176:177], v240 offset:1056
    v_mfma_f32_16x16x32_bf16 v[188:191], a[180:183], a[4:7], 0
    ds_read_b64_tr_b16 a[178:179], v240 offset:1312
    v_mfma_f32_16x16x32_bf16 v[184:187], a[184:187], a[8:11], v[184:187]
    ds_read_b64_tr_b16 a[180:181], v240 offset:2080
    v_mfma_f32_16x16x32_bf16 v[188:191], a[184:187], a[12:15], v[188:191]
    ds_read_b64_tr_b16 a[182:183], v240 offset:2336
    s_waitcnt lgkmcnt(8)
    v_mfma_f32_16x16x32_bf16 v[184:187], a[188:191], a[16:19], v[184:187]
    ds_read_b64_tr_b16 a[184:185], v240 offset:3104
    v_cvt_pk_bf16_f32 v176, v176, v177
    v_mfma_f32_16x16x32_bf16 v[188:191], a[188:191], a[20:23], v[188:191]
    ds_read_b64_tr_b16 a[186:187], v240 offset:3360
    v_cvt_pk_bf16_f32 v177, v178, v179
    v_mfma_f32_16x16x32_bf16 v[184:187], a[192:195], a[24:27], v[184:187]
    ds_read_b64_tr_b16 a[188:189], v240 offset:4128
    v_cvt_pk_bf16_f32 v178, v180, v181
    v_mfma_f32_16x16x32_bf16 v[188:191], a[192:195], a[28:31], v[188:191]
    ds_read_b64_tr_b16 a[190:191], v240 offset:4384
    v_cvt_pk_bf16_f32 v179, v182, v183
    v_mfma_f32_16x16x32_bf16 v[184:187], a[196:199], a[32:35], v[184:187]
    ds_read_b64_tr_b16 a[192:193], v240 offset:5152
    buffer_store_dwordx4 v[176:179], v254, s[20:23], s55 offen offset:0 sc1
    v_mfma_f32_16x16x32_bf16 v[188:191], a[196:199], a[36:39], v[188:191]
    ds_read_b64_tr_b16 a[194:195], v240 offset:5408
    s_waitcnt lgkmcnt(8)
    s_waitcnt vmcnt(3)
    v_cmp_ne_u32 vcc, s51, v81
    s_nop 0
    s_cmp_lg_u64 vcc, 0
    s_cbranch_scc1 L_spin_ep
L_back_ep:
    v_mfma_f32_16x16x32_bf16 v[184:187], a[168:171], a[40:43], v[184:187]
    ds_read_b64_tr_b16 a[196:197], v242 offset:32
    s_xor_b32 s67, s65, 4
    s_mul_i32 s67, s67, 221184
    s_add_u32 s67, s67, s54
    buffer_load_dwordx4 v[32:35], v254, s[20:23], s67 offen offset:0 sc1
    buffer_load_dwordx4 v[36:39], v254, s[20:23], s67 offen offset:1024 sc1
    v_mfma_f32_16x16x32_bf16 v[188:191], a[168:171], a[44:47], v[188:191]
    ds_read_b64_tr_b16 a[198:199], v242 offset:288
    v_mfma_f32_16x16x32_bf16 v[184:187], a[172:175], a[48:51], v[184:187]
    ds_read_b64_tr_b16 a[168:169], v242 offset:1056
    v_mfma_f32_16x16x32_bf16 v[188:191], a[172:175], a[52:55], v[188:191]
    ds_read_b64_tr_b16 a[170:171], v242 offset:1312
    v_mfma_f32_16x16x32_bf16 v[136:139], v[120:123], v[124:127], v[136:139]
    v_mfma_f32_16x16x32_bf16 v[136:139], v[120:123], v[128:131], v[136:139]
    v_mfma_f32_16x16x32_bf16 v[184:187], a[176:179], a[56:59], v[184:187]
    ds_read_b64_tr_b16 a[172:173], v242 offset:2080
    s_xor_b32 s67, s65, 5
    s_mul_i32 s67, s67, 221184
    s_add_u32 s67, s67, s54
    buffer_load_dwordx4 v[40:43], v254, s[20:23], s67 offen offset:0 sc1
    buffer_load_dwordx4 v[44:47], v254, s[20:23], s67 offen offset:1024 sc1
    v_mfma_f32_16x16x32_bf16 v[188:191], a[176:179], a[60:63], v[188:191]
    ds_read_b64_tr_b16 a[174:175], v242 offset:2336
    s_waitcnt lgkmcnt(8)
    v_mfma_f32_16x16x32_bf16 v[184:187], a[180:183], a[64:67], v[184:187]
    ds_read_b64_tr_b16 a[176:177], v242 offset:24736
    v_mfma_f32_16x16x32_bf16 v[188:191], a[180:183], a[68:71], v[188:191]
    ds_read_b64_tr_b16 a[178:179], v242 offset:24992
    v_mfma_f32_16x16x32_bf16 v[184:187], a[184:187], a[72:75], v[184:187]
    ds_read_b64_tr_b16 a[180:181], v242 offset:25760
    v_mfma_f32_16x16x32_bf16 v[188:191], a[184:187], a[76:79], v[188:191]
    ds_read_b64_tr_b16 a[182:183], v242 offset:26016
    v_mfma_f32_16x16x32_bf16 v[184:187], a[188:191], a[80:83], v[184:187]
    ds_read_b64_tr_b16 a[184:185], v242 offset:26784
    v_cvt_pk_bf16_f32 v136, v136, v137
    v_mfma_f32_16x16x32_bf16 v[188:191], a[188:191], a[84:87], v[188:191]
    ds_read_b64_tr_b16 a[186:187], v242 offset:27040
    s_waitcnt lgkmcnt(8)
    v_mfma_f32_16x16x32_bf16 v[184:187], a[192:195], a[88:91], v[184:187]
    ds_read_b64_tr_b16 a[188:189], v242 offset:27808
    v_cvt_pk_bf16_f32 v137, v138, v139
    v_mfma_f32_16x16x32_bf16 v[188:191], a[192:195], a[92:95], v[188:191]
    ds_read_b64_tr_b16 a[190:191], v242 offset:28064
    buffer_store_dwordx2 v[136:137], v135, s[36:39], s52 offen
    v_mfma_f32_16x16x32_bf16 v[184:187], a[196:199], a[144:147], v[184:187]
    ds_read_b64_tr_b16 a[192:193], v242 offset:28832
    v_mfma_f32_16x16x32_bf16 v[188:191], a[196:199], a[148:151], v[188:191]
    ds_read_b64_tr_b16 a[194:195], v242 offset:29088
    v_mfma_f32_16x16x32_bf16 v[184:187], a[168:171], a[152:155], v[184:187]
    ds_read_b64_tr_b16 a[196:197], v242 offset:29856
    v_mfma_f32_16x16x32_bf16 v[188:191], a[168:171], a[156:159], v[188:191]
    ds_read_b64_tr_b16 a[198:199], v242 offset:30112
    s_waitcnt lgkmcnt(8)
    v_mfma_f32_16x16x32_bf16 v[184:187], a[172:175], a[160:163], v[184:187]
    ds_read_b64_tr_b16 a[168:169], v241 offset:25216
    v_mfma_f32_16x16x32_bf16 v[188:191], a[172:175], a[164:167], v[188:191]
    ds_read_b64_tr_b16 a[170:171], v241 offset:25472
    v_mfma_f32_16x16x32_bf16 v[184:187], a[176:179], a[96:99], v[184:187]
    ds_read_b64_tr_b16 a[172:173], v241 offset:25248
    buffer_load_dwordx4 v[24:27], v254, s[20:23], s78 offen offset:0 sc1
    v_mfma_f32_16x16x32_bf16 v[188:191], a[176:179], a[100:103], v[188:191]
    ds_read_b64_tr_b16 a[174:175], v241 offset:25504
    v_mfma_f32_16x16x32_bf16 v[184:187], a[180:183], a[104:107], v[184:187]
    ds_read_b64_tr_b16 a[176:177], v241 offset:26240
    buffer_load_dwordx4 v[28:31], v254, s[20:23], s78 offen offset:1024 sc1
    v_mfma_f32_16x16x32_bf16 v[188:191], a[180:183], a[108:111], v[188:191]
    ds_read_b64_tr_b16 a[178:179], v241 offset:26496
    s_waitcnt lgkmcnt(8)
    v_mfma_f32_16x16x32_bf16 v[184:187], a[184:187], a[112:115], v[184:187]
    ds_read_b64_tr_b16 a[180:181], v241 offset:26272
    v_mfma_f32_16x16x32_bf16 v[188:191], a[184:187], a[116:119], v[188:191]
    ds_read_b64_tr_b16 a[182:183], v241 offset:26528
    v_mfma_f32_16x16x32_bf16 v[184:187], a[188:191], a[120:123], v[184:187]
    ds_read_b64_tr_b16 a[184:185], v241 offset:27264
    v_mfma_f32_16x16x32_bf16 v[188:191], a[188:191], a[124:127], v[188:191]
    ds_read_b64_tr_b16 a[186:187], v241 offset:27520
    v_mfma_f32_16x16x32_bf16 v[184:187], a[192:195], a[128:131], v[184:187]
    ds_read_b64_tr_b16 a[188:189], v241 offset:27296
    v_mfma_f32_16x16x32_bf16 v[188:191], a[192:195], a[132:135], v[188:191]
    ds_read_b64_tr_b16 a[190:191], v241 offset:27552
    s_waitcnt lgkmcnt(8)
    v_mfma_f32_16x16x32_bf16 v[184:187], a[196:199], a[136:139], v[184:187]
    ds_read_b64_tr_b16 a[192:193], v241 offset:28288
    v_mfma_f32_16x16x32_bf16 v[188:191], a[196:199], a[140:143], v[188:191]
    ds_read_b64_tr_b16 a[194:195], v241 offset:28544
    v_mfma_f32_16x16x32_bf16 v[192:195], a[168:171], a[0:3], 0
    ds_read_b64_tr_b16 a[196:197], v241 offset:28320
    v_mfma_f32_16x16x32_bf16 v[196:199], a[168:171], a[4:7], 0
    ds_read_b64_tr_b16 a[198:199], v241 offset:28576
    v_mfma_f32_16x16x32_bf16 v[200:203], a[172:175], a[0:3], 0
    ds_read_b64_tr_b16 a[168:169], v241 offset:29312
    v_mfma_f32_16x16x32_bf16 v[204:207], a[172:175], a[4:7], 0
    ds_read_b64_tr_b16 a[170:171], v241 offset:29568
    s_waitcnt lgkmcnt(8)
    v_mfma_f32_16x16x32_bf16 v[192:195], a[176:179], a[8:11], v[192:195]
    ds_read_b64_tr_b16 a[172:173], v241 offset:29344
    v_cvt_pk_bf16_f32 v184, v184, v185
    v_mfma_f32_16x16x32_bf16 v[196:199], a[176:179], a[12:15], v[196:199]
    ds_read_b64_tr_b16 a[174:175], v241 offset:29600
    v_cvt_pk_bf16_f32 v185, v186, v187
    v_mfma_f32_16x16x32_bf16 v[200:203], a[180:183], a[8:11], v[200:203]
    ds_read_b64_tr_b16 a[176:177], v241 offset:30336
    v_cvt_pk_bf16_f32 v186, v188, v189
    v_mfma_f32_16x16x32_bf16 v[204:207], a[180:183], a[12:15], v[204:207]
    ds_read_b64_tr_b16 a[178:179], v241 offset:30592
    v_cvt_pk_bf16_f32 v187, v190, v191
    v_mfma_f32_16x16x32_bf16 v[192:195], a[184:187], a[16:19], v[192:195]
    ds_read_b64_tr_b16 a[180:181], v241 offset:30368
    buffer_store_dwordx4 v[184:187], v254, s[20:23], s55 offen offset:1024 sc1
    v_mfma_f32_16x16x32_bf16 v[196:199], a[184:187], a[20:23], v[196:199]
    ds_read_b64_tr_b16 a[182:183], v241 offset:30624
    s_waitcnt lgkmcnt(8)
    v_mfma_f32_16x16x32_bf16 v[200:203], a[188:191], a[16:19], v[200:203]
    ds_read_b64_tr_b16 a[184:185], v240 offset:512
    v_mfma_f32_16x16x32_bf16 v[204:207], a[188:191], a[20:23], v[204:207]
    ds_read_b64_tr_b16 a[186:187], v240 offset:768
    v_mfma_f32_16x16x32_bf16 v[192:195], a[192:195], a[24:27], v[192:195]
    ds_read_b64_tr_b16 a[188:189], v240 offset:544
    v_mfma_f32_16x16x32_bf16 v[196:199], a[192:195], a[28:31], v[196:199]
    ds_read_b64_tr_b16 a[190:191], v240 offset:800
    v_mfma_f32_16x16x32_bf16 v[200:203], a[196:199], a[24:27], v[200:203]
    ds_read_b64_tr_b16 a[192:193], v240 offset:1536
    v_mfma_f32_16x16x32_bf16 v[204:207], a[196:199], a[28:31], v[204:207]
    ds_read_b64_tr_b16 a[194:195], v240 offset:1792
    s_waitcnt lgkmcnt(8)
    v_mfma_f32_16x16x32_bf16 v[192:195], a[168:171], a[32:35], v[192:195]
    ds_read_b64_tr_b16 a[196:197], v240 offset:1568
    v_mfma_f32_16x16x32_bf16 v[196:199], a[168:171], a[36:39], v[196:199]
    ds_read_b64_tr_b16 a[198:199], v240 offset:1824
    v_mfma_f32_16x16x32_bf16 v[200:203], a[172:175], a[32:35], v[200:203]
    ds_read_b64_tr_b16 a[168:169], v240 offset:2560
    v_mfma_f32_16x16x32_bf16 v[204:207], a[172:175], a[36:39], v[204:207]
    ds_read_b64_tr_b16 a[170:171], v240 offset:2816
    v_mfma_f32_16x16x32_bf16 v[192:195], a[176:179], a[40:43], v[192:195]
    ds_read_b64_tr_b16 a[172:173], v240 offset:2592
    v_mfma_f32_16x16x32_bf16 v[196:199], a[176:179], a[44:47], v[196:199]
    ds_read_b64_tr_b16 a[174:175], v240 offset:2848
    s_waitcnt lgkmcnt(8)
    v_mfma_f32_16x16x32_bf16 v[200:203], a[180:183], a[40:43], v[200:203]
    ds_read_b64_tr_b16 a[176:177], v240 offset:3584
    v_mfma_f32_16x16x32_bf16 v[204:207], a[180:183], a[44:47], v[204:207]
    ds_read_b64_tr_b16 a[178:179], v240 offset:3840
    v_mfma_f32_16x16x32_bf16 v[192:195], a[184:187], a[48:51], v[192:195]
    ds_read_b64_tr_b16 a[180:181], v240 offset:3616
    buffer_load_dwordx4 v[16:19], v254, s[20:23], s63 offen offset:0 sc1
    v_mfma_f32_16x16x32_bf16 v[196:199], a[184:187], a[52:55], v[196:199]
    ds_read_b64_tr_b16 a[182:183], v240 offset:3872
    v_mfma_f32_16x16x32_bf16 v[200:203], a[188:191], a[48:51], v[200:203]
    ds_read_b64_tr_b16 a[184:185], v240 offset:4608
    buffer_load_dwordx4 v[20:23], v254, s[20:23], s63 offen offset:1024 sc1
    v_mfma_f32_16x16x32_bf16 v[204:207], a[188:191], a[52:55], v[204:207]
    ds_read_b64_tr_b16 a[186:187], v240 offset:4864
    s_waitcnt lgkmcnt(8)
    v_mfma_f32_16x16x32_bf16 v[192:195], a[192:195], a[56:59], v[192:195]
    ds_read_b64_tr_b16 a[188:189], v240 offset:4640
    v_mfma_f32_16x16x32_bf16 v[196:199], a[192:195], a[60:63], v[196:199]
    ds_read_b64_tr_b16 a[190:191], v240 offset:4896
    v_mfma_f32_16x16x32_bf16 v[200:203], a[196:199], a[56:59], v[200:203]
    ds_read_b64_tr_b16 a[192:193], v240 offset:5632
    v_mfma_f32_16x16x32_bf16 v[204:207], a[196:199], a[60:63], v[204:207]
    ds_read_b64_tr_b16 a[194:195], v240 offset:5888
    v_mfma_f32_16x16x32_bf16 v[192:195], a[168:171], a[64:67], v[192:195]
    ds_read_b64_tr_b16 a[196:197], v240 offset:5664
    v_mfma_f32_16x16x32_bf16 v[196:199], a[168:171], a[68:71], v[196:199]
    ds_read_b64_tr_b16 a[198:199], v240 offset:5920
    s_waitcnt lgkmcnt(8)
    v_mfma_f32_16x16x32_bf16 v[200:203], a[172:175], a[64:67], v[200:203]
    ds_read_b64_tr_b16 a[168:169], v242 offset:512
    v_mfma_f32_16x16x32_bf16 v[204:207], a[172:175], a[68:71], v[204:207]
    ds_read_b64_tr_b16 a[170:171], v242 offset:768
    v_mfma_f32_16x16x32_bf16 v[192:195], a[176:179], a[72:75], v[192:195]
    ds_read_b64_tr_b16 a[172:173], v242 offset:544
    v_mfma_f32_16x16x32_bf16 v[196:199], a[176:179], a[76:79], v[196:199]
    ds_read_b64_tr_b16 a[174:175], v242 offset:800
    v_mfma_f32_16x16x32_bf16 v[200:203], a[180:183], a[72:75], v[200:203]
    ds_read_b64_tr_b16 a[176:177], v242 offset:1536
    v_mfma_f32_16x16x32_bf16 v[204:207], a[180:183], a[76:79], v[204:207]
    ds_read_b64_tr_b16 a[178:179], v242 offset:1792
    s_waitcnt lgkmcnt(8)
    v_mfma_f32_16x16x32_bf16 v[192:195], a[184:187], a[80:83], v[192:195]
    ds_read_b64_tr_b16 a[180:181], v242 offset:1568
    v_mfma_f32_16x16x32_bf16 v[196:199], a[184:187], a[84:87], v[196:199]
    ds_read_b64_tr_b16 a[182:183], v242 offset:1824
    v_mfma_f32_16x16x32_bf16 v[200:203], a[188:191], a[80:83], v[200:203]
    ds_read_b64_tr_b16 a[184:185], v242 offset:2560
    v_mfma_f32_16x16x32_bf16 v[204:207], a[188:191], a[84:87], v[204:207]
    ds_read_b64_tr_b16 a[186:187], v242 offset:2816
    v_mfma_f32_16x16x32_bf16 v[192:195], a[192:195], a[88:91], v[192:195]
    ds_read_b64_tr_b16 a[188:189], v242 offset:2592
    v_mfma_f32_16x16x32_bf16 v[196:199], a[192:195], a[92:95], v[196:199]
    ds_read_b64_tr_b16 a[190:191], v242 offset:2848
    s_waitcnt lgkmcnt(8)
    v_mfma_f32_16x16x32_bf16 v[200:203], a[196:199], a[88:91], v[200:203]
    ds_read_b64_tr_b16 a[192:193], v242 offset:25216
    v_mfma_f32_16x16x32_bf16 v[204:207], a[196:199], a[92:95], v[204:207]
    ds_read_b64_tr_b16 a[194:195], v242 offset:25472
    v_mfma_f32_16x16x32_bf16 v[192:195], a[168:171], a[144:147], v[192:195]
    ds_read_b64_tr_b16 a[196:197], v242 offset:25248
    v_mfma_f32_16x16x32_bf16 v[196:199], a[168:171], a[148:151], v[196:199]
    ds_read_b64_tr_b16 a[198:199], v242 offset:25504
    v_mfma_f32_16x16x32_bf16 v[200:203], a[172:175], a[144:147], v[200:203]
    ds_read_b64_tr_b16 a[168:169], v242 offset:26240
    v_mfma_f32_16x16x32_bf16 v[204:207], a[172:175], a[148:151], v[204:207]
    ds_read_b64_tr_b16 a[170:171], v242 offset:26496
    s_waitcnt lgkmcnt(8)
    v_mfma_f32_16x16x32_bf16 v[192:195], a[176:179], a[152:155], v[192:195]
    ds_read_b64_tr_b16 a[172:173], v242 offset:26272
    buffer_load_dwordx4 v[8:11], v254, s[20:23], s62 offen offset:0 sc1
    v_mfma_f32_16x16x32_bf16 v[196:199], a[176:179], a[156:159], v[196:199]
    ds_read_b64_tr_b16 a[174:175], v242 offset:26528
    v_mfma_f32_16x16x32_bf16 v[200:203], a[180:183], a[152:155], v[200:203]
    ds_read_b64_tr_b16 a[176:177], v242 offset:27264
    v_mfma_f32_16x16x32_bf16 v[204:207], a[180:183], a[156:159], v[204:207]
    ds_read_b64_tr_b16 a[178:179], v242 offset:27520
    v_mfma_f32_16x16x32_bf16 v[192:195], a[184:187], a[160:163], v[192:195]
    ds_read_b64_tr_b16 a[180:181], v242 offset:27296
    v_mfma_f32_16x16x32_bf16 v[196:199], a[184:187], a[164:167], v[196:199]
    ds_read_b64_tr_b16 a[182:183], v242 offset:27552
    s_waitcnt lgkmcnt(8)
    v_mfma_f32_16x16x32_bf16 v[200:203], a[188:191], a[160:163], v[200:203]
    ds_read_b64_tr_b16 a[184:185], v242 offset:28288
    v_mfma_f32_16x16x32_bf16 v[204:207], a[188:191], a[164:167], v[204:207]
    ds_read_b64_tr_b16 a[186:187], v242 offset:28544
    v_mfma_f32_16x16x32_bf16 v[192:195], a[192:195], a[96:99], v[192:195]
    ds_read_b64_tr_b16 a[188:189], v242 offset:28320
    v_mfma_f32_16x16x32_bf16 v[196:199], a[192:195], a[100:103], v[196:199]
    ds_read_b64_tr_b16 a[190:191], v242 offset:28576
    v_mfma_f32_16x16x32_bf16 v[200:203], a[196:199], a[96:99], v[200:203]
    ds_read_b64_tr_b16 a[192:193], v242 offset:29312
    v_mfma_f32_16x16x32_bf16 v[204:207], a[196:199], a[100:103], v[204:207]
    ds_read_b64_tr_b16 a[194:195], v242 offset:29568
    s_waitcnt lgkmcnt(8)
    v_mfma_f32_16x16x32_bf16 v[192:195], a[168:171], a[104:107], v[192:195]
    ds_read_b64_tr_b16 a[196:197], v242 offset:29344
    v_mfma_f32_16x16x32_bf16 v[196:199], a[168:171], a[108:111], v[196:199]
    ds_read_b64_tr_b16 a[198:199], v242 offset:29600
    v_mfma_f32_16x16x32_bf16 v[200:203], a[172:175], a[104:107], v[200:203]
    ds_read_b64_tr_b16 a[168:169], v242 offset:30336
    v_mfma_f32_16x16x32_bf16 v[204:207], a[172:175], a[108:111], v[204:207]
    ds_read_b64_tr_b16 a[170:171], v242 offset:30592
    v_mfma_f32_16x16x32_bf16 v[192:195], a[176:179], a[112:115], v[192:195]
    ds_read_b64_tr_b16 a[172:173], v242 offset:30368
    v_mfma_f32_16x16x32_bf16 v[196:199], a[176:179], a[116:119], v[196:199]
    ds_read_b64_tr_b16 a[174:175], v242 offset:30624
    s_waitcnt lgkmcnt(8)
    v_mfma_f32_16x16x32_bf16 v[200:203], a[180:183], a[112:115], v[200:203]
    v_mfma_f32_16x16x32_bf16 v[204:207], a[180:183], a[116:119], v[204:207]
    v_mfma_f32_16x16x32_bf16 v[192:195], a[184:187], a[120:123], v[192:195]
    v_mfma_f32_16x16x32_bf16 v[196:199], a[184:187], a[124:127], v[196:199]
    v_mfma_f32_16x16x32_bf16 v[200:203], a[188:191], a[120:123], v[200:203]
    v_mfma_f32_16x16x32_bf16 v[204:207], a[188:191], a[124:127], v[204:207]
    s_waitcnt lgkmcnt(2)
L_w14:
    s_cbranch_execz L_wret3
    v_mfma_f32_16x16x32_bf16 v[192:195], a[192:195], a[128:131], v[192:195]
    v_mfma_f32_16x16x32_bf16 v[196:199], a[192:195], a[132:135], v[196:199]
    v_mfma_f32_16x16x32_bf16 v[200:203], a[196:199], a[128:131], v[200:203]
    v_mfma_f32_16x16x32_bf16 v[204:207], a[196:199], a[132:135], v[204:207]
    v_mfma_f32_16x16x32_bf16 v[192:195], a[168:171], a[136:139], v[192:195]
    v_mfma_f32_16x16x32_bf16 v[196:199], a[168:171], a[140:143], v[196:199]
    s_waitcnt lgkmcnt(0)
    v_mfma_f32_16x16x32_bf16 v[200:203], a[172:175], a[136:139], v[200:203]
    v_mfma_f32_16x16x32_bf16 v[204:207], a[172:175], a[140:143], v[204:207]
    buffer_load_dwordx4 v[12:15], v254, s[20:23], s62 offen offset:1024 sc1
    s_waitcnt vmcnt(8)
    v_mfma_f32_16x16x32_bf16 v[192:195], a[240:243], a[228:231], v[192:195]
    v_mfma_f32_16x16x32_bf16 v[196:199], a[240:243], a[232:235], v[196:199]
    v_mfma_f32_16x16x32_bf16 v[200:203], a[238:241], a[228:231], v[200:203]
    v_mfma_f32_16x16x32_bf16 v[204:207], a[238:241], a[232:235], v[204:207]
    v_mfma_f32_16x16x32_bf16 v[192:195], a[240:243], v[32:35], v[192:195]
    v_mfma_f32_16x16x32_bf16 v[196:199], a[240:243], v[36:39], v[196:199]
    v_mfma_f32_16x16x32_bf16 v[200:203], a[238:241], v[32:35], v[200:203]
    v_mfma_f32_16x16x32_bf16 v[204:207], a[238:241], v[36:39], v[204:207]
    v_mfma_f32_16x16x32_bf16 v[192:195], a[240:243], v[40:43], v[192:195]
    v_mfma_f32_16x16x32_bf16 v[196:199], a[240:243], v[44:47], v[196:199]
    v_mfma_f32_16x16x32_bf16 v[200:203], a[238:241], v[40:43], v[200:203]
    v_mfma_f32_16x16x32_bf16 v[204:207], a[238:241], v[44:47], v[204:207]
    v_mfma_f32_16x16x32_bf16 v[192:195], a[240:243], v[48:51], v[192:195]
    v_mfma_f32_16x16x32_bf16 v[196:199], a[240:243], v[52:55], v[196:199]
    v_mfma_f32_16x16x32_bf16 v[200:203], a[238:241], v[48:51], v[200:203]
    v_mfma_f32_16x16x32_bf16 v[204:207], a[238:241], v[52:55], v[204:207]
    v_mfma_f32_16x16x32_bf16 v[192:195], a[240:243], v[56:59], v[192:195]
    v_mfma_f32_16x16x32_bf16 v[196:199], a[240:243], v[60:63], v[196:199]
    v_mfma_f32_16x16x32_bf16 v[200:203], a[238:241], v[56:59], v[200:203]
    v_mfma_f32_16x16x32_bf16 v[204:207], a[238:241], v[60:63], v[204:207]
    s_waitcnt vmcnt(5)
L_tchk0:
    v_max_u32 v0, v24, v25
    v_max3_u32 v0, v26, v27, v0
    v_max3_u32 v0, v28, v29, v0
    v_max3_u32 v0, v30, v31, v0
    v_cmp_eq_u32 vcc, -1, v0
    s_nop 0
    s_cmp_lg_u64 vcc, 0
    s_cbranch_scc1 L_tretry0
L_tok0:
    v_mfma_f32_16x16x32_bf16 v[192:195], a[240:243], v[24:27], v[192:195]
    v_mfma_f32_16x16x32_bf16 v[196:199], a[238:241], v[24:27], v[196:199]
    v_mfma_f32_16x16x32_bf16 v[200:203], a[240:243], v[28:31], v[200:203]
    v_mfma_f32_16x16x32_bf16 v[204:207], a[238:241], v[28:31], v[204:207]
    s_waitcnt vmcnt(2)
L_tchk1:
    v_max_u32 v0, v16, v17
    v_max3_u32 v0, v18, v19, v0
    v_max3_u32 v0, v20, v21, v0
    v_max3_u32 v0, v22, v23, v0
    v_cmp_eq_u32 vcc, -1, v0
    s_nop 0
    s_cmp_lg_u64 vcc, 0
    s_cbranch_scc1 L_tretry1
L_tok1:
    v_mfma_f32_16x16x32_bf16 v[192:195], a[240:243], v[16:19], v[192:195]
    v_mfma_f32_16x16x32_bf16 v[196:199], a[238:241], v[16:19], v[196:199]
    v_mfma_f32_16x16x32_bf16 v[200:203], a[240:243], v[20:23], v[200:203]
    v_mfma_f32_16x16x32_bf16 v[204:207], a[238:241], v[20:23], v[204:207]
    s_waitcnt vmcnt(1)
L_tchk2:
    v_max_u32 v0, v8, v9
    v_max3_u32 v0, v10, v11, v0
    v_cmp_eq_u32 vcc, -1, v0
    s_nop 0
    s_cmp_lg_u64 vcc, 0
    s_cbranch_scc1 L_tretry2
L_tok2:
    v_mfma_f32_16x16x32_bf16 v[192:195], a[240:243], v[8:11], v[192:195]
    v_mfma_f32_16x16x32_bf16 v[196:199], a[238:241], v[8:11], v[196:199]
    s_waitcnt vmcnt(0)
L_tchk3:
    v_max_u32 v0, v12, v13
    v_max3_u32 v0, v14, v15, v0
    v_cmp_eq_u32 vcc, -1, v0
    s_nop 0
    s_cmp_lg_u64 vcc, 0
    s_cbranch_scc1 L_tretry3
L_tok3:
    v_mfma_f32_16x16x32_bf16 v[200:203], a[240:243], v[12:15], v[200:203]
    v_mfma_f32_16x16x32_bf16 v[204:207], a[238:241], v[12:15], v[204:207]
    s_nop 1
    v_cvt_pk_bf16_f32 v192, v192, v193
    v_cvt_pk_bf16_f32 v193, v194, v195
    buffer_store_dwordx2 v[192:193], v252, s[36:39], s49 offen offset:0
    v_cvt_pk_bf16_f32 v196, v196, v197
    v_cvt_pk_bf16_f32 v197, v198, v199
    buffer_store_dwordx2 v[196:197], v252, s[36:39], s50 offen offset:0
    s_nop 1
    v_cvt_pk_bf16_f32 v200, v200, v201
    v_cvt_pk_bf16_f32 v201, v202, v203
    buffer_store_dwordx2 v[200:201], v252, s[36:39], s49 offen offset:32
    v_cvt_pk_bf16_f32 v204, v204, v205
    v_cvt_pk_bf16_f32 v205, v206, v207
    buffer_store_dwordx2 v[204:205], v252, s[36:39], s50 offen offset:32
L_end:
    s_endpgm
L_tretry0:
    s_cmp_eq_u32 s53, 0
    s_cbranch_scc1 L_tok0
    s_sub_u32 s53, s53, 1
    s_sleep 1
    buffer_load_dwordx4 v[24:27], v254, s[20:23], s78 offen offset:0 sc1
    buffer_load_dwordx4 v[28:31], v254, s[20:23], s78 offen offset:1024 sc1
    s_waitcnt vmcnt(0)
    s_branch L_tchk0
L_tretry1:
    s_cmp_eq_u32 s53, 0
    s_cbranch_scc1 L_tok1
    s_sub_u32 s53, s53, 1
    s_sleep 1
    buffer_load_dwordx4 v[16:19], v254, s[20:23], s63 offen offset:0 sc1
    buffer_load_dwordx4 v[20:23], v254, s[20:23], s63 offen offset:1024 sc1
    s_waitcnt vmcnt(0)
    s_branch L_tchk1
L_tretry2:
    s_cmp_eq_u32 s53, 0
    s_cbranch_scc1 L_tok2
    s_sub_u32 s53, s53, 1
    s_sleep 1
    buffer_load_dwordx4 v[8:11], v254, s[20:23], s62 offen offset:0 sc1
    s_waitcnt vmcnt(0)
    s_branch L_tchk2
L_tretry3:
    s_cmp_eq_u32 s53, 0
    s_cbranch_scc1 L_tok3
    s_sub_u32 s53, s53, 1
    s_sleep 1
    buffer_load_dwordx4 v[12:15], v254, s[20:23], s62 offen offset:1024 sc1
    s_waitcnt vmcnt(0)
    s_branch L_tchk3
L_Tslow:
    v_mov_b32 v180, 1.0
    v_mov_b32 v182, 1.0
    ds_read_b64 a[168:169], v24 offset:0
    ds_read_b64 a[170:171], v24 offset:3136
    ds_read_b64 a[172:173], v24 offset:128
    ds_read_b64 a[174:175], v24 offset:3264
    ds_read_b64 a[176:177], v24 offset:256
    ds_read_b64 a[178:179], v24 offset:3392
    ds_read_b64 a[180:181], v24 offset:384
    ds_read_b64 a[182:183], v24 offset:3520
    ds_read_b64 a[184:185], v24 offset:512
    ds_read_b64 a[186:187], v24 offset:3648
    ds_read_b64 a[188:189], v24 offset:640
    ds_read_b64 a[190:191], v24 offset:3776
    s_waitcnt lgkmcnt(10)
    v_mfma_f32_16x16x32_bf16 v[32:35], a[168:171], v[0:3], v[16:19]
    ds_read_b64 a[192:193], v24 offset:768
    ds_read_b64 a[194:195], v24 offset:3904
    s_nop 1
    s_waitcnt lgkmcnt(10)
    v_mfma_f32_16x16x32_bf16 v[36:39], a[172:175], v[0:3], 0
    ds_read_b64 a[196:197], v24 offset:896
    v_mfma_f32_16x16x32_bf16 v[108:111], a[172:175], v[4:7], v[16:19]
    ds_read_b64 a[198:199], v24 offset:4032
    s_nop 1
    s_waitcnt lgkmcnt(10)
    v_mfma_f32_16x16x32_bf16 v[40:43], a[176:179], v[0:3], 0
    ds_read_b64 a[168:169], v24 offset:1024
    v_mfma_f32_16x16x32_bf16 v[112:115], a[176:179], v[4:7], 0
    ds_read_b64 a[170:171], v24 offset:4160
    s_nop 1
    s_waitcnt lgkmcnt(10)
    v_mfma_f32_16x16x32_bf16 v[44:47], a[180:183], v[0:3], 0
    ds_read_b64 a[172:173], v24 offset:1152
    v_mfma_f32_16x16x32_bf16 v[116:119], a[180:183], v[4:7], 0
    ds_read_b64 a[174:175], v24 offset:4288
    s_nop 1
    v_max_f32 v176, v32, v33
    v_max_f32_e64 v177, v34, v35
    s_waitcnt lgkmcnt(10)
    v_mfma_f32_16x16x32_bf16 v[48:51], a[184:187], v[0:3], 0
    ds_read_b64 a[176:177], v24 offset:1280
    v_mfma_f32_16x16x32_bf16 v[120:123], a[184:187], v[4:7], 0
    ds_read_b64 a[178:179], v24 offset:4416
    s_nop 1
    v_max3_f32 v176, v36, v37, v176
    v_max3_f32 v177, v38, v39, v177
    v_max_f32 v178, v108, v109
    v_max_f32 v179, v110, v111
    s_waitcnt lgkmcnt(10)
    v_mfma_f32_16x16x32_bf16 v[52:55], a[188:191], v[0:3], 0
    ds_read_b64 a[180:181], v24 offset:1408
    v_mfma_f32_16x16x32_bf16 v[124:127], a[188:191], v[4:7], 0
    ds_read_b64 a[182:183], v24 offset:4544
    s_nop 1
    v_max3_f32 v176, v40, v41, v176
    v_max3_f32 v177, v42, v43, v177
    v_max3_f32 v178, v112, v113, v178
    v_max3_f32 v179, v114, v115, v179
    s_waitcnt lgkmcnt(10)
    v_mfma_f32_16x16x32_bf16 v[56:59], a[192:195], v[0:3], 0
    ds_read_b64 a[184:185], v24 offset:1536
    v_mfma_f32_16x16x32_bf16 v[128:131], a[192:195], v[4:7], 0
    ds_read_b64 a[186:187], v24 offset:4672
    s_nop 1
    v_max3_f32 v176, v44, v45, v176
    v_max3_f32 v177, v46, v47, v177
    v_max3_f32 v178, v116, v117, v178
    v_max3_f32 v179, v118, v119, v179
    s_waitcnt lgkmcnt(10)
    v_mfma_f32_16x16x32_bf16 v[60:63], a[196:199], v[0:3], 0
    ds_read_b64 a[188:189], v24 offset:1664
    v_mfma_f32_16x16x32_bf16 v[132:135], a[196:199], v[4:7], 0
    ds_read_b64 a[190:191], v24 offset:4800
    s_nop 1
    v_max3_f32 v176, v48, v49, v176
    v_max3_f32 v177, v50, v51, v177
    v_max3_f32 v178, v120, v121, v178
    v_max3_f32 v179, v122, v123, v179
    s_waitcnt lgkmcnt(10)
    v_mfma_f32_16x16x32_bf16 v[64:67], a[168:171], v[0:3], 0
    ds_read_b64 a[192:193], v24 offset:1792
    v_mfma_f32_16x16x32_bf16 v[136:139], a[168:171], v[4:7], 0
    ds_read_b64 a[194:195], v24 offset:4928
    s_nop 1
    v_max3_f32 v176, v52, v53, v176
    v_max3_f32 v177, v54, v55, v177
    v_max3_f32 v178, v124, v125, v178
    v_max3_f32 v179, v126, v127, v179
    s_waitcnt lgkmcnt(10)
    v_mfma_f32_16x16x32_bf16 v[68:71], a[172:175], v[0:3], 0
    ds_read_b64 a[196:197], v24 offset:1920
    v_mfma_f32_16x16x32_bf16 v[140:143], a[172:175], v[4:7], 0
    ds_read_b64 a[198:199], v24 offset:5056
    s_nop 1
    v_max3_f32 v176, v56, v57, v176
    v_max3_f32 v177, v58, v59, v177
    v_max3_f32 v178, v128, v129, v178
    v_max3_f32 v179, v130, v131, v179
    s_waitcnt lgkmcnt(10)
    v_mfma_f32_16x16x32_bf16 v[72:75], a[176:179], v[0:3], 0
    ds_read_b64 a[168:169], v24 offset:2048
    v_mfma_f32_16x16x32_bf16 v[144:147], a[176:179], v[4:7], 0
    ds_read_b64 a[170:171], v24 offset:5184
    s_nop 1
    v_max3_f32 v176, v60, v61, v176
    v_max3_f32 v177, v62, v63, v177
    v_max3_f32 v178, v132, v133, v178
    v_max3_f32 v179, v134, v135, v179
    s_waitcnt lgkmcnt(10)
    v_mfma_f32_16x16x32_bf16 v[76:79], a[180:183], v[0:3], 0
    ds_read_b64 a[172:173], v24 offset:2176
    v_mfma_f32_16x16x32_bf16 v[148:151], a[180:183], v[4:7], 0
    ds_read_b64 a[174:175], v24 offset:5312
    s_nop 1
    v_max3_f32 v176, v64, v65, v176
    v_max3_f32 v177, v66, v67, v177
    v_max3_f32 v178, v136, v137, v178
    v_max3_f32 v179, v138, v139, v179
    s_waitcnt lgkmcnt(10)
    v_mfma_f32_16x16x32_bf16 v[80:83], a[184:187], v[0:3], 0
    v_mfma_f32_16x16x32_bf16 v[152:155], a[184:187], v[4:7], 0
    s_nop 1
    v_max3_f32 v176, v68, v69, v176
    v_max3_f32 v177, v70, v71, v177
    v_max3_f32 v178, v140, v141, v178
    v_max3_f32 v179, v142, v143, v179
    s_waitcnt lgkmcnt(8)
    v_mfma_f32_16x16x32_bf16 v[84:87], a[188:191], v[0:3], 0
    v_mfma_f32_16x16x32_bf16 v[156:159], a[188:191], v[4:7], 0
    s_nop 1
    v_max3_f32 v176, v72, v73, v176
    v_max3_f32 v177, v74, v75, v177
    v_max3_f32 v178, v144, v145, v178
    v_max3_f32 v179, v146, v147, v179
    s_waitcnt lgkmcnt(6)
    v_mfma_f32_16x16x32_bf16 v[88:91], a[192:195], v[0:3], 0
    v_mfma_f32_16x16x32_bf16 v[160:163], a[192:195], v[4:7], 0
    s_nop 1
    v_max3_f32 v176, v76, v77, v176
    v_max3_f32 v177, v78, v79, v177
    v_max3_f32 v178, v148, v149, v178
    v_max3_f32 v179, v150, v151, v179
    s_waitcnt lgkmcnt(4)
    v_mfma_f32_16x16x32_bf16 v[92:95], a[196:199], v[0:3], 0
    v_mfma_f32_16x16x32_bf16 v[164:167], a[196:199], v[4:7], 0
    s_nop 1
    v_max3_f32 v176, v80, v81, v176
    v_max3_f32 v177, v82, v83, v177
    v_max3_f32 v178, v152, v153, v178
    v_max3_f32 v179, v154, v155, v179
    s_waitcnt lgkmcnt(2)
    v_mfma_f32_16x16x32_bf16 v[96:99], a[168:171], v[0:3], v[20:23]
    v_mfma_f32_16x16x32_bf16 v[168:171], a[168:171], v[4:7], 0
    s_nop 1
    v_max3_f32 v176, v84, v85, v176
    v_max3_f32 v177, v86, v87, v177
    v_max3_f32 v178, v156, v157, v178
    v_max3_f32 v179, v158, v159, v179
    s_waitcnt lgkmcnt(0)
    v_mfma_f32_16x16x32_bf16 v[172:175], a[172:175], v[4:7], v[20:23]
    s_nop 1
    v_max3_f32 v176, v88, v89, v176
    v_max3_f32 v177, v90, v91, v177
    v_max3_f32 v178, v160, v161, v178
    v_max3_f32 v179, v162, v163, v179
    s_nop 7
    v_max3_f32 v176, v92, v93, v176
    v_max3_f32 v177, v94, v95, v177
    v_max3_f32 v178, v164, v165, v178
    v_max3_f32 v179, v166, v167, v179
    v_max3_f32 v176, v96, v97, v176
    v_max3_f32 v177, v98, v99, v177
    v_max3_f32 v178, v168, v169, v178
    v_max3_f32 v179, v170, v171, v179
    v_max3_f32 v178, v172, v173, v178
    v_max3_f32 v179, v174, v175, v179
    v_max_f32 v176, v176, v177
    v_max_f32 v178, v178, v179
    v_mov_b32 v177, v176
    v_mov_b32 v179, v178
    s_nop 1
    v_permlane32_swap_b32 v176, v177
    v_permlane32_swap_b32 v178, v179
    s_nop 0
    v_max_f32 v176, v176, v177
    v_max_f32 v178, v178, v179
    v_mov_b32 v177, v176
    v_mov_b32 v179, v178
    s_nop 1
    v_permlane16_swap_b32 v176, v177
    v_permlane16_swap_b32 v178, v179
    s_nop 0
    v_max_f32 v176, v176, v177
    v_max_f32 v178, v178, v179
    v_mul_f32 v181, -1.0, v176
    v_mul_f32 v183, -1.0, v178
    v_pk_fma_f32 v[32:33], v[32:33], v[180:181], v[180:181] op_sel:[0,0,1] op_sel_hi:[1,0,1]
    v_pk_fma_f32 v[34:35], v[34:35], v[180:181], v[180:181] op_sel:[0,0,1] op_sel_hi:[1,0,1]
    v_pk_fma_f32 v[36:37], v[36:37], v[180:181], v[180:181] op_sel:[0,0,1] op_sel_hi:[1,0,1]
    v_pk_fma_f32 v[38:39], v[38:39], v[180:181], v[180:181] op_sel:[0,0,1] op_sel_hi:[1,0,1]
    v_pk_fma_f32 v[108:109], v[108:109], v[182:183], v[182:183] op_sel:[0,0,1] op_sel_hi:[1,0,1]
    v_pk_fma_f32 v[110:111], v[110:111], v[182:183], v[182:183] op_sel:[0,0,1] op_sel_hi:[1,0,1]
    ds_read_b64_tr_b16 a[176:177], v26 offset:0
    ds_read_b64_tr_b16 a[178:179], v26 offset:128
    ds_read_b64_tr_b16 a[180:181], v27 offset:0
    ds_read_b64_tr_b16 a[182:183], v27 offset:128
    v_exp_f32 v32, v32
    v_exp_f32 v33, v33
    v_exp_f32 v34, v34
    v_exp_f32 v35, v35
    v_exp_f32 v36, v36
    v_exp_f32 v37, v37
    v_exp_f32 v38, v38
    v_exp_f32 v39, v39
    v_exp_f32 v108, v108
    v_exp_f32 v109, v109
    v_exp_f32 v110, v110
    v_exp_f32 v111, v111
    v_cvt_pk_bf16_f32 v32, v32, v33
    v_cvt_pk_bf16_f32 v33, v34, v35
    v_cvt_pk_bf16_f32 v34, v36, v37
    v_cvt_pk_bf16_f32 v35, v38, v39
    v_mov_b32 v104, 0
    v_mov_b32 v105, 0
    v_cvt_pk_bf16_f32 v106, v108, v109
    v_cvt_pk_bf16_f32 v107, v110, v111
    v_pk_fma_f32 v[40:41], v[40:41], v[180:181], v[180:181] op_sel:[0,0,1] op_sel_hi:[1,0,1]
    v_pk_fma_f32 v[42:43], v[42:43], v[180:181], v[180:181] op_sel:[0,0,1] op_sel_hi:[1,0,1]
    v_pk_fma_f32 v[44:45], v[44:45], v[180:181], v[180:181] op_sel:[0,0,1] op_sel_hi:[1,0,1]
    v_pk_fma_f32 v[46:47], v[46:47], v[180:181], v[180:181] op_sel:[0,0,1] op_sel_hi:[1,0,1]
    v_pk_fma_f32 v[112:113], v[112:113], v[182:183], v[182:183] op_sel:[0,0,1] op_sel_hi:[1,0,1]
    v_pk_fma_f32 v[114:115], v[114:115], v[182:183], v[182:183] op_sel:[0,0,1] op_sel_hi:[1,0,1]
    v_pk_fma_f32 v[116:117], v[116:117], v[182:183], v[182:183] op_sel:[0,0,1] op_sel_hi:[1,0,1]
    v_pk_fma_f32 v[118:119], v[118:119], v[182:183], v[182:183] op_sel:[0,0,1] op_sel_hi:[1,0,1]
    s_waitcnt lgkmcnt(0)
    v_mfma_f32_16x16x32_bf16 v[208:211], a[176:179], v[32:35], 0
    ds_read_b64_tr_b16 a[184:185], v26 offset:256
    v_exp_f32 v40, v40
    v_exp_f32 v41, v41
    v_exp_f32 v42, v42
    v_exp_f32_e64 v43, v43
    v_mfma_f32_16x16x32_bf16 v[216:219], a[176:179], v[104:107], 0
    ds_read_b64_tr_b16 a[186:187], v26 offset:384
    v_exp_f32 v44, v44
    v_exp_f32 v45, v45
    v_exp_f32 v46, v46
    v_exp_f32 v47, v47
    v_exp_f32_e64 v112, v112
    v_mfma_f32_16x16x32_bf16 v[212:215], a[180:183], v[32:35], 0
    ds_read_b64_tr_b16 a[188:189], v27 offset:256
    v_exp_f32 v113, v113
    v_exp_f32 v114, v114
    v_exp_f32 v115, v115
    v_exp_f32 v116, v116
    v_exp_f32_e64 v117, v117
    v_mfma_f32_16x16x32_bf16 v[220:223], a[180:183], v[104:107], 0
    ds_read_b64_tr_b16 a[190:191], v27 offset:384
    v_exp_f32 v118, v118
    v_exp_f32 v119, v119
    v_cvt_pk_bf16_f32 v40, v40, v41
    v_cvt_pk_bf16_f32 v41, v42, v43
    v_cvt_pk_bf16_f32 v42, v44, v45
    v_cvt_pk_bf16_f32 v43, v46, v47
    v_cvt_pk_bf16_f32 v112, v112, v113
    v_cvt_pk_bf16_f32 v113, v114, v115
    v_cvt_pk_bf16_f32 v114, v116, v117
    v_cvt_pk_bf16_f32 v115, v118, v119
    v_pk_fma_f32 v[48:49], v[48:49], v[180:181], v[180:181] op_sel:[0,0,1] op_sel_hi:[1,0,1]
    v_pk_fma_f32 v[50:51], v[50:51], v[180:181], v[180:181] op_sel:[0,0,1] op_sel_hi:[1,0,1]
    v_pk_fma_f32 v[52:53], v[52:53], v[180:181], v[180:181] op_sel:[0,0,1] op_sel_hi:[1,0,1]
    v_pk_fma_f32 v[54:55], v[54:55], v[180:181], v[180:181] op_sel:[0,0,1] op_sel_hi:[1,0,1]
    v_pk_fma_f32 v[120:121], v[120:121], v[182:183], v[182:183] op_sel:[0,0,1] op_sel_hi:[1,0,1]
    v_pk_fma_f32 v[122:123], v[122:123], v[182:183], v[182:183] op_sel:[0,0,1] op_sel_hi:[1,0,1]
    v_pk_fma_f32 v[124:125], v[124:125], v[182:183], v[182:183] op_sel:[0,0,1] op_sel_hi:[1,0,1]
    v_pk_fma_f32 v[126:127], v[126:127], v[182:183], v[182:183] op_sel:[0,0,1] op_sel_hi:[1,0,1]
    s_waitcnt lgkmcnt(0)
    v_mfma_f32_16x16x32_bf16 v[208:211], a[184:187], v[40:43], v[208:211]
    ds_read_b64_tr_b16 a[192:193], v26 offset:512
    v_exp_f32 v48, v48
    v_exp_f32 v49, v49
    v_exp_f32 v50, v50
    v_exp_f32_e64 v51, v51
    v_mfma_f32_16x16x32_bf16 v[216:219], a[184:187], v[112:115], v[216:219]
    ds_read_b64_tr_b16 a[194:195], v26 offset:640
    v_exp_f32 v52, v52
    v_exp_f32 v53, v53
    v_exp_f32 v54, v54
    v_exp_f32 v55, v55
    v_exp_f32_e64 v120, v120
    v_mfma_f32_16x16x32_bf16 v[212:215], a[188:191], v[40:43], v[212:215]
    ds_read_b64_tr_b16 a[196:197], v27 offset:512
    v_exp_f32 v121, v121
    v_exp_f32 v122, v122
    v_exp_f32 v123, v123
    v_exp_f32 v124, v124
    v_exp_f32_e64 v125, v125
    v_mfma_f32_16x16x32_bf16 v[220:223], a[188:191], v[112:115], v[220:223]
    ds_read_b64_tr_b16 a[198:199], v27 offset:640
    v_exp_f32 v126, v126
    v_exp_f32 v127, v127
    v_cvt_pk_bf16_f32 v48, v48, v49
    v_cvt_pk_bf16_f32 v49, v50, v51
    v_cvt_pk_bf16_f32 v50, v52, v53
    v_cvt_pk_bf16_f32 v51, v54, v55
    v_cvt_pk_bf16_f32 v120, v120, v121
    v_cvt_pk_bf16_f32 v121, v122, v123
    v_cvt_pk_bf16_f32 v122, v124, v125
    v_cvt_pk_bf16_f32 v123, v126, v127
    v_pk_fma_f32 v[56:57], v[56:57], v[180:181], v[180:181] op_sel:[0,0,1] op_sel_hi:[1,0,1]
    v_pk_fma_f32 v[58:59], v[58:59], v[180:181], v[180:181] op_sel:[0,0,1] op_sel_hi:[1,0,1]
    v_pk_fma_f32 v[60:61], v[60:61], v[180:181], v[180:181] op_sel:[0,0,1] op_sel_hi:[1,0,1]
    v_pk_fma_f32 v[62:63], v[62:63], v[180:181], v[180:181] op_sel:[0,0,1] op_sel_hi:[1,0,1]
    v_pk_fma_f32 v[128:129], v[128:129], v[182:183], v[182:183] op_sel:[0,0,1] op_sel_hi:[1,0,1]
    v_pk_fma_f32 v[130:131], v[130:131], v[182:183], v[182:183] op_sel:[0,0,1] op_sel_hi:[1,0,1]
    v_pk_fma_f32 v[132:133], v[132:133], v[182:183], v[182:183] op_sel:[0,0,1] op_sel_hi:[1,0,1]
    v_pk_fma_f32 v[134:135], v[134:135], v[182:183], v[182:183] op_sel:[0,0,1] op_sel_hi:[1,0,1]
    s_waitcnt lgkmcnt(0)
    v_mfma_f32_16x16x32_bf16 v[208:211], a[192:195], v[48:51], v[208:211]
    ds_read_b64_tr_b16 a[168:169], v26 offset:768
    v_exp_f32 v56, v56
    v_exp_f32 v57, v57
    v_exp_f32 v58, v58
    v_exp_f32_e64 v59, v59
    v_mfma_f32_16x16x32_bf16 v[216:219], a[192:195], v[120:123], v[216:219]
    ds_read_b64_tr_b16 a[170:171], v26 offset:896
    v_exp_f32 v60, v60
    v_exp_f32 v61, v61
    v_exp_f32 v62, v62
    v_exp_f32 v63, v63
    v_exp_f32_e64 v128, v128
    v_mfma_f32_16x16x32_bf16 v[212:215], a[196:199], v[48:51], v[212:215]
    ds_read_b64_tr_b16 a[172:173], v27 offset:768
    v_exp_f32 v129, v129
    v_exp_f32 v130, v130
    v_exp_f32 v131, v131
    v_exp_f32 v132, v132
    v_exp_f32_e64 v133, v133
    v_mfma_f32_16x16x32_bf16 v[220:223], a[196:199], v[120:123], v[220:223]
    ds_read_b64_tr_b16 a[174:175], v27 offset:896
    v_exp_f32 v134, v134
    v_exp_f32 v135, v135
    v_cvt_pk_bf16_f32 v56, v56, v57
    v_cvt_pk_bf16_f32 v57, v58, v59
    v_cvt_pk_bf16_f32 v58, v60, v61
    v_cvt_pk_bf16_f32 v59, v62, v63
    v_cvt_pk_bf16_f32 v128, v128, v129
    v_cvt_pk_bf16_f32 v129, v130, v131
    v_cvt_pk_bf16_f32 v130, v132, v133
    v_cvt_pk_bf16_f32 v131, v134, v135
    v_pk_fma_f32 v[64:65], v[64:65], v[180:181], v[180:181] op_sel:[0,0,1] op_sel_hi:[1,0,1]
    v_pk_fma_f32 v[66:67], v[66:67], v[180:181], v[180:181] op_sel:[0,0,1] op_sel_hi:[1,0,1]
    v_pk_fma_f32 v[68:69], v[68:69], v[180:181], v[180:181] op_sel:[0,0,1] op_sel_hi:[1,0,1]
    v_pk_fma_f32 v[70:71], v[70:71], v[180:181], v[180:181] op_sel:[0,0,1] op_sel_hi:[1,0,1]
    v_pk_fma_f32 v[136:137], v[136:137], v[182:183], v[182:183] op_sel:[0,0,1] op_sel_hi:[1,0,1]
    v_pk_fma_f32 v[138:139], v[138:139], v[182:183], v[182:183] op_sel:[0,0,1] op_sel_hi:[1,0,1]
    v_pk_fma_f32 v[140:141], v[140:141], v[182:183], v[182:183] op_sel:[0,0,1] op_sel_hi:[1,0,1]
    v_pk_fma_f32 v[142:143], v[142:143], v[182:183], v[182:183] op_sel:[0,0,1] op_sel_hi:[1,0,1]
    s_waitcnt lgkmcnt(0)
    v_mfma_f32_16x16x32_bf16 v[208:211], a[168:171], v[56:59], v[208:211]
    ds_read_b64_tr_b16 a[176:177], v26 offset:1024
    v_exp_f32 v64, v64
    v_exp_f32 v65, v65
    v_exp_f32 v66, v66
    v_exp_f32_e64 v67, v67
    v_mfma_f32_16x16x32_bf16 v[216:219], a[168:171], v[128:131], v[216:219]
    ds_read_b64_tr_b16 a[178:179], v26 offset:1152
    v_exp_f32 v68, v68
    v_exp_f32 v69, v69
    v_exp_f32 v70, v70
    v_exp_f32 v71, v71
    v_exp_f32_e64 v136, v136
    v_mfma_f32_16x16x32_bf16 v[212:215], a[172:175], v[56:59], v[212:215]
    ds_read_b64_tr_b16 a[180:181], v27 offset:1024
    v_exp_f32 v137, v137
    v_exp_f32 v138, v138
    v_exp_f32 v139, v139
    v_exp_f32 v140, v140
    v_exp_f32_e64 v141, v141
    v_mfma_f32_16x16x32_bf16 v[220:223], a[172:175], v[128:131], v[220:223]
    ds_read_b64_tr_b16 a[182:183], v27 offset:1152
    v_exp_f32 v142, v142
    v_exp_f32 v143, v143
    v_cvt_pk_bf16_f32 v64, v64, v65
    v_cvt_pk_bf16_f32 v65, v66, v67
    v_cvt_pk_bf16_f32 v66, v68, v69
    v_cvt_pk_bf16_f32 v67, v70, v71
    v_cvt_pk_bf16_f32 v136, v136, v137
    v_cvt_pk_bf16_f32 v137, v138, v139
    v_cvt_pk_bf16_f32 v138, v140, v141
    v_cvt_pk_bf16_f32 v139, v142, v143
    v_pk_fma_f32 v[72:73], v[72:73], v[180:181], v[180:181] op_sel:[0,0,1] op_sel_hi:[1,0,1]
    v_pk_fma_f32 v[74:75], v[74:75], v[180:181], v[180:181] op_sel:[0,0,1] op_sel_hi:[1,0,1]
    v_pk_fma_f32 v[76:77], v[76:77], v[180:181], v[180:181] op_sel:[0,0,1] op_sel_hi:[1,0,1]
    v_pk_fma_f32 v[78:79], v[78:79], v[180:181], v[180:181] op_sel:[0,0,1] op_sel_hi:[1,0,1]
    v_pk_fma_f32 v[144:145], v[144:145], v[182:183], v[182:183] op_sel:[0,0,1] op_sel_hi:[1,0,1]
    v_pk_fma_f32 v[146:147], v[146:147], v[182:183], v[182:183] op_sel:[0,0,1] op_sel_hi:[1,0,1]
    v_pk_fma_f32 v[148:149], v[148:149], v[182:183], v[182:183] op_sel:[0,0,1] op_sel_hi:[1,0,1]
    v_pk_fma_f32 v[150:151], v[150:151], v[182:183], v[182:183] op_sel:[0,0,1] op_sel_hi:[1,0,1]
    s_waitcnt lgkmcnt(0)
    v_mfma_f32_16x16x32_bf16 v[208:211], a[176:179], v[64:67], v[208:211]
    ds_read_b64_tr_b16 a[184:185], v26 offset:1280
    v_exp_f32 v72, v72
    v_exp_f32 v73, v73
    v_exp_f32 v74, v74
    v_exp_f32_e64 v75, v75
    v_mfma_f32_16x16x32_bf16 v[216:219], a[176:179], v[136:139], v[216:219]
    ds_read_b64_tr_b16 a[186:187], v26 offset:1408
    v_exp_f32 v76, v76
    v_exp_f32 v77, v77
    v_exp_f32 v78, v78
    v_exp_f32 v79, v79
    v_exp_f32_e64 v144, v144
    v_mfma_f32_16x16x32_bf16 v[212:215], a[180:183], v[64:67], v[212:215]
    ds_read_b64_tr_b16 a[188:189], v27 offset:1280
    v_exp_f32 v145, v145
    v_exp_f32 v146, v146
    v_exp_f32 v147, v147
    v_exp_f32 v148, v148
    v_exp_f32_e64 v149, v149
    v_mfma_f32_16x16x32_bf16 v[220:223], a[180:183], v[136:139], v[220:223]
    ds_read_b64_tr_b16 a[190:191], v27 offset:1408
    v_exp_f32 v150, v150
    v_exp_f32 v151, v151
    v_cvt_pk_bf16_f32 v72, v72, v73
    v_cvt_pk_bf16_f32 v73, v74, v75
    v_cvt_pk_bf16_f32 v74, v76, v77
    v_cvt_pk_bf16_f32 v75, v78, v79
    v_cvt_pk_bf16_f32 v144, v144, v145
    v_cvt_pk_bf16_f32 v145, v146, v147
    v_cvt_pk_bf16_f32 v146, v148, v149
    v_cvt_pk_bf16_f32 v147, v150, v151
    v_pk_fma_f32 v[80:81], v[80:81], v[180:181], v[180:181] op_sel:[0,0,1] op_sel_hi:[1,0,1]
    v_pk_fma_f32 v[82:83], v[82:83], v[180:181], v[180:181] op_sel:[0,0,1] op_sel_hi:[1,0,1]
    v_pk_fma_f32 v[84:85], v[84:85], v[180:181], v[180:181] op_sel:[0,0,1] op_sel_hi:[1,0,1]
    v_pk_fma_f32 v[86:87], v[86:87], v[180:181], v[180:181] op_sel:[0,0,1] op_sel_hi:[1,0,1]
    v_pk_fma_f32 v[152:153], v[152:153], v[182:183], v[182:183] op_sel:[0,0,1] op_sel_hi:[1,0,1]
    v_pk_fma_f32 v[154:155], v[154:155], v[182:183], v[182:183] op_sel:[0,0,1] op_sel_hi:[1,0,1]
    v_pk_fma_f32 v[156:157], v[156:157], v[182:183], v[182:183] op_sel:[0,0,1] op_sel_hi:[1,0,1]
    v_pk_fma_f32 v[158:159], v[158:159], v[182:183], v[182:183] op_sel:[0,0,1] op_sel_hi:[1,0,1]
    s_waitcnt lgkmcnt(0)
    v_mfma_f32_16x16x32_bf16 v[208:211], a[184:187], v[72:75], v[208:211]
    ds_read_b64_tr_b16 a[192:193], v26 offset:1536
    v_exp_f32 v80, v80
    v_exp_f32 v81, v81
    v_exp_f32 v82, v82
    v_exp_f32_e64 v83, v83
    v_mfma_f32_16x16x32_bf16 v[216:219], a[184:187], v[144:147], v[216:219]
    ds_read_b64_tr_b16 a[194:195], v26 offset:1664
    v_exp_f32 v84, v84
    v_exp_f32 v85, v85
    v_exp_f32 v86, v86
    v_exp_f32 v87, v87
    v_exp_f32_e64 v152, v152
    v_mfma_f32_16x16x32_bf16 v[212:215], a[188:191], v[72:75], v[212:215]
    ds_read_b64_tr_b16 a[196:197], v27 offset:1536
    v_exp_f32 v153, v153
    v_exp_f32 v154, v154
    v_exp_f32 v155, v155
    v_exp_f32 v156, v156
    v_exp_f32_e64 v157, v157
    v_mfma_f32_16x16x32_bf16 v[220:223], a[188:191], v[144:147], v[220:223]
    ds_read_b64_tr_b16 a[198:199], v27 offset:1664
    v_exp_f32 v158, v158
    v_exp_f32 v159, v159
    v_cvt_pk_bf16_f32 v80, v80, v81
    v_cvt_pk_bf16_f32 v81, v82, v83
    v_cvt_pk_bf16_f32 v82, v84, v85
    v_cvt_pk_bf16_f32 v83, v86, v87
    v_cvt_pk_bf16_f32 v152, v152, v153
    v_cvt_pk_bf16_f32 v153, v154, v155
    v_cvt_pk_bf16_f32 v154, v156, v157
    v_cvt_pk_bf16_f32 v155, v158, v159
    v_pk_fma_f32 v[88:89], v[88:89], v[180:181], v[180:181] op_sel:[0,0,1] op_sel_hi:[1,0,1]
    v_pk_fma_f32 v[90:91], v[90:91], v[180:181], v[180:181] op_sel:[0,0,1] op_sel_hi:[1,0,1]
    v_pk_fma_f32 v[92:93], v[92:93], v[180:181], v[180:181] op_sel:[0,0,1] op_sel_hi:[1,0,1]
    v_pk_fma_f32 v[94:95], v[94:95], v[180:181], v[180:181] op_sel:[0,0,1] op_sel_hi:[1,0,1]
    v_pk_fma_f32 v[160:161], v[160:161], v[182:183], v[182:183] op_sel:[0,0,1] op_sel_hi:[1,0,1]
    v_pk_fma_f32 v[162:163], v[162:163], v[182:183], v[182:183] op_sel:[0,0,1] op_sel_hi:[1,0,1]
    v_pk_fma_f32 v[164:165], v[164:165], v[182:183], v[182:183] op_sel:[0,0,1] op_sel_hi:[1,0,1]
    v_pk_fma_f32 v[166:167], v[166:167], v[182:183], v[182:183] op_sel:[0,0,1] op_sel_hi:[1,0,1]
    s_waitcnt lgkmcnt(0)
    v_mfma_f32_16x16x32_bf16 v[208:211], a[192:195], v[80:83], v[208:211]
    ds_read_b64_tr_b16 a[168:169], v26 offset:1792
    v_exp_f32 v88, v88
    v_exp_f32 v89, v89
    v_exp_f32 v90, v90
    v_exp_f32_e64 v91, v91
    v_mfma_f32_16x16x32_bf16 v[216:219], a[192:195], v[152:155], v[216:219]
    ds_read_b64_tr_b16 a[170:171], v26 offset:1920
    v_exp_f32 v92, v92
    v_exp_f32 v93, v93
    v_exp_f32 v94, v94
    v_exp_f32 v95, v95
    v_exp_f32_e64 v160, v160
    v_mfma_f32_16x16x32_bf16 v[212:215], a[196:199], v[80:83], v[212:215]
    ds_read_b64_tr_b16 a[172:173], v27 offset:1792
    v_exp_f32 v161, v161
    v_exp_f32 v162, v162
    v_exp_f32 v163, v163
    v_exp_f32 v164, v164
    v_exp_f32_e64 v165, v165
    v_mfma_f32_16x16x32_bf16 v[220:223], a[196:199], v[152:155], v[220:223]
    ds_read_b64_tr_b16 a[174:175], v27 offset:1920
    v_exp_f32 v166, v166
    v_exp_f32 v167, v167
    v_cvt_pk_bf16_f32 v88, v88, v89
    v_cvt_pk_bf16_f32 v89, v90, v91
    v_cvt_pk_bf16_f32 v90, v92, v93
    v_cvt_pk_bf16_f32 v91, v94, v95
    v_cvt_pk_bf16_f32 v160, v160, v161
    v_cvt_pk_bf16_f32 v161, v162, v163
    v_cvt_pk_bf16_f32 v162, v164, v165
    v_cvt_pk_bf16_f32 v163, v166, v167
    v_pk_fma_f32 v[96:97], v[96:97], v[180:181], v[180:181] op_sel:[0,0,1] op_sel_hi:[1,0,1]
    v_pk_fma_f32 v[98:99], v[98:99], v[180:181], v[180:181] op_sel:[0,0,1] op_sel_hi:[1,0,1]
    v_pk_fma_f32 v[168:169], v[168:169], v[182:183], v[182:183] op_sel:[0,0,1] op_sel_hi:[1,0,1]
    v_pk_fma_f32 v[170:171], v[170:171], v[182:183], v[182:183] op_sel:[0,0,1] op_sel_hi:[1,0,1]
    v_pk_fma_f32 v[172:173], v[172:173], v[182:183], v[182:183] op_sel:[0,0,1] op_sel_hi:[1,0,1]
    v_pk_fma_f32 v[174:175], v[174:175], v[182:183], v[182:183] op_sel:[0,0,1] op_sel_hi:[1,0,1]
    s_waitcnt lgkmcnt(0)
    v_mfma_f32_16x16x32_bf16 v[208:211], a[168:171], v[88:91], v[208:211]
    ds_read_b64_tr_b16 a[176:177], v26 offset:2048
    v_exp_f32 v96, v96
    v_exp_f32 v97, v97
    v_exp_f32 v98, v98
    v_mfma_f32_16x16x32_bf16 v[216:219], a[168:171], v[160:163], v[216:219]
    ds_read_b64_tr_b16 a[178:179], v26 offset:2176
    v_exp_f32 v99, v99
    v_exp_f32 v168, v168
    v_exp_f32 v169, v169
    v_exp_f32 v170, v170
    v_mfma_f32_16x16x32_bf16 v[212:215], a[172:175], v[88:91], v[212:215]
    ds_read_b64_tr_b16 a[180:181], v27 offset:2048
    v_exp_f32 v171, v171
    v_exp_f32 v172, v172
    v_exp_f32 v173, v173
    v_exp_f32 v174, v174
    v_mfma_f32_16x16x32_bf16 v[220:223], a[172:175], v[160:163], v[220:223]
    ds_read_b64_tr_b16 a[182:183], v27 offset:2176
    v_exp_f32_e64 v175, v175
    v_cvt_pk_bf16_f32 v96, v96, v97
    v_cvt_pk_bf16_f32 v97, v98, v99
    v_mov_b32 v98, 0
    v_mov_b32 v99, 0
    v_cvt_pk_bf16_f32 v168, v168, v169
    v_cvt_pk_bf16_f32 v169, v170, v171
    v_cvt_pk_bf16_f32 v170, v172, v173
    v_cvt_pk_bf16_f32 v171, v174, v175
    s_nop 1
    s_waitcnt lgkmcnt(0)
    v_mfma_f32_16x16x32_bf16 v[208:211], a[176:179], v[96:99], v[208:211]
    v_mfma_f32_16x16x32_bf16 v[216:219], a[176:179], v[168:171], v[216:219]
    v_mfma_f32_16x16x32_bf16 v[212:215], a[180:183], v[96:99], v[212:215]
    v_mfma_f32_16x16x32_bf16 v[220:223], a[180:183], v[168:171], v[220:223]
    ds_read_b64 a[184:185], v25 offset:0
    ds_read_b64 a[186:187], v25 offset:3136
    ds_read_b64 a[188:189], v25 offset:128
    ds_read_b64 a[190:191], v25 offset:3264
    ds_read_b64 a[192:193], v25 offset:256
    ds_read_b64 a[194:195], v25 offset:3392
    ds_read_b64 a[196:197], v25 offset:384
    ds_read_b64 a[198:199], v25 offset:3520
    ds_read_b64 a[168:169], v25 offset:512
    ds_read_b64 a[170:171], v25 offset:3648
    ds_read_b64 a[172:173], v25 offset:640
    ds_read_b64 a[174:175], v25 offset:3776
    s_waitcnt lgkmcnt(10)
    v_mfma_f32_16x16x32_bf16 v[32:35], a[184:187], v[8:11], v[16:19]
    ds_read_b64 a[176:177], v25 offset:768
    ds_read_b64 a[178:179], v25 offset:3904
    s_nop 1
    s_waitcnt lgkmcnt(10)
    v_mfma_f32_16x16x32_bf16 v[36:39], a[188:191], v[8:11], 0
    ds_read_b64 a[180:181], v25 offset:896
    v_mfma_f32_16x16x32_bf16 v[108:111], a[188:191], v[12:15], v[16:19]
    ds_read_b64 a[182:183], v25 offset:4032
    s_nop 1
    s_waitcnt lgkmcnt(10)
    v_mfma_f32_16x16x32_bf16 v[40:43], a[192:195], v[8:11], 0
    ds_read_b64 a[184:185], v25 offset:1024
    v_mfma_f32_16x16x32_bf16 v[112:115], a[192:195], v[12:15], 0
    ds_read_b64 a[186:187], v25 offset:4160
    s_nop 1
    s_waitcnt lgkmcnt(10)
    v_mfma_f32_16x16x32_bf16 v[44:47], a[196:199], v[8:11], 0
    ds_read_b64 a[188:189], v25 offset:1152
    v_mfma_f32_16x16x32_bf16 v[116:119], a[196:199], v[12:15], 0
    ds_read_b64 a[190:191], v25 offset:4288
    s_nop 1
    v_max_f32 v176, v32, v33
    v_max_f32_e64 v177, v34, v35
    s_waitcnt lgkmcnt(10)
    v_mfma_f32_16x16x32_bf16 v[48:51], a[168:171], v[8:11], 0
    ds_read_b64 a[192:193], v25 offset:1280
    v_mfma_f32_16x16x32_bf16 v[120:123], a[168:171], v[12:15], 0
    ds_read_b64 a[194:195], v25 offset:4416
    s_nop 1
    v_max3_f32 v176, v36, v37, v176
    v_max3_f32 v177, v38, v39, v177
    v_max_f32 v178, v108, v109
    v_max_f32 v179, v110, v111
    s_waitcnt lgkmcnt(10)
    v_mfma_f32_16x16x32_bf16 v[52:55], a[172:175], v[8:11], 0
    ds_read_b64 a[196:197], v25 offset:1408
    v_mfma_f32_16x16x32_bf16 v[124:127], a[172:175], v[12:15], 0
    ds_read_b64 a[198:199], v25 offset:4544
    s_nop 1
    v_max3_f32 v176, v40, v41, v176
    v_max3_f32 v177, v42, v43, v177
    v_max3_f32 v178, v112, v113, v178
    v_max3_f32 v179, v114, v115, v179
    s_waitcnt lgkmcnt(10)
    v_mfma_f32_16x16x32_bf16 v[56:59], a[176:179], v[8:11], 0
    ds_read_b64 a[168:169], v25 offset:1536
    v_mfma_f32_16x16x32_bf16 v[128:131], a[176:179], v[12:15], 0
    ds_read_b64 a[170:171], v25 offset:4672
    s_nop 1
    v_max3_f32 v176, v44, v45, v176
    v_max3_f32 v177, v46, v47, v177
    v_max3_f32 v178, v116, v117, v178
    v_max3_f32 v179, v118, v119, v179
    s_waitcnt lgkmcnt(10)
    v_mfma_f32_16x16x32_bf16 v[60:63], a[180:183], v[8:11], 0
    ds_read_b64 a[172:173], v25 offset:1664
    v_mfma_f32_16x16x32_bf16 v[132:135], a[180:183], v[12:15], 0
    ds_read_b64 a[174:175], v25 offset:4800
    s_nop 1
    v_max3_f32 v176, v48, v49, v176
    v_max3_f32 v177, v50, v51, v177
    v_max3_f32 v178, v120, v121, v178
    v_max3_f32 v179, v122, v123, v179
    s_waitcnt lgkmcnt(10)
    v_mfma_f32_16x16x32_bf16 v[64:67], a[184:187], v[8:11], 0
    ds_read_b64 a[176:177], v25 offset:1792
    v_mfma_f32_16x16x32_bf16 v[136:139], a[184:187], v[12:15], 0
    ds_read_b64 a[178:179], v25 offset:4928
    s_nop 1
    v_max3_f32 v176, v52, v53, v176
    v_max3_f32 v177, v54, v55, v177
    v_max3_f32 v178, v124, v125, v178
    v_max3_f32 v179, v126, v127, v179
    s_waitcnt lgkmcnt(10)
    v_mfma_f32_16x16x32_bf16 v[68:71], a[188:191], v[8:11], 0
    ds_read_b64 a[180:181], v25 offset:1920
    v_mfma_f32_16x16x32_bf16 v[140:143], a[188:191], v[12:15], 0
    ds_read_b64 a[182:183], v25 offset:5056
    s_nop 1
    v_max3_f32 v176, v56, v57, v176
    v_max3_f32 v177, v58, v59, v177
    v_max3_f32 v178, v128, v129, v178
    v_max3_f32 v179, v130, v131, v179
    s_waitcnt lgkmcnt(10)
    v_mfma_f32_16x16x32_bf16 v[72:75], a[192:195], v[8:11], 0
    ds_read_b64 a[184:185], v25 offset:2048
    v_mfma_f32_16x16x32_bf16 v[144:147], a[192:195], v[12:15], 0
    ds_read_b64 a[186:187], v25 offset:5184
    s_nop 1
    v_max3_f32 v176, v60, v61, v176
    v_max3_f32 v177, v62, v63, v177
    v_max3_f32 v178, v132, v133, v178
    v_max3_f32 v179, v134, v135, v179
    s_waitcnt lgkmcnt(10)
    v_mfma_f32_16x16x32_bf16 v[76:79], a[196:199], v[8:11], 0
    ds_read_b64 a[188:189], v25 offset:2176
    v_mfma_f32_16x16x32_bf16 v[148:151], a[196:199], v[12:15], 0
    ds_read_b64 a[190:191], v25 offset:5312
    s_nop 1
    v_max3_f32 v176, v64, v65, v176
    v_max3_f32 v177, v66, v67, v177
    v_max3_f32 v178, v136, v137, v178
    v_max3_f32 v179, v138, v139, v179
    s_waitcnt lgkmcnt(10)
    v_mfma_f32_16x16x32_bf16 v[80:83], a[168:171], v[8:11], 0
    v_mfma_f32_16x16x32_bf16 v[152:155], a[168:171], v[12:15], 0
    s_nop 1
    v_max3_f32 v176, v68, v69, v176
    v_max3_f32 v177, v70, v71, v177
    v_max3_f32 v178, v140, v141, v178
    v_max3_f32 v179, v142, v143, v179
    s_waitcnt lgkmcnt(8)
    v_mfma_f32_16x16x32_bf16 v[84:87], a[172:175], v[8:11], 0
    v_mfma_f32_16x16x32_bf16 v[156:159], a[172:175], v[12:15], 0
    s_nop 1
    v_max3_f32 v176, v72, v73, v176
    v_max3_f32 v177, v74, v75, v177
    v_max3_f32 v178, v144, v145, v178
    v_max3_f32 v179, v146, v147, v179
    s_waitcnt lgkmcnt(6)
    v_mfma_f32_16x16x32_bf16 v[88:91], a[176:179], v[8:11], 0
    v_mfma_f32_16x16x32_bf16 v[160:163], a[176:179], v[12:15], 0
    s_nop 1
    v_max3_f32 v176, v76, v77, v176
    v_max3_f32 v177, v78, v79, v177
    v_max3_f32 v178, v148, v149, v178
    v_max3_f32 v179, v150, v151, v179
    s_waitcnt lgkmcnt(4)
    v_mfma_f32_16x16x32_bf16 v[92:95], a[180:183], v[8:11], 0
    v_mfma_f32_16x16x32_bf16 v[164:167], a[180:183], v[12:15], 0
    s_nop 1
    v_max3_f32 v176, v80, v81, v176
    v_max3_f32 v177, v82, v83, v177
    v_max3_f32 v178, v152, v153, v178
    v_max3_f32 v179, v154, v155, v179
    s_waitcnt lgkmcnt(2)
    v_mfma_f32_16x16x32_bf16 v[96:99], a[184:187], v[8:11], v[20:23]
    v_mfma_f32_16x16x32_bf16 v[168:171], a[184:187], v[12:15], 0
    s_nop 1
    v_max3_f32 v176, v84, v85, v176
    v_max3_f32 v177, v86, v87, v177
    v_max3_f32 v178, v156, v157, v178
    v_max3_f32 v179, v158, v159, v179
    s_waitcnt lgkmcnt(0)
    v_mfma_f32_16x16x32_bf16 v[172:175], a[188:191], v[12:15], v[20:23]
    s_nop 1
    v_max3_f32 v176, v88, v89, v176
    v_max3_f32 v177, v90, v91, v177
    v_max3_f32 v178, v160, v161, v178
    v_max3_f32 v179, v162, v163, v179
    s_nop 7
    v_max3_f32 v176, v92, v93, v176
    v_max3_f32 v177, v94, v95, v177
    v_max3_f32 v178, v164, v165, v178
    v_max3_f32 v179, v166, v167, v179
    v_max3_f32 v176, v96, v97, v176
    v_max3_f32 v177, v98, v99, v177
    v_max3_f32 v178, v168, v169, v178
    v_max3_f32 v179, v170, v171, v179
    v_max3_f32 v178, v172, v173, v178
    v_max3_f32 v179, v174, v175, v179
    v_max_f32 v176, v176, v177
    v_max_f32 v178, v178, v179
    v_mov_b32 v177, v176
    v_mov_b32 v179, v178
    s_nop 1
    v_permlane32_swap_b32 v176, v177
    v_permlane32_swap_b32 v178, v179
    s_nop 0
    v_max_f32 v176, v176, v177
    v_max_f32 v178, v178, v179
    v_mov_b32 v177, v176
    v_mov_b32 v179, v178
    s_nop 1
    v_permlane16_swap_b32 v176, v177
    v_permlane16_swap_b32 v178, v179
    s_nop 0
    v_max_f32 v176, v176, v177
    v_max_f32 v178, v178, v179
    v_mul_f32 v181, -1.0, v176
    v_mul_f32 v183, -1.0, v178
    v_pk_fma_f32 v[32:33], v[32:33], v[180:181], v[180:181] op_sel:[0,0,1] op_sel_hi:[1,0,1]
    v_pk_fma_f32 v[34:35], v[34:35], v[180:181], v[180:181] op_sel:[0,0,1] op_sel_hi:[1,0,1]
    v_pk_fma_f32 v[36:37], v[36:37], v[180:181], v[180:181] op_sel:[0,0,1] op_sel_hi:[1,0,1]
    v_pk_fma_f32 v[38:39], v[38:39], v[180:181], v[180:181] op_sel:[0,0,1] op_sel_hi:[1,0,1]
    v_pk_fma_f32 v[108:109], v[108:109], v[182:183], v[182:183] op_sel:[0,0,1] op_sel_hi:[1,0,1]
    v_pk_fma_f32 v[110:111], v[110:111], v[182:183], v[182:183] op_sel:[0,0,1] op_sel_hi:[1,0,1]
    ds_read_b64_tr_b16 a[192:193], v26 offset:18816
    ds_read_b64_tr_b16 a[194:195], v26 offset:18944
    ds_read_b64_tr_b16 a[196:197], v27 offset:0
    ds_read_b64_tr_b16 a[198:199], v27 offset:128
    v_exp_f32 v32, v32
    v_exp_f32 v33, v33
    v_exp_f32 v34, v34
    v_exp_f32 v35, v35
    v_exp_f32 v36, v36
    v_exp_f32 v37, v37
    v_exp_f32 v38, v38
    v_exp_f32 v39, v39
    v_exp_f32 v108, v108
    v_exp_f32 v109, v109
    v_exp_f32 v110, v110
    v_exp_f32 v111, v111
    v_cvt_pk_bf16_f32 v32, v32, v33
    v_cvt_pk_bf16_f32 v33, v34, v35
    v_cvt_pk_bf16_f32 v34, v36, v37
    v_cvt_pk_bf16_f32 v35, v38, v39
    v_mov_b32 v104, 0
    v_mov_b32 v105, 0
    v_cvt_pk_bf16_f32 v106, v108, v109
    v_cvt_pk_bf16_f32 v107, v110, v111
    v_pk_fma_f32 v[40:41], v[40:41], v[180:181], v[180:181] op_sel:[0,0,1] op_sel_hi:[1,0,1]
    v_pk_fma_f32 v[42:43], v[42:43], v[180:181], v[180:181] op_sel:[0,0,1] op_sel_hi:[1,0,1]
    v_pk_fma_f32 v[44:45], v[44:45], v[180:181], v[180:181] op_sel:[0,0,1] op_sel_hi:[1,0,1]
    v_pk_fma_f32 v[46:47], v[46:47], v[180:181], v[180:181] op_sel:[0,0,1] op_sel_hi:[1,0,1]
    v_pk_fma_f32 v[112:113], v[112:113], v[182:183], v[182:183] op_sel:[0,0,1] op_sel_hi:[1,0,1]
    v_pk_fma_f32 v[114:115], v[114:115], v[182:183], v[182:183] op_sel:[0,0,1] op_sel_hi:[1,0,1]
    v_pk_fma_f32 v[116:117], v[116:117], v[182:183], v[182:183] op_sel:[0,0,1] op_sel_hi:[1,0,1]
    v_pk_fma_f32 v[118:119], v[118:119], v[182:183], v[182:183] op_sel:[0,0,1] op_sel_hi:[1,0,1]
    s_waitcnt lgkmcnt(0)
    v_mfma_f32_16x16x32_bf16 v[224:227], a[192:195], v[32:35], 0
    ds_read_b64_tr_b16 a[168:169], v26 offset:19072
    v_exp_f32 v40, v40
    v_exp_f32 v41, v41
    v_exp_f32 v42, v42
    v_exp_f32_e64 v43, v43
    v_mfma_f32_16x16x32_bf16 v[232:235], a[192:195], v[104:107], 0
    ds_read_b64_tr_b16 a[170:171], v26 offset:19200
    v_exp_f32 v44, v44
    v_exp_f32 v45, v45
    v_exp_f32 v46, v46
    v_exp_f32 v47, v47
    v_exp_f32_e64 v112, v112
    v_mfma_f32_16x16x32_bf16 v[228:231], a[196:199], v[32:35], 0
    ds_read_b64_tr_b16 a[172:173], v27 offset:256
    v_exp_f32 v113, v113
    v_exp_f32 v114, v114
    v_exp_f32 v115, v115
    v_exp_f32 v116, v116
    v_exp_f32_e64 v117, v117
    v_mfma_f32_16x16x32_bf16 v[236:239], a[196:199], v[104:107], 0
    ds_read_b64_tr_b16 a[174:175], v27 offset:384
    v_exp_f32 v118, v118
    v_exp_f32 v119, v119
    v_cvt_pk_bf16_f32 v40, v40, v41
    v_cvt_pk_bf16_f32 v41, v42, v43
    v_cvt_pk_bf16_f32 v42, v44, v45
    v_cvt_pk_bf16_f32 v43, v46, v47
    v_cvt_pk_bf16_f32 v112, v112, v113
    v_cvt_pk_bf16_f32 v113, v114, v115
    v_cvt_pk_bf16_f32 v114, v116, v117
    v_cvt_pk_bf16_f32 v115, v118, v119
    v_pk_fma_f32 v[48:49], v[48:49], v[180:181], v[180:181] op_sel:[0,0,1] op_sel_hi:[1,0,1]
    v_pk_fma_f32 v[50:51], v[50:51], v[180:181], v[180:181] op_sel:[0,0,1] op_sel_hi:[1,0,1]
    v_pk_fma_f32 v[52:53], v[52:53], v[180:181], v[180:181] op_sel:[0,0,1] op_sel_hi:[1,0,1]
    v_pk_fma_f32 v[54:55], v[54:55], v[180:181], v[180:181] op_sel:[0,0,1] op_sel_hi:[1,0,1]
    v_pk_fma_f32 v[120:121], v[120:121], v[182:183], v[182:183] op_sel:[0,0,1] op_sel_hi:[1,0,1]
    v_pk_fma_f32 v[122:123], v[122:123], v[182:183], v[182:183] op_sel:[0,0,1] op_sel_hi:[1,0,1]
    v_pk_fma_f32 v[124:125], v[124:125], v[182:183], v[182:183] op_sel:[0,0,1] op_sel_hi:[1,0,1]
    v_pk_fma_f32 v[126:127], v[126:127], v[182:183], v[182:183] op_sel:[0,0,1] op_sel_hi:[1,0,1]
    s_waitcnt lgkmcnt(0)
    v_mfma_f32_16x16x32_bf16 v[224:227], a[168:171], v[40:43], v[224:227]
    ds_read_b64_tr_b16 a[176:177], v26 offset:19328
    v_exp_f32 v48, v48
    v_exp_f32 v49, v49
    v_exp_f32 v50, v50
    v_exp_f32_e64 v51, v51
    v_mfma_f32_16x16x32_bf16 v[232:235], a[168:171], v[112:115], v[232:235]
    ds_read_b64_tr_b16 a[178:179], v26 offset:19456
    v_exp_f32 v52, v52
    v_exp_f32 v53, v53
    v_exp_f32 v54, v54
    v_exp_f32 v55, v55
    v_exp_f32_e64 v120, v120
    v_mfma_f32_16x16x32_bf16 v[228:231], a[172:175], v[40:43], v[228:231]
    ds_read_b64_tr_b16 a[180:181], v27 offset:512
    v_exp_f32 v121, v121
    v_exp_f32 v122, v122
    v_exp_f32 v123, v123
    v_exp_f32 v124, v124
    v_exp_f32_e64 v125, v125
    v_mfma_f32_16x16x32_bf16 v[236:239], a[172:175], v[112:115], v[236:239]
    ds_read_b64_tr_b16 a[182:183], v27 offset:640
    v_exp_f32 v126, v126
    v_exp_f32 v127, v127
    v_cvt_pk_bf16_f32 v48, v48, v49
    v_cvt_pk_bf16_f32 v49, v50, v51
    v_cvt_pk_bf16_f32 v50, v52, v53
    v_cvt_pk_bf16_f32 v51, v54, v55
    v_cvt_pk_bf16_f32 v120, v120, v121
    v_cvt_pk_bf16_f32 v121, v122, v123
    v_cvt_pk_bf16_f32 v122, v124, v125
    v_cvt_pk_bf16_f32 v123, v126, v127
    v_pk_fma_f32 v[56:57], v[56:57], v[180:181], v[180:181] op_sel:[0,0,1] op_sel_hi:[1,0,1]
    v_pk_fma_f32 v[58:59], v[58:59], v[180:181], v[180:181] op_sel:[0,0,1] op_sel_hi:[1,0,1]
    v_pk_fma_f32 v[60:61], v[60:61], v[180:181], v[180:181] op_sel:[0,0,1] op_sel_hi:[1,0,1]
    v_pk_fma_f32 v[62:63], v[62:63], v[180:181], v[180:181] op_sel:[0,0,1] op_sel_hi:[1,0,1]
    v_pk_fma_f32 v[128:129], v[128:129], v[182:183], v[182:183] op_sel:[0,0,1] op_sel_hi:[1,0,1]
    v_pk_fma_f32 v[130:131], v[130:131], v[182:183], v[182:183] op_sel:[0,0,1] op_sel_hi:[1,0,1]
    v_pk_fma_f32 v[132:133], v[132:133], v[182:183], v[182:183] op_sel:[0,0,1] op_sel_hi:[1,0,1]
    v_pk_fma_f32 v[134:135], v[134:135], v[182:183], v[182:183] op_sel:[0,0,1] op_sel_hi:[1,0,1]
    s_waitcnt lgkmcnt(0)
    v_mfma_f32_16x16x32_bf16 v[224:227], a[176:179], v[48:51], v[224:227]
    ds_read_b64_tr_b16 a[184:185], v26 offset:19584
    v_exp_f32 v56, v56
    v_exp_f32 v57, v57
    v_exp_f32 v58, v58
    v_exp_f32_e64 v59, v59
    v_mfma_f32_16x16x32_bf16 v[232:235], a[176:179], v[120:123], v[232:235]
    ds_read_b64_tr_b16 a[186:187], v26 offset:19712
    v_exp_f32 v60, v60
    v_exp_f32 v61, v61
    v_exp_f32 v62, v62
    v_exp_f32 v63, v63
    v_exp_f32_e64 v128, v128
    v_mfma_f32_16x16x32_bf16 v[228:231], a[180:183], v[48:51], v[228:231]
    ds_read_b64_tr_b16 a[188:189], v27 offset:768
    v_exp_f32 v129, v129
    v_exp_f32 v130, v130
    v_exp_f32 v131, v131
    v_exp_f32 v132, v132
    v_exp_f32_e64 v133, v133
    v_mfma_f32_16x16x32_bf16 v[236:239], a[180:183], v[120:123], v[236:239]
    ds_read_b64_tr_b16 a[190:191], v27 offset:896
    v_exp_f32 v134, v134
    v_exp_f32 v135, v135
    v_cvt_pk_bf16_f32 v56, v56, v57
    v_cvt_pk_bf16_f32 v57, v58, v59
    v_cvt_pk_bf16_f32 v58, v60, v61
    v_cvt_pk_bf16_f32 v59, v62, v63
    v_cvt_pk_bf16_f32 v128, v128, v129
    v_cvt_pk_bf16_f32 v129, v130, v131
    v_cvt_pk_bf16_f32 v130, v132, v133
    v_cvt_pk_bf16_f32 v131, v134, v135
    v_pk_fma_f32 v[64:65], v[64:65], v[180:181], v[180:181] op_sel:[0,0,1] op_sel_hi:[1,0,1]
    v_pk_fma_f32 v[66:67], v[66:67], v[180:181], v[180:181] op_sel:[0,0,1] op_sel_hi:[1,0,1]
    v_pk_fma_f32 v[68:69], v[68:69], v[180:181], v[180:181] op_sel:[0,0,1] op_sel_hi:[1,0,1]
    v_pk_fma_f32 v[70:71], v[70:71], v[180:181], v[180:181] op_sel:[0,0,1] op_sel_hi:[1,0,1]
    v_pk_fma_f32 v[136:137], v[136:137], v[182:183], v[182:183] op_sel:[0,0,1] op_sel_hi:[1,0,1]
    v_pk_fma_f32 v[138:139], v[138:139], v[182:183], v[182:183] op_sel:[0,0,1] op_sel_hi:[1,0,1]
    v_pk_fma_f32 v[140:141], v[140:141], v[182:183], v[182:183] op_sel:[0,0,1] op_sel_hi:[1,0,1]
    v_pk_fma_f32 v[142:143], v[142:143], v[182:183], v[182:183] op_sel:[0,0,1] op_sel_hi:[1,0,1]
    s_waitcnt lgkmcnt(0)
    v_mfma_f32_16x16x32_bf16 v[224:227], a[184:187], v[56:59], v[224:227]
    ds_read_b64_tr_b16 a[192:193], v26 offset:19840
    v_exp_f32 v64, v64
    v_exp_f32 v65, v65
    v_exp_f32 v66, v66
    v_exp_f32_e64 v67, v67
    v_mfma_f32_16x16x32_bf16 v[232:235], a[184:187], v[128:131], v[232:235]
    ds_read_b64_tr_b16 a[194:195], v26 offset:19968
    v_exp_f32 v68, v68
    v_exp_f32 v69, v69
    v_exp_f32 v70, v70
    v_exp_f32 v71, v71
    v_exp_f32_e64 v136, v136
    v_mfma_f32_16x16x32_bf16 v[228:231], a[188:191], v[56:59], v[228:231]
    ds_read_b64_tr_b16 a[196:197], v27 offset:1024
    v_exp_f32 v137, v137
    v_exp_f32 v138, v138
    v_exp_f32 v139, v139
    v_exp_f32 v140, v140
    v_exp_f32_e64 v141, v141
    v_mfma_f32_16x16x32_bf16 v[236:239], a[188:191], v[128:131], v[236:239]
    ds_read_b64_tr_b16 a[198:199], v27 offset:1152
    v_exp_f32 v142, v142
    v_exp_f32 v143, v143
    v_cvt_pk_bf16_f32 v64, v64, v65
    v_cvt_pk_bf16_f32 v65, v66, v67
    v_cvt_pk_bf16_f32 v66, v68, v69
    v_cvt_pk_bf16_f32 v67, v70, v71
    v_cvt_pk_bf16_f32 v136, v136, v137
    v_cvt_pk_bf16_f32 v137, v138, v139
    v_cvt_pk_bf16_f32 v138, v140, v141
    v_cvt_pk_bf16_f32 v139, v142, v143
    v_pk_fma_f32 v[72:73], v[72:73], v[180:181], v[180:181] op_sel:[0,0,1] op_sel_hi:[1,0,1]
    v_pk_fma_f32 v[74:75], v[74:75], v[180:181], v[180:181] op_sel:[0,0,1] op_sel_hi:[1,0,1]
    v_pk_fma_f32 v[76:77], v[76:77], v[180:181], v[180:181] op_sel:[0,0,1] op_sel_hi:[1,0,1]
    v_pk_fma_f32 v[78:79], v[78:79], v[180:181], v[180:181] op_sel:[0,0,1] op_sel_hi:[1,0,1]
    v_pk_fma_f32 v[144:145], v[144:145], v[182:183], v[182:183] op_sel:[0,0,1] op_sel_hi:[1,0,1]
    v_pk_fma_f32 v[146:147], v[146:147], v[182:183], v[182:183] op_sel:[0,0,1] op_sel_hi:[1,0,1]
    v_pk_fma_f32 v[148:149], v[148:149], v[182:183], v[182:183] op_sel:[0,0,1] op_sel_hi:[1,0,1]
    v_pk_fma_f32 v[150:151], v[150:151], v[182:183], v[182:183] op_sel:[0,0,1] op_sel_hi:[1,0,1]
    s_waitcnt lgkmcnt(0)
    v_mfma_f32_16x16x32_bf16 v[224:227], a[192:195], v[64:67], v[224:227]
    ds_read_b64_tr_b16 a[168:169], v26 offset:20096
    v_exp_f32 v72, v72
    v_exp_f32 v73, v73
    v_exp_f32 v74, v74
    v_exp_f32_e64 v75, v75
    v_mfma_f32_16x16x32_bf16 v[232:235], a[192:195], v[136:139], v[232:235]
    ds_read_b64_tr_b16 a[170:171], v26 offset:20224
    v_exp_f32 v76, v76
    v_exp_f32 v77, v77
    v_exp_f32 v78, v78
    v_exp_f32 v79, v79
    v_exp_f32_e64 v144, v144
    v_mfma_f32_16x16x32_bf16 v[228:231], a[196:199], v[64:67], v[228:231]
    ds_read_b64_tr_b16 a[172:173], v27 offset:1280
    v_exp_f32 v145, v145
    v_exp_f32 v146, v146
    v_exp_f32 v147, v147
    v_exp_f32 v148, v148
    v_exp_f32_e64 v149, v149
    v_mfma_f32_16x16x32_bf16 v[236:239], a[196:199], v[136:139], v[236:239]
    ds_read_b64_tr_b16 a[174:175], v27 offset:1408
    v_exp_f32 v150, v150
    v_exp_f32 v151, v151
    v_cvt_pk_bf16_f32 v72, v72, v73
    v_cvt_pk_bf16_f32 v73, v74, v75
    v_cvt_pk_bf16_f32 v74, v76, v77
    v_cvt_pk_bf16_f32 v75, v78, v79
    v_cvt_pk_bf16_f32 v144, v144, v145
    v_cvt_pk_bf16_f32 v145, v146, v147
    v_cvt_pk_bf16_f32 v146, v148, v149
    v_cvt_pk_bf16_f32 v147, v150, v151
    v_pk_fma_f32 v[80:81], v[80:81], v[180:181], v[180:181] op_sel:[0,0,1] op_sel_hi:[1,0,1]
    v_pk_fma_f32 v[82:83], v[82:83], v[180:181], v[180:181] op_sel:[0,0,1] op_sel_hi:[1,0,1]
    v_pk_fma_f32 v[84:85], v[84:85], v[180:181], v[180:181] op_sel:[0,0,1] op_sel_hi:[1,0,1]
    v_pk_fma_f32 v[86:87], v[86:87], v[180:181], v[180:181] op_sel:[0,0,1] op_sel_hi:[1,0,1]
    v_pk_fma_f32 v[152:153], v[152:153], v[182:183], v[182:183] op_sel:[0,0,1] op_sel_hi:[1,0,1]
    v_pk_fma_f32 v[154:155], v[154:155], v[182:183], v[182:183] op_sel:[0,0,1] op_sel_hi:[1,0,1]
    v_pk_fma_f32 v[156:157], v[156:157], v[182:183], v[182:183] op_sel:[0,0,1] op_sel_hi:[1,0,1]
    v_pk_fma_f32 v[158:159], v[158:159], v[182:183], v[182:183] op_sel:[0,0,1] op_sel_hi:[1,0,1]
    s_waitcnt lgkmcnt(0)
    v_mfma_f32_16x16x32_bf16 v[224:227], a[168:171], v[72:75], v[224:227]
    ds_read_b64_tr_b16 a[176:177], v26 offset:20352
    v_exp_f32 v80, v80
    v_exp_f32 v81, v81
    v_exp_f32 v82, v82
    v_exp_f32_e64 v83, v83
    v_mfma_f32_16x16x32_bf16 v[232:235], a[168:171], v[144:147], v[232:235]
    ds_read_b64_tr_b16 a[178:179], v26 offset:20480
    v_exp_f32 v84, v84
    v_exp_f32 v85, v85
    v_exp_f32 v86, v86
    v_exp_f32 v87, v87
    v_exp_f32_e64 v152, v152
    v_mfma_f32_16x16x32_bf16 v[228:231], a[172:175], v[72:75], v[228:231]
    ds_read_b64_tr_b16 a[180:181], v27 offset:1536
    v_exp_f32 v153, v153
    v_exp_f32 v154, v154
    v_exp_f32 v155, v155
    v_exp_f32 v156, v156
    v_exp_f32_e64 v157, v157
    v_mfma_f32_16x16x32_bf16 v[236:239], a[172:175], v[144:147], v[236:239]
    ds_read_b64_tr_b16 a[182:183], v27 offset:1664
    v_exp_f32 v158, v158
    v_exp_f32 v159, v159
    v_cvt_pk_bf16_f32 v80, v80, v81
    v_cvt_pk_bf16_f32 v81, v82, v83
    v_cvt_pk_bf16_f32 v82, v84, v85
    v_cvt_pk_bf16_f32 v83, v86, v87
    v_cvt_pk_bf16_f32 v152, v152, v153
    v_cvt_pk_bf16_f32 v153, v154, v155
    v_cvt_pk_bf16_f32 v154, v156, v157
    v_cvt_pk_bf16_f32 v155, v158, v159
    v_pk_fma_f32 v[88:89], v[88:89], v[180:181], v[180:181] op_sel:[0,0,1] op_sel_hi:[1,0,1]
    v_pk_fma_f32 v[90:91], v[90:91], v[180:181], v[180:181] op_sel:[0,0,1] op_sel_hi:[1,0,1]
    v_pk_fma_f32 v[92:93], v[92:93], v[180:181], v[180:181] op_sel:[0,0,1] op_sel_hi:[1,0,1]
    v_pk_fma_f32 v[94:95], v[94:95], v[180:181], v[180:181] op_sel:[0,0,1] op_sel_hi:[1,0,1]
    v_pk_fma_f32 v[160:161], v[160:161], v[182:183], v[182:183] op_sel:[0,0,1] op_sel_hi:[1,0,1]
    v_pk_fma_f32 v[162:163], v[162:163], v[182:183], v[182:183] op_sel:[0,0,1] op_sel_hi:[1,0,1]
    v_pk_fma_f32 v[164:165], v[164:165], v[182:183], v[182:183] op_sel:[0,0,1] op_sel_hi:[1,0,1]
    v_pk_fma_f32 v[166:167], v[166:167], v[182:183], v[182:183] op_sel:[0,0,1] op_sel_hi:[1,0,1]
    s_waitcnt lgkmcnt(0)
    v_mfma_f32_16x16x32_bf16 v[224:227], a[176:179], v[80:83], v[224:227]
    ds_read_b64_tr_b16 a[184:185], v26 offset:20608
    v_exp_f32 v88, v88
    v_exp_f32 v89, v89
    v_exp_f32 v90, v90
    v_exp_f32_e64 v91, v91
    v_mfma_f32_16x16x32_bf16 v[232:235], a[176:179], v[152:155], v[232:235]
    ds_read_b64_tr_b16 a[186:187], v26 offset:20736
    v_exp_f32 v92, v92
    v_exp_f32 v93, v93
    v_exp_f32 v94, v94
    v_exp_f32 v95, v95
    v_exp_f32_e64 v160, v160
    v_mfma_f32_16x16x32_bf16 v[228:231], a[180:183], v[80:83], v[228:231]
    ds_read_b64_tr_b16 a[188:189], v27 offset:1792
    v_exp_f32 v161, v161
    v_exp_f32 v162, v162
    v_exp_f32 v163, v163
    v_exp_f32 v164, v164
    v_exp_f32_e64 v165, v165
    v_mfma_f32_16x16x32_bf16 v[236:239], a[180:183], v[152:155], v[236:239]
    ds_read_b64_tr_b16 a[190:191], v27 offset:1920
    v_exp_f32 v166, v166
    v_exp_f32 v167, v167
    v_cvt_pk_bf16_f32 v88, v88, v89
    v_cvt_pk_bf16_f32 v89, v90, v91
    v_cvt_pk_bf16_f32 v90, v92, v93
    v_cvt_pk_bf16_f32 v91, v94, v95
    v_cvt_pk_bf16_f32 v160, v160, v161
    v_cvt_pk_bf16_f32 v161, v162, v163
    v_cvt_pk_bf16_f32 v162, v164, v165
    v_cvt_pk_bf16_f32 v163, v166, v167
    v_pk_fma_f32 v[96:97], v[96:97], v[180:181], v[180:181] op_sel:[0,0,1] op_sel_hi:[1,0,1]
    v_pk_fma_f32 v[98:99], v[98:99], v[180:181], v[180:181] op_sel:[0,0,1] op_sel_hi:[1,0,1]
    v_pk_fma_f32 v[168:169], v[168:169], v[182:183], v[182:183] op_sel:[0,0,1] op_sel_hi:[1,0,1]
    v_pk_fma_f32 v[170:171], v[170:171], v[182:183], v[182:183] op_sel:[0,0,1] op_sel_hi:[1,0,1]
    v_pk_fma_f32 v[172:173], v[172:173], v[182:183], v[182:183] op_sel:[0,0,1] op_sel_hi:[1,0,1]
    v_pk_fma_f32 v[174:175], v[174:175], v[182:183], v[182:183] op_sel:[0,0,1] op_sel_hi:[1,0,1]
    s_waitcnt lgkmcnt(0)
    v_mfma_f32_16x16x32_bf16 v[224:227], a[184:187], v[88:91], v[224:227]
    ds_read_b64_tr_b16 a[192:193], v26 offset:20864
    v_exp_f32 v96, v96
    v_exp_f32 v97, v97
    v_exp_f32 v98, v98
    v_mfma_f32_16x16x32_bf16 v[232:235], a[184:187], v[160:163], v[232:235]
    ds_read_b64_tr_b16 a[194:195], v26 offset:20992
    v_exp_f32 v99, v99
    v_exp_f32 v168, v168
    v_exp_f32 v169, v169
    v_exp_f32 v170, v170
    v_mfma_f32_16x16x32_bf16 v[228:231], a[188:191], v[88:91], v[228:231]
    ds_read_b64_tr_b16 a[196:197], v27 offset:2048
    v_exp_f32 v171, v171
    v_exp_f32 v172, v172
    v_exp_f32 v173, v173
    v_exp_f32 v174, v174
    v_mfma_f32_16x16x32_bf16 v[236:239], a[188:191], v[160:163], v[236:239]
    ds_read_b64_tr_b16 a[198:199], v27 offset:2176
    v_exp_f32_e64 v175, v175
    v_cvt_pk_bf16_f32 v96, v96, v97
    v_cvt_pk_bf16_f32 v97, v98, v99
    v_mov_b32 v98, 0
    v_mov_b32 v99, 0
    v_cvt_pk_bf16_f32 v168, v168, v169
    v_cvt_pk_bf16_f32 v169, v170, v171
    v_cvt_pk_bf16_f32 v170, v172, v173
    v_cvt_pk_bf16_f32 v171, v174, v175
    s_nop 1
    s_waitcnt lgkmcnt(0)
    v_mfma_f32_16x16x32_bf16 v[224:227], a[192:195], v[96:99], v[224:227]
    v_mfma_f32_16x16x32_bf16 v[232:235], a[192:195], v[168:171], v[232:235]
    v_mfma_f32_16x16x32_bf16 v[228:231], a[196:199], v[96:99], v[228:231]
    v_mfma_f32_16x16x32_bf16 v[236:239], a[196:199], v[168:171], v[236:239]
    s_nop 7
    v_mov_b32 v84, v212
    v_mov_b32 v88, v212
    v_mov_b32 v85, v220
    v_mov_b32 v89, v220
    v_mov_b32 v86, v228
    v_mov_b32 v90, v228
    v_mov_b32 v87, v236
    v_mov_b32 v91, v236
    s_nop 1
    v_permlane16_swap_b32 v88, v84
    v_permlane16_swap_b32 v89, v85
    v_permlane16_swap_b32 v90, v86
    v_permlane16_swap_b32 v91, v87
    s_nop 0
    s_branch L_Tnorm
L_tagspin:
    s_cmp_eq_u32 s53, 0
    s_cbranch_scc1 L_tagok
    s_sub_u32 s53, s53, 1
    s_sleep 1
    buffer_load_dword v207, off, s[32:35], 0 sc1
    s_waitcnt vmcnt(0)
    s_branch L_tagchk
L_spin_kv:
    s_cmp_eq_u32 s53, 0
    s_cbranch_scc1 L_back_kv
    s_sub_u32 s53, s53, 1
    s_sleep 1
    buffer_load_dword v250, v249, s[20:23], 0 offen offset:0 sc1
    s_waitcnt vmcnt(0)
    v_cmp_ne_u32 vcc, s51, v250
    s_nop 0
    s_cmp_lg_u64 vcc, 0
    s_cbranch_scc1 L_spin_kv
    s_branch L_back_kv
L_spin_h1:
    s_cmp_eq_u32 s53, 0
    s_cbranch_scc1 L_back_h1
    s_sub_u32 s53, s53, 1
    s_sleep 1
    buffer_load_dword v250, v249, s[20:23], 0 offen offset:8 sc1
    s_waitcnt vmcnt(0)
    v_cmp_ne_u32 vcc, s51, v250
    s_nop 0
    s_cmp_lg_u64 vcc, 0
    s_cbranch_scc1 L_spin_h1
    s_branch L_back_h1
L_spin_hp:
    s_cmp_eq_u32 s53, 0
    s_cbranch_scc1 L_back_hp
    s_sub_u32 s53, s53, 1
    s_sleep 1
    buffer_load_dword v250, v249, s[20:23], 0 offen offset:0 sc1
    s_waitcnt vmcnt(0)
    v_cmp_ne_u32 vcc, s51, v250
    s_nop 0
    s_cmp_lg_u64 vcc, 0
    s_cbranch_scc1 L_spin_hp
    s_branch L_back_hp
L_spin_op:
    s_cmp_eq_u32 s53, 0
    s_cbranch_scc1 L_back_op
    s_sub_u32 s53, s53, 1
    s_sleep 1
    buffer_load_dword v81, v80, s[20:23], 0 offen offset:4 sc1
    s_waitcnt vmcnt(0)
    v_cmp_ne_u32 vcc, s51, v81
    s_nop 0
    s_cmp_lg_u64 vcc, 0
    s_cbranch_scc1 L_spin_op
    s_branch L_back_op
L_spin_mp:
    s_cmp_eq_u32 s53, 0
    s_cbranch_scc1 L_back_mp
    s_sub_u32 s53, s53, 1
    s_sleep 1
    buffer_load_dword v81, v80, s[20:23], s48 offen offset:0 sc1
    s_waitcnt vmcnt(0)
    v_cmp_ne_u32 vcc, s51, v81
    s_nop 0
    s_cmp_lg_u64 vcc, 0
    s_cbranch_scc1 L_spin_mp
    s_branch L_back_mp
L_spin_ep:
    s_cmp_eq_u32 s53, 0
    s_cbranch_scc1 L_back_ep
    s_sub_u32 s53, s53, 1
    s_sleep 1
    buffer_load_dword v81, v80, s[20:23], s48 offen offset:0 sc1
    s_waitcnt vmcnt(0)
    v_cmp_ne_u32 vcc, s51, v81
    s_nop 0
    s_cmp_lg_u64 vcc, 0
    s_cbranch_scc1 L_spin_ep
    s_branch L_back_ep
.section .rodata,"a"
.p2align 6
.amdhsa_kernel parallel_sum__sliding_block__glu_gated_bilinear__prompt_kernel
  .amdhsa_next_free_vgpr 512
  .amdhsa_next_free_sgpr 102
  .amdhsa_accum_offset 256
  .amdhsa_group_segment_fixed_size 0
  .amdhsa_kernarg_size 80
  .amdhsa_user_sgpr_count 2
  .amdhsa_user_sgpr_kernarg_segment_ptr 1
  .amdhsa_system_sgpr_workgroup_id_x 1
  .amdhsa_float_denorm_mode_32 3
.end_amdhsa_kernel
```
